```python
import torch

def _softmax(x, axis=-1):
    return torch.softmax(x, dim=axis)

def _gelu(x):
    return torch.nn.functional.gelu(x, approximate='tanh')

def _silu(x):
    return torch.nn.functional.silu(x)

def _sigmoid(x):
    return torch.sigmoid(x)

def _layernorm(x, axis=-1, eps=1e-05):
    m = x.mean(dim=axis, keepdim=True)
    v = x.var(dim=axis, keepdim=True, unbiased=False)
    return (x - m) / torch.sqrt(v + eps)

def _scatter_add(tgt, idx, src, axis=0):
    return tgt.clone().index_add_(axis, idx, src)

def _segment_sum(src, seg, n):
    out = torch.zeros((n,) + src.shape[1:], dtype=src.dtype)
    return out.index_add_(0, seg, src)

def _pad(x, pw):
    flat = tuple((v for pair in reversed(pw) for v in pair))
    return torch.nn.functional.pad(x, flat)
kernel_name = 'interleave_layers__memory_aug_recurrent_mem_tr__dense_activation_relu__prompt'

def setup_inputs():

    _w = lambda a: (lambda t: t.to(torch.bfloat16) if t.is_floating_point() else t)(torch.as_tensor(a))

    def _A_setup():
        B, S, Dm = (1, 2048, 640)
        H, Dh = (32, 192)
        M, seg = (8, 32)
        seg = min(seg, S)
        S = S // seg * seg
        return {'x': _w((lambda *s: torch.randn(*s, dtype=torch.bfloat16) * 0.05)(B, S, Dm)), 'mem0': _w((lambda *s: torch.randn(*s, dtype=torch.bfloat16) * 0.8)(B, M, Dm)), 'Wq': _w((lambda *s: torch.randn(*s, dtype=torch.bfloat16) * 0.8)(Dm, H, Dh) * Dm ** (-0.5)), 'Wk': _w((lambda *s: torch.randn(*s, dtype=torch.bfloat16) * 0.8)(Dm, H, Dh) * Dm ** (-0.5)), 'Wv': _w((lambda *s: torch.randn(*s, dtype=torch.bfloat16) * 0.8)(Dm, H, Dh) * Dm ** (-0.5)), 'Wo': _w((lambda *s: torch.randn(*s, dtype=torch.bfloat16) * 0.8)(H, Dh, Dm) * (H * Dh) ** (-0.5)), 'seg_len': seg}
    _A_in = _A_setup()

    def _B_setup():
        B, S, D, Dff = (1, 2048, 640, 1536)
        return {'x': _w((lambda *s: torch.randn(*s, dtype=torch.bfloat16) * 0.05)(B, S, D)), 'w1': _w((lambda *s: torch.randn(*s, dtype=torch.bfloat16) * 0.05)(D, Dff)), 'w2': _w((lambda *s: torch.randn(*s, dtype=torch.bfloat16) * 0.05)(Dff, D))}
    _B_in = _B_setup()
    return {'A_x': _A_in['x'], 'A_mem0': _A_in['mem0'], 'A_Wq': _A_in['Wq'], 'A_Wk': _A_in['Wk'], 'A_Wv': _A_in['Wv'], 'A_Wo': _A_in['Wo'], 'A_seg_len': _A_in['seg_len'], 'B_x': _B_in['x'], 'B_w1': _B_in['w1'], 'B_w2': _B_in['w2']}

def reference(A_x, A_mem0, A_Wq, A_Wk, A_Wv, A_Wo, A_seg_len, B_x, B_w1, B_w2):

    def _A_ref(x, mem0, Wq, Wk, Wv, Wo, seg_len):
        B, S, Dm = x.shape
        H, Dh = (Wq.shape[1], Wq.shape[2])
        M = mem0.shape[1]
        scale = Dh ** (-0.5)
        n_seg = S // seg_len
        L = M + seg_len
        idx = torch.arange(L)
        mask = (idx[:, None] < M) | (idx[:, None] >= idx[None, :])
        mem = mem0
        outs = []
        for s in range(n_seg):
            xs = x[:, s * seg_len:(s + 1) * seg_len, :].clone()
            h = torch.concatenate([mem, xs], axis=1)
            q = torch.einsum('btd,dhe->bhte', h, Wq)
            k = torch.einsum('btd,dhe->bhte', h, Wk)
            v = torch.einsum('btd,dhe->bhte', h, Wv)
            scores = torch.einsum('bhqe,bhke->bhqk', q, k) * scale
            scores = torch.where(mask[None, None], scores, -1000000000.0)
            p = _softmax(scores, axis=-1)
            o = torch.einsum('bhqk,bhke->bhqe', p, v)
            o = torch.einsum('bhte,hed->btd', o, Wo)
            mem = o[:, :M, :].clone()
            outs.append(o[:, M:, :])
        return torch.concatenate(outs, axis=1)

    def _B_ref(x, w1, w2):
        h = torch.einsum('bsd,df->bsf', x, w1)
        zero = torch.zeros_like(h)
        h = torch.maximum(h, zero)
        return torch.einsum('bsf,fd->bsd', h, w2)
    x = A_x
    x = x + _A_ref(_layernorm(x, axis=-1), A_mem0, A_Wq, A_Wk, A_Wv, A_Wo, A_seg_len)
    x = x + _B_ref(_layernorm(x, axis=-1), B_w1, B_w2)
    x = x + _A_ref(_layernorm(x, axis=-1), A_mem0, A_Wq, A_Wk, A_Wv, A_Wo, A_seg_len)
    x = x + _B_ref(_layernorm(x, axis=-1), B_w1, B_w2)
    return x
```

```asm
; @launch grid=(256,1,1) block=(256,1,1) lds=163840
.amdgcn_target "amdgcn-amd-amdhsa--gfx950"
.text
.globl interleave_layers__memory_aug_recurrent_mem_tr__dense_activation_relu__prompt_kernel
.p2align 8
.type interleave_layers__memory_aug_recurrent_mem_tr__dense_activation_relu__prompt_kernel,@function
interleave_layers__memory_aug_recurrent_mem_tr__dense_activation_relu__prompt_kernel:
  s_cmp_ge_u32 s2, 256
  s_cbranch_scc0 L_go
  s_endpgm
L_go:
  s_load_dwordx16 s[16:31], s[0:1], 0
  s_load_dwordx8 s[32:39], s[0:1], 64
  s_load_dwordx2 s[40:41], s[0:1], 96
  s_getreg_b32 s42, hwreg(HW_REG_XCC_ID, 0, 4)
  s_and_b32 s42, s42, 7
  s_xor_b32 s42, s42, 0
  v_lshrrev_b32 v1, 6, v0
  v_and_b32 v0, 63, v0
  s_mov_b32 s45, 0
  v_readfirstlane_b32 s3, v1
  s_mov_b32 s44, 0
  s_waitcnt lgkmcnt(0)
  s_mov_b32 s4, s40
  s_and_b32 s5, s41, 0xffff
  s_mov_b32 s6, 268435456
  s_mov_b32 s7, 0x20000
  s_mov_b32 s8, s38
  s_and_b32 s9, s39, 0xffff
  s_mov_b32 s10, 256
  s_mov_b32 s11, 0x20000
  s_mov_b32 s12, s16
  s_and_b32 s13, s17, 0xffff
  s_mov_b32 s14, 2621440
  s_mov_b32 s15, 0x20000
  s_cmp_eq_u32 s3, 0
  s_cbranch_scc0 L_norank
  s_lshl_b32 s46, s42, 6
  s_lshl_b32 s47, s42, 2
  s_add_u32 s48, s47, 120
  s_add_u32 s47, s47, 172
  s_cmp_ge_u32 s42, 2
  s_cselect_b32 s46, s48, s46
  s_cmp_ge_u32 s42, 5
  s_cselect_b32 s46, s47, s46
  s_mov_b64 exec, 1
  v_mov_b32 v2, s46
  v_mov_b32 v3, 1
  buffer_atomic_add v3, v2, s[8:11], 0 offen sc0 sc1
  s_mov_b64 exec, -1
L_norank:
  s_lshl_b32 s46, s2, 2
  s_add_u32 s46, s46, s3
  s_mul_i32 s46, s46, 18432
  v_lshlrev_b32 v1, 4, v0
  s_mov_b32 s47, 0x10000000
  v_mov_b32 v4, 0
  v_mov_b32 v5, 0
  v_mov_b32 v6, 0
  v_mov_b32 v7, 0
  buffer_store_dwordx4 v[4:7], v1, s[4:7], s46 offen offset:0 sc1
  buffer_store_dwordx4 v[4:7], v1, s[4:7], s46 offen offset:1024 sc1
  buffer_store_dwordx4 v[4:7], v1, s[4:7], s46 offen offset:2048 sc1
  buffer_store_dwordx4 v[4:7], v1, s[4:7], s46 offen offset:3072 sc1
  s_add_u32 s46, s46, 4096
  buffer_store_dwordx4 v[4:7], v1, s[4:7], s46 offen offset:0 sc1
  buffer_store_dwordx4 v[4:7], v1, s[4:7], s46 offen offset:1024 sc1
  buffer_store_dwordx4 v[4:7], v1, s[4:7], s46 offen offset:2048 sc1
  buffer_store_dwordx4 v[4:7], v1, s[4:7], s46 offen offset:3072 sc1
  s_add_u32 s46, s46, 4096
  buffer_store_dwordx4 v[4:7], v1, s[4:7], s46 offen offset:0 sc1
  buffer_store_dwordx4 v[4:7], v1, s[4:7], s46 offen offset:1024 sc1
  buffer_store_dwordx4 v[4:7], v1, s[4:7], s46 offen offset:2048 sc1
  buffer_store_dwordx4 v[4:7], v1, s[4:7], s46 offen offset:3072 sc1
  s_add_u32 s46, s46, 4096
  buffer_store_dwordx4 v[4:7], v1, s[4:7], s46 offen offset:0 sc1
  buffer_store_dwordx4 v[4:7], v1, s[4:7], s46 offen offset:1024 sc1
  buffer_store_dwordx4 v[4:7], v1, s[4:7], s46 offen offset:2048 sc1
  buffer_store_dwordx4 v[4:7], v1, s[4:7], s46 offen offset:3072 sc1
  s_add_u32 s46, s46, 4096
  buffer_store_dwordx4 v[4:7], v1, s[4:7], s46 offen offset:0 sc1
  buffer_store_dwordx4 v[4:7], v1, s[4:7], s46 offen offset:1024 sc1
  s_cmp_eq_u32 s3, 0
  s_cbranch_scc0 L_norank2
  s_waitcnt vmcnt(18)
  v_mov_b32 v2, 0
  s_mov_b64 exec, 1
  ds_write_b32 v2, v3
  s_waitcnt lgkmcnt(0)
  s_mov_b64 exec, -1
L_norank2:
  s_barrier
  v_mov_b32 v2, 0
  ds_read_b32 v3, v2
  s_waitcnt lgkmcnt(0)
  s_nop 0
  v_readfirstlane_b32 s43, v3
  s_barrier
  s_min_u32 s43, s43, 31
  s_cmp_lt_u32 s42, 2
  s_cbranch_scc0 nxF_1
  s_getpc_b64 s[46:47]
LJchainF:
  s_add_u32 s46, s46, R_chainF-LJchainF
  s_addc_u32 s47, s47, 0
  s_setpc_b64 s[46:47]
nxF_1:
  s_cmp_lt_u32 s42, 4
  s_cbranch_scc0 nxF_2
  s_getpc_b64 s[46:47]
LJattF:
  s_add_u32 s46, s46, R_attF-LJattF
  s_addc_u32 s47, s47, 0
  s_setpc_b64 s[46:47]
nxF_2:
  s_cmp_lt_u32 s42, 5
  s_cbranch_scc0 nxF_3
  s_getpc_b64 s[46:47]
LJffnF:
  s_add_u32 s46, s46, R_ffnF-LJffnF
  s_addc_u32 s47, s47, 0
  s_setpc_b64 s[46:47]
nxF_3:
  s_cmp_lt_u32 s42, 8
  s_cbranch_scc0 nxF_4
  s_getpc_b64 s[46:47]
LJqkvF:
  s_add_u32 s46, s46, R_qkvF-LJqkvF
  s_addc_u32 s47, s47, 0
  s_setpc_b64 s[46:47]
nxF_4:
  s_endpgm
  .p2align 6
R_chainF:
  s_lshr_b32 s52, s43, 1
  s_lshl_b32 s46, s42, 4
  s_add_u32 s52, s52, s46
  s_and_b32 s53, s43, 1
  s_lshl_b32 s54, s42, 5
  s_add_u32 s54, s54, s43
  v_add_u32 v40, 0, v0
  v_mul_u32_u24 v41, 43691, v40
  v_lshrrev_b32 v41, 20, v41
  v_mul_u32_u24 v42, 24, v41
  v_sub_u32 v40, v40, v42
  v_lshlrev_b32 v40, 4, v40
  v_mul_u32_u24 v41, 12288, v41
  v_add_u32 v16, v40, v41
  v_add_u32 v40, 64, v0
  v_mul_u32_u24 v41, 43691, v40
  v_lshrrev_b32 v41, 20, v41
  v_mul_u32_u24 v42, 24, v41
  v_sub_u32 v40, v40, v42
  v_lshlrev_b32 v40, 4, v40
  v_mul_u32_u24 v41, 12288, v41
  v_add_u32 v17, v40, v41
  v_add_u32 v40, 128, v0
  v_mul_u32_u24 v41, 43691, v40
  v_lshrrev_b32 v41, 20, v41
  v_mul_u32_u24 v42, 24, v41
  v_sub_u32 v40, v40, v42
  v_lshlrev_b32 v40, 4, v40
  v_mul_u32_u24 v41, 12288, v41
  v_add_u32 v18, v40, v41
  s_mul_i32 s46, s3, 98304
  v_add_u32 v16, s46, v16
  v_add_u32 v17, s46, v17
  v_add_u32 v18, s46, v18
  s_mul_i32 s46, s53, 3932160
  s_mul_i32 s47, s52, 384
  s_add_u32 s46, s46, s47
  v_add_u32 v16, s46, v16
  v_add_u32 v17, s46, v17
  v_add_u32 v18, s46, v18
  v_add_u32 v40, 0, v0
  v_mul_u32_u24 v41, 26215, v40
  v_lshrrev_b32 v41, 20, v41
  v_mul_u32_u24 v42, 40, v41
  v_sub_u32 v40, v40, v42
  v_lshlrev_b32 v40, 4, v40
  v_mul_u32_u24 v41, 1280, v41
  v_add_u32 v20, v40, v41
  v_add_u32 v40, 64, v0
  v_mul_u32_u24 v41, 26215, v40
  v_lshrrev_b32 v41, 20, v41
  v_mul_u32_u24 v42, 40, v41
  v_sub_u32 v40, v40, v42
  v_lshlrev_b32 v40, 4, v40
  v_mul_u32_u24 v41, 1280, v41
  v_add_u32 v21, v40, v41
  v_add_u32 v40, 128, v0
  v_mul_u32_u24 v41, 26215, v40
  v_lshrrev_b32 v41, 20, v41
  v_mul_u32_u24 v42, 40, v41
  v_sub_u32 v40, v40, v42
  v_lshlrev_b32 v40, 4, v40
  v_mul_u32_u24 v41, 1280, v41
  v_add_u32 v22, v40, v41
  v_add_u32 v40, 192, v0
  v_mul_u32_u24 v41, 26215, v40
  v_lshrrev_b32 v41, 20, v41
  v_mul_u32_u24 v42, 40, v41
  v_sub_u32 v40, v40, v42
  v_lshlrev_b32 v40, 4, v40
  v_mul_u32_u24 v41, 1280, v41
  v_add_u32 v23, v40, v41
  v_add_u32 v40, 256, v0
  v_mul_u32_u24 v41, 26215, v40
  v_lshrrev_b32 v41, 20, v41
  v_mul_u32_u24 v42, 40, v41
  v_sub_u32 v40, v40, v42
  v_lshlrev_b32 v40, 4, v40
  v_mul_u32_u24 v41, 1280, v41
  v_add_u32 v24, v40, v41
  s_mul_i32 s46, s3, 10240
  v_add_u32 v20, s46, v20
  v_add_u32 v21, s46, v21
  v_add_u32 v22, s46, v22
  v_add_u32 v23, s46, v23
  v_add_u32 v24, s46, v24
  s_mul_i32 s46, s52, 245760
  s_mul_i32 s47, s53, 640
  s_add_u32 s46, s46, s47
  v_add_u32 v20, s46, v20
  v_add_u32 v21, s46, v21
  v_add_u32 v22, s46, v22
  v_add_u32 v23, s46, v23
  v_add_u32 v24, s46, v24
  v_lshrrev_b32 v40, 4, v0
  v_mul_u32_u24 v40, 8, v40
  v_bfe_u32 v41, v0, 2, 2
  v_add_u32 v40, v40, v41
  v_mul_u32_u24 v40, 384, v40
  v_and_b32 v41, 3, v0
  v_mul_u32_u24 v41, 8, v41
  v_add_u32 v26, v40, v41
  s_mul_i32 s46, s3, 96
  v_add_u32 v26, s46, v26
  v_add_u32 v27, 0x10000, v26
  v_add_u32 v28, 0x20000, v26
  v_lshrrev_b32 v40, 4, v0
  v_mul_u32_u24 v40, 4, v40
  v_bfe_u32 v41, v0, 2, 2
  v_add_u32 v40, v40, v41
  v_mul_u32_u24 v40, 640, v40
  v_and_b32 v41, 3, v0
  v_mul_u32_u24 v41, 16, v41
  v_add_u32 v29, v40, v41
  s_lshl_b32 s46, s3, 7
  v_add_u32 v29, s46, v29
  v_add_u32 v30, 0x10000, v29
  v_add_u32 v31, 0x20000, v29
  v_lshrrev_b32 v40, 4, v0
  v_mul_u32_u24 v40, 4, v40
  v_bfe_u32 v41, v0, 2, 2
  v_add_u32 v40, v40, v41
  v_mul_u32_u24 v40, 640, v40
  v_and_b32 v41, 3, v0
  v_mul_u32_u24 v41, 8, v41
  v_add_u32 v32, v40, v41
  s_lshl_b32 s46, s3, 5
  s_add_u32 s46, s46, 512
  v_add_u32 v32, s46, v32
  v_add_u32 v33, 0x10000, v32
  v_add_u32 v34, 0x20000, v32
  s_mul_i32 s55, s3, 3072
  s_mul_i32 s56, s3, 5120
  s_lshr_b32 s57, s3, 1
  s_mul_i32 s57, s57, 40960
  s_mov_b32 s60, s20
  s_and_b32 s61, s21, 0xffff
  s_mov_b32 s62, 7864320
  s_mov_b32 s63, 0x20000
  s_mov_b32 s64, s22
  s_and_b32 s65, s23, 0xffff
  s_mov_b32 s66, 7864320
  s_mov_b32 s67, 0x20000
  s_mov_b32 s68, s24
  s_and_b32 s69, s25, 0xffff
  s_mov_b32 s70, 7864320
  s_mov_b32 s71, 0x20000
  s_mov_b32 s72, s26
  s_and_b32 s73, s27, 0xffff
  s_mov_b32 s74, 7864320
  s_mov_b32 s75, 0x20000
  s_mov_b32 s46, 0
  s_add_u32 m0, s55, 0
  s_nop 0
  buffer_load_dwordx4 v16, s[60:63], s46 offen lds
  s_mov_b32 s46, 0
  s_add_u32 m0, s55, 1024
  s_nop 0
  buffer_load_dwordx4 v17, s[60:63], s46 offen lds
  s_mov_b32 s46, 0
  s_add_u32 m0, s55, 2048
  s_nop 0
  buffer_load_dwordx4 v18, s[60:63], s46 offen lds
  s_mov_b32 s46, 393216
  s_add_u32 m0, s55, 12288
  s_nop 0
  buffer_load_dwordx4 v16, s[60:63], s46 offen lds
  s_mov_b32 s46, 393216
  s_add_u32 m0, s55, 13312
  s_nop 0
  buffer_load_dwordx4 v17, s[60:63], s46 offen lds
  s_mov_b32 s46, 393216
  s_add_u32 m0, s55, 14336
  s_nop 0
  buffer_load_dwordx4 v18, s[60:63], s46 offen lds
  s_mov_b32 s46, 786432
  s_add_u32 m0, s55, 24576
  s_nop 0
  buffer_load_dwordx4 v16, s[60:63], s46 offen lds
  s_mov_b32 s46, 786432
  s_add_u32 m0, s55, 25600
  s_nop 0
  buffer_load_dwordx4 v17, s[60:63], s46 offen lds
  s_mov_b32 s46, 786432
  s_add_u32 m0, s55, 26624
  s_nop 0
  buffer_load_dwordx4 v18, s[60:63], s46 offen lds
  s_mov_b32 s46, 1179648
  s_add_u32 m0, s55, 36864
  s_nop 0
  buffer_load_dwordx4 v16, s[60:63], s46 offen lds
  s_mov_b32 s46, 1179648
  s_add_u32 m0, s55, 37888
  s_nop 0
  buffer_load_dwordx4 v17, s[60:63], s46 offen lds
  s_mov_b32 s46, 1179648
  s_add_u32 m0, s55, 38912
  s_nop 0
  buffer_load_dwordx4 v18, s[60:63], s46 offen lds
  s_mov_b32 s46, 1572864
  s_add_u32 m0, s55, 49152
  s_nop 0
  buffer_load_dwordx4 v16, s[60:63], s46 offen lds
  s_mov_b32 s46, 1572864
  s_add_u32 m0, s55, 50176
  s_nop 0
  buffer_load_dwordx4 v17, s[60:63], s46 offen lds
  s_mov_b32 s46, 1572864
  s_add_u32 m0, s55, 51200
  s_nop 0
  buffer_load_dwordx4 v18, s[60:63], s46 offen lds
  s_mov_b32 s46, 1966080
  s_add_u32 m0, s55, 61440
  s_nop 0
  buffer_load_dwordx4 v16, s[60:63], s46 offen lds
  s_mov_b32 s46, 1966080
  s_add_u32 m0, s55, 62464
  s_nop 0
  buffer_load_dwordx4 v17, s[60:63], s46 offen lds
  s_mov_b32 s46, 1966080
  s_add_u32 m0, s55, 63488
  s_nop 0
  buffer_load_dwordx4 v18, s[60:63], s46 offen lds
  s_mov_b32 s46, 2359296
  s_add_u32 m0, s55, 73728
  s_nop 0
  buffer_load_dwordx4 v16, s[60:63], s46 offen lds
  s_mov_b32 s46, 2359296
  s_add_u32 m0, s55, 74752
  s_nop 0
  buffer_load_dwordx4 v17, s[60:63], s46 offen lds
  s_mov_b32 s46, 2359296
  s_add_u32 m0, s55, 75776
  s_nop 0
  buffer_load_dwordx4 v18, s[60:63], s46 offen lds
  s_mov_b32 s46, 2752512
  s_add_u32 m0, s55, 86016
  s_nop 0
  buffer_load_dwordx4 v16, s[60:63], s46 offen lds
  s_mov_b32 s46, 2752512
  s_add_u32 m0, s55, 87040
  s_nop 0
  buffer_load_dwordx4 v17, s[60:63], s46 offen lds
  s_mov_b32 s46, 2752512
  s_add_u32 m0, s55, 88064
  s_nop 0
  buffer_load_dwordx4 v18, s[60:63], s46 offen lds
  s_mov_b32 s46, 3145728
  s_add_u32 m0, s55, 98304
  s_nop 0
  buffer_load_dwordx4 v16, s[60:63], s46 offen lds
  s_mov_b32 s46, 3145728
  s_add_u32 m0, s55, 99328
  s_nop 0
  buffer_load_dwordx4 v17, s[60:63], s46 offen lds
  s_mov_b32 s46, 3145728
  s_add_u32 m0, s55, 100352
  s_nop 0
  buffer_load_dwordx4 v18, s[60:63], s46 offen lds
  s_mov_b32 s46, 3538944
  s_add_u32 m0, s55, 110592
  s_nop 0
  buffer_load_dwordx4 v16, s[60:63], s46 offen lds
  s_mov_b32 s46, 3538944
  s_add_u32 m0, s55, 111616
  s_nop 0
  buffer_load_dwordx4 v17, s[60:63], s46 offen lds
  s_mov_b32 s46, 3538944
  s_add_u32 m0, s55, 112640
  s_nop 0
  buffer_load_dwordx4 v18, s[60:63], s46 offen lds
  s_mov_b32 s46, 0
  s_add_u32 m0, s55, 122880
  s_nop 0
  buffer_load_dwordx4 v16, s[64:67], s46 offen lds
  s_mov_b32 s46, 0
  s_add_u32 m0, s55, 123904
  s_nop 0
  buffer_load_dwordx4 v17, s[64:67], s46 offen lds
  s_mov_b32 s46, 0
  s_add_u32 m0, s55, 124928
  s_nop 0
  buffer_load_dwordx4 v18, s[64:67], s46 offen lds
  s_mov_b32 s46, 393216
  s_add_u32 m0, s55, 135168
  s_nop 0
  buffer_load_dwordx4 v16, s[64:67], s46 offen lds
  s_mov_b32 s46, 393216
  s_add_u32 m0, s55, 136192
  s_nop 0
  buffer_load_dwordx4 v17, s[64:67], s46 offen lds
  s_mov_b32 s46, 393216
  s_add_u32 m0, s55, 137216
  s_nop 0
  buffer_load_dwordx4 v18, s[64:67], s46 offen lds
  s_mov_b32 s46, 786432
  s_add_u32 m0, s55, 147456
  s_nop 0
  buffer_load_dwordx4 v16, s[64:67], s46 offen lds
  s_mov_b32 s46, 786432
  s_add_u32 m0, s55, 148480
  s_nop 0
  buffer_load_dwordx4 v17, s[64:67], s46 offen lds
  s_mov_b32 s46, 786432
  s_add_u32 m0, s55, 149504
  s_nop 0
  buffer_load_dwordx4 v18, s[64:67], s46 offen lds
  s_waitcnt vmcnt(36)
  s_barrier
  s_cmp_eq_u32 s3, 0
  s_cbranch_scc0 arrF_6
  s_mov_b64 exec, 1
  v_mov_b32 v150, 140
  v_mov_b32 v149, 1
  buffer_atomic_add v149, v150, s[8:11], 0 offen sc0 sc1
  s_mov_b64 exec, -1
arrF_6:
  ds_read_b64_tr_b16 a[0:1], v26 offset:0
  ds_read_b64_tr_b16 a[2:3], v26 offset:1536
  ds_read_b64_tr_b16 a[40:41], v26 offset:32
  ds_read_b64_tr_b16 a[42:43], v26 offset:1568
  ds_read_b64_tr_b16 a[80:81], v26 offset:64
  ds_read_b64_tr_b16 a[82:83], v26 offset:1600
  s_waitcnt lgkmcnt(0)
  s_waitcnt vmcnt(33)
  s_barrier
  s_mov_b32 s46, 1179648
  s_add_u32 m0, s55, 0
  s_nop 0
  buffer_load_dwordx4 v16, s[64:67], s46 offen lds
  s_mov_b32 s46, 1179648
  s_add_u32 m0, s55, 1024
  s_nop 0
  buffer_load_dwordx4 v17, s[64:67], s46 offen lds
  s_mov_b32 s46, 1179648
  s_add_u32 m0, s55, 2048
  s_nop 0
  buffer_load_dwordx4 v18, s[64:67], s46 offen lds
  ds_read_b64_tr_b16 a[4:5], v26 offset:12288
  ds_read_b64_tr_b16 a[6:7], v26 offset:13824
  ds_read_b64_tr_b16 a[44:45], v26 offset:12320
  ds_read_b64_tr_b16 a[46:47], v26 offset:13856
  ds_read_b64_tr_b16 a[84:85], v26 offset:12352
  ds_read_b64_tr_b16 a[86:87], v26 offset:13888
  s_waitcnt lgkmcnt(0)
  s_waitcnt vmcnt(33)
  s_barrier
  s_mov_b32 s46, 1572864
  s_add_u32 m0, s55, 12288
  s_nop 0
  buffer_load_dwordx4 v16, s[64:67], s46 offen lds
  s_mov_b32 s46, 1572864
  s_add_u32 m0, s55, 13312
  s_nop 0
  buffer_load_dwordx4 v17, s[64:67], s46 offen lds
  s_mov_b32 s46, 1572864
  s_add_u32 m0, s55, 14336
  s_nop 0
  buffer_load_dwordx4 v18, s[64:67], s46 offen lds
  ds_read_b64_tr_b16 a[8:9], v26 offset:24576
  ds_read_b64_tr_b16 a[10:11], v26 offset:26112
  ds_read_b64_tr_b16 a[48:49], v26 offset:24608
  ds_read_b64_tr_b16 a[50:51], v26 offset:26144
  ds_read_b64_tr_b16 a[88:89], v26 offset:24640
  ds_read_b64_tr_b16 a[90:91], v26 offset:26176
  s_waitcnt lgkmcnt(0)
  s_waitcnt vmcnt(33)
  s_barrier
  s_mov_b32 s46, 1966080
  s_add_u32 m0, s55, 24576
  s_nop 0
  buffer_load_dwordx4 v16, s[64:67], s46 offen lds
  s_mov_b32 s46, 1966080
  s_add_u32 m0, s55, 25600
  s_nop 0
  buffer_load_dwordx4 v17, s[64:67], s46 offen lds
  s_mov_b32 s46, 1966080
  s_add_u32 m0, s55, 26624
  s_nop 0
  buffer_load_dwordx4 v18, s[64:67], s46 offen lds
  ds_read_b64_tr_b16 a[12:13], v26 offset:36864
  ds_read_b64_tr_b16 a[14:15], v26 offset:38400
  ds_read_b64_tr_b16 a[52:53], v26 offset:36896
  ds_read_b64_tr_b16 a[54:55], v26 offset:38432
  ds_read_b64_tr_b16 a[92:93], v26 offset:36928
  ds_read_b64_tr_b16 a[94:95], v26 offset:38464
  s_waitcnt lgkmcnt(0)
  s_waitcnt vmcnt(33)
  s_barrier
  s_mov_b32 s46, 2359296
  s_add_u32 m0, s55, 36864
  s_nop 0
  buffer_load_dwordx4 v16, s[64:67], s46 offen lds
  s_mov_b32 s46, 2359296
  s_add_u32 m0, s55, 37888
  s_nop 0
  buffer_load_dwordx4 v17, s[64:67], s46 offen lds
  s_mov_b32 s46, 2359296
  s_add_u32 m0, s55, 38912
  s_nop 0
  buffer_load_dwordx4 v18, s[64:67], s46 offen lds
  ds_read_b64_tr_b16 a[16:17], v26 offset:49152
  ds_read_b64_tr_b16 a[18:19], v26 offset:50688
  ds_read_b64_tr_b16 a[56:57], v26 offset:49184
  ds_read_b64_tr_b16 a[58:59], v26 offset:50720
  ds_read_b64_tr_b16 a[96:97], v26 offset:49216
  ds_read_b64_tr_b16 a[98:99], v26 offset:50752
  s_waitcnt lgkmcnt(0)
  s_waitcnt vmcnt(33)
  s_barrier
  s_mov_b32 s46, 2752512
  s_add_u32 m0, s55, 49152
  s_nop 0
  buffer_load_dwordx4 v16, s[64:67], s46 offen lds
  s_mov_b32 s46, 2752512
  s_add_u32 m0, s55, 50176
  s_nop 0
  buffer_load_dwordx4 v17, s[64:67], s46 offen lds
  s_mov_b32 s46, 2752512
  s_add_u32 m0, s55, 51200
  s_nop 0
  buffer_load_dwordx4 v18, s[64:67], s46 offen lds
  ds_read_b64_tr_b16 a[20:21], v26 offset:61440
  ds_read_b64_tr_b16 a[22:23], v26 offset:62976
  ds_read_b64_tr_b16 a[60:61], v26 offset:61472
  ds_read_b64_tr_b16 a[62:63], v26 offset:63008
  ds_read_b64_tr_b16 a[100:101], v26 offset:61504
  ds_read_b64_tr_b16 a[102:103], v26 offset:63040
  s_waitcnt lgkmcnt(0)
  s_waitcnt vmcnt(33)
  s_barrier
  s_mov_b32 s46, 3145728
  s_add_u32 m0, s55, 61440
  s_nop 0
  buffer_load_dwordx4 v16, s[64:67], s46 offen lds
  s_mov_b32 s46, 3145728
  s_add_u32 m0, s55, 62464
  s_nop 0
  buffer_load_dwordx4 v17, s[64:67], s46 offen lds
  s_mov_b32 s46, 3145728
  s_add_u32 m0, s55, 63488
  s_nop 0
  buffer_load_dwordx4 v18, s[64:67], s46 offen lds
  ds_read_b64_tr_b16 a[24:25], v27 offset:8192
  ds_read_b64_tr_b16 a[26:27], v27 offset:9728
  ds_read_b64_tr_b16 a[64:65], v27 offset:8224
  ds_read_b64_tr_b16 a[66:67], v27 offset:9760
  ds_read_b64_tr_b16 a[104:105], v27 offset:8256
  ds_read_b64_tr_b16 a[106:107], v27 offset:9792
  s_waitcnt lgkmcnt(0)
  s_waitcnt vmcnt(33)
  s_barrier
  s_mov_b32 s46, 3538944
  s_add_u32 m0, s55, 73728
  s_nop 0
  buffer_load_dwordx4 v16, s[64:67], s46 offen lds
  s_mov_b32 s46, 3538944
  s_add_u32 m0, s55, 74752
  s_nop 0
  buffer_load_dwordx4 v17, s[64:67], s46 offen lds
  s_mov_b32 s46, 3538944
  s_add_u32 m0, s55, 75776
  s_nop 0
  buffer_load_dwordx4 v18, s[64:67], s46 offen lds
  ds_read_b64_tr_b16 a[28:29], v27 offset:20480
  ds_read_b64_tr_b16 a[30:31], v27 offset:22016
  ds_read_b64_tr_b16 a[68:69], v27 offset:20512
  ds_read_b64_tr_b16 a[70:71], v27 offset:22048
  ds_read_b64_tr_b16 a[108:109], v27 offset:20544
  ds_read_b64_tr_b16 a[110:111], v27 offset:22080
  s_waitcnt lgkmcnt(0)
  s_waitcnt vmcnt(33)
  s_barrier
  ds_read_b64_tr_b16 a[32:33], v27 offset:32768
  ds_read_b64_tr_b16 a[34:35], v27 offset:34304
  ds_read_b64_tr_b16 a[72:73], v27 offset:32800
  ds_read_b64_tr_b16 a[74:75], v27 offset:34336
  ds_read_b64_tr_b16 a[112:113], v27 offset:32832
  ds_read_b64_tr_b16 a[114:115], v27 offset:34368
  s_waitcnt lgkmcnt(0)
  s_waitcnt vmcnt(30)
  s_barrier
  s_mov_b32 s46, 0
  s_add_u32 m0, s56, 86016
  s_nop 0
  buffer_load_dwordx4 v20, s[72:75], s46 offen lds
  s_mov_b32 s46, 0
  s_add_u32 m0, s56, 87040
  s_nop 0
  buffer_load_dwordx4 v21, s[72:75], s46 offen lds
  s_mov_b32 s46, 0
  s_add_u32 m0, s56, 88064
  s_nop 0
  buffer_load_dwordx4 v22, s[72:75], s46 offen lds
  s_mov_b32 s46, 0
  s_add_u32 m0, s56, 89088
  s_nop 0
  buffer_load_dwordx4 v23, s[72:75], s46 offen lds
  s_mov_b32 s46, 0
  s_add_u32 m0, s56, 90112
  s_nop 0
  buffer_load_dwordx4 v24, s[72:75], s46 offen lds
  ds_read_b64_tr_b16 a[36:37], v27 offset:45056
  ds_read_b64_tr_b16 a[38:39], v27 offset:46592
  ds_read_b64_tr_b16 a[76:77], v27 offset:45088
  ds_read_b64_tr_b16 a[78:79], v27 offset:46624
  ds_read_b64_tr_b16 a[116:117], v27 offset:45120
  ds_read_b64_tr_b16 a[118:119], v27 offset:46656
  s_waitcnt lgkmcnt(0)
  s_waitcnt vmcnt(32)
  s_barrier
  ds_read_b64_tr_b16 a[120:121], v27 offset:57344
  ds_read_b64_tr_b16 a[122:123], v27 offset:58880
  ds_read_b64_tr_b16 a[160:161], v27 offset:57376
  ds_read_b64_tr_b16 a[162:163], v27 offset:58912
  ds_read_b64_tr_b16 a[200:201], v27 offset:57408
  ds_read_b64_tr_b16 a[202:203], v27 offset:58944
  s_waitcnt lgkmcnt(0)
  s_waitcnt vmcnt(29)
  s_barrier
  s_mov_b32 s46, 61440
  s_add_u32 m0, s56, 106496
  s_nop 0
  buffer_load_dwordx4 v20, s[72:75], s46 offen lds
  s_mov_b32 s46, 61440
  s_add_u32 m0, s56, 107520
  s_nop 0
  buffer_load_dwordx4 v21, s[72:75], s46 offen lds
  s_mov_b32 s46, 61440
  s_add_u32 m0, s56, 108544
  s_nop 0
  buffer_load_dwordx4 v22, s[72:75], s46 offen lds
  s_mov_b32 s46, 61440
  s_add_u32 m0, s56, 109568
  s_nop 0
  buffer_load_dwordx4 v23, s[72:75], s46 offen lds
  s_mov_b32 s46, 61440
  s_add_u32 m0, s56, 110592
  s_nop 0
  buffer_load_dwordx4 v24, s[72:75], s46 offen lds
  ds_read_b64_tr_b16 a[124:125], v28 offset:4096
  ds_read_b64_tr_b16 a[126:127], v28 offset:5632
  ds_read_b64_tr_b16 a[164:165], v28 offset:4128
  ds_read_b64_tr_b16 a[166:167], v28 offset:5664
  ds_read_b64_tr_b16 a[204:205], v28 offset:4160
  ds_read_b64_tr_b16 a[206:207], v28 offset:5696
  s_waitcnt lgkmcnt(0)
  s_waitcnt vmcnt(31)
  s_barrier
  s_mov_b32 s46, 122880
  s_add_u32 m0, s56, 126976
  s_nop 0
  buffer_load_dwordx4 v20, s[72:75], s46 offen lds
  s_mov_b32 s46, 122880
  s_add_u32 m0, s56, 128000
  s_nop 0
  buffer_load_dwordx4 v21, s[72:75], s46 offen lds
  s_mov_b32 s46, 122880
  s_add_u32 m0, s56, 129024
  s_nop 0
  buffer_load_dwordx4 v22, s[72:75], s46 offen lds
  s_mov_b32 s46, 122880
  s_add_u32 m0, s56, 130048
  s_nop 0
  buffer_load_dwordx4 v23, s[72:75], s46 offen lds
  s_mov_b32 s46, 122880
  s_add_u32 m0, s56, 131072
  s_nop 0
  buffer_load_dwordx4 v24, s[72:75], s46 offen lds
  ds_read_b64_tr_b16 a[128:129], v28 offset:16384
  ds_read_b64_tr_b16 a[130:131], v28 offset:17920
  ds_read_b64_tr_b16 a[168:169], v28 offset:16416
  ds_read_b64_tr_b16 a[170:171], v28 offset:17952
  ds_read_b64_tr_b16 a[208:209], v28 offset:16448
  ds_read_b64_tr_b16 a[210:211], v28 offset:17984
  s_waitcnt lgkmcnt(0)
  s_waitcnt vmcnt(33)
  s_barrier
  ds_read_b64_tr_b16 a[132:133], v26 offset:0
  ds_read_b64_tr_b16 a[134:135], v26 offset:1536
  ds_read_b64_tr_b16 a[172:173], v26 offset:32
  ds_read_b64_tr_b16 a[174:175], v26 offset:1568
  ds_read_b64_tr_b16 a[212:213], v26 offset:64
  ds_read_b64_tr_b16 a[214:215], v26 offset:1600
  s_waitcnt lgkmcnt(0)
  s_waitcnt vmcnt(30)
  s_barrier
  ds_read_b64_tr_b16 a[136:137], v26 offset:12288
  ds_read_b64_tr_b16 a[138:139], v26 offset:13824
  ds_read_b64_tr_b16 a[176:177], v26 offset:12320
  ds_read_b64_tr_b16 a[178:179], v26 offset:13856
  ds_read_b64_tr_b16 a[216:217], v26 offset:12352
  ds_read_b64_tr_b16 a[218:219], v26 offset:13888
  s_waitcnt lgkmcnt(0)
  s_waitcnt vmcnt(27)
  s_barrier
  s_mov_b32 s46, 184320
  s_add_u32 m0, s56, 0
  s_nop 0
  buffer_load_dwordx4 v20, s[72:75], s46 offen lds
  s_mov_b32 s46, 184320
  s_add_u32 m0, s56, 1024
  s_nop 0
  buffer_load_dwordx4 v21, s[72:75], s46 offen lds
  s_mov_b32 s46, 184320
  s_add_u32 m0, s56, 2048
  s_nop 0
  buffer_load_dwordx4 v22, s[72:75], s46 offen lds
  s_mov_b32 s46, 184320
  s_add_u32 m0, s56, 3072
  s_nop 0
  buffer_load_dwordx4 v23, s[72:75], s46 offen lds
  s_mov_b32 s46, 184320
  s_add_u32 m0, s56, 4096
  s_nop 0
  buffer_load_dwordx4 v24, s[72:75], s46 offen lds
  ds_read_b64_tr_b16 a[140:141], v26 offset:24576
  ds_read_b64_tr_b16 a[142:143], v26 offset:26112
  ds_read_b64_tr_b16 a[180:181], v26 offset:24608
  ds_read_b64_tr_b16 a[182:183], v26 offset:26144
  ds_read_b64_tr_b16 a[220:221], v26 offset:24640
  ds_read_b64_tr_b16 a[222:223], v26 offset:26176
  s_waitcnt lgkmcnt(0)
  s_waitcnt vmcnt(29)
  s_barrier
  ds_read_b64_tr_b16 a[144:145], v26 offset:36864
  ds_read_b64_tr_b16 a[146:147], v26 offset:38400
  ds_read_b64_tr_b16 a[184:185], v26 offset:36896
  ds_read_b64_tr_b16 a[186:187], v26 offset:38432
  ds_read_b64_tr_b16 a[224:225], v26 offset:36928
  ds_read_b64_tr_b16 a[226:227], v26 offset:38464
  s_waitcnt lgkmcnt(0)
  s_waitcnt vmcnt(26)
  s_barrier
  s_add_u32 s46, s57, 40960
  s_add_u32 m0, s56, 20480
  s_nop 0
  buffer_load_dwordx4 v20, s[72:75], s46 offen lds
  s_add_u32 s46, s57, 40960
  s_add_u32 m0, s56, 21504
  s_nop 0
  buffer_load_dwordx4 v21, s[72:75], s46 offen lds
  s_add_u32 s46, s57, 40960
  s_add_u32 m0, s56, 22528
  s_nop 0
  buffer_load_dwordx4 v22, s[72:75], s46 offen lds
  s_add_u32 s46, s57, 40960
  s_add_u32 m0, s56, 23552
  s_nop 0
  buffer_load_dwordx4 v23, s[72:75], s46 offen lds
  s_add_u32 s46, s57, 40960
  s_add_u32 m0, s56, 24576
  s_nop 0
  buffer_load_dwordx4 v24, s[72:75], s46 offen lds
  ds_read_b64_tr_b16 a[148:149], v26 offset:49152
  ds_read_b64_tr_b16 a[150:151], v26 offset:50688
  ds_read_b64_tr_b16 a[188:189], v26 offset:49184
  ds_read_b64_tr_b16 a[190:191], v26 offset:50720
  ds_read_b64_tr_b16 a[228:229], v26 offset:49216
  ds_read_b64_tr_b16 a[230:231], v26 offset:50752
  s_waitcnt lgkmcnt(0)
  s_waitcnt vmcnt(28)
  s_barrier
  s_add_u32 s46, s57, 163840
  s_add_u32 m0, s56, 40960
  s_nop 0
  buffer_load_dwordx4 v20, s[72:75], s46 offen lds
  s_add_u32 s46, s57, 163840
  s_add_u32 m0, s56, 41984
  s_nop 0
  buffer_load_dwordx4 v21, s[72:75], s46 offen lds
  s_add_u32 s46, s57, 163840
  s_add_u32 m0, s56, 43008
  s_nop 0
  buffer_load_dwordx4 v22, s[72:75], s46 offen lds
  s_add_u32 s46, s57, 163840
  s_add_u32 m0, s56, 44032
  s_nop 0
  buffer_load_dwordx4 v23, s[72:75], s46 offen lds
  s_add_u32 s46, s57, 163840
  s_add_u32 m0, s56, 45056
  s_nop 0
  buffer_load_dwordx4 v24, s[72:75], s46 offen lds
  ds_read_b64_tr_b16 a[152:153], v26 offset:61440
  ds_read_b64_tr_b16 a[154:155], v26 offset:62976
  ds_read_b64_tr_b16 a[192:193], v26 offset:61472
  ds_read_b64_tr_b16 a[194:195], v26 offset:63008
  ds_read_b64_tr_b16 a[232:233], v26 offset:61504
  ds_read_b64_tr_b16 a[234:235], v26 offset:63040
  s_waitcnt lgkmcnt(0)
  s_waitcnt vmcnt(30)
  s_barrier
  s_mov_b32 s46, 0
  s_add_u32 m0, s55, 61440
  s_nop 0
  buffer_load_dwordx4 v16, s[68:71], s46 offen lds
  s_mov_b32 s46, 0
  s_add_u32 m0, s55, 62464
  s_nop 0
  buffer_load_dwordx4 v17, s[68:71], s46 offen lds
  s_mov_b32 s46, 0
  s_add_u32 m0, s55, 63488
  s_nop 0
  buffer_load_dwordx4 v18, s[68:71], s46 offen lds
  ds_read_b64_tr_b16 a[156:157], v27 offset:8192
  ds_read_b64_tr_b16 a[158:159], v27 offset:9728
  ds_read_b64_tr_b16 a[196:197], v27 offset:8224
  ds_read_b64_tr_b16 a[198:199], v27 offset:9760
  ds_read_b64_tr_b16 a[236:237], v27 offset:8256
  ds_read_b64_tr_b16 a[238:239], v27 offset:9792
  s_waitcnt lgkmcnt(0)
  s_waitcnt vmcnt(28)
  s_barrier
  s_mov_b32 s46, 393216
  s_add_u32 m0, s55, 73728
  s_nop 0
  buffer_load_dwordx4 v16, s[68:71], s46 offen lds
  s_mov_b32 s46, 393216
  s_add_u32 m0, s55, 74752
  s_nop 0
  buffer_load_dwordx4 v17, s[68:71], s46 offen lds
  s_mov_b32 s46, 393216
  s_add_u32 m0, s55, 75776
  s_nop 0
  buffer_load_dwordx4 v18, s[68:71], s46 offen lds
  ds_read_b64_tr_b16 a[240:241], v30 offset:20480
  ds_read_b64_tr_b16 a[242:243], v30 offset:30720
  ds_read_b64_tr_b16 v[160:161], v30 offset:20488
  ds_read_b64_tr_b16 v[162:163], v30 offset:30728
  ds_read_b64_tr_b16 v[184:185], v30 offset:20544
  ds_read_b64_tr_b16 v[186:187], v30 offset:30784
  ds_read_b64_tr_b16 v[208:209], v30 offset:20552
  ds_read_b64_tr_b16 v[210:211], v30 offset:30792
  ds_read_b64_tr_b16 v[232:233], v33 offset:20480
  ds_read_b64_tr_b16 v[234:235], v33 offset:30720
  s_waitcnt lgkmcnt(0)
  s_waitcnt vmcnt(26)
  s_barrier
  s_mov_b32 s46, 786432
  s_add_u32 m0, s55, 86016
  s_nop 0
  buffer_load_dwordx4 v16, s[68:71], s46 offen lds
  s_mov_b32 s46, 786432
  s_add_u32 m0, s55, 87040
  s_nop 0
  buffer_load_dwordx4 v17, s[68:71], s46 offen lds
  s_mov_b32 s46, 786432
  s_add_u32 m0, s55, 88064
  s_nop 0
  buffer_load_dwordx4 v18, s[68:71], s46 offen lds
  ds_read_b64_tr_b16 a[244:245], v30 offset:40960
  ds_read_b64_tr_b16 a[246:247], v30 offset:51200
  ds_read_b64_tr_b16 v[164:165], v30 offset:40968
  ds_read_b64_tr_b16 v[166:167], v30 offset:51208
  ds_read_b64_tr_b16 v[188:189], v30 offset:41024
  ds_read_b64_tr_b16 v[190:191], v30 offset:51264
  ds_read_b64_tr_b16 v[212:213], v30 offset:41032
  ds_read_b64_tr_b16 v[214:215], v30 offset:51272
  ds_read_b64_tr_b16 v[236:237], v33 offset:40960
  ds_read_b64_tr_b16 v[238:239], v33 offset:51200
  s_waitcnt lgkmcnt(0)
  s_waitcnt vmcnt(24)
  s_barrier
  s_mov_b32 s46, 1179648
  s_add_u32 m0, s55, 98304
  s_nop 0
  buffer_load_dwordx4 v16, s[68:71], s46 offen lds
  s_mov_b32 s46, 1179648
  s_add_u32 m0, s55, 99328
  s_nop 0
  buffer_load_dwordx4 v17, s[68:71], s46 offen lds
  s_mov_b32 s46, 1179648
  s_add_u32 m0, s55, 100352
  s_nop 0
  buffer_load_dwordx4 v18, s[68:71], s46 offen lds
  s_mov_b32 s46, 1572864
  s_add_u32 m0, s55, 110592
  s_nop 0
  buffer_load_dwordx4 v16, s[68:71], s46 offen lds
  s_mov_b32 s46, 1572864
  s_add_u32 m0, s55, 111616
  s_nop 0
  buffer_load_dwordx4 v17, s[68:71], s46 offen lds
  s_mov_b32 s46, 1572864
  s_add_u32 m0, s55, 112640
  s_nop 0
  buffer_load_dwordx4 v18, s[68:71], s46 offen lds
  ds_read_b64_tr_b16 a[248:249], v30 offset:61440
  ds_read_b64_tr_b16 a[250:251], v31 offset:6144
  ds_read_b64_tr_b16 v[168:169], v30 offset:61448
  ds_read_b64_tr_b16 v[170:171], v31 offset:6152
  ds_read_b64_tr_b16 v[192:193], v30 offset:61504
  ds_read_b64_tr_b16 v[194:195], v31 offset:6208
  ds_read_b64_tr_b16 v[216:217], v30 offset:61512
  ds_read_b64_tr_b16 v[218:219], v31 offset:6216
  ds_read_b64_tr_b16 v[240:241], v33 offset:61440
  ds_read_b64_tr_b16 v[242:243], v34 offset:6144
  s_waitcnt lgkmcnt(0)
  s_waitcnt vmcnt(25)
  s_barrier
  s_mov_b32 s46, 1966080
  s_add_u32 m0, s55, 122880
  s_nop 0
  buffer_load_dwordx4 v16, s[68:71], s46 offen lds
  s_mov_b32 s46, 1966080
  s_add_u32 m0, s55, 123904
  s_nop 0
  buffer_load_dwordx4 v17, s[68:71], s46 offen lds
  s_mov_b32 s46, 1966080
  s_add_u32 m0, s55, 124928
  s_nop 0
  buffer_load_dwordx4 v18, s[68:71], s46 offen lds
  s_mov_b32 s46, 2359296
  s_add_u32 m0, s55, 135168
  s_nop 0
  buffer_load_dwordx4 v16, s[68:71], s46 offen lds
  s_mov_b32 s46, 2359296
  s_add_u32 m0, s55, 136192
  s_nop 0
  buffer_load_dwordx4 v17, s[68:71], s46 offen lds
  s_mov_b32 s46, 2359296
  s_add_u32 m0, s55, 137216
  s_nop 0
  buffer_load_dwordx4 v18, s[68:71], s46 offen lds
  s_mov_b32 s46, 2752512
  s_add_u32 m0, s55, 147456
  s_nop 0
  buffer_load_dwordx4 v16, s[68:71], s46 offen lds
  s_mov_b32 s46, 2752512
  s_add_u32 m0, s55, 148480
  s_nop 0
  buffer_load_dwordx4 v17, s[68:71], s46 offen lds
  s_mov_b32 s46, 2752512
  s_add_u32 m0, s55, 149504
  s_nop 0
  buffer_load_dwordx4 v18, s[68:71], s46 offen lds
  ds_read_b64_tr_b16 a[252:253], v29 offset:0
  ds_read_b64_tr_b16 a[254:255], v29 offset:10240
  ds_read_b64_tr_b16 v[172:173], v29 offset:8
  ds_read_b64_tr_b16 v[174:175], v29 offset:10248
  ds_read_b64_tr_b16 v[196:197], v29 offset:64
  ds_read_b64_tr_b16 v[198:199], v29 offset:10304
  ds_read_b64_tr_b16 v[220:221], v29 offset:72
  ds_read_b64_tr_b16 v[222:223], v29 offset:10312
  ds_read_b64_tr_b16 v[244:245], v32 offset:0
  ds_read_b64_tr_b16 v[246:247], v32 offset:10240
  s_waitcnt lgkmcnt(0)
  s_waitcnt vmcnt(29)
  s_barrier
  s_mov_b32 s46, 3145728
  s_add_u32 m0, s55, 0
  s_nop 0
  buffer_load_dwordx4 v16, s[68:71], s46 offen lds
  s_mov_b32 s46, 3145728
  s_add_u32 m0, s55, 1024
  s_nop 0
  buffer_load_dwordx4 v17, s[68:71], s46 offen lds
  s_mov_b32 s46, 3145728
  s_add_u32 m0, s55, 2048
  s_nop 0
  buffer_load_dwordx4 v18, s[68:71], s46 offen lds
  ds_read_b64_tr_b16 v[152:153], v29 offset:20480
  ds_read_b64_tr_b16 v[154:155], v29 offset:30720
  ds_read_b64_tr_b16 v[176:177], v29 offset:20488
  ds_read_b64_tr_b16 v[178:179], v29 offset:30728
  ds_read_b64_tr_b16 v[200:201], v29 offset:20544
  ds_read_b64_tr_b16 v[202:203], v29 offset:30784
  ds_read_b64_tr_b16 v[224:225], v29 offset:20552
  ds_read_b64_tr_b16 v[226:227], v29 offset:30792
  ds_read_b64_tr_b16 v[248:249], v32 offset:20480
  ds_read_b64_tr_b16 v[250:251], v32 offset:30720
  s_waitcnt lgkmcnt(0)
  s_waitcnt vmcnt(27)
  s_barrier
  s_mov_b32 s46, 3538944
  s_add_u32 m0, s55, 12288
  s_nop 0
  buffer_load_dwordx4 v16, s[68:71], s46 offen lds
  s_mov_b32 s46, 3538944
  s_add_u32 m0, s55, 13312
  s_nop 0
  buffer_load_dwordx4 v17, s[68:71], s46 offen lds
  s_mov_b32 s46, 3538944
  s_add_u32 m0, s55, 14336
  s_nop 0
  buffer_load_dwordx4 v18, s[68:71], s46 offen lds
  ds_read_b64_tr_b16 v[156:157], v29 offset:40960
  ds_read_b64_tr_b16 v[158:159], v29 offset:51200
  ds_read_b64_tr_b16 v[180:181], v29 offset:40968
  ds_read_b64_tr_b16 v[182:183], v29 offset:51208
  ds_read_b64_tr_b16 v[204:205], v29 offset:41024
  ds_read_b64_tr_b16 v[206:207], v29 offset:51264
  ds_read_b64_tr_b16 v[228:229], v29 offset:41032
  ds_read_b64_tr_b16 v[230:231], v29 offset:51272
  ds_read_b64_tr_b16 v[252:253], v32 offset:40960
  ds_read_b64_tr_b16 v[254:255], v32 offset:51200
  s_waitcnt lgkmcnt(0)
  s_waitcnt vmcnt(27)
  s_barrier
  ds_read_b64_tr_b16 v[36:37], v26 offset:61440
  ds_read_b64_tr_b16 v[38:39], v26 offset:62976
  ds_read_b64_tr_b16 v[40:41], v26 offset:61472
  ds_read_b64_tr_b16 v[42:43], v26 offset:63008
  ds_read_b64_tr_b16 v[44:45], v26 offset:61504
  ds_read_b64_tr_b16 v[46:47], v26 offset:63040
  s_waitcnt lgkmcnt(0)
  s_waitcnt vmcnt(24)
  s_barrier
  ds_read_b64_tr_b16 v[48:49], v27 offset:8192
  ds_read_b64_tr_b16 v[50:51], v27 offset:9728
  ds_read_b64_tr_b16 v[52:53], v27 offset:8224
  ds_read_b64_tr_b16 v[54:55], v27 offset:9760
  ds_read_b64_tr_b16 v[56:57], v27 offset:8256
  ds_read_b64_tr_b16 v[58:59], v27 offset:9792
  s_waitcnt lgkmcnt(0)
  s_waitcnt vmcnt(21)
  s_barrier
  ds_read_b64_tr_b16 v[60:61], v27 offset:20480
  ds_read_b64_tr_b16 v[62:63], v27 offset:22016
  ds_read_b64_tr_b16 v[64:65], v27 offset:20512
  ds_read_b64_tr_b16 v[66:67], v27 offset:22048
  ds_read_b64_tr_b16 v[68:69], v27 offset:20544
  ds_read_b64_tr_b16 v[70:71], v27 offset:22080
  s_waitcnt lgkmcnt(0)
  s_waitcnt vmcnt(18)
  s_barrier
  ds_read_b64_tr_b16 v[72:73], v27 offset:32768
  ds_read_b64_tr_b16 v[74:75], v27 offset:34304
  ds_read_b64_tr_b16 v[76:77], v27 offset:32800
  ds_read_b64_tr_b16 v[78:79], v27 offset:34336
  ds_read_b64_tr_b16 v[80:81], v27 offset:32832
  ds_read_b64_tr_b16 v[82:83], v27 offset:34368
  s_waitcnt lgkmcnt(0)
  s_waitcnt vmcnt(15)
  s_barrier
  ds_read_b64_tr_b16 v[84:85], v27 offset:45056
  ds_read_b64_tr_b16 v[86:87], v27 offset:46592
  ds_read_b64_tr_b16 v[88:89], v27 offset:45088
  ds_read_b64_tr_b16 v[90:91], v27 offset:46624
  ds_read_b64_tr_b16 v[92:93], v27 offset:45120
  ds_read_b64_tr_b16 v[94:95], v27 offset:46656
  s_waitcnt lgkmcnt(0)
  s_waitcnt vmcnt(12)
  s_barrier
  ds_read_b64_tr_b16 v[96:97], v27 offset:57344
  ds_read_b64_tr_b16 v[98:99], v27 offset:58880
  ds_read_b64_tr_b16 v[100:101], v27 offset:57376
  ds_read_b64_tr_b16 v[102:103], v27 offset:58912
  ds_read_b64_tr_b16 v[104:105], v27 offset:57408
  ds_read_b64_tr_b16 v[106:107], v27 offset:58944
  s_waitcnt lgkmcnt(0)
  s_waitcnt vmcnt(9)
  s_barrier
  ds_read_b64_tr_b16 v[108:109], v28 offset:4096
  ds_read_b64_tr_b16 v[110:111], v28 offset:5632
  ds_read_b64_tr_b16 v[112:113], v28 offset:4128
  ds_read_b64_tr_b16 v[114:115], v28 offset:5664
  ds_read_b64_tr_b16 v[116:117], v28 offset:4160
  ds_read_b64_tr_b16 v[118:119], v28 offset:5696
  s_waitcnt lgkmcnt(0)
  s_waitcnt vmcnt(6)
  s_barrier
  ds_read_b64_tr_b16 v[120:121], v28 offset:16384
  ds_read_b64_tr_b16 v[122:123], v28 offset:17920
  ds_read_b64_tr_b16 v[124:125], v28 offset:16416
  ds_read_b64_tr_b16 v[126:127], v28 offset:17952
  ds_read_b64_tr_b16 v[128:129], v28 offset:16448
  ds_read_b64_tr_b16 v[130:131], v28 offset:17984
  s_waitcnt lgkmcnt(0)
  s_waitcnt vmcnt(3)
  s_barrier
  ds_read_b64_tr_b16 v[132:133], v26 offset:0
  ds_read_b64_tr_b16 v[134:135], v26 offset:1536
  ds_read_b64_tr_b16 v[136:137], v26 offset:32
  ds_read_b64_tr_b16 v[138:139], v26 offset:1568
  ds_read_b64_tr_b16 v[140:141], v26 offset:64
  ds_read_b64_tr_b16 v[142:143], v26 offset:1600
  s_waitcnt lgkmcnt(0)
  s_waitcnt vmcnt(0)
  s_barrier
  ds_read_b64_tr_b16 v[144:145], v26 offset:12288
  ds_read_b64_tr_b16 v[146:147], v26 offset:13824
  ds_read_b64_tr_b16 v[4:5], v26 offset:12320
  ds_read_b64_tr_b16 v[6:7], v26 offset:13856
  ds_read_b64_tr_b16 v[8:9], v26 offset:12352
  ds_read_b64_tr_b16 v[10:11], v26 offset:13888
  s_waitcnt lgkmcnt(0)
  s_barrier
  s_mul_i32 s46, s3, 30720
  v_lshlrev_b32 v1, 4, v0
  v_add_u32 v2, s46, v1
  ds_write_b128 v2, v[36:39] offset:0
  ds_write_b128 v2, v[40:43] offset:1024
  ds_write_b128 v2, v[44:47] offset:2048
  ds_write_b128 v2, v[48:51] offset:3072
  ds_write_b128 v2, v[52:55] offset:4096
  ds_write_b128 v2, v[56:59] offset:5120
  ds_write_b128 v2, v[60:63] offset:6144
  ds_write_b128 v2, v[64:67] offset:7168
  ds_write_b128 v2, v[68:71] offset:8192
  ds_write_b128 v2, v[72:75] offset:9216
  ds_write_b128 v2, v[76:79] offset:10240
  ds_write_b128 v2, v[80:83] offset:11264
  ds_write_b128 v2, v[84:87] offset:12288
  ds_write_b128 v2, v[88:91] offset:13312
  ds_write_b128 v2, v[92:95] offset:14336
  ds_write_b128 v2, v[96:99] offset:15360
  ds_write_b128 v2, v[100:103] offset:16384
  ds_write_b128 v2, v[104:107] offset:17408
  ds_write_b128 v2, v[108:111] offset:18432
  ds_write_b128 v2, v[112:115] offset:19456
  ds_write_b128 v2, v[116:119] offset:20480
  ds_write_b128 v2, v[120:123] offset:21504
  ds_write_b128 v2, v[124:127] offset:22528
  ds_write_b128 v2, v[128:131] offset:23552
  ds_write_b128 v2, v[132:135] offset:24576
  ds_write_b128 v2, v[136:139] offset:25600
  ds_write_b128 v2, v[140:143] offset:26624
  ds_write_b128 v2, v[144:147] offset:27648
  ds_write_b128 v2, v[4:7] offset:28672
  ds_write_b128 v2, v[8:11] offset:29696
  s_waitcnt lgkmcnt(0)
  v_mov_b32 v10, v2
  v_lshlrev_b32 v2, 3, v0
  v_add_u32 v11, 122880, v1
  s_mov_b32 s12, s18
  s_and_b32 s13, s19, 0xffff
  s_mov_b32 s14, 10240
  s_mov_b32 s15, 0x20000
  s_mov_b32 s48, 0x00ff00ff
  s_mov_b32 s49, 0x00ff00ff
  s_mov_b32 s50, 0x00ff00ff
  s_mov_b32 s51, 0xff00ff00
  v_and_b32 v30, 1, v0
  v_lshlrev_b32 v30, 4, v30
  v_mov_b32 v31, 0x3f80
  v_lshlrev_b32 v30, v30, v31
  v_bfe_u32 v31, v0, 1, 2
  v_cmp_eq_u32 vcc, 0, v31
  s_nop 1
  v_cndmask_b32 v16, 0, v30, vcc
  v_cmp_eq_u32 vcc, 1, v31
  s_nop 1
  v_cndmask_b32 v17, 0, v30, vcc
  v_cmp_eq_u32 vcc, 2, v31
  s_nop 1
  v_cndmask_b32 v18, 0, v30, vcc
  v_cmp_eq_u32 vcc, 3, v31
  s_nop 1
  v_cndmask_b32 v19, 0, v30, vcc
  v_cndmask_b32 v20, 0, v16, s[50:51]
  v_cndmask_b32 v21, 0, v17, s[50:51]
  v_cndmask_b32 v22, 0, v18, s[50:51]
  v_cndmask_b32 v23, 0, v19, s[50:51]
  v_lshrrev_b32 v30, 5, v0
  v_lshlrev_b32 v30, 8, v30
  v_and_b32 v31, 15, v0
  v_lshlrev_b32 v31, 4, v31
  v_add_u32 v30, v30, v31
  s_mul_i32 s46, s3, 2560
  v_add_u32 v30, s46, v30
  v_bfe_u32 v32, v0, 4, 1
  v_lshlrev_b32 v33, 3, v32
  v_add_u32 v4, v30, v33
  v_add_u32 v4, 147456, v4
  s_mul_i32 s46, s42, 20480
  s_add_u32 s46, s46, 11665408
  s_mul_i32 s47, s53, 10240
  s_add_u32 s46, s46, s47
  s_xor_b32 s58, s42, 1
  s_mul_i32 s58, s58, 20480
  s_add_u32 s58, s58, 14811136
  s_add_u32 s58, s58, s47
  s_sub_u32 s58, s58, s46
  v_mul_lo_u32 v32, s58, v32
  v_add_u32 v3, v30, v32
  v_add_u32 v3, s46, v3
  v_lshrrev_b32 v32, 4, v0
  v_mul_u32_u24 v5, 20480, v32
  v_add_u32 v5, v5, v31
  v_bfe_u32 v32, v0, 4, 1
  v_lshlrev_b32 v32, 30, v32
  v_lshrrev_b32 v33, 5, v0
  v_lshlrev_b32 v33, 8, v33
  v_add3_u32 v6, v31, v32, v33
  s_lshl_b32 s46, s3, 12
  s_add_u32 s46, s46, 8192
  v_add_u32 v7, s46, v11
  s_lshl_b32 s46, s3, 10
  v_add_u32 v8, s46, v11
  s_add_u32 s28, s46, 122880
  s_add_u32 s29, s46, 125952
  s_lshl_b32 s30, s3, 12
  s_add_u32 s30, s30, 132096
  s_lshr_b32 s46, s3, 1
  s_lshl_b32 s46, s46, 10
  s_and_b32 s47, s3, 1
  s_lshl_b32 s47, s47, 3
  s_add_u32 s46, s46, s47
  s_add_u32 s59, s46, 38912
  v_add_u32 v9, s59, v11
  s_lshl_b32 s60, s54, 2
  s_add_u32 s60, s60, s3
  s_xor_b32 s61, s60, 4
  s_mul_i32 s60, s60, 5120
  s_add_u32 s60, s60, 4456448
  s_mul_i32 s61, s61, 5120
  s_add_u32 s61, s61, 4456448
  s_mul_i32 s62, s54, 10240
  s_add_u32 s62, s62, 3801088
  s_lshl_b32 s46, s3, 9
  s_add_u32 s63, s62, s46
  s_add_u32 s63, s63, 8192
  s_lshl_b32 s46, s3, 11
  s_add_u32 s62, s62, s46
  s_lshl_b32 s70, s3, 5
  s_add_u32 s70, s70, s43
  s_cmp_ge_u32 s70, 40
  s_cselect_b32 s46, 10240-40*256, 0
  s_lshl_b32 s47, s70, 8
  s_add_u32 s47, s47, s46
  s_mul_i32 s46, s42, 327680
  s_add_u32 s46, s46, s47
  s_add_u32 s64, s46, 3801088
  s_add_u32 s65, s64, 81920
  s_add_u32 s66, s65, 81920
  s_add_u32 s67, s66, 81920
  s_mul_i32 s46, s42, 20480
  s_add_u32 s46, s46, s47
  s_add_u32 s68, s46, 11665408
  s_add_u32 s69, s46, 14811136
  s_mul_i32 s71, s52, 12288
  s_mul_i32 s46, s53, 6144
  s_add_u32 s71, s71, s46
  s_mul_i32 s46, s3, 1536
  s_add_u32 s71, s71, s46
  s_add_u32 s71, s71, 37748736
  s_lshl_b32 s72, s52, 8
  s_lshl_b32 s46, s53, 7
  s_add_u32 s72, s72, s46
  s_lshl_b32 s46, s3, 5
  s_add_u32 s72, s72, s46
  s_add_u32 s72, s72, 794624
  s_mul_i32 s83, s52, 12288
  s_mul_i32 s46, s3, 3072
  s_add_u32 s83, s83, s46
  s_add_u32 s83, s83, 119537664
  s_lshl_b32 s46, s52, 9
  s_lshl_b32 s47, s3, 5
  s_add_u32 s46, s46, s47
  s_add_u32 s94, s46, 1441920
  v_bfe_u32 v30, v0, 2, 2
  v_lshrrev_b32 v31, 4, v0
  v_cmp_eq_u32 vcc, v30, v31
  v_and_b32 v30, 1, v0
  v_lshlrev_b32 v30, 4, v30
  v_mov_b32 v31, 0x3f80
  v_lshlrev_b32 v30, v30, v31
  v_cndmask_b32 v30, 0, v30, vcc
  v_bfe_u32 v31, v0, 1, 1
  v_cmp_eq_u32 vcc, 0, v31
  s_nop 1
  v_cndmask_b32 v14, 0, v30, vcc
  v_cndmask_b32 v15, v30, 0, vcc
  s_mov_b32 s86, 0x00003f80
  s_mov_b32 s87, 0x3f800000
  s_mov_b32 s88, 1037384597
  s_mov_b32 s89, 0xff800000
  s_mov_b32 s56, 0x33333333
  s_mov_b32 s57, 0x33333333
  s_waitcnt vmcnt(0)
  v_readfirstlane_b32 s44, v149
  v_mov_b32 v150, 0
  s_mov_b32 s46, 64
  v_writelane_b32 v150, s46, 1
  s_mov_b32 s46, 128
  v_writelane_b32 v150, s46, 2
  s_mov_b32 s46, 132
  v_writelane_b32 v150, s46, 3
  s_mov_b32 s46, 136
  v_writelane_b32 v150, s46, 4
  s_mov_b32 s46, 192
  v_writelane_b32 v150, s46, 5
  s_mov_b32 s46, 196
  v_writelane_b32 v150, s46, 6
  s_mov_b32 s46, 200
  v_writelane_b32 v150, s46, 7
  s_mov_b32 s46, 140
  v_writelane_b32 v150, s46, 8
  s_mov_b64 exec, 0x1ff
gsF_7:
  buffer_load_dword v151, v150, s[8:11], 0 offen sc1
  s_waitcnt vmcnt(0)
  s_nop 0
  v_readlane_b32 s46, v151, 8
  s_cmp_ge_u32 s46, 256
  s_cbranch_scc1 gsokF_8
  s_add_u32 s45, s45, 1
  s_cmp_gt_u32 s45, 1048576
  s_cbranch_scc1 failcF_5
  s_sleep 4
  s_branch gsF_7
gsokF_8:
  buffer_load_dword v151, v150, s[8:11], 0 offen sc1
  s_waitcnt vmcnt(0)
  s_mov_b64 exec, 0xff
  v_cmp_ne_u32 vcc, 32, v151
  s_mov_b64 exec, -1
  s_cbranch_vccz balF_9
  s_getpc_b64 s[46:47]
pcF_10:
  s_add_u32 s46, s46, L_SAFE-pcF_10
  s_addc_u32 s47, s47, 0
  s_setpc_b64 s[46:47]
balF_9:
  s_mov_b32 s16, 0xffff0000
  s_mov_b32 s17, 0xffff0000
  s_mov_b32 s18, 0
  s_mov_b32 s77, 0
  s_mov_b32 s78, 1
  s_min_u32 s81, s77, 63
  s_add_u32 s82, s77, 56
  s_min_u32 s82, s82, 127
  s_cmp_lt_u32 s77, 8
  s_cselect_b32 s82, s81, s82
  s_lshl_b32 s95, s81, 14
  s_add_u32 s95, s95, s94
  s_sub_u32 s46, s82, s81
  s_lshl_b32 s46, s46, 14
  v_mov_b32 v13, s46
  v_cndmask_b32 v13, v13, 0, s[56:57]
  v_and_b32 v12, 16, v1
  v_lshl_add_u32 v13, v12, 3, v13
  s_mov_b32 s73, s81
  s_mov_b32 s74, s82
  s_mul_i32 s73, s73, 393216
  s_add_u32 s73, s73, s83
  s_mul_i32 s74, s74, 393216
  s_add_u32 s74, s74, s83
fwF_11:
  s_sub_u32 s46, s82, s81
  s_lshl_b32 s46, s46, 14
  v_mov_b32 v13, s46
  v_cndmask_b32 v13, v13, 0, s[56:57]
  v_and_b32 v12, 16, v1
  v_lshl_add_u32 v13, v12, 3, v13
  buffer_load_dword v13, v13, s[4:7], s95 offen sc1
  s_waitcnt vmcnt(0)
  v_cmp_eq_u32 vcc, 0, v13
  s_cbranch_vccz foF_12
  s_add_u32 s45, s45, 1
  s_cmp_gt_u32 s45, 1048576
  s_cbranch_scc1 failcF_5
  s_sleep 2
  s_branch fwF_11
foF_12:
  buffer_load_dwordx4 v[100:103], v1, s[4:7], s73 offen offset:0 sc1
  buffer_load_dwordx4 v[104:107], v1, s[4:7], s73 offen offset:1024 sc1
  buffer_load_dwordx4 v[108:111], v1, s[4:7], s73 offen offset:2048 sc1
  buffer_load_dwordx4 v[112:115], v1, s[4:7], s74 offen offset:0 sc1
  buffer_load_dwordx4 v[116:119], v1, s[4:7], s74 offen offset:1024 sc1
  buffer_load_dwordx4 v[120:123], v1, s[4:7], s74 offen offset:2048 sc1
  s_add_u32 s75, s73, 50331648
  s_add_u32 s76, s74, 50331648
  v_bfe_u32 v30, v1, 4, 3
  v_mul_u32_u24 v30, 1280, v30
  v_lshrrev_b32 v31, 8, v1
  v_lshlrev_b32 v31, 4, v31
  v_add_u32 v30, v30, v31
  s_mul_i32 s46, s53, 640
  s_lshl_b32 s47, s3, 6
  s_add_u32 s46, s46, s47
  v_add_u32 v30, s46, v30
  s_lshl_b32 s46, s3, 10
  v_add_u32 v31, s46, v11
  buffer_load_dwordx4 v[64:67], v30, s[12:15], 0 offen offset:0
  buffer_load_dwordx4 v[68:71], v30, s[12:15], 0 offen offset:256
  buffer_load_dwordx4 v[72:75], v30, s[12:15], 0 offen offset:512
  s_waitcnt vmcnt(0)
  ds_write_b128 v31, v[64:67] offset:24576
  ds_write_b128 v31, v[68:71] offset:28672
  s_cmp_ge_u32 s3, 2
  s_cbranch_scc1 m0F_13
  ds_write_b128 v31, v[72:75] offset:32768
m0F_13:
  s_mov_b64 exec, -1
  v_mov_b32 v0, s89
  s_branch p1F_15
  .p2align 6
stepF_14:
  buffer_load_dwordx4 v[24:27], v3, s[4:7], s80 offen offset:0 sc1
  buffer_load_dwordx4 v[28:31], v3, s[4:7], s80 offen offset:512 sc1
  buffer_load_dwordx4 v[32:35], v3, s[4:7], s80 offen offset:1024 sc1
  buffer_load_dwordx4 v[36:39], v3, s[4:7], s80 offen offset:1536 sc1
  buffer_load_dwordx4 v[40:43], v3, s[4:7], s80 offen offset:2048 sc1
  s_waitcnt vmcnt(0)
bF_17:
  v_mfma_f32_16x16x32_bf16 v[64:67], v[20:23], v[24:27], 0
  v_xor_b32 v12, s79, v24
  v_mfma_f32_16x16x32_bf16 v[68:71], v[20:23], v[28:31], 0
  v_bitop3_b32 v12, v12, v28, s79 bitop3:0xf6
  v_mfma_f32_16x16x32_bf16 v[72:75], v[20:23], v[32:35], 0
  v_bitop3_b32 v12, v12, v32, s79 bitop3:0xf6
  v_mfma_f32_16x16x32_bf16 v[76:79], v[20:23], v[36:39], 0
  v_bitop3_b32 v12, v12, v36, s79 bitop3:0xf6
  v_mfma_f32_16x16x32_bf16 v[80:83], v[20:23], v[40:43], 0
  v_bitop3_b32 v12, v12, v40, s79 bitop3:0xf6
  v_and_b32 v12, 1, v12
  v_cmp_ne_u32 vcc, 0, v12
  s_cbranch_vccnz rtF_18
  v_cvt_pk_bf16_f32 v88, v64, v65
  v_cvt_pk_bf16_f32 v89, v66, v67
  ds_write_b64 v4, v[88:89] offset:0
  v_cvt_pk_bf16_f32 v90, v68, v69
  v_cvt_pk_bf16_f32 v91, v70, v71
  ds_write_b64 v4, v[90:91] offset:512
  v_cvt_pk_bf16_f32 v92, v72, v73
  v_cvt_pk_bf16_f32 v93, v74, v75
  ds_write_b64 v4, v[92:93] offset:1024
  v_cvt_pk_bf16_f32 v94, v76, v77
  v_cvt_pk_bf16_f32 v95, v78, v79
  ds_write_b64 v4, v[94:95] offset:1536
  v_cvt_pk_bf16_f32 v96, v80, v81
  v_cvt_pk_bf16_f32 v97, v82, v83
  ds_write_b64 v4, v[96:97] offset:2048
  s_cmp_eq_u32 s77, 8
  s_cbranch_scc1 p1F_15x
p1F_15:
  s_waitcnt vmcnt(0) lgkmcnt(0)
  s_barrier
  ds_read_b128 v[24:27], v11 offset:24576
  ds_read_b128 v[28:31], v11 offset:25600
  ds_read_b128 v[32:35], v11 offset:26624
  ds_read_b128 v[36:39], v11 offset:27648
  ds_read_b128 v[40:43], v11 offset:28672
  ds_read_b128 v[44:47], v11 offset:29696
  ds_read_b128 v[48:51], v11 offset:30720
  ds_read_b128 v[52:55], v11 offset:31744
  ds_read_b128 v[56:59], v11 offset:32768
  ds_read_b128 v[60:63], v11 offset:33792
  s_waitcnt lgkmcnt(9)
  v_mfma_f32_16x16x32_bf16 v[64:67], a[0:3], v[24:27], 0
  v_mov_b32 v12, 1
  buffer_load_dwordx4 v[124:127], v1, s[4:7], s75 offen offset:0 sc1
  v_mfma_f32_16x16x32_bf16 v[68:71], a[40:43], v[24:27], 0
  s_sub_u32 s46, s72, 8192
  s_waitcnt lgkmcnt(8)
  v_mfma_f32_16x16x32_bf16 v[64:67], a[4:7], v[28:31], v[64:67]
  buffer_store_dword v12, off, s[4:7], s46 sc1
  s_add_u32 s55, s77, 1
  buffer_load_dwordx4 v[128:131], v1, s[4:7], s75 offen offset:1024 sc1
  v_mfma_f32_16x16x32_bf16 v[68:71], a[44:47], v[28:31], v[68:71]
  s_min_u32 s81, s55, 63
  s_waitcnt lgkmcnt(7)
  v_mfma_f32_16x16x32_bf16 v[64:67], a[8:11], v[32:35], v[64:67]
  buffer_load_dwordx4 v[132:135], v1, s[4:7], s75 offen offset:2048 sc1
  v_mfma_f32_16x16x32_bf16 v[68:71], a[48:51], v[32:35], v[68:71]
  s_add_u32 s82, s55, 56
  s_waitcnt lgkmcnt(6)
  v_mfma_f32_16x16x32_bf16 v[64:67], a[12:15], v[36:39], v[64:67]
  s_mov_b32 m0, s28
  s_nop 0
  buffer_load_dwordx4 v1, s[4:7], s76 offen offset:0 sc1 lds
  v_mfma_f32_16x16x32_bf16 v[68:71], a[52:55], v[36:39], v[68:71]
  s_min_u32 s82, s82, 127
  s_waitcnt lgkmcnt(5)
  v_mfma_f32_16x16x32_bf16 v[64:67], a[16:19], v[40:43], v[64:67]
  s_mov_b32 m0, s29
  s_nop 0
  buffer_load_dwordx4 v1, s[4:7], s76 offen offset:1024 sc1 lds
  v_mfma_f32_16x16x32_bf16 v[68:71], a[56:59], v[40:43], v[68:71]
  s_cmp_lt_u32 s55, 8
  s_waitcnt lgkmcnt(4)
  v_mfma_f32_16x16x32_bf16 v[64:67], a[20:23], v[44:47], v[64:67]
  s_mov_b32 m0, s30
  s_nop 0
  buffer_load_dwordx4 v1, s[4:7], s76 offen offset:2048 sc1 lds
  v_mfma_f32_16x16x32_bf16 v[68:71], a[60:63], v[44:47], v[68:71]
  s_cselect_b32 s82, s81, s82
  s_waitcnt lgkmcnt(3)
  v_mfma_f32_16x16x32_bf16 v[64:67], a[24:27], v[48:51], v[64:67]
  s_lshl_b32 s95, s81, 14
  v_mfma_f32_16x16x32_bf16 v[68:71], a[64:67], v[48:51], v[68:71]
  s_add_u32 s95, s95, s94
  s_waitcnt lgkmcnt(2)
  v_mfma_f32_16x16x32_bf16 v[64:67], a[28:31], v[52:55], v[64:67]
  s_sub_u32 s46, s82, s81
  v_mfma_f32_16x16x32_bf16 v[68:71], a[68:71], v[52:55], v[68:71]
  s_lshl_b32 s46, s46, 14
  s_waitcnt lgkmcnt(1)
  v_mfma_f32_16x16x32_bf16 v[64:67], a[32:35], v[56:59], v[64:67]
  v_mov_b32 v13, s46
  v_mfma_f32_16x16x32_bf16 v[68:71], a[72:75], v[56:59], v[68:71]
  v_cndmask_b32 v13, v13, 0, s[56:57]
  s_waitcnt lgkmcnt(0)
  v_mfma_f32_16x16x32_bf16 v[64:67], a[36:39], v[60:63], v[64:67]
  v_and_b32 v12, 16, v1
  v_mfma_f32_16x16x32_bf16 v[68:71], a[76:79], v[60:63], v[68:71]
  v_lshl_add_u32 v13, v12, 3, v13
  v_mfma_f32_16x16x32_bf16 v[72:75], a[80:83], v[24:27], 0
  s_mov_b32 s73, s81
  v_mfma_f32_16x16x32_bf16 v[84:87], a[200:203], v[24:27], 0
  s_mov_b32 s74, s82
  v_mfma_f32_16x16x32_bf16 v[72:75], a[84:87], v[28:31], v[72:75]
  s_mul_i32 s73, s73, 393216
  v_mfma_f32_16x16x32_bf16 v[84:87], a[204:207], v[28:31], v[84:87]
  s_add_u32 s73, s73, s83
  v_mfma_f32_16x16x32_bf16 v[72:75], a[88:91], v[32:35], v[72:75]
  s_mul_i32 s74, s74, 393216
  v_mfma_f32_16x16x32_bf16 v[84:87], a[208:211], v[32:35], v[84:87]
  s_add_u32 s74, s74, s83
  v_mfma_f32_16x16x32_bf16 v[72:75], a[92:95], v[36:39], v[72:75]
  buffer_load_dword v13, v13, s[4:7], s95 offen sc1
  v_mfma_f32_16x16x32_bf16 v[84:87], a[212:215], v[36:39], v[84:87]
  v_cvt_pk_bf16_f32 v148, v64, v65
  v_mfma_f32_16x16x32_bf16 v[72:75], a[96:99], v[40:43], v[72:75]
  v_cvt_pk_bf16_f32 v149, v66, v67
  v_mfma_f32_16x16x32_bf16 v[84:87], a[216:219], v[40:43], v[84:87]
  v_cvt_pk_bf16_f32 v150, v68, v69
  v_mfma_f32_16x16x32_bf16 v[72:75], a[100:103], v[44:47], v[72:75]
  v_cvt_pk_bf16_f32 v151, v70, v71
  v_mfma_f32_16x16x32_bf16 v[84:87], a[220:223], v[44:47], v[84:87]
  v_bfi_b32 v148, 1, s78, v148
  v_mfma_f32_16x16x32_bf16 v[72:75], a[104:107], v[48:51], v[72:75]
  buffer_store_dwordx4 v[148:151], v1, s[4:7], s60 offen offset:1536
  v_mfma_f32_16x16x32_bf16 v[84:87], a[224:227], v[48:51], v[84:87]
  v_mfma_f32_16x16x32_bf16 v[72:75], a[108:111], v[52:55], v[72:75]
  v_mfma_f32_16x16x32_bf16 v[84:87], a[228:231], v[52:55], v[84:87]
  v_mfma_f32_16x16x32_bf16 v[72:75], a[112:115], v[56:59], v[72:75]
  v_mfma_f32_16x16x32_bf16 v[84:87], a[232:235], v[56:59], v[84:87]
  v_mfma_f32_16x16x32_bf16 v[72:75], a[116:119], v[60:63], v[72:75]
  v_mfma_f32_16x16x32_bf16 v[84:87], a[236:239], v[60:63], v[84:87]
  v_mfma_f32_16x16x32_bf16 v[76:79], a[120:123], v[24:27], 0
  v_mfma_f32_16x16x32_bf16 v[80:83], a[160:163], v[24:27], 0
  v_mfma_f32_16x16x32_bf16 v[76:79], a[124:127], v[28:31], v[76:79]
  v_mfma_f32_16x16x32_bf16 v[80:83], a[164:167], v[28:31], v[80:83]
  v_mfma_f32_16x16x32_bf16 v[76:79], a[128:131], v[32:35], v[76:79]
  v_mfma_f32_16x16x32_bf16 v[80:83], a[168:171], v[32:35], v[80:83]
  v_mfma_f32_16x16x32_bf16 v[76:79], a[132:135], v[36:39], v[76:79]
  v_mfma_f32_16x16x32_bf16 v[80:83], a[172:175], v[36:39], v[80:83]
  v_cvt_pk_bf16_f32 v148, v72, v73
  v_mfma_f32_16x16x32_bf16 v[76:79], a[136:139], v[40:43], v[76:79]
  v_cvt_pk_bf16_f32 v149, v74, v75
  v_mfma_f32_16x16x32_bf16 v[80:83], a[176:179], v[40:43], v[80:83]
  v_cvt_pk_bf16_f32 v150, v84, v85
  v_mfma_f32_16x16x32_bf16 v[76:79], a[140:143], v[44:47], v[76:79]
  v_cvt_pk_bf16_f32 v151, v86, v87
  v_mfma_f32_16x16x32_bf16 v[80:83], a[180:183], v[44:47], v[80:83]
  v_bfi_b32 v148, 1, s78, v148
  v_mfma_f32_16x16x32_bf16 v[76:79], a[144:147], v[48:51], v[76:79]
  buffer_store_dwordx4 v[148:151], v1, s[4:7], s60 offen offset:3584
  v_mfma_f32_16x16x32_bf16 v[80:83], a[184:187], v[48:51], v[80:83]
  ds_read_b128 v[24:27], v10 offset:12288
  v_mfma_f32_16x16x32_bf16 v[76:79], a[148:151], v[52:55], v[76:79]
  ds_read_b128 v[28:31], v10 offset:13312
  v_mfma_f32_16x16x32_bf16 v[80:83], a[188:191], v[52:55], v[80:83]
  ds_read_b128 v[32:35], v10 offset:14336
  v_mfma_f32_16x16x32_bf16 v[76:79], a[152:155], v[56:59], v[76:79]
  ds_read_b128 v[36:39], v10 offset:15360
  v_mfma_f32_16x16x32_bf16 v[80:83], a[192:195], v[56:59], v[80:83]
  ds_read_b128 v[136:139], v10 offset:16384
  v_mfma_f32_16x16x32_bf16 v[76:79], a[156:159], v[60:63], v[76:79]
  ds_read_b128 v[140:143], v10 offset:17408
  v_mfma_f32_16x16x32_bf16 v[80:83], a[196:199], v[60:63], v[80:83]
  s_waitcnt lgkmcnt(3)
  v_mfma_f32_16x16x32_bf16 v[88:91], v[40:43], v[24:27], 0
  ds_read_b128 v[24:27], v10 offset:18432
  v_mfma_f32_16x16x32_bf16 v[92:95], v[40:43], v[28:31], 0
  ds_read_b128 v[28:31], v10 offset:19456
  v_mfma_f32_16x16x32_bf16 v[96:99], v[40:43], v[32:35], 0
  ds_read_b128 v[32:35], v10 offset:20480
  v_cvt_pk_bf16_f32 v144, v76, v77
  s_waitcnt lgkmcnt(3)
  v_mfma_f32_16x16x32_bf16 v[88:91], v[44:47], v[36:39], v[88:91]
  ds_read_b128 v[36:39], v10 offset:21504
  v_cvt_pk_bf16_f32 v145, v78, v79
  v_mfma_f32_16x16x32_bf16 v[92:95], v[44:47], v[136:139], v[92:95]
  ds_read_b128 v[136:139], v10 offset:22528
  v_cvt_pk_bf16_f32 v146, v80, v81
  v_mfma_f32_16x16x32_bf16 v[96:99], v[44:47], v[140:143], v[96:99]
  ds_read_b128 v[140:143], v10 offset:23552
  v_cvt_pk_bf16_f32 v147, v82, v83
  s_waitcnt lgkmcnt(3)
  v_mfma_f32_16x16x32_bf16 v[88:91], v[48:51], v[24:27], v[88:91]
  ds_read_b128 v[24:27], v10 offset:24576
  v_bfi_b32 v144, 1, s78, v144
  buffer_load_dwordx4 v[40:43], v1, s[4:7], s61 offen offset:1536 sc1
  v_mfma_f32_16x16x32_bf16 v[92:95], v[48:51], v[28:31], v[92:95]
  ds_read_b128 v[28:31], v10 offset:25600
  buffer_store_dwordx4 v[144:147], v1, s[4:7], s60 offen offset:2560
  buffer_load_dwordx4 v[44:47], v1, s[4:7], s61 offen offset:3584 sc1
  v_mfma_f32_16x16x32_bf16 v[96:99], v[48:51], v[32:35], v[96:99]
  ds_read_b128 v[32:35], v10 offset:26624
  ds_read_b128 v[48:51], v10 offset:27648
  s_waitcnt lgkmcnt(4)
  v_mfma_f32_16x16x32_bf16 v[88:91], v[52:55], v[36:39], v[88:91]
  ds_read_b128 v[36:39], v10 offset:28672
  v_mfma_f32_16x16x32_bf16 v[92:95], v[52:55], v[136:139], v[92:95]
  ds_read_b128 v[136:139], v10 offset:29696
  v_mfma_f32_16x16x32_bf16 v[96:99], v[52:55], v[140:143], v[96:99]
  ds_read_b128 v[52:55], v11 offset:24576
  ds_read_b128 v[140:143], v10 offset:0
  s_waitcnt lgkmcnt(5)
  v_mfma_f32_16x16x32_bf16 v[88:91], v[56:59], v[24:27], v[88:91]
  ds_read_b128 v[24:27], v10 offset:1024
  v_mfma_f32_16x16x32_bf16 v[92:95], v[56:59], v[28:31], v[92:95]
  ds_read_b128 v[28:31], v10 offset:2048
  v_mfma_f32_16x16x32_bf16 v[96:99], v[56:59], v[32:35], v[96:99]
  ds_read_b128 v[32:35], v11 offset:25600
  ds_read_b128 v[56:59], v10 offset:3072
  s_waitcnt lgkmcnt(6)
  v_mfma_f32_16x16x32_bf16 v[88:91], v[60:63], v[48:51], v[88:91]
  ds_read_b128 v[48:51], v10 offset:4096
  v_mfma_f32_16x16x32_bf16 v[92:95], v[60:63], v[36:39], v[92:95]
  ds_read_b128 v[36:39], v10 offset:5120
  v_mfma_f32_16x16x32_bf16 v[96:99], v[60:63], v[136:139], v[96:99]
  ds_read_b128 v[60:63], v11 offset:26624
  ds_read_b128 v[136:139], v10 offset:6144
  s_waitcnt lgkmcnt(6)
  v_mfma_f32_16x16x32_bf16 v[88:91], v[52:55], v[140:143], v[88:91]
  ds_read_b128 v[140:143], v10 offset:7168
  v_mfma_f32_16x16x32_bf16 v[92:95], v[52:55], v[24:27], v[92:95]
  ds_read_b128 v[24:27], v10 offset:8192
  v_mfma_f32_16x16x32_bf16 v[96:99], v[52:55], v[28:31], v[96:99]
  ds_read_b128 v[28:31], v11 offset:27648
  ds_read_b128 v[52:55], v10 offset:9216
  s_waitcnt lgkmcnt(6)
  v_mfma_f32_16x16x32_bf16 v[88:91], v[32:35], v[56:59], v[88:91]
  ds_read_b128 v[56:59], v10 offset:10240
  v_mfma_f32_16x16x32_bf16 v[92:95], v[32:35], v[48:51], v[92:95]
  ds_read_b128 v[48:51], v10 offset:11264
  s_waitcnt vmcnt(0)
bF_19:
  v_bitop3_b32 v12, v40, v44, s78 bitop3:0x7e
  v_and_b32 v12, 1, v12
  v_cmp_ne_u32 vcc, 0, v12
  s_cbranch_vccnz rtF_20
  v_mfma_f32_16x16x16_bf16 v[72:75], v[14:15], v[44:45], v[72:75]
  v_mfma_f32_16x16x16_bf16 v[64:67], v[14:15], v[40:41], v[64:67]
  v_mfma_f32_16x16x16_bf16 v[68:71], v[14:15], v[42:43], v[68:71]
  v_mfma_f32_16x16x32_bf16 v[96:99], v[32:35], v[36:39], v[96:99]
  s_waitcnt lgkmcnt(4)
  v_mfma_f32_16x16x32_bf16 v[88:91], v[60:63], v[136:139], v[88:91]
  v_mfma_f32_16x16x32_bf16 v[92:95], v[60:63], v[140:143], v[92:95]
  v_mfma_f32_16x16x32_bf16 v[96:99], v[60:63], v[24:27], v[96:99]
  s_waitcnt lgkmcnt(0)
  v_mfma_f32_16x16x32_bf16 v[88:91], v[28:31], v[52:55], v[88:91]
  v_cvt_pk_bf16_f32 v72, v72, v73
  v_cvt_pk_bf16_f32 v73, v74, v75
  v_mfma_f32_16x16x32_bf16 v[92:95], v[28:31], v[56:59], v[92:95]
  v_cvt_pk_bf16_f32 v64, v64, v65
  v_cvt_pk_bf16_f32 v65, v66, v67
  v_mfma_f32_16x16x32_bf16 v[96:99], v[28:31], v[48:51], v[96:99]
  v_cvt_pk_bf16_f32 v66, v68, v69
  v_cvt_pk_bf16_f32 v67, v70, v71
  s_nop 1
  v_mfma_f32_16x16x16_bf16 v[28:31], v[108:109], v[72:73], 0
  v_cndmask_b32 v40, v0, 0, s[50:51]
  v_cndmask_b32 v41, v0, 0, s[50:51]
  v_mfma_f32_16x16x16_bf16 v[48:51], v[120:121], v[72:73], 0
  v_cndmask_b32 v42, v0, 0, s[50:51]
  v_cndmask_b32 v43, v0, 0, s[50:51]
  v_mfma_f32_16x16x16_bf16 v[32:35], v[110:111], v[72:73], 0
  buffer_load_dwordx4 v[24:27], v1, s[4:7], s61 offen offset:2560 sc1
  v_xor_b32 v74, 0x1000, v7
  v_xor_b32 v75, 0x2000, v7
  v_mfma_f32_16x16x16_bf16 v[52:55], v[122:123], v[72:73], 0
  v_cvt_pk_bf16_f32 v36, v88, v89
  v_mfma_f32_16x16x16_bf16 v[40:43], v[150:151], v[72:73], v[40:43]
  v_cvt_pk_bf16_f32 v37, v90, v91
  v_mfma_f32_16x16x16_bf16 v[40:43], v[46:47], v[72:73], v[40:43]
  v_cvt_pk_bf16_f32 v38, v92, v93
  v_mfma_f32_16x16x32_bf16 v[28:31], v[100:103], v[64:67], v[28:31]
  v_cvt_pk_bf16_f32 v39, v94, v95
  v_mfma_f32_16x16x32_bf16 v[48:51], v[112:115], v[64:67], v[48:51]
  v_bfi_b32 v36, 1, s78, v36
  v_mfma_f32_16x16x32_bf16 v[32:35], v[104:107], v[64:67], v[32:35]
  buffer_store_dwordx4 v[36:39], v1, s[4:7], s60 offen offset:512
  v_mfma_f32_16x16x32_bf16 v[52:55], v[116:119], v[64:67], v[52:55]
  v_cvt_pk_bf16_f32 v68, v96, v97
  v_mfma_f32_16x16x32_bf16 v[40:43], v[144:147], v[64:67], v[40:43]
  v_cvt_pk_bf16_f32 v69, v98, v99
  v_bfi_b32 v68, 1, s78, v68
  buffer_store_dwordx2 v[68:69], v2, s[4:7], s60 offen
  v_cndmask_b32 v28, v48, v28, s[48:49]
  v_cndmask_b32 v29, v49, v29, s[48:49]
  v_cndmask_b32 v30, v50, v30, s[48:49]
  v_cndmask_b32 v31, v51, v31, s[48:49]
  ds_write_b128 v7, v[28:31]
  v_cndmask_b32 v32, v52, v32, s[48:49]
  v_cndmask_b32 v33, v53, v33, s[48:49]
  v_cndmask_b32 v34, v54, v34, s[48:49]
  v_cndmask_b32 v35, v55, v35, s[48:49]
  ds_write_b128 v7, v[32:35] offset:1024
  s_waitcnt vmcnt(2)
bF_21:
  v_mfma_f32_16x16x32_bf16 v[48:51], v[24:27], v[64:67], v[40:43]
  v_xor_b32 v12, s78, v24
  v_and_b32 v12, 1, v12
  v_cmp_ne_u32 vcc, 0, v12
  s_cbranch_vccnz rtF_22
  s_cmp_eq_u32 s53, 0
  v_xor_b32 v12, 0x3000, v7
  v_cvt_pk_bf16_f32 v56, v88, v89
  v_cvt_pk_bf16_f32 v57, v90, v91
  ds_write_b128 v7, v[48:51] offset:2048
  v_cvt_pk_bf16_f32 v60, v92, v93
  v_cvt_pk_bf16_f32 v61, v94, v95
  v_mfma_f32_16x16x16_bf16 v[76:79], v[14:15], v[24:25], v[76:79]
  v_mfma_f32_16x16x16_bf16 v[80:83], v[14:15], v[26:27], v[80:83]
  v_mfma_f32_16x16x16_bf16 v[84:87], v[14:15], v[46:47], v[84:87]
  s_waitcnt lgkmcnt(0)
  s_barrier
  ds_read_b128 v[100:103], v74 offset:0
  ds_read_b128 v[104:107], v75 offset:0
  ds_read_b128 v[108:111], v12 offset:0
  ds_read_b128 v[112:115], v74 offset:1024
  ds_read_b128 v[116:119], v75 offset:1024
  ds_read_b128 v[120:123], v12 offset:1024
  ds_read_b128 v[40:43], v74 offset:2048
  ds_read_b128 v[52:55], v75 offset:2048
  ds_read_b128 v[64:67], v12 offset:2048
  ds_read_b128 v[136:139], v8
  ds_read_b128 v[140:143], v8 offset:4096
  ds_read_b128 v[144:147], v7 offset:3072
  s_cbranch_scc0 nkF_24
  v_cvt_pk_bf16_f32 v88, v76, v77
  v_cvt_pk_bf16_f32 v89, v78, v79
  v_cvt_pk_bf16_f32 v90, v80, v81
  v_cvt_pk_bf16_f32 v91, v82, v83
  v_cvt_pk_bf16_f32 v92, v84, v85
  v_cvt_pk_bf16_f32 v93, v86, v87
nkF_24:
  v_mov_b32 v150, s88
  buffer_load_dwordx4 v[36:39], v1, s[4:7], s61 offen offset:512 sc1
  buffer_load_dwordx2 v[70:71], v2, s[4:7], s61 offen sc1
  s_waitcnt lgkmcnt(9)
  v_pk_add_f32 v[100:101], v[100:101], v[104:105]
  v_pk_add_f32 v[28:29], v[28:29], v[108:109]
  v_pk_add_f32 v[102:103], v[102:103], v[106:107]
  v_pk_add_f32 v[30:31], v[30:31], v[110:111]
  v_pk_add_f32 v[28:29], v[28:29], v[100:101]
  v_pk_add_f32 v[30:31], v[30:31], v[102:103]
  s_waitcnt lgkmcnt(6)
  v_pk_add_f32 v[112:113], v[112:113], v[116:117]
  v_pk_add_f32 v[32:33], v[32:33], v[120:121]
  v_pk_add_f32 v[114:115], v[114:115], v[118:119]
  v_pk_add_f32 v[34:35], v[34:35], v[122:123]
  v_pk_add_f32 v[32:33], v[32:33], v[112:113]
  v_pk_add_f32 v[34:35], v[34:35], v[114:115]
  v_max3_f32 v148, v28, v29, v30
  v_max3_f32 v149, v31, v32, v33
  v_max3_f32 v148, v148, v34, v35
  s_waitcnt lgkmcnt(3)
  v_pk_add_f32 v[40:41], v[40:41], v[52:53]
  v_pk_add_f32 v[48:49], v[48:49], v[64:65]
  v_pk_add_f32 v[42:43], v[42:43], v[54:55]
  v_pk_add_f32 v[50:51], v[50:51], v[66:67]
  v_pk_add_f32 v[48:49], v[48:49], v[40:41]
  v_pk_add_f32 v[50:51], v[50:51], v[42:43]
  v_max3_f32 v149, v149, v48, v49
  v_max3_f32 v148, v148, v50, v51
  v_max_f32 v148, v148, v149
  v_cmp_eq_u32 vcc, 0, v13
  s_cbranch_vccnz kwF_25
koF_26:
  v_mov_b32 v149, v148
  buffer_load_dwordx4 v[100:103], v1, s[4:7], s73 offen offset:0 sc1
  s_nop 0
  v_permlane16_swap_b32 v148, v149
  v_max_f32 v148, v148, v149
  v_mov_b32 v149, v148
  buffer_load_dwordx4 v[104:107], v1, s[4:7], s73 offen offset:1024 sc1
  s_nop 0
  v_permlane32_swap_b32 v148, v149
  v_max_f32 v148, v148, v149
  v_mul_f32 v148, s88, v148
  v_pk_fma_f32 v[28:29], v[28:29], v[150:151], v[148:149] op_sel_hi:[1,0,0] neg_lo:[0,0,1] neg_hi:[0,0,1]
  v_pk_fma_f32 v[30:31], v[30:31], v[150:151], v[148:149] op_sel_hi:[1,0,0] neg_lo:[0,0,1] neg_hi:[0,0,1]
  v_pk_fma_f32 v[32:33], v[32:33], v[150:151], v[148:149] op_sel_hi:[1,0,0] neg_lo:[0,0,1] neg_hi:[0,0,1]
  v_pk_fma_f32 v[34:35], v[34:35], v[150:151], v[148:149] op_sel_hi:[1,0,0] neg_lo:[0,0,1] neg_hi:[0,0,1]
  v_pk_fma_f32 v[48:49], v[48:49], v[150:151], v[148:149] op_sel_hi:[1,0,0] neg_lo:[0,0,1] neg_hi:[0,0,1]
  v_pk_fma_f32 v[50:51], v[50:51], v[150:151], v[148:149] op_sel_hi:[1,0,0] neg_lo:[0,0,1] neg_hi:[0,0,1]
  v_exp_f32 v28, v28
  buffer_load_dwordx4 v[108:111], v1, s[4:7], s73 offen offset:2048 sc1
  v_exp_f32 v29, v29
  v_exp_f32 v30, v30
  v_exp_f32 v31, v31
  v_exp_f32 v32, v32
  v_exp_f32 v33, v33
  v_exp_f32 v34, v34
  buffer_load_dwordx4 v[112:115], v1, s[4:7], s74 offen offset:0 sc1
  v_exp_f32 v35, v35
  v_exp_f32 v48, v48
  v_cvt_pk_bf16_f32 v64, v28, v29
  v_cvt_pk_bf16_f32 v65, v30, v31
  v_cvt_pk_bf16_f32 v66, v32, v33
  v_cvt_pk_bf16_f32 v67, v34, v35
  v_cndmask_b32 v76, 0, v64, s[48:49]
  v_cndmask_b32 v77, 0, v65, s[48:49]
  v_cndmask_b32 v78, 0, v66, s[48:49]
  v_cndmask_b32 v79, 0, v67, s[48:49]
  v_cndmask_b32 v80, v64, 0, s[48:49]
  v_cndmask_b32 v81, v65, 0, s[48:49]
  v_mfma_f32_16x16x32_bf16 v[24:27], v[124:127], v[76:79], 0
  v_cndmask_b32 v82, v66, 0, s[48:49]
  v_cndmask_b32 v83, v67, 0, s[48:49]
  v_mfma_f32_16x16x32_bf16 v[52:55], v[128:131], v[76:79], 0
  v_exp_f32 v49, v49
  v_exp_f32 v50, v50
  v_mfma_f32_16x16x32_bf16 v[44:47], v[132:135], v[76:79], 0
  v_exp_f32 v51, v51
  v_cvt_pk_bf16_f32 v84, v48, v49
  s_waitcnt lgkmcnt(0)
  v_mfma_f32_16x16x32_bf16 v[24:27], v[136:139], v[80:83], v[24:27]
  v_cvt_pk_bf16_f32 v86, v48, v49
  v_cvt_pk_bf16_f32 v85, v50, v51
  v_mfma_f32_16x16x32_bf16 v[52:55], v[140:143], v[80:83], v[52:55]
  v_cvt_pk_bf16_f32 v87, v50, v51
  buffer_load_dwordx4 v[116:119], v1, s[4:7], s74 offen offset:1024 sc1
  s_waitcnt vmcnt(5)
  v_mfma_f32_16x16x32_bf16 v[44:47], v[144:147], v[80:83], v[44:47]
bF_27:
  v_bitop3_b32 v12, v36, v70, s78 bitop3:0x7e
  v_and_b32 v12, 1, v12
  v_cmp_ne_u32 vcc, 0, v12
  s_cbranch_vccnz rtF_28
  v_mov_b32 v58, v36
  v_mov_b32 v59, v37
  v_mfma_f32_16x16x32_bf16 v[44:47], v[68:71], v[84:87], v[44:47]
  v_mov_b32 v62, v38
  v_mov_b32 v63, v39
  buffer_load_dwordx4 v[120:123], v1, s[4:7], s74 offen offset:2048 sc1
  v_mfma_f32_16x16x32_bf16 v[24:27], v[56:59], v[84:87], v[24:27]
  s_cmp_eq_u32 s77, 71
  s_cbranch_scc1 cendF_16
  v_mfma_f32_16x16x32_bf16 v[52:55], v[60:63], v[84:87], v[52:55]
  s_cmp_eq_u32 s53, 1
  v_add_f32 v148, v28, v30
  v_add_f32 v149, v29, v31
  v_add_f32 v150, v32, v34
  v_add_f32 v151, v33, v35
  v_pk_add_f32 v[148:149], v[148:149], v[48:49]
  v_pk_add_f32 v[150:151], v[150:151], v[50:51]
  v_pk_add_f32 v[148:149], v[148:149], v[150:151]
  v_add_f32 v148, v148, v149
  v_cvt_pk_bf16_f32 v32, v44, v45
  v_cvt_pk_bf16_f32 v33, v46, v47
  ds_write_b64 v9, v[32:33]
  v_cvt_pk_bf16_f32 v28, v24, v25
  v_cvt_pk_bf16_f32 v29, v26, v27
  v_cvt_pk_bf16_f32 v30, v52, v53
  v_cvt_pk_bf16_f32 v31, v54, v55
  ds_write_b128 v8, v[28:31] offset:34816
  s_cbranch_scc0 nvF_29
  v_mfma_f32_16x16x16_bf16 v[88:91], v[14:15], v[58:59], v[88:91]
  v_mfma_f32_16x16x16_bf16 v[92:95], v[14:15], v[62:63], v[92:95]
  v_mfma_f32_16x16x16_bf16 v[96:99], v[14:15], v[70:71], v[96:99]
nvF_29:
  s_waitcnt lgkmcnt(0)
  s_barrier
  ds_read_b128 v[28:31], v11 offset:34816
  ds_read_b128 v[32:35], v11 offset:35840
  ds_read_b128 v[36:39], v11 offset:36864
  ds_read_b128 v[40:43], v11 offset:37888
  ds_read_b128 v[48:51], v11 offset:38912
  ds_read_b128 v[56:59], v11 offset:39936
  s_cbranch_scc0 nvF_30
  v_cvt_pk_bf16_f32 v88, v88, v89
  v_cvt_pk_bf16_f32 v89, v90, v91
  v_cvt_pk_bf16_f32 v90, v92, v93
  v_cvt_pk_bf16_f32 v91, v94, v95
  v_cvt_pk_bf16_f32 v92, v96, v97
  v_cvt_pk_bf16_f32 v93, v98, v99
nvF_30:
  s_waitcnt lgkmcnt(5)
  v_mfma_f32_16x16x32_bf16 v[64:67], a[240:243], v[28:31], 0
  v_mov_b32 v149, v148
  v_mfma_f32_16x16x32_bf16 v[68:71], v[160:163], v[28:31], 0
  s_nop 0
  s_waitcnt lgkmcnt(4)
  v_mfma_f32_16x16x32_bf16 v[64:67], a[244:247], v[32:35], v[64:67]
  v_permlane16_swap_b32 v148, v149
  v_mfma_f32_16x16x32_bf16 v[68:71], v[164:167], v[32:35], v[68:71]
  v_add_f32 v148, v148, v149
  s_waitcnt lgkmcnt(3)
  v_mfma_f32_16x16x32_bf16 v[64:67], a[248:251], v[36:39], v[64:67]
  v_mov_b32 v149, v148
  v_mfma_f32_16x16x32_bf16 v[68:71], v[168:171], v[36:39], v[68:71]
  s_nop 0
  s_waitcnt lgkmcnt(2)
  v_mfma_f32_16x16x32_bf16 v[64:67], a[252:255], v[40:43], v[64:67]
  v_permlane32_swap_b32 v148, v149
  v_mfma_f32_16x16x32_bf16 v[68:71], v[172:175], v[40:43], v[68:71]
  v_add_f32 v148, v148, v149
  s_waitcnt lgkmcnt(1)
  v_mfma_f32_16x16x32_bf16 v[64:67], v[152:155], v[48:51], v[64:67]
  v_rcp_f32 v148, v148
  v_mfma_f32_16x16x32_bf16 v[68:71], v[176:179], v[48:51], v[68:71]
  s_waitcnt lgkmcnt(0)
  v_mfma_f32_16x16x32_bf16 v[64:67], v[156:159], v[56:59], v[64:67]
  v_mfma_f32_16x16x32_bf16 v[68:71], v[180:183], v[56:59], v[68:71]
  v_mfma_f32_16x16x32_bf16 v[80:83], v[232:235], v[28:31], 0
  s_mov_b32 s79, 1
  v_mfma_f32_16x16x32_bf16 v[80:83], v[236:239], v[32:35], v[80:83]
  s_nop 0
  v_mfma_f32_16x16x32_bf16 v[80:83], v[240:243], v[36:39], v[80:83]
  s_nop 0
  s_nop 0
  v_mul_f32 v64, v64, v148
  v_mul_f32 v65, v65, v148
  v_mfma_f32_16x16x32_bf16 v[80:83], v[244:247], v[40:43], v[80:83]
  s_mul_i32 s80, s77, 40960
  v_mul_f32 v66, v66, v148
  v_mul_f32 v67, v67, v148
  v_mfma_f32_16x16x32_bf16 v[80:83], v[248:251], v[48:51], v[80:83]
  s_add_u32 s84, s69, s80
  v_mul_f32 v68, v68, v148
  v_mul_f32 v69, v69, v148
  v_mfma_f32_16x16x32_bf16 v[80:83], v[252:255], v[56:59], v[80:83]
  s_add_u32 s85, s68, s80
  v_mul_f32 v70, v70, v148
  v_mul_f32 v71, v71, v148
  v_mfma_f32_16x16x32_bf16 v[72:75], v[184:187], v[28:31], 0
  v_cvt_pk_bf16_f32 v24, v64, v65
  v_cvt_pk_bf16_f32 v25, v66, v67
  v_mfma_f32_16x16x32_bf16 v[76:79], v[208:211], v[28:31], 0
  v_cvt_pk_bf16_f32 v26, v68, v69
  v_mfma_f32_16x16x32_bf16 v[72:75], v[188:191], v[32:35], v[72:75]
  v_cvt_pk_bf16_f32 v27, v70, v71
  v_bfi_b32 v24, 1, s78, v24
  v_mfma_f32_16x16x32_bf16 v[76:79], v[212:215], v[32:35], v[76:79]
  buffer_store_dwordx4 v[24:27], v1, s[4:7], s62 offen offset:0
  v_mfma_f32_16x16x32_bf16 v[72:75], v[192:195], v[36:39], v[72:75]
  v_mul_f32 v80, v80, v148
  v_mul_f32 v81, v81, v148
  v_mfma_f32_16x16x32_bf16 v[76:79], v[216:219], v[36:39], v[76:79]
  v_mul_f32 v82, v82, v148
  v_mfma_f32_16x16x32_bf16 v[72:75], v[196:199], v[40:43], v[72:75]
  v_mul_f32 v83, v83, v148
  v_cvt_pk_bf16_f32 v54, v80, v81
  v_mfma_f32_16x16x32_bf16 v[76:79], v[220:223], v[40:43], v[76:79]
  v_cvt_pk_bf16_f32 v55, v82, v83
  v_cvt_pk_bf16_f32 v52, v80, v81
  v_mfma_f32_16x16x32_bf16 v[72:75], v[200:203], v[48:51], v[72:75]
  v_cvt_pk_bf16_f32 v53, v82, v83
  v_permlane16_swap_b32 v52, v54
  v_mfma_f32_16x16x32_bf16 v[76:79], v[224:227], v[48:51], v[76:79]
  v_permlane16_swap_b32 v53, v55
  v_bfi_b32 v52, 1, s78, v52
  v_mfma_f32_16x16x32_bf16 v[72:75], v[204:207], v[56:59], v[72:75]
  buffer_store_dwordx4 v[52:55], v6, s[4:7], s63 offen
  v_mfma_f32_16x16x32_bf16 v[76:79], v[228:231], v[56:59], v[76:79]
  s_cmp_ge_u32 s70, 80
  s_nop 5
  v_pk_mul_f32 v[72:73], v[72:73], v[148:149] op_sel_hi:[1,0]
  v_pk_mul_f32 v[74:75], v[74:75], v[148:149] op_sel_hi:[1,0]
  v_pk_mul_f32 v[76:77], v[76:77], v[148:149] op_sel_hi:[1,0]
  v_pk_mul_f32 v[78:79], v[78:79], v[148:149] op_sel_hi:[1,0]
  v_cvt_pk_bf16_f32 v44, v72, v73
  v_cvt_pk_bf16_f32 v45, v74, v75
  v_cvt_pk_bf16_f32 v46, v76, v77
  v_cvt_pk_bf16_f32 v47, v78, v79
  v_bfi_b32 v44, 1, s78, v44
  buffer_store_dwordx4 v[44:47], v1, s[4:7], s62 offen offset:1024
  s_cbranch_scc1 nrF_31
  s_sleep 5
  buffer_load_dwordx4 v[28:31], v5, s[4:7], s64 offen sc1
  buffer_load_dwordx4 v[32:35], v5, s[4:7], s65 offen sc1
  buffer_load_dwordx4 v[36:39], v5, s[4:7], s66 offen sc1
  buffer_load_dwordx4 v[40:43], v5, s[4:7], s67 offen sc1
  s_waitcnt vmcnt(0)
saF_32:
  v_mfma_f32_16x16x32_bf16 v[84:87], v[16:19], v[28:31], 0
  v_bitop3_b32 v12, v28, v32, s78 bitop3:0x7e
  v_mfma_f32_16x16x32_bf16 v[84:87], v[16:19], v[32:35], v[84:87]
  v_bitop3_b32 v12, v12, v36, s78 bitop3:0xf6
  v_mfma_f32_16x16x32_bf16 v[84:87], v[16:19], v[36:39], v[84:87]
  v_bitop3_b32 v12, v12, v40, s78 bitop3:0xf6
  v_mfma_f32_16x16x32_bf16 v[84:87], v[16:19], v[40:43], v[84:87]
  v_and_b32 v12, 1, v12
  v_cmp_ne_u32 vcc, 0, v12
  s_cbranch_vccnz sbF_33
  s_nop 4
  v_cvt_pk_bf16_f32 v150, v84, v85
  v_cvt_pk_bf16_f32 v151, v86, v87
  v_cvt_pk_bf16_f32 v148, v84, v85
  v_cvt_pk_bf16_f32 v149, v86, v87
  s_mov_b32 exec_hi, 0
  v_permlane16_swap_b32 v148, v150
  v_permlane16_swap_b32 v149, v151
  v_bfi_b32 v148, 1, s79, v148
  buffer_store_dwordx4 v[148:151], v6, s[4:7], s84 offen sc1
  buffer_store_dwordx4 v[148:151], v6, s[4:7], s85 offen
  s_mov_b32 exec_hi, -1
  s_barrier
  buffer_store_dwordx4 v[88:91], v1, s[4:7], s71 offen sc1
  buffer_store_dwordx2 v[92:93], v2, s[4:7], s71 offen offset:1024 sc1
  s_add_u32 s75, s73, 50331648
  s_add_u32 s76, s74, 50331648
  s_mov_b32 s77, s55
  s_xor_b32 s78, s78, 1
  s_add_u32 s71, s71, 393216
  s_add_u32 s72, s72, 8192
  s_sleep 10
  s_branch stepF_14
nrF_31:
  s_waitcnt vmcnt(3)
  s_barrier
  buffer_store_dwordx4 v[88:91], v1, s[4:7], s71 offen sc1
  buffer_store_dwordx2 v[92:93], v2, s[4:7], s71 offen offset:1024 sc1
  s_add_u32 s75, s73, 50331648
  s_add_u32 s76, s74, 50331648
  s_mov_b32 s77, s55
  s_xor_b32 s78, s78, 1
  s_add_u32 s71, s71, 393216
  s_add_u32 s72, s72, 8192
  s_sleep 10
  s_branch stepF_14
p1F_15x:
  s_waitcnt vmcnt(0) lgkmcnt(0)
  s_barrier
  v_bfe_u32 v30, v1, 4, 3
  v_mul_u32_u24 v30, 1280, v30
  v_lshrrev_b32 v31, 8, v1
  v_lshlrev_b32 v31, 4, v31
  v_add_u32 v30, v30, v31
  s_mul_i32 s46, s53, 640
  s_lshl_b32 s47, s3, 6
  s_add_u32 s46, s46, s47
  v_add_u32 v30, s46, v30
  s_lshl_b32 s46, s3, 10
  v_add_u32 v31, s46, v11
  buffer_load_dwordx4 v[64:67], v30, s[12:15], 0 offen offset:0
  buffer_load_dwordx4 v[68:71], v30, s[12:15], 0 offen offset:256
  buffer_load_dwordx4 v[72:75], v30, s[12:15], 0 offen offset:512
  s_waitcnt vmcnt(0)
  s_mov_b32 exec_lo, 0xff00ff00
  s_mov_b32 exec_hi, 0xff00ff00
  ds_write_b128 v31, v[64:67] offset:24576
  ds_write_b128 v31, v[68:71] offset:28672
  s_cmp_ge_u32 s3, 2
  s_cbranch_scc1 m0F_39
  ds_write_b128 v31, v[72:75] offset:32768
m0F_39:
  s_mov_b64 exec, -1
  s_branch p1F_15
kwF_25:
fwF_40:
  s_sub_u32 s46, s82, s81
  s_lshl_b32 s46, s46, 14
  v_mov_b32 v13, s46
  v_cndmask_b32 v13, v13, 0, s[56:57]
  v_and_b32 v12, 16, v1
  v_lshl_add_u32 v13, v12, 3, v13
  buffer_load_dword v13, v13, s[4:7], s95 offen sc1
  s_waitcnt vmcnt(0)
  v_cmp_eq_u32 vcc, 0, v13
  s_cbranch_vccz foF_41
  s_add_u32 s45, s45, 1
  s_cmp_gt_u32 s45, 1048576
  s_cbranch_scc1 failcF_5
  s_sleep 1
  s_branch fwF_40
foF_41:
  s_branch koF_26
sbF_33:
  s_mov_b64 exec, vcc
  buffer_load_dwordx4 v[28:31], v5, s[4:7], s64 offen sc1
  buffer_load_dwordx4 v[32:35], v5, s[4:7], s65 offen sc1
  buffer_load_dwordx4 v[36:39], v5, s[4:7], s66 offen sc1
  buffer_load_dwordx4 v[40:43], v5, s[4:7], s67 offen sc1
  s_mov_b64 exec, -1
  s_add_u32 s45, s45, 1
  s_cmp_gt_u32 s45, 1048576
  s_cbranch_scc1 failcF_5
  s_mov_b32 s18, 1
  s_waitcnt vmcnt(0)
  s_branch saF_32
rtF_18:
  s_mov_b64 exec, vcc
  buffer_load_dwordx4 v[24:27], v3, s[4:7], s80 offen offset:0 sc1
  buffer_load_dwordx4 v[28:31], v3, s[4:7], s80 offen offset:512 sc1
  buffer_load_dwordx4 v[32:35], v3, s[4:7], s80 offen offset:1024 sc1
  buffer_load_dwordx4 v[36:39], v3, s[4:7], s80 offen offset:1536 sc1
  buffer_load_dwordx4 v[40:43], v3, s[4:7], s80 offen offset:2048 sc1
  s_mov_b64 exec, -1
  s_add_u32 s45, s45, 1
  s_cmp_gt_u32 s45, 1048576
  s_cbranch_scc1 failcF_5
  s_waitcnt vmcnt(0)
  s_branch bF_17
rtF_20:
  s_mov_b64 exec, vcc
  buffer_load_dwordx4 v[40:43], v1, s[4:7], s61 offen offset:1536 sc1
  buffer_load_dwordx4 v[44:47], v1, s[4:7], s61 offen offset:3584 sc1
  s_mov_b64 exec, -1
  s_add_u32 s45, s45, 1
  s_cmp_gt_u32 s45, 1048576
  s_cbranch_scc1 failcF_5
  s_waitcnt vmcnt(0)
  s_branch bF_19
rtF_22:
  s_mov_b64 exec, vcc
  buffer_load_dwordx4 v[24:27], v1, s[4:7], s61 offen offset:2560 sc1
  s_mov_b64 exec, -1
  s_add_u32 s45, s45, 1
  s_cmp_gt_u32 s45, 1048576
  s_cbranch_scc1 failcF_5
  s_waitcnt vmcnt(0)
  s_branch bF_21
rtF_28:
  s_mov_b64 exec, vcc
  buffer_load_dwordx4 v[36:39], v1, s[4:7], s61 offen offset:512 sc1
  buffer_load_dwordx2 v[70:71], v2, s[4:7], s61 offen sc1
  s_mov_b64 exec, -1
  s_add_u32 s45, s45, 1
  s_cmp_gt_u32 s45, 1048576
  s_cbranch_scc1 failcF_5
  s_waitcnt vmcnt(0)
  s_branch bF_27
cendF_16:
  s_cmp_eq_u32 s53, 1
  s_cbranch_scc0 nvF_42
  v_mfma_f32_16x16x16_bf16 v[88:91], v[14:15], v[58:59], v[88:91]
  v_mfma_f32_16x16x16_bf16 v[92:95], v[14:15], v[62:63], v[92:95]
  v_mfma_f32_16x16x16_bf16 v[96:99], v[14:15], v[70:71], v[96:99]
  s_nop 7
  v_cvt_pk_bf16_f32 v88, v88, v89
  v_cvt_pk_bf16_f32 v89, v90, v91
  v_cvt_pk_bf16_f32 v90, v92, v93
  v_cvt_pk_bf16_f32 v91, v94, v95
  v_cvt_pk_bf16_f32 v92, v96, v97
  v_cvt_pk_bf16_f32 v93, v98, v99
nvF_42:
  buffer_store_dwordx4 v[88:91], v1, s[4:7], s71 offen sc1
  buffer_store_dwordx2 v[92:93], v2, s[4:7], s71 offen offset:1024 sc1
  s_waitcnt vmcnt(0)
  v_mov_b32 v12, 1
  buffer_store_dword v12, off, s[4:7], s72 sc1
  s_endpgm
failcF_5:
  s_mov_b64 exec, 1
  v_mov_b32 v150, 224
  v_mov_b32 v151, 1
  buffer_atomic_or v151, v150, s[8:11], 0 offen sc1
  s_endpgm
  .p2align 6
R_attF:
  s_sub_u32 s52, s42, 2
  s_waitcnt vmcnt(0)
  s_barrier
  s_cmp_eq_u32 s3, 0
  s_cbranch_scc0 arrF_44
  s_mov_b64 exec, 1
  v_mov_b32 v150, 140
  v_mov_b32 v149, 1
  buffer_atomic_add v149, v150, s[8:11], 0 offen sc0 sc1
  s_mov_b64 exec, -1
arrF_44:
  s_lshl_b32 s53, s43, 1
  s_add_u32 s53, s53, s52
  s_mul_i32 s54, s53, 40960
  s_mul_i32 s46, s3, 10240
  s_add_u32 s54, s54, s46
  v_mul_u32_u24 v1, 20, v0
  s_add_u32 s46, s54, 0
  buffer_load_dwordx4 v[8:11], v1, s[12:15], s46 offen
  buffer_load_dword v12, v1, s[12:15], s46 offen offset:16
  s_add_u32 s46, s54, 1280
  buffer_load_dwordx4 v[14:17], v1, s[12:15], s46 offen
  buffer_load_dword v18, v1, s[12:15], s46 offen offset:16
  s_add_u32 s46, s54, 2560
  buffer_load_dwordx4 v[20:23], v1, s[12:15], s46 offen
  buffer_load_dword v24, v1, s[12:15], s46 offen offset:16
  s_add_u32 s46, s54, 3840
  buffer_load_dwordx4 v[26:29], v1, s[12:15], s46 offen
  buffer_load_dword v30, v1, s[12:15], s46 offen offset:16
  s_add_u32 s46, s54, 5120
  buffer_load_dwordx4 v[32:35], v1, s[12:15], s46 offen
  buffer_load_dword v36, v1, s[12:15], s46 offen offset:16
  s_add_u32 s46, s54, 6400
  buffer_load_dwordx4 v[38:41], v1, s[12:15], s46 offen
  buffer_load_dword v42, v1, s[12:15], s46 offen offset:16
  s_add_u32 s46, s54, 7680
  buffer_load_dwordx4 v[44:47], v1, s[12:15], s46 offen
  buffer_load_dword v48, v1, s[12:15], s46 offen offset:16
  s_add_u32 s46, s54, 8960
  buffer_load_dwordx4 v[50:53], v1, s[12:15], s46 offen
  buffer_load_dword v54, v1, s[12:15], s46 offen offset:16
  s_waitcnt vmcnt(14)
  v_lshlrev_b32 v60, 16, v8
  v_and_b32 v61, 0xffff0000, v8
  v_lshlrev_b32 v62, 16, v9
  v_and_b32 v63, 0xffff0000, v9
  v_lshlrev_b32 v64, 16, v10
  v_and_b32 v65, 0xffff0000, v10
  v_lshlrev_b32 v66, 16, v11
  v_and_b32 v67, 0xffff0000, v11
  v_lshlrev_b32 v68, 16, v12
  v_and_b32 v69, 0xffff0000, v12
  v_add_f32 v70, v60, v61
  v_add_f32 v70, v70, v62
  v_add_f32 v70, v70, v63
  v_add_f32 v70, v70, v64
  v_add_f32 v70, v70, v65
  v_add_f32 v70, v70, v66
  v_add_f32 v70, v70, v67
  v_add_f32 v70, v70, v68
  v_add_f32 v70, v70, v69
  s_nop 1
  v_add_f32_dpp v70, v70, v70 quad_perm:[1,0,3,2] row_mask:0xf bank_mask:0xf
  s_nop 1
  v_add_f32_dpp v70, v70, v70 quad_perm:[2,3,0,1] row_mask:0xf bank_mask:0xf
  s_nop 1
  v_add_f32_dpp v70, v70, v70 row_half_mirror row_mask:0xf bank_mask:0xf
  s_nop 1
  v_add_f32_dpp v70, v70, v70 row_mirror row_mask:0xf bank_mask:0xf
  v_mov_b32 v72, v70
  s_nop 1
  v_permlane16_swap_b32 v70, v72
  v_add_f32 v70, v70, v72
  v_mov_b32 v72, v70
  s_nop 1
  v_permlane32_swap_b32 v70, v72
  v_add_f32 v70, v70, v72
  v_mul_f32 v70, 0x3acccccd, v70
  v_sub_f32 v80, v60, v70
  v_sub_f32 v81, v61, v70
  v_sub_f32 v82, v62, v70
  v_sub_f32 v83, v63, v70
  v_sub_f32 v84, v64, v70
  v_sub_f32 v85, v65, v70
  v_sub_f32 v86, v66, v70
  v_sub_f32 v87, v67, v70
  v_sub_f32 v88, v68, v70
  v_sub_f32 v89, v69, v70
  v_mul_f32 v71, v80, v80
  v_fmac_f32 v71, v81, v81
  v_fmac_f32 v71, v82, v82
  v_fmac_f32 v71, v83, v83
  v_fmac_f32 v71, v84, v84
  v_fmac_f32 v71, v85, v85
  v_fmac_f32 v71, v86, v86
  v_fmac_f32 v71, v87, v87
  v_fmac_f32 v71, v88, v88
  v_fmac_f32 v71, v89, v89
  s_nop 1
  v_add_f32_dpp v71, v71, v71 quad_perm:[1,0,3,2] row_mask:0xf bank_mask:0xf
  s_nop 1
  v_add_f32_dpp v71, v71, v71 quad_perm:[2,3,0,1] row_mask:0xf bank_mask:0xf
  s_nop 1
  v_add_f32_dpp v71, v71, v71 row_half_mirror row_mask:0xf bank_mask:0xf
  s_nop 1
  v_add_f32_dpp v71, v71, v71 row_mirror row_mask:0xf bank_mask:0xf
  v_mov_b32 v72, v71
  s_nop 1
  v_permlane16_swap_b32 v71, v72
  v_add_f32 v71, v71, v72
  v_mov_b32 v72, v71
  s_nop 1
  v_permlane32_swap_b32 v71, v72
  v_add_f32 v71, v71, v72
  v_mul_f32 v71, 0x3acccccd, v71
  v_cvt_pk_bf16_f32 v70, v70, v70
  v_and_b32 v70, 0xffff0000, v70
  v_cvt_pk_bf16_f32 v71, v71, v71
  v_and_b32 v71, 0xffff0000, v71
  v_add_f32 v71, 0x3727c5ac, v71
  v_cvt_pk_bf16_f32 v71, v71, v71
  v_and_b32 v71, 0xffff0000, v71
  v_pk_add_f32 v[60:61], v[60:61], v[70:71] op_sel_hi:[1,0] neg_lo:[0,1] neg_hi:[0,1]
  v_pk_add_f32 v[62:63], v[62:63], v[70:71] op_sel_hi:[1,0] neg_lo:[0,1] neg_hi:[0,1]
  v_pk_add_f32 v[64:65], v[64:65], v[70:71] op_sel_hi:[1,0] neg_lo:[0,1] neg_hi:[0,1]
  v_pk_add_f32 v[66:67], v[66:67], v[70:71] op_sel_hi:[1,0] neg_lo:[0,1] neg_hi:[0,1]
  v_pk_add_f32 v[68:69], v[68:69], v[70:71] op_sel_hi:[1,0] neg_lo:[0,1] neg_hi:[0,1]
  v_sqrt_f32 v71, v71
  v_cvt_pk_bf16_f32 v74, v60, v61
  v_cvt_pk_bf16_f32 v75, v62, v63
  v_cvt_pk_bf16_f32 v76, v64, v65
  v_cvt_pk_bf16_f32 v77, v66, v67
  v_cvt_pk_bf16_f32 v78, v68, v69
  v_cvt_pk_bf16_f32 v71, v71, v71
  v_and_b32 v71, 0xffff0000, v71
  v_rcp_f32 v71, v71
  v_lshlrev_b32 v60, 16, v74
  v_and_b32 v61, 0xffff0000, v74
  v_lshlrev_b32 v62, 16, v75
  v_and_b32 v63, 0xffff0000, v75
  v_lshlrev_b32 v64, 16, v76
  v_and_b32 v65, 0xffff0000, v76
  v_lshlrev_b32 v66, 16, v77
  v_and_b32 v67, 0xffff0000, v77
  v_lshlrev_b32 v68, 16, v78
  v_and_b32 v69, 0xffff0000, v78
  v_pk_mul_f32 v[60:61], v[60:61], v[70:71] op_sel:[0,1] op_sel_hi:[1,1]
  v_pk_mul_f32 v[62:63], v[62:63], v[70:71] op_sel:[0,1] op_sel_hi:[1,1]
  v_pk_mul_f32 v[64:65], v[64:65], v[70:71] op_sel:[0,1] op_sel_hi:[1,1]
  v_pk_mul_f32 v[66:67], v[66:67], v[70:71] op_sel:[0,1] op_sel_hi:[1,1]
  v_pk_mul_f32 v[68:69], v[68:69], v[70:71] op_sel:[0,1] op_sel_hi:[1,1]
  v_cvt_pk_bf16_f32 v92, v60, v61
  v_cvt_pk_bf16_f32 v93, v62, v63
  v_cvt_pk_bf16_f32 v94, v64, v65
  v_cvt_pk_bf16_f32 v95, v66, v67
  v_cvt_pk_bf16_f32 v96, v68, v69
  s_add_u32 s46, s54, 18874368
  buffer_store_dwordx4 v[92:95], v1, s[4:7], s46 offen sc1
  buffer_store_dword v96, v1, s[4:7], s46 offen offset:16 sc1
  s_waitcnt vmcnt(14)
  v_lshlrev_b32 v60, 16, v14
  v_and_b32 v61, 0xffff0000, v14
  v_lshlrev_b32 v62, 16, v15
  v_and_b32 v63, 0xffff0000, v15
  v_lshlrev_b32 v64, 16, v16
  v_and_b32 v65, 0xffff0000, v16
  v_lshlrev_b32 v66, 16, v17
  v_and_b32 v67, 0xffff0000, v17
  v_lshlrev_b32 v68, 16, v18
  v_and_b32 v69, 0xffff0000, v18
  v_add_f32 v70, v60, v61
  v_add_f32 v70, v70, v62
  v_add_f32 v70, v70, v63
  v_add_f32 v70, v70, v64
  v_add_f32 v70, v70, v65
  v_add_f32 v70, v70, v66
  v_add_f32 v70, v70, v67
  v_add_f32 v70, v70, v68
  v_add_f32 v70, v70, v69
  s_nop 1
  v_add_f32_dpp v70, v70, v70 quad_perm:[1,0,3,2] row_mask:0xf bank_mask:0xf
  s_nop 1
  v_add_f32_dpp v70, v70, v70 quad_perm:[2,3,0,1] row_mask:0xf bank_mask:0xf
  s_nop 1
  v_add_f32_dpp v70, v70, v70 row_half_mirror row_mask:0xf bank_mask:0xf
  s_nop 1
  v_add_f32_dpp v70, v70, v70 row_mirror row_mask:0xf bank_mask:0xf
  v_mov_b32 v72, v70
  s_nop 1
  v_permlane16_swap_b32 v70, v72
  v_add_f32 v70, v70, v72
  v_mov_b32 v72, v70
  s_nop 1
  v_permlane32_swap_b32 v70, v72
  v_add_f32 v70, v70, v72
  v_mul_f32 v70, 0x3acccccd, v70
  v_sub_f32 v80, v60, v70
  v_sub_f32 v81, v61, v70
  v_sub_f32 v82, v62, v70
  v_sub_f32 v83, v63, v70
  v_sub_f32 v84, v64, v70
  v_sub_f32 v85, v65, v70
  v_sub_f32 v86, v66, v70
  v_sub_f32 v87, v67, v70
  v_sub_f32 v88, v68, v70
  v_sub_f32 v89, v69, v70
  v_mul_f32 v71, v80, v80
  v_fmac_f32 v71, v81, v81
  v_fmac_f32 v71, v82, v82
  v_fmac_f32 v71, v83, v83
  v_fmac_f32 v71, v84, v84
  v_fmac_f32 v71, v85, v85
  v_fmac_f32 v71, v86, v86
  v_fmac_f32 v71, v87, v87
  v_fmac_f32 v71, v88, v88
  v_fmac_f32 v71, v89, v89
  s_nop 1
  v_add_f32_dpp v71, v71, v71 quad_perm:[1,0,3,2] row_mask:0xf bank_mask:0xf
  s_nop 1
  v_add_f32_dpp v71, v71, v71 quad_perm:[2,3,0,1] row_mask:0xf bank_mask:0xf
  s_nop 1
  v_add_f32_dpp v71, v71, v71 row_half_mirror row_mask:0xf bank_mask:0xf
  s_nop 1
  v_add_f32_dpp v71, v71, v71 row_mirror row_mask:0xf bank_mask:0xf
  v_mov_b32 v72, v71
  s_nop 1
  v_permlane16_swap_b32 v71, v72
  v_add_f32 v71, v71, v72
  v_mov_b32 v72, v71
  s_nop 1
  v_permlane32_swap_b32 v71, v72
  v_add_f32 v71, v71, v72
  v_mul_f32 v71, 0x3acccccd, v71
  v_cvt_pk_bf16_f32 v70, v70, v70
  v_and_b32 v70, 0xffff0000, v70
  v_cvt_pk_bf16_f32 v71, v71, v71
  v_and_b32 v71, 0xffff0000, v71
  v_add_f32 v71, 0x3727c5ac, v71
  v_cvt_pk_bf16_f32 v71, v71, v71
  v_and_b32 v71, 0xffff0000, v71
  v_pk_add_f32 v[60:61], v[60:61], v[70:71] op_sel_hi:[1,0] neg_lo:[0,1] neg_hi:[0,1]
  v_pk_add_f32 v[62:63], v[62:63], v[70:71] op_sel_hi:[1,0] neg_lo:[0,1] neg_hi:[0,1]
  v_pk_add_f32 v[64:65], v[64:65], v[70:71] op_sel_hi:[1,0] neg_lo:[0,1] neg_hi:[0,1]
  v_pk_add_f32 v[66:67], v[66:67], v[70:71] op_sel_hi:[1,0] neg_lo:[0,1] neg_hi:[0,1]
  v_pk_add_f32 v[68:69], v[68:69], v[70:71] op_sel_hi:[1,0] neg_lo:[0,1] neg_hi:[0,1]
  v_sqrt_f32 v71, v71
  v_cvt_pk_bf16_f32 v74, v60, v61
  v_cvt_pk_bf16_f32 v75, v62, v63
  v_cvt_pk_bf16_f32 v76, v64, v65
  v_cvt_pk_bf16_f32 v77, v66, v67
  v_cvt_pk_bf16_f32 v78, v68, v69
  v_cvt_pk_bf16_f32 v71, v71, v71
  v_and_b32 v71, 0xffff0000, v71
  v_rcp_f32 v71, v71
  v_lshlrev_b32 v60, 16, v74
  v_and_b32 v61, 0xffff0000, v74
  v_lshlrev_b32 v62, 16, v75
  v_and_b32 v63, 0xffff0000, v75
  v_lshlrev_b32 v64, 16, v76
  v_and_b32 v65, 0xffff0000, v76
  v_lshlrev_b32 v66, 16, v77
  v_and_b32 v67, 0xffff0000, v77
  v_lshlrev_b32 v68, 16, v78
  v_and_b32 v69, 0xffff0000, v78
  v_pk_mul_f32 v[60:61], v[60:61], v[70:71] op_sel:[0,1] op_sel_hi:[1,1]
  v_pk_mul_f32 v[62:63], v[62:63], v[70:71] op_sel:[0,1] op_sel_hi:[1,1]
  v_pk_mul_f32 v[64:65], v[64:65], v[70:71] op_sel:[0,1] op_sel_hi:[1,1]
  v_pk_mul_f32 v[66:67], v[66:67], v[70:71] op_sel:[0,1] op_sel_hi:[1,1]
  v_pk_mul_f32 v[68:69], v[68:69], v[70:71] op_sel:[0,1] op_sel_hi:[1,1]
  v_cvt_pk_bf16_f32 v92, v60, v61
  v_cvt_pk_bf16_f32 v93, v62, v63
  v_cvt_pk_bf16_f32 v94, v64, v65
  v_cvt_pk_bf16_f32 v95, v66, v67
  v_cvt_pk_bf16_f32 v96, v68, v69
  s_add_u32 s46, s54, 18875648
  buffer_store_dwordx4 v[92:95], v1, s[4:7], s46 offen sc1
  buffer_store_dword v96, v1, s[4:7], s46 offen offset:16 sc1
  s_waitcnt vmcnt(14)
  v_lshlrev_b32 v60, 16, v20
  v_and_b32 v61, 0xffff0000, v20
  v_lshlrev_b32 v62, 16, v21
  v_and_b32 v63, 0xffff0000, v21
  v_lshlrev_b32 v64, 16, v22
  v_and_b32 v65, 0xffff0000, v22
  v_lshlrev_b32 v66, 16, v23
  v_and_b32 v67, 0xffff0000, v23
  v_lshlrev_b32 v68, 16, v24
  v_and_b32 v69, 0xffff0000, v24
  v_add_f32 v70, v60, v61
  v_add_f32 v70, v70, v62
  v_add_f32 v70, v70, v63
  v_add_f32 v70, v70, v64
  v_add_f32 v70, v70, v65
  v_add_f32 v70, v70, v66
  v_add_f32 v70, v70, v67
  v_add_f32 v70, v70, v68
  v_add_f32 v70, v70, v69
  s_nop 1
  v_add_f32_dpp v70, v70, v70 quad_perm:[1,0,3,2] row_mask:0xf bank_mask:0xf
  s_nop 1
  v_add_f32_dpp v70, v70, v70 quad_perm:[2,3,0,1] row_mask:0xf bank_mask:0xf
  s_nop 1
  v_add_f32_dpp v70, v70, v70 row_half_mirror row_mask:0xf bank_mask:0xf
  s_nop 1
  v_add_f32_dpp v70, v70, v70 row_mirror row_mask:0xf bank_mask:0xf
  v_mov_b32 v72, v70
  s_nop 1
  v_permlane16_swap_b32 v70, v72
  v_add_f32 v70, v70, v72
  v_mov_b32 v72, v70
  s_nop 1
  v_permlane32_swap_b32 v70, v72
  v_add_f32 v70, v70, v72
  v_mul_f32 v70, 0x3acccccd, v70
  v_sub_f32 v80, v60, v70
  v_sub_f32 v81, v61, v70
  v_sub_f32 v82, v62, v70
  v_sub_f32 v83, v63, v70
  v_sub_f32 v84, v64, v70
  v_sub_f32 v85, v65, v70
  v_sub_f32 v86, v66, v70
  v_sub_f32 v87, v67, v70
  v_sub_f32 v88, v68, v70
  v_sub_f32 v89, v69, v70
  v_mul_f32 v71, v80, v80
  v_fmac_f32 v71, v81, v81
  v_fmac_f32 v71, v82, v82
  v_fmac_f32 v71, v83, v83
  v_fmac_f32 v71, v84, v84
  v_fmac_f32 v71, v85, v85
  v_fmac_f32 v71, v86, v86
  v_fmac_f32 v71, v87, v87
  v_fmac_f32 v71, v88, v88
  v_fmac_f32 v71, v89, v89
  s_nop 1
  v_add_f32_dpp v71, v71, v71 quad_perm:[1,0,3,2] row_mask:0xf bank_mask:0xf
  s_nop 1
  v_add_f32_dpp v71, v71, v71 quad_perm:[2,3,0,1] row_mask:0xf bank_mask:0xf
  s_nop 1
  v_add_f32_dpp v71, v71, v71 row_half_mirror row_mask:0xf bank_mask:0xf
  s_nop 1
  v_add_f32_dpp v71, v71, v71 row_mirror row_mask:0xf bank_mask:0xf
  v_mov_b32 v72, v71
  s_nop 1
  v_permlane16_swap_b32 v71, v72
  v_add_f32 v71, v71, v72
  v_mov_b32 v72, v71
  s_nop 1
  v_permlane32_swap_b32 v71, v72
  v_add_f32 v71, v71, v72
  v_mul_f32 v71, 0x3acccccd, v71
  v_cvt_pk_bf16_f32 v70, v70, v70
  v_and_b32 v70, 0xffff0000, v70
  v_cvt_pk_bf16_f32 v71, v71, v71
  v_and_b32 v71, 0xffff0000, v71
  v_add_f32 v71, 0x3727c5ac, v71
  v_cvt_pk_bf16_f32 v71, v71, v71
  v_and_b32 v71, 0xffff0000, v71
  v_pk_add_f32 v[60:61], v[60:61], v[70:71] op_sel_hi:[1,0] neg_lo:[0,1] neg_hi:[0,1]
  v_pk_add_f32 v[62:63], v[62:63], v[70:71] op_sel_hi:[1,0] neg_lo:[0,1] neg_hi:[0,1]
  v_pk_add_f32 v[64:65], v[64:65], v[70:71] op_sel_hi:[1,0] neg_lo:[0,1] neg_hi:[0,1]
  v_pk_add_f32 v[66:67], v[66:67], v[70:71] op_sel_hi:[1,0] neg_lo:[0,1] neg_hi:[0,1]
  v_pk_add_f32 v[68:69], v[68:69], v[70:71] op_sel_hi:[1,0] neg_lo:[0,1] neg_hi:[0,1]
  v_sqrt_f32 v71, v71
  v_cvt_pk_bf16_f32 v74, v60, v61
  v_cvt_pk_bf16_f32 v75, v62, v63
  v_cvt_pk_bf16_f32 v76, v64, v65
  v_cvt_pk_bf16_f32 v77, v66, v67
  v_cvt_pk_bf16_f32 v78, v68, v69
  v_cvt_pk_bf16_f32 v71, v71, v71
  v_and_b32 v71, 0xffff0000, v71
  v_rcp_f32 v71, v71
  v_lshlrev_b32 v60, 16, v74
  v_and_b32 v61, 0xffff0000, v74
  v_lshlrev_b32 v62, 16, v75
  v_and_b32 v63, 0xffff0000, v75
  v_lshlrev_b32 v64, 16, v76
  v_and_b32 v65, 0xffff0000, v76
  v_lshlrev_b32 v66, 16, v77
  v_and_b32 v67, 0xffff0000, v77
  v_lshlrev_b32 v68, 16, v78
  v_and_b32 v69, 0xffff0000, v78
  v_pk_mul_f32 v[60:61], v[60:61], v[70:71] op_sel:[0,1] op_sel_hi:[1,1]
  v_pk_mul_f32 v[62:63], v[62:63], v[70:71] op_sel:[0,1] op_sel_hi:[1,1]
  v_pk_mul_f32 v[64:65], v[64:65], v[70:71] op_sel:[0,1] op_sel_hi:[1,1]
  v_pk_mul_f32 v[66:67], v[66:67], v[70:71] op_sel:[0,1] op_sel_hi:[1,1]
  v_pk_mul_f32 v[68:69], v[68:69], v[70:71] op_sel:[0,1] op_sel_hi:[1,1]
  v_cvt_pk_bf16_f32 v92, v60, v61
  v_cvt_pk_bf16_f32 v93, v62, v63
  v_cvt_pk_bf16_f32 v94, v64, v65
  v_cvt_pk_bf16_f32 v95, v66, v67
  v_cvt_pk_bf16_f32 v96, v68, v69
  s_add_u32 s46, s54, 18876928
  buffer_store_dwordx4 v[92:95], v1, s[4:7], s46 offen sc1
  buffer_store_dword v96, v1, s[4:7], s46 offen offset:16 sc1
  s_waitcnt vmcnt(14)
  v_lshlrev_b32 v60, 16, v26
  v_and_b32 v61, 0xffff0000, v26
  v_lshlrev_b32 v62, 16, v27
  v_and_b32 v63, 0xffff0000, v27
  v_lshlrev_b32 v64, 16, v28
  v_and_b32 v65, 0xffff0000, v28
  v_lshlrev_b32 v66, 16, v29
  v_and_b32 v67, 0xffff0000, v29
  v_lshlrev_b32 v68, 16, v30
  v_and_b32 v69, 0xffff0000, v30
  v_add_f32 v70, v60, v61
  v_add_f32 v70, v70, v62
  v_add_f32 v70, v70, v63
  v_add_f32 v70, v70, v64
  v_add_f32 v70, v70, v65
  v_add_f32 v70, v70, v66
  v_add_f32 v70, v70, v67
  v_add_f32 v70, v70, v68
  v_add_f32 v70, v70, v69
  s_nop 1
  v_add_f32_dpp v70, v70, v70 quad_perm:[1,0,3,2] row_mask:0xf bank_mask:0xf
  s_nop 1
  v_add_f32_dpp v70, v70, v70 quad_perm:[2,3,0,1] row_mask:0xf bank_mask:0xf
  s_nop 1
  v_add_f32_dpp v70, v70, v70 row_half_mirror row_mask:0xf bank_mask:0xf
  s_nop 1
  v_add_f32_dpp v70, v70, v70 row_mirror row_mask:0xf bank_mask:0xf
  v_mov_b32 v72, v70
  s_nop 1
  v_permlane16_swap_b32 v70, v72
  v_add_f32 v70, v70, v72
  v_mov_b32 v72, v70
  s_nop 1
  v_permlane32_swap_b32 v70, v72
  v_add_f32 v70, v70, v72
  v_mul_f32 v70, 0x3acccccd, v70
  v_sub_f32 v80, v60, v70
  v_sub_f32 v81, v61, v70
  v_sub_f32 v82, v62, v70
  v_sub_f32 v83, v63, v70
  v_sub_f32 v84, v64, v70
  v_sub_f32 v85, v65, v70
  v_sub_f32 v86, v66, v70
  v_sub_f32 v87, v67, v70
  v_sub_f32 v88, v68, v70
  v_sub_f32 v89, v69, v70
  v_mul_f32 v71, v80, v80
  v_fmac_f32 v71, v81, v81
  v_fmac_f32 v71, v82, v82
  v_fmac_f32 v71, v83, v83
  v_fmac_f32 v71, v84, v84
  v_fmac_f32 v71, v85, v85
  v_fmac_f32 v71, v86, v86
  v_fmac_f32 v71, v87, v87
  v_fmac_f32 v71, v88, v88
  v_fmac_f32 v71, v89, v89
  s_nop 1
  v_add_f32_dpp v71, v71, v71 quad_perm:[1,0,3,2] row_mask:0xf bank_mask:0xf
  s_nop 1
  v_add_f32_dpp v71, v71, v71 quad_perm:[2,3,0,1] row_mask:0xf bank_mask:0xf
  s_nop 1
  v_add_f32_dpp v71, v71, v71 row_half_mirror row_mask:0xf bank_mask:0xf
  s_nop 1
  v_add_f32_dpp v71, v71, v71 row_mirror row_mask:0xf bank_mask:0xf
  v_mov_b32 v72, v71
  s_nop 1
  v_permlane16_swap_b32 v71, v72
  v_add_f32 v71, v71, v72
  v_mov_b32 v72, v71
  s_nop 1
  v_permlane32_swap_b32 v71, v72
  v_add_f32 v71, v71, v72
  v_mul_f32 v71, 0x3acccccd, v71
  v_cvt_pk_bf16_f32 v70, v70, v70
  v_and_b32 v70, 0xffff0000, v70
  v_cvt_pk_bf16_f32 v71, v71, v71
  v_and_b32 v71, 0xffff0000, v71
  v_add_f32 v71, 0x3727c5ac, v71
  v_cvt_pk_bf16_f32 v71, v71, v71
  v_and_b32 v71, 0xffff0000, v71
  v_pk_add_f32 v[60:61], v[60:61], v[70:71] op_sel_hi:[1,0] neg_lo:[0,1] neg_hi:[0,1]
  v_pk_add_f32 v[62:63], v[62:63], v[70:71] op_sel_hi:[1,0] neg_lo:[0,1] neg_hi:[0,1]
  v_pk_add_f32 v[64:65], v[64:65], v[70:71] op_sel_hi:[1,0] neg_lo:[0,1] neg_hi:[0,1]
  v_pk_add_f32 v[66:67], v[66:67], v[70:71] op_sel_hi:[1,0] neg_lo:[0,1] neg_hi:[0,1]
  v_pk_add_f32 v[68:69], v[68:69], v[70:71] op_sel_hi:[1,0] neg_lo:[0,1] neg_hi:[0,1]
  v_sqrt_f32 v71, v71
  v_cvt_pk_bf16_f32 v74, v60, v61
  v_cvt_pk_bf16_f32 v75, v62, v63
  v_cvt_pk_bf16_f32 v76, v64, v65
  v_cvt_pk_bf16_f32 v77, v66, v67
  v_cvt_pk_bf16_f32 v78, v68, v69
  v_cvt_pk_bf16_f32 v71, v71, v71
  v_and_b32 v71, 0xffff0000, v71
  v_rcp_f32 v71, v71
  v_lshlrev_b32 v60, 16, v74
  v_and_b32 v61, 0xffff0000, v74
  v_lshlrev_b32 v62, 16, v75
  v_and_b32 v63, 0xffff0000, v75
  v_lshlrev_b32 v64, 16, v76
  v_and_b32 v65, 0xffff0000, v76
  v_lshlrev_b32 v66, 16, v77
  v_and_b32 v67, 0xffff0000, v77
  v_lshlrev_b32 v68, 16, v78
  v_and_b32 v69, 0xffff0000, v78
  v_pk_mul_f32 v[60:61], v[60:61], v[70:71] op_sel:[0,1] op_sel_hi:[1,1]
  v_pk_mul_f32 v[62:63], v[62:63], v[70:71] op_sel:[0,1] op_sel_hi:[1,1]
  v_pk_mul_f32 v[64:65], v[64:65], v[70:71] op_sel:[0,1] op_sel_hi:[1,1]
  v_pk_mul_f32 v[66:67], v[66:67], v[70:71] op_sel:[0,1] op_sel_hi:[1,1]
  v_pk_mul_f32 v[68:69], v[68:69], v[70:71] op_sel:[0,1] op_sel_hi:[1,1]
  v_cvt_pk_bf16_f32 v92, v60, v61
  v_cvt_pk_bf16_f32 v93, v62, v63
  v_cvt_pk_bf16_f32 v94, v64, v65
  v_cvt_pk_bf16_f32 v95, v66, v67
  v_cvt_pk_bf16_f32 v96, v68, v69
  s_add_u32 s46, s54, 18878208
  buffer_store_dwordx4 v[92:95], v1, s[4:7], s46 offen sc1
  buffer_store_dword v96, v1, s[4:7], s46 offen offset:16 sc1
  s_waitcnt vmcnt(14)
  v_lshlrev_b32 v60, 16, v32
  v_and_b32 v61, 0xffff0000, v32
  v_lshlrev_b32 v62, 16, v33
  v_and_b32 v63, 0xffff0000, v33
  v_lshlrev_b32 v64, 16, v34
  v_and_b32 v65, 0xffff0000, v34
  v_lshlrev_b32 v66, 16, v35
  v_and_b32 v67, 0xffff0000, v35
  v_lshlrev_b32 v68, 16, v36
  v_and_b32 v69, 0xffff0000, v36
  v_add_f32 v70, v60, v61
  v_add_f32 v70, v70, v62
  v_add_f32 v70, v70, v63
  v_add_f32 v70, v70, v64
  v_add_f32 v70, v70, v65
  v_add_f32 v70, v70, v66
  v_add_f32 v70, v70, v67
  v_add_f32 v70, v70, v68
  v_add_f32 v70, v70, v69
  s_nop 1
  v_add_f32_dpp v70, v70, v70 quad_perm:[1,0,3,2] row_mask:0xf bank_mask:0xf
  s_nop 1
  v_add_f32_dpp v70, v70, v70 quad_perm:[2,3,0,1] row_mask:0xf bank_mask:0xf
  s_nop 1
  v_add_f32_dpp v70, v70, v70 row_half_mirror row_mask:0xf bank_mask:0xf
  s_nop 1
  v_add_f32_dpp v70, v70, v70 row_mirror row_mask:0xf bank_mask:0xf
  v_mov_b32 v72, v70
  s_nop 1
  v_permlane16_swap_b32 v70, v72
  v_add_f32 v70, v70, v72
  v_mov_b32 v72, v70
  s_nop 1
  v_permlane32_swap_b32 v70, v72
  v_add_f32 v70, v70, v72
  v_mul_f32 v70, 0x3acccccd, v70
  v_sub_f32 v80, v60, v70
  v_sub_f32 v81, v61, v70
  v_sub_f32 v82, v62, v70
  v_sub_f32 v83, v63, v70
  v_sub_f32 v84, v64, v70
  v_sub_f32 v85, v65, v70
  v_sub_f32 v86, v66, v70
  v_sub_f32 v87, v67, v70
  v_sub_f32 v88, v68, v70
  v_sub_f32 v89, v69, v70
  v_mul_f32 v71, v80, v80
  v_fmac_f32 v71, v81, v81
  v_fmac_f32 v71, v82, v82
  v_fmac_f32 v71, v83, v83
  v_fmac_f32 v71, v84, v84
  v_fmac_f32 v71, v85, v85
  v_fmac_f32 v71, v86, v86
  v_fmac_f32 v71, v87, v87
  v_fmac_f32 v71, v88, v88
  v_fmac_f32 v71, v89, v89
  s_nop 1
  v_add_f32_dpp v71, v71, v71 quad_perm:[1,0,3,2] row_mask:0xf bank_mask:0xf
  s_nop 1
  v_add_f32_dpp v71, v71, v71 quad_perm:[2,3,0,1] row_mask:0xf bank_mask:0xf
  s_nop 1
  v_add_f32_dpp v71, v71, v71 row_half_mirror row_mask:0xf bank_mask:0xf
  s_nop 1
  v_add_f32_dpp v71, v71, v71 row_mirror row_mask:0xf bank_mask:0xf
  v_mov_b32 v72, v71
  s_nop 1
  v_permlane16_swap_b32 v71, v72
  v_add_f32 v71, v71, v72
  v_mov_b32 v72, v71
  s_nop 1
  v_permlane32_swap_b32 v71, v72
  v_add_f32 v71, v71, v72
  v_mul_f32 v71, 0x3acccccd, v71
  v_cvt_pk_bf16_f32 v70, v70, v70
  v_and_b32 v70, 0xffff0000, v70
  v_cvt_pk_bf16_f32 v71, v71, v71
  v_and_b32 v71, 0xffff0000, v71
  v_add_f32 v71, 0x3727c5ac, v71
  v_cvt_pk_bf16_f32 v71, v71, v71
  v_and_b32 v71, 0xffff0000, v71
  v_pk_add_f32 v[60:61], v[60:61], v[70:71] op_sel_hi:[1,0] neg_lo:[0,1] neg_hi:[0,1]
  v_pk_add_f32 v[62:63], v[62:63], v[70:71] op_sel_hi:[1,0] neg_lo:[0,1] neg_hi:[0,1]
  v_pk_add_f32 v[64:65], v[64:65], v[70:71] op_sel_hi:[1,0] neg_lo:[0,1] neg_hi:[0,1]
  v_pk_add_f32 v[66:67], v[66:67], v[70:71] op_sel_hi:[1,0] neg_lo:[0,1] neg_hi:[0,1]
  v_pk_add_f32 v[68:69], v[68:69], v[70:71] op_sel_hi:[1,0] neg_lo:[0,1] neg_hi:[0,1]
  v_sqrt_f32 v71, v71
  v_cvt_pk_bf16_f32 v74, v60, v61
  v_cvt_pk_bf16_f32 v75, v62, v63
  v_cvt_pk_bf16_f32 v76, v64, v65
  v_cvt_pk_bf16_f32 v77, v66, v67
  v_cvt_pk_bf16_f32 v78, v68, v69
  v_cvt_pk_bf16_f32 v71, v71, v71
  v_and_b32 v71, 0xffff0000, v71
  v_rcp_f32 v71, v71
  v_lshlrev_b32 v60, 16, v74
  v_and_b32 v61, 0xffff0000, v74
  v_lshlrev_b32 v62, 16, v75
  v_and_b32 v63, 0xffff0000, v75
  v_lshlrev_b32 v64, 16, v76
  v_and_b32 v65, 0xffff0000, v76
  v_lshlrev_b32 v66, 16, v77
  v_and_b32 v67, 0xffff0000, v77
  v_lshlrev_b32 v68, 16, v78
  v_and_b32 v69, 0xffff0000, v78
  v_pk_mul_f32 v[60:61], v[60:61], v[70:71] op_sel:[0,1] op_sel_hi:[1,1]
  v_pk_mul_f32 v[62:63], v[62:63], v[70:71] op_sel:[0,1] op_sel_hi:[1,1]
  v_pk_mul_f32 v[64:65], v[64:65], v[70:71] op_sel:[0,1] op_sel_hi:[1,1]
  v_pk_mul_f32 v[66:67], v[66:67], v[70:71] op_sel:[0,1] op_sel_hi:[1,1]
  v_pk_mul_f32 v[68:69], v[68:69], v[70:71] op_sel:[0,1] op_sel_hi:[1,1]
  v_cvt_pk_bf16_f32 v92, v60, v61
  v_cvt_pk_bf16_f32 v93, v62, v63
  v_cvt_pk_bf16_f32 v94, v64, v65
  v_cvt_pk_bf16_f32 v95, v66, v67
  v_cvt_pk_bf16_f32 v96, v68, v69
  s_add_u32 s46, s54, 18879488
  buffer_store_dwordx4 v[92:95], v1, s[4:7], s46 offen sc1
  buffer_store_dword v96, v1, s[4:7], s46 offen offset:16 sc1
  s_waitcnt vmcnt(14)
  v_lshlrev_b32 v60, 16, v38
  v_and_b32 v61, 0xffff0000, v38
  v_lshlrev_b32 v62, 16, v39
  v_and_b32 v63, 0xffff0000, v39
  v_lshlrev_b32 v64, 16, v40
  v_and_b32 v65, 0xffff0000, v40
  v_lshlrev_b32 v66, 16, v41
  v_and_b32 v67, 0xffff0000, v41
  v_lshlrev_b32 v68, 16, v42
  v_and_b32 v69, 0xffff0000, v42
  v_add_f32 v70, v60, v61
  v_add_f32 v70, v70, v62
  v_add_f32 v70, v70, v63
  v_add_f32 v70, v70, v64
  v_add_f32 v70, v70, v65
  v_add_f32 v70, v70, v66
  v_add_f32 v70, v70, v67
  v_add_f32 v70, v70, v68
  v_add_f32 v70, v70, v69
  s_nop 1
  v_add_f32_dpp v70, v70, v70 quad_perm:[1,0,3,2] row_mask:0xf bank_mask:0xf
  s_nop 1
  v_add_f32_dpp v70, v70, v70 quad_perm:[2,3,0,1] row_mask:0xf bank_mask:0xf
  s_nop 1
  v_add_f32_dpp v70, v70, v70 row_half_mirror row_mask:0xf bank_mask:0xf
  s_nop 1
  v_add_f32_dpp v70, v70, v70 row_mirror row_mask:0xf bank_mask:0xf
  v_mov_b32 v72, v70
  s_nop 1
  v_permlane16_swap_b32 v70, v72
  v_add_f32 v70, v70, v72
  v_mov_b32 v72, v70
  s_nop 1
  v_permlane32_swap_b32 v70, v72
  v_add_f32 v70, v70, v72
  v_mul_f32 v70, 0x3acccccd, v70
  v_sub_f32 v80, v60, v70
  v_sub_f32 v81, v61, v70
  v_sub_f32 v82, v62, v70
  v_sub_f32 v83, v63, v70
  v_sub_f32 v84, v64, v70
  v_sub_f32 v85, v65, v70
  v_sub_f32 v86, v66, v70
  v_sub_f32 v87, v67, v70
  v_sub_f32 v88, v68, v70
  v_sub_f32 v89, v69, v70
  v_mul_f32 v71, v80, v80
  v_fmac_f32 v71, v81, v81
  v_fmac_f32 v71, v82, v82
  v_fmac_f32 v71, v83, v83
  v_fmac_f32 v71, v84, v84
  v_fmac_f32 v71, v85, v85
  v_fmac_f32 v71, v86, v86
  v_fmac_f32 v71, v87, v87
  v_fmac_f32 v71, v88, v88
  v_fmac_f32 v71, v89, v89
  s_nop 1
  v_add_f32_dpp v71, v71, v71 quad_perm:[1,0,3,2] row_mask:0xf bank_mask:0xf
  s_nop 1
  v_add_f32_dpp v71, v71, v71 quad_perm:[2,3,0,1] row_mask:0xf bank_mask:0xf
  s_nop 1
  v_add_f32_dpp v71, v71, v71 row_half_mirror row_mask:0xf bank_mask:0xf
  s_nop 1
  v_add_f32_dpp v71, v71, v71 row_mirror row_mask:0xf bank_mask:0xf
  v_mov_b32 v72, v71
  s_nop 1
  v_permlane16_swap_b32 v71, v72
  v_add_f32 v71, v71, v72
  v_mov_b32 v72, v71
  s_nop 1
  v_permlane32_swap_b32 v71, v72
  v_add_f32 v71, v71, v72
  v_mul_f32 v71, 0x3acccccd, v71
  v_cvt_pk_bf16_f32 v70, v70, v70
  v_and_b32 v70, 0xffff0000, v70
  v_cvt_pk_bf16_f32 v71, v71, v71
  v_and_b32 v71, 0xffff0000, v71
  v_add_f32 v71, 0x3727c5ac, v71
  v_cvt_pk_bf16_f32 v71, v71, v71
  v_and_b32 v71, 0xffff0000, v71
  v_pk_add_f32 v[60:61], v[60:61], v[70:71] op_sel_hi:[1,0] neg_lo:[0,1] neg_hi:[0,1]
  v_pk_add_f32 v[62:63], v[62:63], v[70:71] op_sel_hi:[1,0] neg_lo:[0,1] neg_hi:[0,1]
  v_pk_add_f32 v[64:65], v[64:65], v[70:71] op_sel_hi:[1,0] neg_lo:[0,1] neg_hi:[0,1]
  v_pk_add_f32 v[66:67], v[66:67], v[70:71] op_sel_hi:[1,0] neg_lo:[0,1] neg_hi:[0,1]
  v_pk_add_f32 v[68:69], v[68:69], v[70:71] op_sel_hi:[1,0] neg_lo:[0,1] neg_hi:[0,1]
  v_sqrt_f32 v71, v71
  v_cvt_pk_bf16_f32 v74, v60, v61
  v_cvt_pk_bf16_f32 v75, v62, v63
  v_cvt_pk_bf16_f32 v76, v64, v65
  v_cvt_pk_bf16_f32 v77, v66, v67
  v_cvt_pk_bf16_f32 v78, v68, v69
  v_cvt_pk_bf16_f32 v71, v71, v71
  v_and_b32 v71, 0xffff0000, v71
  v_rcp_f32 v71, v71
  v_lshlrev_b32 v60, 16, v74
  v_and_b32 v61, 0xffff0000, v74
  v_lshlrev_b32 v62, 16, v75
  v_and_b32 v63, 0xffff0000, v75
  v_lshlrev_b32 v64, 16, v76
  v_and_b32 v65, 0xffff0000, v76
  v_lshlrev_b32 v66, 16, v77
  v_and_b32 v67, 0xffff0000, v77
  v_lshlrev_b32 v68, 16, v78
  v_and_b32 v69, 0xffff0000, v78
  v_pk_mul_f32 v[60:61], v[60:61], v[70:71] op_sel:[0,1] op_sel_hi:[1,1]
  v_pk_mul_f32 v[62:63], v[62:63], v[70:71] op_sel:[0,1] op_sel_hi:[1,1]
  v_pk_mul_f32 v[64:65], v[64:65], v[70:71] op_sel:[0,1] op_sel_hi:[1,1]
  v_pk_mul_f32 v[66:67], v[66:67], v[70:71] op_sel:[0,1] op_sel_hi:[1,1]
  v_pk_mul_f32 v[68:69], v[68:69], v[70:71] op_sel:[0,1] op_sel_hi:[1,1]
  v_cvt_pk_bf16_f32 v92, v60, v61
  v_cvt_pk_bf16_f32 v93, v62, v63
  v_cvt_pk_bf16_f32 v94, v64, v65
  v_cvt_pk_bf16_f32 v95, v66, v67
  v_cvt_pk_bf16_f32 v96, v68, v69
  s_add_u32 s46, s54, 18880768
  buffer_store_dwordx4 v[92:95], v1, s[4:7], s46 offen sc1
  buffer_store_dword v96, v1, s[4:7], s46 offen offset:16 sc1
  s_waitcnt vmcnt(14)
  v_lshlrev_b32 v60, 16, v44
  v_and_b32 v61, 0xffff0000, v44
  v_lshlrev_b32 v62, 16, v45
  v_and_b32 v63, 0xffff0000, v45
  v_lshlrev_b32 v64, 16, v46
  v_and_b32 v65, 0xffff0000, v46
  v_lshlrev_b32 v66, 16, v47
  v_and_b32 v67, 0xffff0000, v47
  v_lshlrev_b32 v68, 16, v48
  v_and_b32 v69, 0xffff0000, v48
  v_add_f32 v70, v60, v61
  v_add_f32 v70, v70, v62
  v_add_f32 v70, v70, v63
  v_add_f32 v70, v70, v64
  v_add_f32 v70, v70, v65
  v_add_f32 v70, v70, v66
  v_add_f32 v70, v70, v67
  v_add_f32 v70, v70, v68
  v_add_f32 v70, v70, v69
  s_nop 1
  v_add_f32_dpp v70, v70, v70 quad_perm:[1,0,3,2] row_mask:0xf bank_mask:0xf
  s_nop 1
  v_add_f32_dpp v70, v70, v70 quad_perm:[2,3,0,1] row_mask:0xf bank_mask:0xf
  s_nop 1
  v_add_f32_dpp v70, v70, v70 row_half_mirror row_mask:0xf bank_mask:0xf
  s_nop 1
  v_add_f32_dpp v70, v70, v70 row_mirror row_mask:0xf bank_mask:0xf
  v_mov_b32 v72, v70
  s_nop 1
  v_permlane16_swap_b32 v70, v72
  v_add_f32 v70, v70, v72
  v_mov_b32 v72, v70
  s_nop 1
  v_permlane32_swap_b32 v70, v72
  v_add_f32 v70, v70, v72
  v_mul_f32 v70, 0x3acccccd, v70
  v_sub_f32 v80, v60, v70
  v_sub_f32 v81, v61, v70
  v_sub_f32 v82, v62, v70
  v_sub_f32 v83, v63, v70
  v_sub_f32 v84, v64, v70
  v_sub_f32 v85, v65, v70
  v_sub_f32 v86, v66, v70
  v_sub_f32 v87, v67, v70
  v_sub_f32 v88, v68, v70
  v_sub_f32 v89, v69, v70
  v_mul_f32 v71, v80, v80
  v_fmac_f32 v71, v81, v81
  v_fmac_f32 v71, v82, v82
  v_fmac_f32 v71, v83, v83
  v_fmac_f32 v71, v84, v84
  v_fmac_f32 v71, v85, v85
  v_fmac_f32 v71, v86, v86
  v_fmac_f32 v71, v87, v87
  v_fmac_f32 v71, v88, v88
  v_fmac_f32 v71, v89, v89
  s_nop 1
  v_add_f32_dpp v71, v71, v71 quad_perm:[1,0,3,2] row_mask:0xf bank_mask:0xf
  s_nop 1
  v_add_f32_dpp v71, v71, v71 quad_perm:[2,3,0,1] row_mask:0xf bank_mask:0xf
  s_nop 1
  v_add_f32_dpp v71, v71, v71 row_half_mirror row_mask:0xf bank_mask:0xf
  s_nop 1
  v_add_f32_dpp v71, v71, v71 row_mirror row_mask:0xf bank_mask:0xf
  v_mov_b32 v72, v71
  s_nop 1
  v_permlane16_swap_b32 v71, v72
  v_add_f32 v71, v71, v72
  v_mov_b32 v72, v71
  s_nop 1
  v_permlane32_swap_b32 v71, v72
  v_add_f32 v71, v71, v72
  v_mul_f32 v71, 0x3acccccd, v71
  v_cvt_pk_bf16_f32 v70, v70, v70
  v_and_b32 v70, 0xffff0000, v70
  v_cvt_pk_bf16_f32 v71, v71, v71
  v_and_b32 v71, 0xffff0000, v71
  v_add_f32 v71, 0x3727c5ac, v71
  v_cvt_pk_bf16_f32 v71, v71, v71
  v_and_b32 v71, 0xffff0000, v71
  v_pk_add_f32 v[60:61], v[60:61], v[70:71] op_sel_hi:[1,0] neg_lo:[0,1] neg_hi:[0,1]
  v_pk_add_f32 v[62:63], v[62:63], v[70:71] op_sel_hi:[1,0] neg_lo:[0,1] neg_hi:[0,1]
  v_pk_add_f32 v[64:65], v[64:65], v[70:71] op_sel_hi:[1,0] neg_lo:[0,1] neg_hi:[0,1]
  v_pk_add_f32 v[66:67], v[66:67], v[70:71] op_sel_hi:[1,0] neg_lo:[0,1] neg_hi:[0,1]
  v_pk_add_f32 v[68:69], v[68:69], v[70:71] op_sel_hi:[1,0] neg_lo:[0,1] neg_hi:[0,1]
  v_sqrt_f32 v71, v71
  v_cvt_pk_bf16_f32 v74, v60, v61
  v_cvt_pk_bf16_f32 v75, v62, v63
  v_cvt_pk_bf16_f32 v76, v64, v65
  v_cvt_pk_bf16_f32 v77, v66, v67
  v_cvt_pk_bf16_f32 v78, v68, v69
  v_cvt_pk_bf16_f32 v71, v71, v71
  v_and_b32 v71, 0xffff0000, v71
  v_rcp_f32 v71, v71
  v_lshlrev_b32 v60, 16, v74
  v_and_b32 v61, 0xffff0000, v74
  v_lshlrev_b32 v62, 16, v75
  v_and_b32 v63, 0xffff0000, v75
  v_lshlrev_b32 v64, 16, v76
  v_and_b32 v65, 0xffff0000, v76
  v_lshlrev_b32 v66, 16, v77
  v_and_b32 v67, 0xffff0000, v77
  v_lshlrev_b32 v68, 16, v78
  v_and_b32 v69, 0xffff0000, v78
  v_pk_mul_f32 v[60:61], v[60:61], v[70:71] op_sel:[0,1] op_sel_hi:[1,1]
  v_pk_mul_f32 v[62:63], v[62:63], v[70:71] op_sel:[0,1] op_sel_hi:[1,1]
  v_pk_mul_f32 v[64:65], v[64:65], v[70:71] op_sel:[0,1] op_sel_hi:[1,1]
  v_pk_mul_f32 v[66:67], v[66:67], v[70:71] op_sel:[0,1] op_sel_hi:[1,1]
  v_pk_mul_f32 v[68:69], v[68:69], v[70:71] op_sel:[0,1] op_sel_hi:[1,1]
  v_cvt_pk_bf16_f32 v92, v60, v61
  v_cvt_pk_bf16_f32 v93, v62, v63
  v_cvt_pk_bf16_f32 v94, v64, v65
  v_cvt_pk_bf16_f32 v95, v66, v67
  v_cvt_pk_bf16_f32 v96, v68, v69
  s_add_u32 s46, s54, 18882048
  buffer_store_dwordx4 v[92:95], v1, s[4:7], s46 offen sc1
  buffer_store_dword v96, v1, s[4:7], s46 offen offset:16 sc1
  s_waitcnt vmcnt(14)
  v_lshlrev_b32 v60, 16, v50
  v_and_b32 v61, 0xffff0000, v50
  v_lshlrev_b32 v62, 16, v51
  v_and_b32 v63, 0xffff0000, v51
  v_lshlrev_b32 v64, 16, v52
  v_and_b32 v65, 0xffff0000, v52
  v_lshlrev_b32 v66, 16, v53
  v_and_b32 v67, 0xffff0000, v53
  v_lshlrev_b32 v68, 16, v54
  v_and_b32 v69, 0xffff0000, v54
  v_add_f32 v70, v60, v61
  v_add_f32 v70, v70, v62
  v_add_f32 v70, v70, v63
  v_add_f32 v70, v70, v64
  v_add_f32 v70, v70, v65
  v_add_f32 v70, v70, v66
  v_add_f32 v70, v70, v67
  v_add_f32 v70, v70, v68
  v_add_f32 v70, v70, v69
  s_nop 1
  v_add_f32_dpp v70, v70, v70 quad_perm:[1,0,3,2] row_mask:0xf bank_mask:0xf
  s_nop 1
  v_add_f32_dpp v70, v70, v70 quad_perm:[2,3,0,1] row_mask:0xf bank_mask:0xf
  s_nop 1
  v_add_f32_dpp v70, v70, v70 row_half_mirror row_mask:0xf bank_mask:0xf
  s_nop 1
  v_add_f32_dpp v70, v70, v70 row_mirror row_mask:0xf bank_mask:0xf
  v_mov_b32 v72, v70
  s_nop 1
  v_permlane16_swap_b32 v70, v72
  v_add_f32 v70, v70, v72
  v_mov_b32 v72, v70
  s_nop 1
  v_permlane32_swap_b32 v70, v72
  v_add_f32 v70, v70, v72
  v_mul_f32 v70, 0x3acccccd, v70
  v_sub_f32 v80, v60, v70
  v_sub_f32 v81, v61, v70
  v_sub_f32 v82, v62, v70
  v_sub_f32 v83, v63, v70
  v_sub_f32 v84, v64, v70
  v_sub_f32 v85, v65, v70
  v_sub_f32 v86, v66, v70
  v_sub_f32 v87, v67, v70
  v_sub_f32 v88, v68, v70
  v_sub_f32 v89, v69, v70
  v_mul_f32 v71, v80, v80
  v_fmac_f32 v71, v81, v81
  v_fmac_f32 v71, v82, v82
  v_fmac_f32 v71, v83, v83
  v_fmac_f32 v71, v84, v84
  v_fmac_f32 v71, v85, v85
  v_fmac_f32 v71, v86, v86
  v_fmac_f32 v71, v87, v87
  v_fmac_f32 v71, v88, v88
  v_fmac_f32 v71, v89, v89
  s_nop 1
  v_add_f32_dpp v71, v71, v71 quad_perm:[1,0,3,2] row_mask:0xf bank_mask:0xf
  s_nop 1
  v_add_f32_dpp v71, v71, v71 quad_perm:[2,3,0,1] row_mask:0xf bank_mask:0xf
  s_nop 1
  v_add_f32_dpp v71, v71, v71 row_half_mirror row_mask:0xf bank_mask:0xf
  s_nop 1
  v_add_f32_dpp v71, v71, v71 row_mirror row_mask:0xf bank_mask:0xf
  v_mov_b32 v72, v71
  s_nop 1
  v_permlane16_swap_b32 v71, v72
  v_add_f32 v71, v71, v72
  v_mov_b32 v72, v71
  s_nop 1
  v_permlane32_swap_b32 v71, v72
  v_add_f32 v71, v71, v72
  v_mul_f32 v71, 0x3acccccd, v71
  v_cvt_pk_bf16_f32 v70, v70, v70
  v_and_b32 v70, 0xffff0000, v70
  v_cvt_pk_bf16_f32 v71, v71, v71
  v_and_b32 v71, 0xffff0000, v71
  v_add_f32 v71, 0x3727c5ac, v71
  v_cvt_pk_bf16_f32 v71, v71, v71
  v_and_b32 v71, 0xffff0000, v71
  v_pk_add_f32 v[60:61], v[60:61], v[70:71] op_sel_hi:[1,0] neg_lo:[0,1] neg_hi:[0,1]
  v_pk_add_f32 v[62:63], v[62:63], v[70:71] op_sel_hi:[1,0] neg_lo:[0,1] neg_hi:[0,1]
  v_pk_add_f32 v[64:65], v[64:65], v[70:71] op_sel_hi:[1,0] neg_lo:[0,1] neg_hi:[0,1]
  v_pk_add_f32 v[66:67], v[66:67], v[70:71] op_sel_hi:[1,0] neg_lo:[0,1] neg_hi:[0,1]
  v_pk_add_f32 v[68:69], v[68:69], v[70:71] op_sel_hi:[1,0] neg_lo:[0,1] neg_hi:[0,1]
  v_sqrt_f32 v71, v71
  v_cvt_pk_bf16_f32 v74, v60, v61
  v_cvt_pk_bf16_f32 v75, v62, v63
  v_cvt_pk_bf16_f32 v76, v64, v65
  v_cvt_pk_bf16_f32 v77, v66, v67
  v_cvt_pk_bf16_f32 v78, v68, v69
  v_cvt_pk_bf16_f32 v71, v71, v71
  v_and_b32 v71, 0xffff0000, v71
  v_rcp_f32 v71, v71
  v_lshlrev_b32 v60, 16, v74
  v_and_b32 v61, 0xffff0000, v74
  v_lshlrev_b32 v62, 16, v75
  v_and_b32 v63, 0xffff0000, v75
  v_lshlrev_b32 v64, 16, v76
  v_and_b32 v65, 0xffff0000, v76
  v_lshlrev_b32 v66, 16, v77
  v_and_b32 v67, 0xffff0000, v77
  v_lshlrev_b32 v68, 16, v78
  v_and_b32 v69, 0xffff0000, v78
  v_pk_mul_f32 v[60:61], v[60:61], v[70:71] op_sel:[0,1] op_sel_hi:[1,1]
  v_pk_mul_f32 v[62:63], v[62:63], v[70:71] op_sel:[0,1] op_sel_hi:[1,1]
  v_pk_mul_f32 v[64:65], v[64:65], v[70:71] op_sel:[0,1] op_sel_hi:[1,1]
  v_pk_mul_f32 v[66:67], v[66:67], v[70:71] op_sel:[0,1] op_sel_hi:[1,1]
  v_pk_mul_f32 v[68:69], v[68:69], v[70:71] op_sel:[0,1] op_sel_hi:[1,1]
  v_cvt_pk_bf16_f32 v92, v60, v61
  v_cvt_pk_bf16_f32 v93, v62, v63
  v_cvt_pk_bf16_f32 v94, v64, v65
  v_cvt_pk_bf16_f32 v95, v66, v67
  v_cvt_pk_bf16_f32 v96, v68, v69
  s_add_u32 s46, s54, 18883328
  buffer_store_dwordx4 v[92:95], v1, s[4:7], s46 offen sc1
  buffer_store_dword v96, v1, s[4:7], s46 offen offset:16 sc1
  s_waitcnt vmcnt(0)
  v_readfirstlane_b32 s44, v149
  v_mov_b32 v150, 0
  s_mov_b32 s46, 64
  v_writelane_b32 v150, s46, 1
  s_mov_b32 s46, 128
  v_writelane_b32 v150, s46, 2
  s_mov_b32 s46, 132
  v_writelane_b32 v150, s46, 3
  s_mov_b32 s46, 136
  v_writelane_b32 v150, s46, 4
  s_mov_b32 s46, 192
  v_writelane_b32 v150, s46, 5
  s_mov_b32 s46, 196
  v_writelane_b32 v150, s46, 6
  s_mov_b32 s46, 200
  v_writelane_b32 v150, s46, 7
  s_mov_b32 s46, 140
  v_writelane_b32 v150, s46, 8
  s_mov_b64 exec, 0x1ff
gsF_45:
  buffer_load_dword v151, v150, s[8:11], 0 offen sc1
  s_waitcnt vmcnt(0)
  s_nop 0
  v_readlane_b32 s46, v151, 8
  s_cmp_ge_u32 s46, 256
  s_cbranch_scc1 gsokF_46
  s_add_u32 s45, s45, 1
  s_cmp_gt_u32 s45, 1048576
  s_cbranch_scc1 failaF_43
  s_sleep 4
  s_branch gsF_45
gsokF_46:
  buffer_load_dword v151, v150, s[8:11], 0 offen sc1
  s_waitcnt vmcnt(0)
  s_mov_b64 exec, 0xff
  v_cmp_ne_u32 vcc, 32, v151
  s_mov_b64 exec, -1
  s_cbranch_vccz balF_47
  s_getpc_b64 s[46:47]
pcF_48:
  s_add_u32 s46, s46, L_SAFE-pcF_48
  s_addc_u32 s47, s47, 0
  s_setpc_b64 s[46:47]
balF_47:
  s_waitcnt vmcnt(0)
  s_lshl_b32 s46, s53, 11
  s_lshl_b32 s47, s3, 9
  s_add_u32 s46, s46, s47
  s_add_u32 s46, s46, 0
  v_mov_b32 v2, 1
  buffer_store_dword v2, off, s[4:7], s46 sc1
  v_add_u32 v40, 0, v0
  v_mul_u32_u24 v41, 26215, v40
  v_lshrrev_b32 v41, 20, v41
  v_mul_u32_u24 v42, 40, v41
  v_sub_u32 v40, v40, v42
  v_lshlrev_b32 v40, 4, v40
  v_mul_u32_u24 v41, 1280, v41
  v_add_u32 v20, v40, v41
  v_add_u32 v40, 64, v0
  v_mul_u32_u24 v41, 26215, v40
  v_lshrrev_b32 v41, 20, v41
  v_mul_u32_u24 v42, 40, v41
  v_sub_u32 v40, v40, v42
  v_lshlrev_b32 v40, 4, v40
  v_mul_u32_u24 v41, 1280, v41
  v_add_u32 v21, v40, v41
  v_add_u32 v40, 128, v0
  v_mul_u32_u24 v41, 26215, v40
  v_lshrrev_b32 v41, 20, v41
  v_mul_u32_u24 v42, 40, v41
  v_sub_u32 v40, v40, v42
  v_lshlrev_b32 v40, 4, v40
  v_mul_u32_u24 v41, 1280, v41
  v_add_u32 v22, v40, v41
  v_add_u32 v40, 192, v0
  v_mul_u32_u24 v41, 26215, v40
  v_lshrrev_b32 v41, 20, v41
  v_mul_u32_u24 v42, 40, v41
  v_sub_u32 v40, v40, v42
  v_lshlrev_b32 v40, 4, v40
  v_mul_u32_u24 v41, 1280, v41
  v_add_u32 v23, v40, v41
  v_add_u32 v40, 256, v0
  v_mul_u32_u24 v41, 26215, v40
  v_lshrrev_b32 v41, 20, v41
  v_mul_u32_u24 v42, 40, v41
  v_sub_u32 v40, v40, v42
  v_lshlrev_b32 v40, 4, v40
  v_mul_u32_u24 v41, 1280, v41
  v_add_u32 v24, v40, v41
  s_mul_i32 s46, s3, 10240
  v_add_u32 v20, s46, v20
  v_add_u32 v21, s46, v21
  v_add_u32 v22, s46, v22
  v_add_u32 v23, s46, v23
  v_add_u32 v24, s46, v24
  s_mul_i32 s46, s43, 245760
  s_and_b32 s47, s43, 1
  s_mul_i32 s57, s47, 640
  s_add_u32 s46, s46, s57
  v_add_u32 v20, s46, v20
  v_add_u32 v21, s46, v21
  v_add_u32 v22, s46, v22
  v_add_u32 v23, s46, v23
  v_add_u32 v24, s46, v24
  s_mul_i32 s57, s47, 491520
  s_sub_u32 s57, 245760, s57
  v_add_u32 v52, s57, v20
  v_add_u32 v53, s57, v21
  v_add_u32 v54, s57, v22
  v_add_u32 v55, s57, v23
  v_add_u32 v56, s57, v24
  v_lshrrev_b32 v40, 4, v0
  v_mul_u32_u24 v40, 4, v40
  v_bfe_u32 v41, v0, 2, 2
  v_add_u32 v40, v40, v41
  v_mul_u32_u24 v40, 640, v40
  v_and_b32 v41, 3, v0
  v_mul_u32_u24 v41, 8, v41
  v_add_u32 v29, v40, v41
  s_mul_i32 s46, s3, 160
  v_add_u32 v29, s46, v29
  v_add_u32 v30, 0x10000, v29
  v_add_u32 v31, 0x20000, v29
  s_mul_i32 s56, s3, 5120
  s_mov_b32 s60, s26
  s_and_b32 s61, s27, 0xffff
  s_mov_b32 s62, 7864320
  s_mov_b32 s63, 0x20000
  s_sleep 127
  s_sleep 127
  s_mov_b32 s46, 0
  s_add_u32 m0, s56, 0
  s_nop 0
  buffer_load_dwordx4 v20, s[60:63], s46 offen lds
  s_mov_b32 s46, 0
  s_add_u32 m0, s56, 1024
  s_nop 0
  buffer_load_dwordx4 v21, s[60:63], s46 offen lds
  s_mov_b32 s46, 0
  s_add_u32 m0, s56, 2048
  s_nop 0
  buffer_load_dwordx4 v22, s[60:63], s46 offen lds
  s_mov_b32 s46, 0
  s_add_u32 m0, s56, 3072
  s_nop 0
  buffer_load_dwordx4 v23, s[60:63], s46 offen lds
  s_mov_b32 s46, 0
  s_add_u32 m0, s56, 4096
  s_nop 0
  buffer_load_dwordx4 v24, s[60:63], s46 offen lds
  s_mov_b32 s46, 40960
  s_add_u32 m0, s56, 20480
  s_nop 0
  buffer_load_dwordx4 v20, s[60:63], s46 offen lds
  s_mov_b32 s46, 40960
  s_add_u32 m0, s56, 21504
  s_nop 0
  buffer_load_dwordx4 v21, s[60:63], s46 offen lds
  s_mov_b32 s46, 40960
  s_add_u32 m0, s56, 22528
  s_nop 0
  buffer_load_dwordx4 v22, s[60:63], s46 offen lds
  s_mov_b32 s46, 40960
  s_add_u32 m0, s56, 23552
  s_nop 0
  buffer_load_dwordx4 v23, s[60:63], s46 offen lds
  s_mov_b32 s46, 40960
  s_add_u32 m0, s56, 24576
  s_nop 0
  buffer_load_dwordx4 v24, s[60:63], s46 offen lds
  s_mov_b32 s46, 81920
  s_add_u32 m0, s56, 40960
  s_nop 0
  buffer_load_dwordx4 v20, s[60:63], s46 offen lds
  s_mov_b32 s46, 81920
  s_add_u32 m0, s56, 41984
  s_nop 0
  buffer_load_dwordx4 v21, s[60:63], s46 offen lds
  s_mov_b32 s46, 81920
  s_add_u32 m0, s56, 43008
  s_nop 0
  buffer_load_dwordx4 v22, s[60:63], s46 offen lds
  s_mov_b32 s46, 81920
  s_add_u32 m0, s56, 44032
  s_nop 0
  buffer_load_dwordx4 v23, s[60:63], s46 offen lds
  s_mov_b32 s46, 81920
  s_add_u32 m0, s56, 45056
  s_nop 0
  buffer_load_dwordx4 v24, s[60:63], s46 offen lds
  s_mov_b32 s46, 122880
  s_add_u32 m0, s56, 61440
  s_nop 0
  buffer_load_dwordx4 v20, s[60:63], s46 offen lds
  s_mov_b32 s46, 122880
  s_add_u32 m0, s56, 62464
  s_nop 0
  buffer_load_dwordx4 v21, s[60:63], s46 offen lds
  s_mov_b32 s46, 122880
  s_add_u32 m0, s56, 63488
  s_nop 0
  buffer_load_dwordx4 v22, s[60:63], s46 offen lds
  s_mov_b32 s46, 122880
  s_add_u32 m0, s56, 64512
  s_nop 0
  buffer_load_dwordx4 v23, s[60:63], s46 offen lds
  s_mov_b32 s46, 122880
  s_add_u32 m0, s56, 65536
  s_nop 0
  buffer_load_dwordx4 v24, s[60:63], s46 offen lds
  s_mov_b32 s46, 163840
  s_add_u32 m0, s56, 81920
  s_nop 0
  buffer_load_dwordx4 v20, s[60:63], s46 offen lds
  s_mov_b32 s46, 163840
  s_add_u32 m0, s56, 82944
  s_nop 0
  buffer_load_dwordx4 v21, s[60:63], s46 offen lds
  s_mov_b32 s46, 163840
  s_add_u32 m0, s56, 83968
  s_nop 0
  buffer_load_dwordx4 v22, s[60:63], s46 offen lds
  s_mov_b32 s46, 163840
  s_add_u32 m0, s56, 84992
  s_nop 0
  buffer_load_dwordx4 v23, s[60:63], s46 offen lds
  s_mov_b32 s46, 163840
  s_add_u32 m0, s56, 86016
  s_nop 0
  buffer_load_dwordx4 v24, s[60:63], s46 offen lds
  s_mov_b32 s46, 204800
  s_add_u32 m0, s56, 102400
  s_nop 0
  buffer_load_dwordx4 v20, s[60:63], s46 offen lds
  s_mov_b32 s46, 204800
  s_add_u32 m0, s56, 103424
  s_nop 0
  buffer_load_dwordx4 v21, s[60:63], s46 offen lds
  s_mov_b32 s46, 204800
  s_add_u32 m0, s56, 104448
  s_nop 0
  buffer_load_dwordx4 v22, s[60:63], s46 offen lds
  s_mov_b32 s46, 204800
  s_add_u32 m0, s56, 105472
  s_nop 0
  buffer_load_dwordx4 v23, s[60:63], s46 offen lds
  s_mov_b32 s46, 204800
  s_add_u32 m0, s56, 106496
  s_nop 0
  buffer_load_dwordx4 v24, s[60:63], s46 offen lds
  s_mov_b32 s46, 0
  s_add_u32 m0, s56, 122880
  s_nop 0
  buffer_load_dwordx4 v52, s[60:63], s46 offen lds
  s_mov_b32 s46, 0
  s_add_u32 m0, s56, 123904
  s_nop 0
  buffer_load_dwordx4 v53, s[60:63], s46 offen lds
  s_mov_b32 s46, 0
  s_add_u32 m0, s56, 124928
  s_nop 0
  buffer_load_dwordx4 v54, s[60:63], s46 offen lds
  s_mov_b32 s46, 0
  s_add_u32 m0, s56, 125952
  s_nop 0
  buffer_load_dwordx4 v55, s[60:63], s46 offen lds
  s_mov_b32 s46, 0
  s_add_u32 m0, s56, 126976
  s_nop 0
  buffer_load_dwordx4 v56, s[60:63], s46 offen lds
  s_mov_b32 s46, 40960
  s_add_u32 m0, s56, 143360
  s_nop 0
  buffer_load_dwordx4 v52, s[60:63], s46 offen lds
  s_mov_b32 s46, 40960
  s_add_u32 m0, s56, 144384
  s_nop 0
  buffer_load_dwordx4 v53, s[60:63], s46 offen lds
  s_mov_b32 s46, 40960
  s_add_u32 m0, s56, 145408
  s_nop 0
  buffer_load_dwordx4 v54, s[60:63], s46 offen lds
  s_mov_b32 s46, 40960
  s_add_u32 m0, s56, 146432
  s_nop 0
  buffer_load_dwordx4 v55, s[60:63], s46 offen lds
  s_mov_b32 s46, 40960
  s_add_u32 m0, s56, 147456
  s_nop 0
  buffer_load_dwordx4 v56, s[60:63], s46 offen lds
  s_waitcnt vmcnt(35)
  s_barrier
  ds_read_b64_tr_b16 a[0:1], v29 offset:0
  ds_read_b64_tr_b16 a[2:3], v29 offset:10240
  ds_read_b64_tr_b16 a[48:49], v29 offset:32
  ds_read_b64_tr_b16 a[50:51], v29 offset:10272
  ds_read_b64_tr_b16 a[96:97], v29 offset:64
  ds_read_b64_tr_b16 a[98:99], v29 offset:10304
  ds_read_b64_tr_b16 a[144:145], v29 offset:96
  ds_read_b64_tr_b16 a[146:147], v29 offset:10336
  ds_read_b64_tr_b16 a[192:193], v29 offset:128
  ds_read_b64_tr_b16 a[194:195], v29 offset:10368
  s_waitcnt lgkmcnt(0)
  s_waitcnt vmcnt(30)
  s_barrier
  s_mov_b32 s46, 81920
  s_add_u32 m0, s56, 0
  s_nop 0
  buffer_load_dwordx4 v52, s[60:63], s46 offen lds
  s_mov_b32 s46, 81920
  s_add_u32 m0, s56, 1024
  s_nop 0
  buffer_load_dwordx4 v53, s[60:63], s46 offen lds
  s_mov_b32 s46, 81920
  s_add_u32 m0, s56, 2048
  s_nop 0
  buffer_load_dwordx4 v54, s[60:63], s46 offen lds
  s_mov_b32 s46, 81920
  s_add_u32 m0, s56, 3072
  s_nop 0
  buffer_load_dwordx4 v55, s[60:63], s46 offen lds
  s_mov_b32 s46, 81920
  s_add_u32 m0, s56, 4096
  s_nop 0
  buffer_load_dwordx4 v56, s[60:63], s46 offen lds
  ds_read_b64_tr_b16 a[4:5], v29 offset:20480
  ds_read_b64_tr_b16 a[6:7], v29 offset:30720
  ds_read_b64_tr_b16 a[52:53], v29 offset:20512
  ds_read_b64_tr_b16 a[54:55], v29 offset:30752
  ds_read_b64_tr_b16 a[100:101], v29 offset:20544
  ds_read_b64_tr_b16 a[102:103], v29 offset:30784
  ds_read_b64_tr_b16 a[148:149], v29 offset:20576
  ds_read_b64_tr_b16 a[150:151], v29 offset:30816
  ds_read_b64_tr_b16 a[196:197], v29 offset:20608
  ds_read_b64_tr_b16 a[198:199], v29 offset:30848
  s_waitcnt lgkmcnt(0)
  s_waitcnt vmcnt(30)
  s_barrier
  s_mov_b32 s46, 122880
  s_add_u32 m0, s56, 20480
  s_nop 0
  buffer_load_dwordx4 v52, s[60:63], s46 offen lds
  s_mov_b32 s46, 122880
  s_add_u32 m0, s56, 21504
  s_nop 0
  buffer_load_dwordx4 v53, s[60:63], s46 offen lds
  s_mov_b32 s46, 122880
  s_add_u32 m0, s56, 22528
  s_nop 0
  buffer_load_dwordx4 v54, s[60:63], s46 offen lds
  s_mov_b32 s46, 122880
  s_add_u32 m0, s56, 23552
  s_nop 0
  buffer_load_dwordx4 v55, s[60:63], s46 offen lds
  s_mov_b32 s46, 122880
  s_add_u32 m0, s56, 24576
  s_nop 0
  buffer_load_dwordx4 v56, s[60:63], s46 offen lds
  ds_read_b64_tr_b16 a[8:9], v29 offset:40960
  ds_read_b64_tr_b16 a[10:11], v29 offset:51200
  ds_read_b64_tr_b16 a[56:57], v29 offset:40992
  ds_read_b64_tr_b16 a[58:59], v29 offset:51232
  ds_read_b64_tr_b16 a[104:105], v29 offset:41024
  ds_read_b64_tr_b16 a[106:107], v29 offset:51264
  ds_read_b64_tr_b16 a[152:153], v29 offset:41056
  ds_read_b64_tr_b16 a[154:155], v29 offset:51296
  ds_read_b64_tr_b16 a[200:201], v29 offset:41088
  ds_read_b64_tr_b16 a[202:203], v29 offset:51328
  s_waitcnt lgkmcnt(0)
  s_waitcnt vmcnt(30)
  s_barrier
  s_mov_b32 s46, 163840
  s_add_u32 m0, s56, 40960
  s_nop 0
  buffer_load_dwordx4 v52, s[60:63], s46 offen lds
  s_mov_b32 s46, 163840
  s_add_u32 m0, s56, 41984
  s_nop 0
  buffer_load_dwordx4 v53, s[60:63], s46 offen lds
  s_mov_b32 s46, 163840
  s_add_u32 m0, s56, 43008
  s_nop 0
  buffer_load_dwordx4 v54, s[60:63], s46 offen lds
  s_mov_b32 s46, 163840
  s_add_u32 m0, s56, 44032
  s_nop 0
  buffer_load_dwordx4 v55, s[60:63], s46 offen lds
  s_mov_b32 s46, 163840
  s_add_u32 m0, s56, 45056
  s_nop 0
  buffer_load_dwordx4 v56, s[60:63], s46 offen lds
  ds_read_b64_tr_b16 a[12:13], v29 offset:61440
  ds_read_b64_tr_b16 a[14:15], v30 offset:6144
  ds_read_b64_tr_b16 a[60:61], v29 offset:61472
  ds_read_b64_tr_b16 a[62:63], v30 offset:6176
  ds_read_b64_tr_b16 a[108:109], v29 offset:61504
  ds_read_b64_tr_b16 a[110:111], v30 offset:6208
  ds_read_b64_tr_b16 a[156:157], v29 offset:61536
  ds_read_b64_tr_b16 a[158:159], v30 offset:6240
  ds_read_b64_tr_b16 a[204:205], v29 offset:61568
  ds_read_b64_tr_b16 a[206:207], v30 offset:6272
  s_waitcnt lgkmcnt(0)
  s_waitcnt vmcnt(30)
  s_barrier
  s_mov_b32 s46, 204800
  s_add_u32 m0, s56, 61440
  s_nop 0
  buffer_load_dwordx4 v52, s[60:63], s46 offen lds
  s_mov_b32 s46, 204800
  s_add_u32 m0, s56, 62464
  s_nop 0
  buffer_load_dwordx4 v53, s[60:63], s46 offen lds
  s_mov_b32 s46, 204800
  s_add_u32 m0, s56, 63488
  s_nop 0
  buffer_load_dwordx4 v54, s[60:63], s46 offen lds
  s_mov_b32 s46, 204800
  s_add_u32 m0, s56, 64512
  s_nop 0
  buffer_load_dwordx4 v55, s[60:63], s46 offen lds
  s_mov_b32 s46, 204800
  s_add_u32 m0, s56, 65536
  s_nop 0
  buffer_load_dwordx4 v56, s[60:63], s46 offen lds
  ds_read_b64_tr_b16 a[16:17], v30 offset:16384
  ds_read_b64_tr_b16 a[18:19], v30 offset:26624
  ds_read_b64_tr_b16 a[64:65], v30 offset:16416
  ds_read_b64_tr_b16 a[66:67], v30 offset:26656
  ds_read_b64_tr_b16 a[112:113], v30 offset:16448
  ds_read_b64_tr_b16 a[114:115], v30 offset:26688
  ds_read_b64_tr_b16 a[160:161], v30 offset:16480
  ds_read_b64_tr_b16 a[162:163], v30 offset:26720
  ds_read_b64_tr_b16 a[208:209], v30 offset:16512
  ds_read_b64_tr_b16 a[210:211], v30 offset:26752
  s_waitcnt lgkmcnt(0)
  s_waitcnt vmcnt(30)
  s_barrier
  ds_read_b64_tr_b16 a[20:21], v30 offset:36864
  ds_read_b64_tr_b16 a[22:23], v30 offset:47104
  ds_read_b64_tr_b16 a[68:69], v30 offset:36896
  ds_read_b64_tr_b16 a[70:71], v30 offset:47136
  ds_read_b64_tr_b16 a[116:117], v30 offset:36928
  ds_read_b64_tr_b16 a[118:119], v30 offset:47168
  ds_read_b64_tr_b16 a[164:165], v30 offset:36960
  ds_read_b64_tr_b16 a[166:167], v30 offset:47200
  ds_read_b64_tr_b16 a[212:213], v30 offset:36992
  ds_read_b64_tr_b16 a[214:215], v30 offset:47232
  s_waitcnt lgkmcnt(0)
  s_waitcnt vmcnt(25)
  s_barrier
  ds_read_b64_tr_b16 a[24:25], v30 offset:57344
  ds_read_b64_tr_b16 a[26:27], v31 offset:2048
  ds_read_b64_tr_b16 a[72:73], v30 offset:57376
  ds_read_b64_tr_b16 a[74:75], v31 offset:2080
  ds_read_b64_tr_b16 a[120:121], v30 offset:57408
  ds_read_b64_tr_b16 a[122:123], v31 offset:2112
  ds_read_b64_tr_b16 a[168:169], v30 offset:57440
  ds_read_b64_tr_b16 a[170:171], v31 offset:2144
  ds_read_b64_tr_b16 a[216:217], v30 offset:57472
  ds_read_b64_tr_b16 a[218:219], v31 offset:2176
  s_waitcnt lgkmcnt(0)
  s_waitcnt vmcnt(20)
  s_barrier
  ds_read_b64_tr_b16 a[28:29], v31 offset:12288
  ds_read_b64_tr_b16 a[30:31], v31 offset:22528
  ds_read_b64_tr_b16 a[76:77], v31 offset:12320
  ds_read_b64_tr_b16 a[78:79], v31 offset:22560
  ds_read_b64_tr_b16 a[124:125], v31 offset:12352
  ds_read_b64_tr_b16 a[126:127], v31 offset:22592
  ds_read_b64_tr_b16 a[172:173], v31 offset:12384
  ds_read_b64_tr_b16 a[174:175], v31 offset:22624
  ds_read_b64_tr_b16 a[220:221], v31 offset:12416
  ds_read_b64_tr_b16 a[222:223], v31 offset:22656
  s_waitcnt lgkmcnt(0)
  s_waitcnt vmcnt(15)
  s_barrier
  ds_read_b64_tr_b16 a[32:33], v29 offset:0
  ds_read_b64_tr_b16 a[34:35], v29 offset:10240
  ds_read_b64_tr_b16 a[80:81], v29 offset:32
  ds_read_b64_tr_b16 a[82:83], v29 offset:10272
  ds_read_b64_tr_b16 a[128:129], v29 offset:64
  ds_read_b64_tr_b16 a[130:131], v29 offset:10304
  ds_read_b64_tr_b16 a[176:177], v29 offset:96
  ds_read_b64_tr_b16 a[178:179], v29 offset:10336
  ds_read_b64_tr_b16 a[224:225], v29 offset:128
  ds_read_b64_tr_b16 a[226:227], v29 offset:10368
  s_waitcnt lgkmcnt(0)
  s_waitcnt vmcnt(10)
  s_barrier
  ds_read_b64_tr_b16 a[36:37], v29 offset:20480
  ds_read_b64_tr_b16 a[38:39], v29 offset:30720
  ds_read_b64_tr_b16 a[84:85], v29 offset:20512
  ds_read_b64_tr_b16 a[86:87], v29 offset:30752
  ds_read_b64_tr_b16 a[132:133], v29 offset:20544
  ds_read_b64_tr_b16 a[134:135], v29 offset:30784
  ds_read_b64_tr_b16 a[180:181], v29 offset:20576
  ds_read_b64_tr_b16 a[182:183], v29 offset:30816
  ds_read_b64_tr_b16 a[228:229], v29 offset:20608
  ds_read_b64_tr_b16 a[230:231], v29 offset:30848
  s_waitcnt lgkmcnt(0)
  s_waitcnt vmcnt(5)
  s_barrier
  ds_read_b64_tr_b16 a[40:41], v29 offset:40960
  ds_read_b64_tr_b16 a[42:43], v29 offset:51200
  ds_read_b64_tr_b16 a[88:89], v29 offset:40992
  ds_read_b64_tr_b16 a[90:91], v29 offset:51232
  ds_read_b64_tr_b16 a[136:137], v29 offset:41024
  ds_read_b64_tr_b16 a[138:139], v29 offset:51264
  ds_read_b64_tr_b16 a[184:185], v29 offset:41056
  ds_read_b64_tr_b16 a[186:187], v29 offset:51296
  ds_read_b64_tr_b16 a[232:233], v29 offset:41088
  ds_read_b64_tr_b16 a[234:235], v29 offset:51328
  s_waitcnt lgkmcnt(0)
  s_waitcnt vmcnt(0)
  s_barrier
  ds_read_b64_tr_b16 a[44:45], v29 offset:61440
  ds_read_b64_tr_b16 a[46:47], v30 offset:6144
  ds_read_b64_tr_b16 a[92:93], v29 offset:61472
  ds_read_b64_tr_b16 a[94:95], v30 offset:6176
  ds_read_b64_tr_b16 a[140:141], v29 offset:61504
  ds_read_b64_tr_b16 a[142:143], v30 offset:6208
  ds_read_b64_tr_b16 a[188:189], v29 offset:61536
  ds_read_b64_tr_b16 a[190:191], v30 offset:6240
  ds_read_b64_tr_b16 a[236:237], v29 offset:61568
  ds_read_b64_tr_b16 a[238:239], v30 offset:6272
  s_waitcnt lgkmcnt(0)
  s_barrier
  s_mov_b32 s48, 0x00ff00ff
  s_mov_b32 s49, 0x00ff00ff
  s_mov_b32 s50, 0x00ff00ff
  s_mov_b32 s51, 0xff00ff00
  v_and_b32 v30, 1, v0
  v_lshlrev_b32 v30, 4, v30
  v_mov_b32 v31, 0x3f80
  v_lshlrev_b32 v30, v30, v31
  v_bfe_u32 v31, v0, 1, 2
  v_cmp_eq_u32 vcc, 0, v31
  s_nop 1
  v_cndmask_b32 v24, 0, v30, vcc
  v_cmp_eq_u32 vcc, 1, v31
  s_nop 1
  v_cndmask_b32 v25, 0, v30, vcc
  v_cmp_eq_u32 vcc, 2, v31
  s_nop 1
  v_cndmask_b32 v26, 0, v30, vcc
  v_cmp_eq_u32 vcc, 3, v31
  s_nop 1
  v_cndmask_b32 v27, 0, v30, vcc
  v_cndmask_b32 v20, 0, v24, s[50:51]
  v_cndmask_b32 v21, 0, v25, s[50:51]
  v_cndmask_b32 v22, 0, v26, s[50:51]
  v_cndmask_b32 v23, 0, v27, s[50:51]
  s_mov_b32 s56, 0x03ff03ff
  s_mov_b32 s57, 0x03ff03ff
  s_and_b32 s53, s3, 1
  s_lshr_b32 s54, s3, 1
  v_lshlrev_b32 v1, 4, v0
  v_lshlrev_b32 v2, 5, v0
  v_lshlrev_b32 v30, 3, v0
  s_lshl_b32 s46, s53, 10
  v_add_u32 v3, s46, v1
  s_lshl_b32 s46, s53, 3
  v_add_u32 v4, s46, v1
  s_mul_i32 s46, s54, 6144
  v_add_u32 v5, s46, v1
  v_add_u32 v6, 36864, v1
  v_add_u32 v11, 36864, v30
  s_mul_i32 s46, s54, 3072
  v_add_u32 v7, s46, v6
  v_add_u32 v8, s46, v11
  s_mul_i32 s46, s53, 6144
  s_mul_i32 s47, s54, 3072
  s_add_u32 s46, s46, s47
  s_add_u32 s46, s46, 49152
  v_add_u32 v9, s46, v1
  v_add_u32 v10, 49152, v1
  s_mul_i32 s46, s3, 5632
  s_add_u32 s46, s46, 74752
  v_and_b32 v33, 15, v0
  v_mul_u32_u24 v33, 176, v33
  v_lshrrev_b32 v34, 4, v0
  v_lshlrev_b32 v34, 3, v34
  v_add3_u32 v12, v33, v34, s46
  v_add_u32 v33, 0, v0
  v_mul_u32_u24 v34, 6554, v33
  v_lshrrev_b32 v34, 16, v34
  v_add_u32 v33, v33, v34
  v_lshlrev_b32 v33, 4, v33
  v_add_u32 v26, s46, v33
  v_add_u32 v33, 64, v0
  v_mul_u32_u24 v34, 6554, v33
  v_lshrrev_b32 v34, 16, v34
  v_add_u32 v33, v33, v34
  v_lshlrev_b32 v33, 4, v33
  v_add_u32 v27, s46, v33
  v_add_u32 v33, 128, v0
  v_mul_u32_u24 v34, 6554, v33
  v_lshrrev_b32 v34, 16, v34
  v_add_u32 v33, v33, v34
  v_lshlrev_b32 v33, 4, v33
  v_add_u32 v28, s46, v33
  v_add_u32 v33, 192, v0
  v_mul_u32_u24 v34, 6554, v33
  v_lshrrev_b32 v34, 16, v34
  v_add_u32 v33, v33, v34
  v_lshlrev_b32 v33, 4, v33
  v_add_u32 v29, s46, v33
  v_add_u32 v33, 256, v0
  v_mul_u32_u24 v34, 6554, v33
  v_lshrrev_b32 v34, 16, v34
  v_add_u32 v33, v33, v34
  v_lshlrev_b32 v33, 4, v33
  v_add_u32 v30, s46, v33
  v_and_b32 v31, 15, v0
  v_lshrrev_b32 v32, 4, v0
  v_lshrrev_b32 v36, 5, v0
  v_lshlrev_b32 v34, 4, v31
  v_mov_b32 v35, 0x40000000
  v_cndmask_b32 v35, v35, 0, s[56:57]
  v_add_u32 v33, v34, v35
  v_and_b32 v34, 1, v32
  v_mul_u32_u24 v35, 40960, v34
  v_mul_u32_u24 v37, 5120, v36
  v_add3_u32 v14, v33, v35, v37
  v_lshlrev_b32 v34, 3, v34
  v_mul_u32_u24 v37, 160, v36
  v_add3_u32 v33, v33, v34, v37
  s_mul_i32 s46, s3, 320
  v_add_u32 v15, s46, v33
  s_lshl_b32 s46, s3, 3
  s_add_u32 s46, s46, 73728
  v_mov_b32 v16, s46
  v_mov_b32 v17, 73728
  v_lshlrev_b32 v32, 2, v32
  s_cmp_eq_u32 s53, 1
  s_cselect_b64 s[46:47], -1, 0
  v_add_u32 v33, 0, v32
  v_cmp_le_u32 vcc, v33, v31
  s_or_b64 s[64:65], vcc, s[46:47]
  s_and_b64 s[72:73], vcc, s[46:47]
  v_add_u32 v33, 1, v32
  v_cmp_le_u32 vcc, v33, v31
  s_or_b64 s[66:67], vcc, s[46:47]
  s_and_b64 s[74:75], vcc, s[46:47]
  v_add_u32 v33, 2, v32
  v_cmp_le_u32 vcc, v33, v31
  s_or_b64 s[68:69], vcc, s[46:47]
  s_and_b64 s[76:77], vcc, s[46:47]
  v_add_u32 v33, 3, v32
  v_cmp_le_u32 vcc, v33, v31
  s_or_b64 s[70:71], vcc, s[46:47]
  s_and_b64 s[78:79], vcc, s[46:47]
  s_cmp_eq_u32 s52, 0
  s_cselect_b32 s80, -1, 0
  s_cselect_b32 s81, 0, -1
  v_lshlrev_b32 v34, 27, v34
  v_add_u32 v31, v34, v15
  v_mov_b32 v33, 138752
  v_add_u32 v157, 136192, v15
  v_cndmask_b32 v157, v33, v157, s[56:57]
  v_add_u32 v158, 136192, v1
  v_add_u32 v159, 1024, v1
  v_add_u32 v33, 5242624, v1
  v_cmp_gt_u32 vcc, 16, v0
  s_nop 1
  v_cndmask_b32 v159, v33, v159, vcc
  v_add_u32 v247, 768, v1
  v_mov_b32 v33, 0x40000000
  v_cmp_gt_u32 vcc, 32, v0
  s_nop 1
  v_cndmask_b32 v247, v33, v247, vcc
  s_lshl_b32 s83, s52, 6
  s_mul_i32 s85, s83, 393216
  s_mul_i32 s46, s43, 12288
  s_add_u32 s85, s85, s46
  s_mul_i32 s47, s3, 3072
  s_add_u32 s85, s85, s47
  s_add_u32 s85, s85, 69206016
  s_lshl_b32 s86, s83, 14
  s_lshl_b32 s95, s43, 9
  s_add_u32 s86, s86, s95
  s_add_u32 s86, s86, 1441792
  s_mul_i32 s87, s52, 3145728
  s_add_u32 s87, s87, s46
  s_add_u32 s87, s87, s47
  s_add_u32 s87, s87, 37748736
  s_mul_i32 s88, s52, 65536
  s_lshl_b32 s95, s43, 8
  s_add_u32 s88, s88, s95
  s_add_u32 s88, s88, 794624
  s_mul_i32 s90, s52, 1310720
  s_add_u32 s90, s90, 7077888
  s_mul_i32 s95, s43, 20480
  s_add_u32 s89, s90, s95
  s_mul_i32 s95, s3, 5120
  s_add_u32 s89, s89, s95
  s_mul_i32 s95, s43, 160
  s_add_u32 s90, s90, s95
  s_mul_i32 s95, s54, 20480
  s_add_u32 s90, s90, s95
  s_mul_i32 s95, s53, 10240
  s_add_u32 s90, s90, s95
  s_lshl_b32 s62, s52, 6
  s_add_u32 s62, s62, s43
  s_xor_b32 s63, s62, 1
  s_mul_i32 s62, s62, 12288
  s_mul_i32 s63, s63, 12288
  s_add_u32 s95, s47, 9699328
  s_add_u32 s62, s62, s95
  s_add_u32 s63, s63, s95
  s_mul_i32 s95, s43, 1280
  s_mul_i32 s91, s52, 34603008
  s_add_u32 s91, s91, s95
  s_mul_i32 s92, s83, 40960
  s_add_u32 s92, s92, s95
  s_add_u32 s92, s92, 29360128
  s_lshl_b32 s93, s83, 12
  s_lshl_b32 s95, s43, 5
  s_add_u32 s93, s93, s95
  s_add_u32 s93, s93, 258048
  s_mov_b32 s58, s47
  s_mov_b32 s96, 0x3fb8aa3b
  s_mov_b32 s97, 0x3d93cd3a
  s_mov_b32 s82, 0
  s_cmp_eq_u32 s52, 0
  s_cselect_b32 s12, s16, s40
  s_cselect_b32 s13, s17, s41
  s_mov_b32 s14, 0x10000000
  s_cselect_b32 s14, 2621440, s14
  s_and_b32 s13, s13, 0xffff
  s_mov_b32 s15, 0x20000
  v_and_b32 v156, 7, v0
  v_lshlrev_b32 v156, 5, v156
  v_min_u32 v2, 352, v2
fwF_49:
  buffer_load_dword v13, v2, s[4:7], s86 offen sc1
  s_waitcnt vmcnt(0)
fcF_51:
  v_cmp_eq_u32 vcc, 0, v13
  s_cbranch_vccz foF_50
  s_add_u32 s45, s45, 1
  s_cmp_gt_u32 s45, 1048576
  s_cbranch_scc1 failaF_43
  s_sleep 4
  s_branch fwF_49
foF_50:
  s_mov_b32 s94, 0
  s_mov_b32 s59, s58
  s_mov_b32 s30, 0x10000000
  s_mov_b32 s31, 0
  s_add_u32 m0, s59, 0
  s_add_u32 s47, s85, 0
  buffer_load_dwordx4 v1, s[4:7], s47 offen offset:0 sc1 nt lds
  buffer_load_dwordx4 v1, s[4:7], s47 offen offset:1024 sc1 nt lds
  buffer_load_dwordx4 v1, s[4:7], s47 offen offset:2048 sc1 nt lds
  s_add_u32 m0, s59, 12288
  s_add_u32 s47, s85, 50331648
  buffer_load_dwordx4 v1, s[4:7], s47 offen offset:0 sc1 nt lds
  buffer_load_dwordx4 v1, s[4:7], s47 offen offset:1024 sc1 nt lds
  buffer_load_dwordx4 v1, s[4:7], s47 offen offset:2048 sc1 nt lds
  s_add_u32 m0, s59, 24576
  s_add_u32 s47, s85, 100663296
  buffer_load_dwordx4 v1, s[4:7], s47 offen offset:0 sc1 nt lds
  buffer_load_dwordx4 v1, s[4:7], s47 offen offset:1024 sc1 nt lds
  buffer_load_dwordx4 v1, s[4:7], s47 offen offset:2048 sc1 nt lds
  s_waitcnt vmcnt(0)
  s_barrier
  s_mov_b32 s2, 0
  s_mov_b32 s1, s90
  s_mov_b32 s0, 0x20000000
  buffer_load_dword v18, v156, s[4:7], s88 offen sc1
  v_add_u32 v92, s94, v3
  v_add_u32 v93, s94, v1
  v_add_u32 v94, s94, v4
  ds_read_b128 v[32:35], v92 offset:0
  ds_read_b128 v[160:163], v93 offset:12288
  ds_read_b128 v[176:179], v93 offset:13312
  ds_read_b128 v[36:39], v92 offset:3072
  ds_read_b128 v[164:167], v93 offset:15360
  ds_read_b128 v[180:183], v93 offset:16384
  ds_read_b128 v[40:43], v92 offset:6144
  ds_read_b128 v[168:171], v93 offset:18432
  ds_read_b128 v[184:187], v93 offset:19456
  ds_read_b128 v[44:47], v92 offset:9216
  ds_read_b128 v[172:175], v93 offset:21504
  ds_read_b128 v[188:191], v93 offset:22528
  s_waitcnt lgkmcnt(9)
  v_mfma_f32_16x16x32_bf16 v[80:83], v[160:163], v[32:35], 0
  v_mfma_f32_16x16x32_bf16 v[84:87], v[176:179], v[32:35], 0
  ds_read_b64 v[48:49], v94 offset:2048
  ds_read_b128 v[192:195], v93 offset:14336
  s_waitcnt lgkmcnt(8)
  v_mfma_f32_16x16x32_bf16 v[80:83], v[164:167], v[36:39], v[80:83]
  v_mfma_f32_16x16x32_bf16 v[84:87], v[180:183], v[36:39], v[84:87]
  ds_read_b64 v[50:51], v94 offset:5120
  ds_read_b128 v[196:199], v93 offset:17408
  s_waitcnt lgkmcnt(7)
  v_mfma_f32_16x16x32_bf16 v[80:83], v[168:171], v[40:43], v[80:83]
  v_mfma_f32_16x16x32_bf16 v[84:87], v[184:187], v[40:43], v[84:87]
  ds_read_b64 v[52:53], v94 offset:8192
  ds_read_b128 v[200:203], v93 offset:20480
  s_waitcnt lgkmcnt(6)
  v_mfma_f32_16x16x32_bf16 v[80:83], v[172:175], v[44:47], v[80:83]
  v_mfma_f32_16x16x32_bf16 v[84:87], v[188:191], v[44:47], v[84:87]
  ds_read_b64 v[54:55], v94 offset:11264
  ds_read_b128 v[204:207], v93 offset:23552
  s_nop 1
  s_waitcnt lgkmcnt(6)
  v_mfma_f32_16x16x16_bf16 v[96:99], v[192:193], v[48:49], 0
  v_mfma_f32_16x16x16_bf16 v[100:103], v[194:195], v[48:49], 0
  s_waitcnt lgkmcnt(4)
  v_mfma_f32_16x16x16_bf16 v[96:99], v[196:197], v[50:51], v[96:99]
  v_mfma_f32_16x16x16_bf16 v[100:103], v[198:199], v[50:51], v[100:103]
  s_waitcnt lgkmcnt(2)
  v_mfma_f32_16x16x16_bf16 v[96:99], v[200:201], v[52:53], v[96:99]
  v_mfma_f32_16x16x16_bf16 v[100:103], v[202:203], v[52:53], v[100:103]
  s_waitcnt lgkmcnt(0)
  v_mfma_f32_16x16x16_bf16 v[96:99], v[204:205], v[54:55], v[96:99]
  v_mfma_f32_16x16x16_bf16 v[100:103], v[206:207], v[54:55], v[100:103]
  s_mov_b64 s[98:99], 0
  s_mov_b64 s[100:101], 0
  .p2align 6
topF_52:
  s_cmp_lt_u32 s82, 63
  s_cselect_b32 s46, 16384, 0
  s_cselect_b32 s47, 393216, 0
  s_add_u32 s86, s86, s46
  s_add_u32 s85, s85, s47
  v_add_u32 v19, s94, v5
  s_sub_u32 s94, 98304, s94
  s_add_u32 s59, s58, s94
  s_cmp_eq_u32 s3, 0
  s_cselect_b32 s30, s30, 0x10000000
  s_waitcnt vmcnt(0)
  s_barrier
  s_cmp_eq_u32 s31, 1
  s_cbranch_scc1 e2F_54
  v_cmp_eq_u32 vcc, 0, v18
  s_cbranch_vccz hkF_53
  v_mov_b32 v92, 1
  s_waitcnt vmcnt(63)
  buffer_store_dword v92, off, s[4:7], s30 sc1
  s_mov_b32 s30, 0x10000000
fwF_55:
  buffer_load_dword v18, v156, s[4:7], s88 offen sc1
  s_waitcnt vmcnt(0)
fcF_57:
  v_cmp_eq_u32 vcc, 0, v18
  s_cbranch_vccz foF_56
  s_add_u32 s45, s45, 1
  s_cmp_gt_u32 s45, 1048576
  s_cbranch_scc1 failaF_43
  s_branch fwF_55
foF_56:
hkF_53:
  s_add_u32 m0, s58, 36864
  s_nop 0
  buffer_load_dwordx4 v1, s[4:7], s87 offen offset:0 sc1 lds
  buffer_load_dwordx4 v1, s[4:7], s87 offen offset:1024 sc1 lds
  buffer_load_dwordx4 v1, s[4:7], s87 offen offset:2048 sc1 lds
e2F_54:
  v_mov_b32 v92, 1
  s_waitcnt vmcnt(63)
  buffer_store_dword v92, off, s[4:7], s30 sc1
  s_mov_b32 s30, 0x10000000
  buffer_load_dword v13, v2, s[4:7], s86 offen sc1
  buffer_load_dwordx2 v[24:25], v15, s[12:15], s91 offen sc1
  s_mov_b32 s46, s1
  buffer_load_dwordx4 v[160:163], v14, s[4:7], s46 offen sc1
  s_add_u32 s46, s1, 81920
  buffer_load_dwordx4 v[164:167], v14, s[4:7], s46 offen sc1
  s_add_u32 s46, s1, 163840
  buffer_load_dwordx4 v[168:171], v14, s[4:7], s46 offen sc1
  s_add_u32 s46, s1, 245760
  buffer_load_dwordx4 v[172:175], v14, s[4:7], s46 offen sc1
  s_add_u32 s46, s1, 327680
  buffer_load_dwordx4 v[176:179], v14, s[4:7], s46 offen sc1
  s_add_u32 s46, s1, 409600
  buffer_load_dwordx4 v[180:183], v14, s[4:7], s46 offen sc1
  s_add_u32 s46, s1, 491520
  buffer_load_dwordx4 v[184:187], v14, s[4:7], s46 offen sc1
  s_add_u32 s46, s1, 573440
  buffer_load_dwordx4 v[188:191], v14, s[4:7], s46 offen sc1
  v_pk_add_f32 v[80:81], v[80:81], v[96:97]
  v_pk_add_f32 v[82:83], v[82:83], v[98:99]
  v_pk_add_f32 v[84:85], v[84:85], v[100:101]
  v_pk_add_f32 v[86:87], v[86:87], v[102:103]
  v_mov_b32 v98, s97
  v_cvt_pk_bf16_f32 v92, v80, v81
  v_cvt_pk_bf16_f32 v93, v82, v83
  v_cvt_pk_bf16_f32 v94, v84, v85
  v_cvt_pk_bf16_f32 v95, v86, v87
  v_lshlrev_b32 v80, 16, v92
  v_and_b32 v81, 0xffff0000, v92
  v_lshlrev_b32 v82, 16, v93
  v_and_b32 v83, 0xffff0000, v93
  v_lshlrev_b32 v84, 16, v94
  v_and_b32 v85, 0xffff0000, v94
  v_lshlrev_b32 v86, 16, v95
  v_and_b32 v87, 0xffff0000, v95
  v_pk_mul_f32 v[80:81], v[80:81], v[98:99] op_sel_hi:[1,0]
  v_pk_mul_f32 v[82:83], v[82:83], v[98:99] op_sel_hi:[1,0]
  v_pk_mul_f32 v[84:85], v[84:85], v[98:99] op_sel_hi:[1,0]
  v_pk_mul_f32 v[86:87], v[86:87], v[98:99] op_sel_hi:[1,0]
  v_cvt_pk_bf16_f32 v92, v80, v81
  v_cvt_pk_bf16_f32 v93, v82, v83
  v_cvt_pk_bf16_f32 v94, v84, v85
  v_cvt_pk_bf16_f32 v95, v86, v87
  v_lshlrev_b32 v80, 16, v92
  v_and_b32 v81, 0xffff0000, v92
  v_lshlrev_b32 v82, 16, v93
  v_and_b32 v83, 0xffff0000, v93
  v_lshlrev_b32 v84, 16, v94
  v_and_b32 v85, 0xffff0000, v94
  v_lshlrev_b32 v86, 16, v95
  v_and_b32 v87, 0xffff0000, v95
  v_mov_b32 v99, 0xff800000
  v_cndmask_b32 v80, v99, v80, s[64:65]
  v_cndmask_b32 v84, v99, v84, s[72:73]
  v_cndmask_b32 v81, v99, v81, s[66:67]
  v_cndmask_b32 v85, v99, v85, s[74:75]
  v_cndmask_b32 v82, v99, v82, s[68:69]
  v_cndmask_b32 v86, v99, v86, s[76:77]
  v_cndmask_b32 v83, v99, v83, s[70:71]
  v_cndmask_b32 v87, v99, v87, s[78:79]
  v_max3_f32 v96, v80, v81, v82
  v_max3_f32 v97, v83, v84, v85
  v_max3_f32 v96, v96, v86, v87
  s_lshr_b32 s84, s82, 1
  s_and_b32 s84, s84, 1
  s_xor_b32 s84, s84, 1
  s_and_b32 s95, s82, 1
  s_mul_i32 s28, s95, 393216
  s_add_u32 s29, s28, s63
  s_add_u32 s28, s28, s62
  s_mul_i32 s95, s95, 655360
  s_add_u32 s60, s89, s95
  s_add_u32 s61, s60, 4096
  s_add_u32 s95, s90, s95
  s_waitcnt vmcnt(11)
  s_barrier
  ds_read_b128 v[104:107], v6 offset:0
  ds_read_b128 v[108:111], v6 offset:1536
  ds_read_b128 v[112:115], v6 offset:3072
  ds_read_b128 v[116:119], v6 offset:4608
  ds_read_b64 v[120:121], v11 offset:1024
  ds_read_b64 v[122:123], v11 offset:2560
  ds_read_b64 v[124:125], v11 offset:4096
  ds_read_b64 v[126:127], v11 offset:5632
  ds_read_b128 v[128:131], v7 offset:6144
  ds_read_b64 v[132:133], v8 offset:7168
  ds_read_b128 v[134:137], v7 offset:7680
  ds_read_b64 v[138:139], v8 offset:8704
  s_waitcnt lgkmcnt(11)
  v_mfma_f32_16x16x32_bf16 v[88:91], v[104:107], v[32:35], 0
  s_waitcnt lgkmcnt(10)
  v_mfma_f32_16x16x32_bf16 v[88:91], v[108:111], v[36:39], v[88:91]
  s_waitcnt lgkmcnt(9)
  v_mfma_f32_16x16x32_bf16 v[88:91], v[112:115], v[40:43], v[88:91]
  s_waitcnt lgkmcnt(8)
  v_mfma_f32_16x16x32_bf16 v[88:91], v[116:119], v[44:47], v[88:91]
  s_waitcnt lgkmcnt(4)
  v_mfma_f32_16x16x16_bf16 v[100:103], v[120:121], v[48:49], 0
  v_mfma_f32_16x16x16_bf16 v[100:103], v[122:123], v[50:51], v[100:103]
  v_mfma_f32_16x16x16_bf16 v[100:103], v[124:125], v[52:53], v[100:103]
  v_mfma_f32_16x16x16_bf16 v[100:103], v[126:127], v[54:55], v[100:103]
  ds_read_b128 v[56:59], v19 offset:24576
  ds_read_b128 v[60:63], v19 offset:25600
  ds_read_b128 v[64:67], v19 offset:26624
  ds_read_b128 v[68:71], v19 offset:27648
  ds_read_b128 v[72:75], v19 offset:28672
  ds_read_b128 v[76:79], v19 offset:29696
  s_waitcnt vmcnt(9)
  s_branch fcF_60
fwF_58:
  buffer_load_dword v13, v2, s[4:7], s86 offen sc1
  s_waitcnt vmcnt(0)
fcF_60:
  v_cmp_eq_u32 vcc, 0, v13
  s_cbranch_vccz foF_59
  s_add_u32 s45, s45, 1
  s_cmp_gt_u32 s45, 1048576
  s_cbranch_scc1 failaF_43
  s_branch fwF_58
foF_59:
  s_nop 3
  s_add_u32 m0, s59, 0
  s_add_u32 s47, s85, 0
  buffer_load_dwordx4 v1, s[4:7], s47 offen offset:0 sc1 nt lds
  buffer_load_dwordx4 v1, s[4:7], s47 offen offset:1024 sc1 nt lds
  buffer_load_dwordx4 v1, s[4:7], s47 offen offset:2048 sc1 nt lds
  s_add_u32 m0, s59, 12288
  s_add_u32 s47, s85, 50331648
  buffer_load_dwordx4 v1, s[4:7], s47 offen offset:0 sc1 nt lds
  buffer_load_dwordx4 v1, s[4:7], s47 offen offset:1024 sc1 nt lds
  buffer_load_dwordx4 v1, s[4:7], s47 offen offset:2048 sc1 nt lds
  v_pk_add_f32 v[88:89], v[88:89], v[100:101]
  v_pk_add_f32 v[90:91], v[90:91], v[102:103]
  v_cvt_pk_bf16_f32 v92, v88, v89
  v_cvt_pk_bf16_f32 v93, v90, v91
  v_lshlrev_b32 v88, 16, v92
  v_and_b32 v89, 0xffff0000, v92
  v_lshlrev_b32 v90, 16, v93
  v_and_b32 v91, 0xffff0000, v93
  v_pk_mul_f32 v[88:89], v[88:89], v[98:99] op_sel_hi:[1,0]
  v_pk_mul_f32 v[90:91], v[90:91], v[98:99] op_sel_hi:[1,0]
  v_cvt_pk_bf16_f32 v92, v88, v89
  v_cvt_pk_bf16_f32 v93, v90, v91
  v_lshlrev_b32 v88, 16, v92
  v_and_b32 v89, 0xffff0000, v92
  v_lshlrev_b32 v90, 16, v93
  v_and_b32 v91, 0xffff0000, v93
  v_cndmask_b32 v88, v99, v88, s[80:81]
  v_cndmask_b32 v89, v99, v89, s[80:81]
  v_cndmask_b32 v90, v99, v90, s[80:81]
  v_cndmask_b32 v91, v99, v91, s[80:81]
  v_max3_f32 v97, v97, v88, v89
  v_max3_f32 v96, v96, v90, v91
  v_max_f32 v96, v96, v97
  v_mov_b32 v97, v96
  s_nop 1
  v_permlane16_swap_b32 v96, v97
  v_max_f32 v96, v96, v97
  v_mov_b32 v97, v96
  s_nop 1
  v_permlane32_swap_b32 v96, v97
  v_max_f32 v96, v96, v97
  v_mul_f32 v96, s96, v96
  v_mov_b32 v98, s96
  v_pk_fma_f32 v[80:81], v[80:81], v[98:99], v[96:97] op_sel_hi:[1,0,0] neg_lo:[0,0,1] neg_hi:[0,0,1]
  v_pk_fma_f32 v[82:83], v[82:83], v[98:99], v[96:97] op_sel_hi:[1,0,0] neg_lo:[0,0,1] neg_hi:[0,0,1]
  v_pk_fma_f32 v[84:85], v[84:85], v[98:99], v[96:97] op_sel_hi:[1,0,0] neg_lo:[0,0,1] neg_hi:[0,0,1]
  v_pk_fma_f32 v[86:87], v[86:87], v[98:99], v[96:97] op_sel_hi:[1,0,0] neg_lo:[0,0,1] neg_hi:[0,0,1]
  v_pk_fma_f32 v[88:89], v[88:89], v[98:99], v[96:97] op_sel_hi:[1,0,0] neg_lo:[0,0,1] neg_hi:[0,0,1]
  v_pk_fma_f32 v[90:91], v[90:91], v[98:99], v[96:97] op_sel_hi:[1,0,0] neg_lo:[0,0,1] neg_hi:[0,0,1]
  v_exp_f32 v80, v80
  v_exp_f32 v81, v81
  v_exp_f32 v82, v82
  v_exp_f32 v83, v83
  v_exp_f32 v84, v84
  v_exp_f32 v85, v85
  v_exp_f32 v86, v86
  v_exp_f32 v87, v87
  v_exp_f32 v88, v88
  v_exp_f32 v89, v89
  v_exp_f32 v90, v90
  v_exp_f32 v91, v91
  v_pk_add_f32 v[92:93], v[80:81], v[82:83]
  v_pk_add_f32 v[94:95], v[84:85], v[86:87]
  v_pk_add_f32 v[92:93], v[92:93], v[88:89]
  v_pk_add_f32 v[94:95], v[94:95], v[90:91]
  v_pk_add_f32 v[92:93], v[92:93], v[94:95]
  v_add_f32 v92, v92, v93
  v_mov_b32 v93, v92
  s_nop 1
  v_permlane16_swap_b32 v92, v93
  v_add_f32 v92, v92, v93
  v_mov_b32 v93, v92
  s_nop 1
  v_permlane32_swap_b32 v92, v93
  v_add_f32 v92, v92, v93
  v_rcp_f32 v92, v92
  s_nop 0
  v_pk_mul_f32 v[80:81], v[80:81], v[92:93] op_sel_hi:[1,0]
  v_pk_mul_f32 v[82:83], v[82:83], v[92:93] op_sel_hi:[1,0]
  v_pk_mul_f32 v[84:85], v[84:85], v[92:93] op_sel_hi:[1,0]
  v_pk_mul_f32 v[86:87], v[86:87], v[92:93] op_sel_hi:[1,0]
  v_pk_mul_f32 v[88:89], v[88:89], v[92:93] op_sel_hi:[1,0]
  v_pk_mul_f32 v[90:91], v[90:91], v[92:93] op_sel_hi:[1,0]
  v_cvt_pk_bf16_f32 v96, v80, v81
  v_cvt_pk_bf16_f32 v97, v82, v83
  v_cvt_pk_bf16_f32 v98, v84, v85
  v_cvt_pk_bf16_f32 v99, v86, v87
  v_cvt_pk_bf16_f32 v100, v88, v89
  v_cvt_pk_bf16_f32 v101, v90, v91
  s_waitcnt lgkmcnt(0)
  v_mfma_f32_16x16x32_bf16 v[32:35], v[56:59], v[96:99], 0
  v_mfma_f32_16x16x32_bf16 v[36:39], v[60:63], v[96:99], 0
  v_mfma_f32_16x16x32_bf16 v[40:43], v[64:67], v[96:99], 0
  v_mfma_f32_16x16x32_bf16 v[44:47], v[68:71], v[96:99], 0
  v_mfma_f32_16x16x32_bf16 v[48:51], v[72:75], v[96:99], 0
  v_mfma_f32_16x16x32_bf16 v[52:55], v[76:79], v[96:99], 0
  s_nop 0
  v_mfma_f32_16x16x16_bf16 v[32:35], v[128:129], v[100:101], v[32:35]
  v_mfma_f32_16x16x16_bf16 v[36:39], v[130:131], v[100:101], v[36:39]
  v_mfma_f32_16x16x16_bf16 v[40:43], v[132:133], v[100:101], v[40:43]
  v_mfma_f32_16x16x16_bf16 v[44:47], v[134:135], v[100:101], v[44:47]
  v_mfma_f32_16x16x16_bf16 v[48:51], v[136:137], v[100:101], v[48:51]
  v_mfma_f32_16x16x16_bf16 v[52:55], v[138:139], v[100:101], v[52:55]
  s_nop 3
  v_cvt_pk_bf16_f32 v104, v32, v33
  v_cvt_pk_bf16_f32 v105, v34, v35
  v_cvt_pk_bf16_f32 v106, v36, v37
  v_cvt_pk_bf16_f32 v107, v38, v39
  ds_write_b128 v9, v[104:107] offset:0
  v_bfi_b32 v104, 1, s84, v104
  buffer_store_dwordx4 v[104:107], v1, s[4:7], s28 offen offset:0
  v_cvt_pk_bf16_f32 v108, v40, v41
  v_cvt_pk_bf16_f32 v109, v42, v43
  v_cvt_pk_bf16_f32 v110, v44, v45
  v_cvt_pk_bf16_f32 v111, v46, v47
  ds_write_b128 v9, v[108:111] offset:1024
  v_bfi_b32 v108, 1, s84, v108
  buffer_store_dwordx4 v[108:111], v1, s[4:7], s28 offen offset:1024
  v_cvt_pk_bf16_f32 v112, v48, v49
  v_cvt_pk_bf16_f32 v113, v50, v51
  v_cvt_pk_bf16_f32 v114, v52, v53
  v_cvt_pk_bf16_f32 v115, v54, v55
  ds_write_b128 v9, v[112:115] offset:2048
  v_bfi_b32 v112, 1, s84, v112
  buffer_store_dwordx4 v[112:115], v1, s[4:7], s28 offen offset:2048
  s_waitcnt lgkmcnt(0)
  s_barrier
  ds_read_b128 v[32:35], v10 offset:0
  ds_read_b128 v[36:39], v10 offset:1024
  ds_read_b128 v[40:43], v10 offset:2048
  ds_read_b128 v[44:47], v10 offset:3072
  ds_read_b128 v[48:51], v10 offset:4096
  ds_read_b128 v[52:55], v10 offset:5120
  ds_read_b128 v[56:59], v10 offset:6144
  ds_read_b128 v[60:63], v10 offset:7168
  ds_read_b128 v[64:67], v10 offset:8192
  ds_read_b128 v[68:71], v10 offset:9216
  ds_read_b128 v[72:75], v10 offset:10240
  ds_read_b128 v[76:79], v10 offset:11264
  s_waitcnt vmcnt(9)
bF_61:
  v_bitop3_b32 v238, v160, v164, s2 bitop3:0x7e
  v_bitop3_b32 v238, v238, v168, s2 bitop3:0xf6
  v_bitop3_b32 v238, v238, v172, s2 bitop3:0xf6
  v_bitop3_b32 v238, v238, v176, s2 bitop3:0xf6
  v_bitop3_b32 v238, v238, v180, s2 bitop3:0xf6
  v_bitop3_b32 v238, v238, v184, s2 bitop3:0xf6
  v_bitop3_b32 v238, v238, v188, s2 bitop3:0xf6
  v_and_b32 v238, 1, v238
  v_cmp_ne_u32 vcc, 0, v238
  s_and_b64 vcc, vcc, s[98:99]
  s_cbranch_vccz okF_62
  s_mov_b32 s46, s1
  buffer_load_dwordx4 v[160:163], v14, s[4:7], s46 offen sc1
  s_add_u32 s46, s1, 81920
  buffer_load_dwordx4 v[164:167], v14, s[4:7], s46 offen sc1
  s_add_u32 s46, s1, 163840
  buffer_load_dwordx4 v[168:171], v14, s[4:7], s46 offen sc1
  s_add_u32 s46, s1, 245760
  buffer_load_dwordx4 v[172:175], v14, s[4:7], s46 offen sc1
  s_add_u32 s46, s1, 327680
  buffer_load_dwordx4 v[176:179], v14, s[4:7], s46 offen sc1
  s_add_u32 s46, s1, 409600
  buffer_load_dwordx4 v[180:183], v14, s[4:7], s46 offen sc1
  s_add_u32 s46, s1, 491520
  buffer_load_dwordx4 v[184:187], v14, s[4:7], s46 offen sc1
  s_add_u32 s46, s1, 573440
  buffer_load_dwordx4 v[188:191], v14, s[4:7], s46 offen sc1
  s_add_u32 s45, s45, 1
  s_cmp_gt_u32 s45, 1048576
  s_cbranch_scc1 failaF_43
  s_waitcnt vmcnt(0)
  s_branch bF_61
okF_62:
  s_add_u32 s87, s87, 393216
  s_add_u32 s88, s88, 8192
  s_waitcnt lgkmcnt(6)
  v_mfma_f32_16x16x32_bf16 v[104:107], a[0:3], v[32:35], 0
  v_mfma_f32_16x16x32_bf16 v[208:211], v[20:23], v[160:163], 0
  v_mfma_f32_16x16x32_bf16 v[208:211], v[20:23], v[164:167], v[208:211]
  v_mfma_f32_16x16x32_bf16 v[108:111], a[48:51], v[32:35], 0
  v_mfma_f32_16x16x32_bf16 v[208:211], v[20:23], v[168:171], v[208:211]
  v_mfma_f32_16x16x32_bf16 v[208:211], v[20:23], v[172:175], v[208:211]
  v_mfma_f32_16x16x32_bf16 v[112:115], a[96:99], v[32:35], 0
  v_mfma_f32_16x16x32_bf16 v[208:211], v[20:23], v[176:179], v[208:211]
  v_mfma_f32_16x16x32_bf16 v[208:211], v[20:23], v[180:183], v[208:211]
  v_mfma_f32_16x16x32_bf16 v[116:119], a[144:147], v[32:35], 0
  v_mfma_f32_16x16x32_bf16 v[208:211], v[20:23], v[184:187], v[208:211]
  v_mfma_f32_16x16x32_bf16 v[208:211], v[20:23], v[188:191], v[208:211]
  v_mfma_f32_16x16x32_bf16 v[120:123], a[192:195], v[32:35], 0
  s_nop 0
  s_nop 0
  v_mfma_f32_16x16x32_bf16 v[104:107], a[4:7], v[36:39], v[104:107]
  v_lshlrev_b32 v216, 16, v24
  v_and_b32 v217, 0xffff0000, v24
  v_mfma_f32_16x16x32_bf16 v[108:111], a[52:55], v[36:39], v[108:111]
  v_lshlrev_b32 v218, 16, v25
  v_and_b32 v219, 0xffff0000, v25
  v_mfma_f32_16x16x32_bf16 v[112:115], a[100:103], v[36:39], v[112:115]
  v_cvt_pk_bf16_f32 v232, v208, v209
  v_cvt_pk_bf16_f32 v233, v210, v211
  v_mfma_f32_16x16x32_bf16 v[116:119], a[148:151], v[36:39], v[116:119]
  v_lshlrev_b32 v208, 16, v232
  v_mfma_f32_16x16x32_bf16 v[120:123], a[196:199], v[36:39], v[120:123]
  v_and_b32 v209, 0xffff0000, v232
  v_mfma_f32_16x16x32_bf16 v[104:107], a[8:11], v[40:43], v[104:107]
  v_lshlrev_b32 v210, 16, v233
  v_mfma_f32_16x16x32_bf16 v[108:111], a[56:59], v[40:43], v[108:111]
  v_and_b32 v211, 0xffff0000, v233
  v_mfma_f32_16x16x32_bf16 v[112:115], a[104:107], v[40:43], v[112:115]
  v_add_f32 v216, v216, v208
  v_mfma_f32_16x16x32_bf16 v[116:119], a[152:155], v[40:43], v[116:119]
  v_add_f32 v217, v217, v209
  v_mfma_f32_16x16x32_bf16 v[120:123], a[200:203], v[40:43], v[120:123]
  v_add_f32 v218, v218, v210
  v_mfma_f32_16x16x32_bf16 v[104:107], a[12:15], v[44:47], v[104:107]
  v_add_f32 v219, v219, v211
  v_mfma_f32_16x16x32_bf16 v[108:111], a[60:63], v[44:47], v[108:111]
  v_cvt_pk_bf16_f32 v224, v216, v217
  v_mfma_f32_16x16x32_bf16 v[112:115], a[108:111], v[44:47], v[112:115]
  v_cvt_pk_bf16_f32 v225, v218, v219
  v_mfma_f32_16x16x32_bf16 v[116:119], a[156:159], v[44:47], v[116:119]
  v_lshlrev_b32 v216, 16, v224
  v_mfma_f32_16x16x32_bf16 v[120:123], a[204:207], v[44:47], v[120:123]
  v_and_b32 v217, 0xffff0000, v224
  v_mfma_f32_16x16x32_bf16 v[104:107], a[16:19], v[48:51], v[104:107]
  v_lshlrev_b32 v218, 16, v225
  v_mfma_f32_16x16x32_bf16 v[108:111], a[64:67], v[48:51], v[108:111]
  buffer_load_dword v13, v156, s[4:7], s88 offen sc1
  v_and_b32 v219, 0xffff0000, v225
  v_mfma_f32_16x16x32_bf16 v[112:115], a[112:115], v[48:51], v[112:115]
  buffer_load_dwordx4 v[144:147], v1, s[4:7], s29 offen offset:0 sc1
  v_add_f32 v236, v216, v217
  v_mfma_f32_16x16x32_bf16 v[116:119], a[160:163], v[48:51], v[116:119]
  buffer_load_dwordx4 v[148:151], v1, s[4:7], s29 offen offset:1024 sc1
  v_mul_f32 v237, v216, v216
  v_mfma_f32_16x16x32_bf16 v[120:123], a[208:211], v[48:51], v[120:123]
  buffer_load_dwordx4 v[152:155], v1, s[4:7], s29 offen offset:2048 sc1
  v_fmac_f32 v237, v217, v217
  v_mfma_f32_16x16x32_bf16 v[104:107], a[20:23], v[52:55], v[104:107]
  v_add_f32 v236, v236, v218
  v_mfma_f32_16x16x32_bf16 v[108:111], a[68:71], v[52:55], v[108:111]
  v_fmac_f32 v237, v218, v218
  v_mfma_f32_16x16x32_bf16 v[112:115], a[116:119], v[52:55], v[112:115]
  v_add_f32 v236, v236, v219
  v_mfma_f32_16x16x32_bf16 v[116:119], a[164:167], v[52:55], v[116:119]
  v_fmac_f32 v237, v219, v219
  v_mfma_f32_16x16x32_bf16 v[120:123], a[212:215], v[52:55], v[120:123]
  v_add_f32_dpp v236, v236, v236 quad_perm:[1,0,3,2] row_mask:0xf bank_mask:0xf
  s_waitcnt lgkmcnt(0)
  v_mfma_f32_16x16x32_bf16 v[124:127], a[0:3], v[56:59], 0
  v_add_f32_dpp v237, v237, v237 quad_perm:[1,0,3,2] row_mask:0xf bank_mask:0xf
  v_mfma_f32_16x16x32_bf16 v[128:131], a[48:51], v[56:59], 0
  v_add_f32_dpp v236, v236, v236 quad_perm:[2,3,0,1] row_mask:0xf bank_mask:0xf
  v_mfma_f32_16x16x32_bf16 v[132:135], a[96:99], v[56:59], 0
  v_add_f32_dpp v237, v237, v237 quad_perm:[2,3,0,1] row_mask:0xf bank_mask:0xf
  v_mfma_f32_16x16x32_bf16 v[136:139], a[144:147], v[56:59], 0
  v_add_f32_dpp v236, v236, v236 row_half_mirror row_mask:0xf bank_mask:0xf
  v_mfma_f32_16x16x32_bf16 v[140:143], a[192:195], v[56:59], 0
  v_add_f32_dpp v237, v237, v237 row_half_mirror row_mask:0xf bank_mask:0xf
  v_mfma_f32_16x16x32_bf16 v[124:127], a[4:7], v[60:63], v[124:127]
  v_add_f32_dpp v236, v236, v236 row_mirror row_mask:0xf bank_mask:0xf
  v_mfma_f32_16x16x32_bf16 v[128:131], a[52:55], v[60:63], v[128:131]
  v_add_f32_dpp v237, v237, v237 row_mirror row_mask:0xf bank_mask:0xf
  v_mfma_f32_16x16x32_bf16 v[132:135], a[100:103], v[60:63], v[132:135]
  v_mov_b32 v208, v236
  v_mfma_f32_16x16x32_bf16 v[136:139], a[148:151], v[60:63], v[136:139]
  v_mov_b32 v209, v237
  v_mfma_f32_16x16x32_bf16 v[140:143], a[196:199], v[60:63], v[140:143]
  v_permlane16_swap_b32 v236, v208
  v_mfma_f32_16x16x32_bf16 v[124:127], a[8:11], v[64:67], v[124:127]
  v_permlane16_swap_b32 v237, v209
  v_mfma_f32_16x16x32_bf16 v[128:131], a[56:59], v[64:67], v[128:131]
  v_add_f32 v236, v236, v208
  v_mfma_f32_16x16x32_bf16 v[132:135], a[104:107], v[64:67], v[132:135]
  v_add_f32 v237, v237, v209
  v_mfma_f32_16x16x32_bf16 v[136:139], a[152:155], v[64:67], v[136:139]
  v_mov_b32 v208, v236
  v_mfma_f32_16x16x32_bf16 v[140:143], a[200:203], v[64:67], v[140:143]
  s_waitcnt vmcnt(0)
bF_63:
  v_bitop3_b32 v18, v144, v148, s84 bitop3:0x7e
  v_bitop3_b32 v18, v18, v152, s84 bitop3:0xf6
  v_and_b32 v18, 1, v18
  v_cmp_ne_u32 vcc, 0, v18
  s_cbranch_vccz okF_64
  buffer_load_dwordx4 v[144:147], v1, s[4:7], s29 offen offset:0 sc1
  buffer_load_dwordx4 v[148:151], v1, s[4:7], s29 offen offset:1024 sc1
  buffer_load_dwordx4 v[152:155], v1, s[4:7], s29 offen offset:2048 sc1
  s_add_u32 s45, s45, 1
  s_cmp_gt_u32 s45, 1048576
  s_cbranch_scc1 failaF_43
  s_waitcnt vmcnt(0)
  s_branch bF_63
okF_64:
  v_cmp_eq_u32 vcc, 0, v13
  s_mov_b32 s31, 0
  s_cbranch_vccnz neF_65
  s_mov_b32 s31, 1
  s_add_u32 m0, s58, 36864
  s_nop 0
  buffer_load_dwordx4 v1, s[4:7], s87 offen offset:0 sc1 lds
  buffer_load_dwordx4 v1, s[4:7], s87 offen offset:1024 sc1 lds
  buffer_load_dwordx4 v1, s[4:7], s87 offen offset:2048 sc1 lds
neF_65:
  v_mov_b32 v209, v237
  v_mfma_f32_16x16x32_bf16 v[124:127], a[12:15], v[68:71], v[124:127]
  ds_write_b128 v9, v[144:147] offset:12288
  v_permlane32_swap_b32 v236, v208
  v_mfma_f32_16x16x32_bf16 v[128:131], a[60:63], v[68:71], v[128:131]
  ds_write_b128 v9, v[148:151] offset:13312
  v_permlane32_swap_b32 v237, v209
  v_mfma_f32_16x16x32_bf16 v[132:135], a[108:111], v[68:71], v[132:135]
  ds_write_b128 v9, v[152:155] offset:14336
  v_add_f32 v236, v236, v208
  v_mfma_f32_16x16x32_bf16 v[136:139], a[156:159], v[68:71], v[136:139]
  v_add_f32 v237, v237, v209
  v_mfma_f32_16x16x32_bf16 v[140:143], a[204:207], v[68:71], v[140:143]
  ds_write_b64 v16, v[236:237]
  v_mfma_f32_16x16x32_bf16 v[124:127], a[16:19], v[72:75], v[124:127]
  s_waitcnt lgkmcnt(0)
  s_barrier
  v_mfma_f32_16x16x32_bf16 v[128:131], a[64:67], v[72:75], v[128:131]
  ds_read_b128 v[208:211], v17
  v_mfma_f32_16x16x32_bf16 v[132:135], a[112:115], v[72:75], v[132:135]
  ds_read_b128 v[212:215], v17 offset:16
  v_mfma_f32_16x16x32_bf16 v[136:139], a[160:163], v[72:75], v[136:139]
  ds_read_b128 v[160:163], v10 offset:12288
  v_mfma_f32_16x16x32_bf16 v[140:143], a[208:211], v[72:75], v[140:143]
  ds_read_b128 v[164:167], v10 offset:13312
  v_mfma_f32_16x16x32_bf16 v[124:127], a[20:23], v[76:79], v[124:127]
  ds_read_b128 v[168:171], v10 offset:14336
  v_mfma_f32_16x16x32_bf16 v[128:131], a[68:71], v[76:79], v[128:131]
  ds_read_b128 v[172:175], v10 offset:15360
  v_mfma_f32_16x16x32_bf16 v[132:135], a[116:119], v[76:79], v[132:135]
  ds_read_b128 v[176:179], v10 offset:16384
  v_mfma_f32_16x16x32_bf16 v[136:139], a[164:167], v[76:79], v[136:139]
  ds_read_b128 v[180:183], v10 offset:17408
  v_mfma_f32_16x16x32_bf16 v[140:143], a[212:215], v[76:79], v[140:143]
  ds_read_b128 v[184:187], v10 offset:18432
  ds_read_b128 v[188:191], v10 offset:19456
  ds_read_b128 v[192:195], v10 offset:20480
  ds_read_b128 v[196:199], v10 offset:21504
  ds_read_b128 v[200:203], v10 offset:22528
  ds_read_b128 v[204:207], v10 offset:23552
  s_waitcnt lgkmcnt(6)
  v_mfma_f32_16x16x32_bf16 v[104:107], a[24:27], v[160:163], v[104:107]
  s_add_u32 m0, s59, 24576
  s_add_u32 s47, s85, 100663296
  v_mfma_f32_16x16x32_bf16 v[104:107], a[28:31], v[164:167], v[104:107]
  v_add_f32 v208, v208, v210
  v_mfma_f32_16x16x32_bf16 v[104:107], a[32:35], v[168:171], v[104:107]
  buffer_load_dwordx4 v1, s[4:7], s47 offen offset:0 sc1 nt lds
  v_mfma_f32_16x16x32_bf16 v[104:107], a[36:39], v[172:175], v[104:107]
  v_add_f32 v209, v209, v211
  v_mfma_f32_16x16x32_bf16 v[104:107], a[40:43], v[176:179], v[104:107]
  buffer_load_dwordx4 v1, s[4:7], s47 offen offset:1024 sc1 nt lds
  v_mfma_f32_16x16x32_bf16 v[104:107], a[44:47], v[180:183], v[104:107]
  v_add_f32 v212, v212, v214
  v_mfma_f32_16x16x32_bf16 v[108:111], a[72:75], v[160:163], v[108:111]
  buffer_load_dwordx4 v1, s[4:7], s47 offen offset:2048 sc1 nt lds
  v_mfma_f32_16x16x32_bf16 v[108:111], a[76:79], v[164:167], v[108:111]
  v_add_f32 v213, v213, v215
  v_mfma_f32_16x16x32_bf16 v[108:111], a[80:83], v[168:171], v[108:111]
  v_add_f32 v236, v208, v212
  v_mfma_f32_16x16x32_bf16 v[108:111], a[84:87], v[172:175], v[108:111]
  v_add_f32 v237, v209, v213
  v_mfma_f32_16x16x32_bf16 v[108:111], a[88:91], v[176:179], v[108:111]
  v_mul_f32 v236, 0x3acccccd, v236
  v_mfma_f32_16x16x32_bf16 v[108:111], a[92:95], v[180:183], v[108:111]
  v_mul_f32 v237, 0x3acccccd, v237
  v_mfma_f32_16x16x32_bf16 v[112:115], a[120:123], v[160:163], v[112:115]
  v_fma_f32 v237, -v236, v236, v237
  v_mfma_f32_16x16x32_bf16 v[112:115], a[124:127], v[164:167], v[112:115]
  v_cvt_pk_bf16_f32 v80, v104, v105
  v_max_f32 v237, 0, v237
  v_mfma_f32_16x16x32_bf16 v[112:115], a[128:131], v[168:171], v[112:115]
  v_cvt_pk_bf16_f32 v81, v106, v107
  v_cvt_pk_bf16_f32 v236, v236, v236
  v_mfma_f32_16x16x32_bf16 v[112:115], a[132:135], v[172:175], v[112:115]
  ds_write_b64 v12, v[80:81] offset:0
  v_and_b32 v236, 0xffff0000, v236
  v_mfma_f32_16x16x32_bf16 v[112:115], a[136:139], v[176:179], v[112:115]
  v_cvt_pk_bf16_f32 v237, v237, v237
  v_mfma_f32_16x16x32_bf16 v[112:115], a[140:143], v[180:183], v[112:115]
  v_and_b32 v237, 0xffff0000, v237
  v_mfma_f32_16x16x32_bf16 v[116:119], a[168:171], v[160:163], v[116:119]
  v_add_f32 v237, 0x3727c5ac, v237
  v_mfma_f32_16x16x32_bf16 v[116:119], a[172:175], v[164:167], v[116:119]
  v_cvt_pk_bf16_f32 v82, v108, v109
  v_cvt_pk_bf16_f32 v237, v237, v237
  v_mfma_f32_16x16x32_bf16 v[116:119], a[176:179], v[168:171], v[116:119]
  v_cvt_pk_bf16_f32 v83, v110, v111
  v_and_b32 v237, 0xffff0000, v237
  v_mfma_f32_16x16x32_bf16 v[116:119], a[180:183], v[172:175], v[116:119]
  ds_write_b64 v12, v[82:83] offset:32
  v_sub_f32 v216, v216, v236
  v_mfma_f32_16x16x32_bf16 v[116:119], a[184:187], v[176:179], v[116:119]
  v_sub_f32 v217, v217, v236
  v_mfma_f32_16x16x32_bf16 v[116:119], a[188:191], v[180:183], v[116:119]
  v_sub_f32 v218, v218, v236
  v_mfma_f32_16x16x32_bf16 v[120:123], a[216:219], v[160:163], v[120:123]
  v_sub_f32 v219, v219, v236
  v_mfma_f32_16x16x32_bf16 v[120:123], a[220:223], v[164:167], v[120:123]
  v_cvt_pk_bf16_f32 v80, v112, v113
  v_sqrt_f32 v237, v237
  v_mfma_f32_16x16x32_bf16 v[120:123], a[224:227], v[168:171], v[120:123]
  v_cvt_pk_bf16_f32 v81, v114, v115
  v_cvt_pk_bf16_f32 v232, v216, v217
  v_mfma_f32_16x16x32_bf16 v[120:123], a[228:231], v[172:175], v[120:123]
  ds_write_b64 v12, v[80:81] offset:64
  v_cvt_pk_bf16_f32 v233, v218, v219
  v_mfma_f32_16x16x32_bf16 v[120:123], a[232:235], v[176:179], v[120:123]
  v_cvt_pk_bf16_f32 v237, v237, v237
  s_waitcnt lgkmcnt(0)
  v_mfma_f32_16x16x32_bf16 v[120:123], a[236:239], v[180:183], v[120:123]
  v_and_b32 v237, 0xffff0000, v237
  v_mfma_f32_16x16x32_bf16 v[124:127], a[24:27], v[184:187], v[124:127]
  v_rcp_f32 v237, v237
  v_mfma_f32_16x16x32_bf16 v[124:127], a[28:31], v[188:191], v[124:127]
  v_cvt_pk_bf16_f32 v82, v116, v117
  v_lshlrev_b32 v216, 16, v232
  v_mfma_f32_16x16x32_bf16 v[124:127], a[32:35], v[192:195], v[124:127]
  v_cvt_pk_bf16_f32 v83, v118, v119
  v_and_b32 v217, 0xffff0000, v232
  v_mfma_f32_16x16x32_bf16 v[124:127], a[36:39], v[196:199], v[124:127]
  ds_write_b64 v12, v[82:83] offset:96
  v_lshlrev_b32 v218, 16, v233
  v_mfma_f32_16x16x32_bf16 v[124:127], a[40:43], v[200:203], v[124:127]
  v_and_b32 v219, 0xffff0000, v233
  v_mfma_f32_16x16x32_bf16 v[124:127], a[44:47], v[204:207], v[124:127]
  v_mul_f32 v216, v216, v237
  v_mfma_f32_16x16x32_bf16 v[128:131], a[72:75], v[184:187], v[128:131]
  v_mul_f32 v217, v217, v237
  v_mfma_f32_16x16x32_bf16 v[128:131], a[76:79], v[188:191], v[128:131]
  v_cvt_pk_bf16_f32 v80, v120, v121
  v_mul_f32 v218, v218, v237
  v_mfma_f32_16x16x32_bf16 v[128:131], a[80:83], v[192:195], v[128:131]
  v_cvt_pk_bf16_f32 v81, v122, v123
  v_mul_f32 v219, v219, v237
  v_mfma_f32_16x16x32_bf16 v[128:131], a[84:87], v[196:199], v[128:131]
  ds_write_b64 v12, v[80:81] offset:128
  v_cvt_pk_bf16_f32 v240, v216, v217
  v_mfma_f32_16x16x32_bf16 v[128:131], a[88:91], v[200:203], v[128:131]
  ds_read_b128 v[84:87], v26
  v_cvt_pk_bf16_f32 v241, v218, v219
  v_mfma_f32_16x16x32_bf16 v[128:131], a[92:95], v[204:207], v[128:131]
  ds_read_b128 v[88:91], v27
  v_mov_b32 v242, v240
  v_mfma_f32_16x16x32_bf16 v[132:135], a[120:123], v[184:187], v[132:135]
  v_mov_b32 v243, v241
  v_mfma_f32_16x16x32_bf16 v[132:135], a[124:127], v[188:191], v[132:135]
  v_cvt_pk_bf16_f32 v80, v124, v125
  v_permlane16_swap_b32 v240, v242
  v_mfma_f32_16x16x32_bf16 v[132:135], a[128:131], v[192:195], v[132:135]
  v_cvt_pk_bf16_f32 v81, v126, v127
  v_permlane16_swap_b32 v241, v243
  v_mfma_f32_16x16x32_bf16 v[132:135], a[132:135], v[196:199], v[132:135]
  ds_write_b64 v12, v[80:81] offset:2816
  v_mov_b32 v226, v224
  v_mfma_f32_16x16x32_bf16 v[132:135], a[136:139], v[200:203], v[132:135]
  v_mov_b32 v227, v225
  v_mfma_f32_16x16x32_bf16 v[132:135], a[140:143], v[204:207], v[132:135]
  v_permlane16_swap_b32 v224, v226
  v_mfma_f32_16x16x32_bf16 v[136:139], a[168:171], v[184:187], v[136:139]
  v_permlane16_swap_b32 v225, v227
  v_mfma_f32_16x16x32_bf16 v[136:139], a[172:175], v[188:191], v[136:139]
  s_waitcnt lgkmcnt(2)
  v_bfi_b32 v84, 1, s84, v84
  buffer_store_dwordx4 v[84:87], v1, s[4:7], s60 offen offset:0
  s_sub_u32 s55, s0, 5242880
  v_mfma_f32_16x16x32_bf16 v[136:139], a[176:179], v[192:195], v[136:139]
  v_cvt_pk_bf16_f32 v82, v128, v129
  buffer_store_dwordx4 v[240:243], v31, s[4:7], s55 offen sc1
  v_mfma_f32_16x16x32_bf16 v[136:139], a[180:183], v[196:199], v[136:139]
  v_cvt_pk_bf16_f32 v83, v130, v131
  buffer_store_dwordx4 v[224:227], v31, s[4:7], s0 offen sc1
  v_mfma_f32_16x16x32_bf16 v[136:139], a[184:187], v[200:203], v[136:139]
  ds_write_b64 v12, v[82:83] offset:2848
  v_mfma_f32_16x16x32_bf16 v[136:139], a[188:191], v[204:207], v[136:139]
  v_mfma_f32_16x16x32_bf16 v[140:143], a[216:219], v[184:187], v[140:143]
  v_mfma_f32_16x16x32_bf16 v[140:143], a[220:223], v[188:191], v[140:143]
  s_waitcnt lgkmcnt(2)
  v_bfi_b32 v88, 1, s84, v88
  buffer_store_dwordx4 v[88:91], v1, s[4:7], s60 offen offset:1024
  v_mfma_f32_16x16x32_bf16 v[140:143], a[224:227], v[192:195], v[140:143]
  v_cvt_pk_bf16_f32 v80, v132, v133
  v_mfma_f32_16x16x32_bf16 v[140:143], a[228:231], v[196:199], v[140:143]
  v_cvt_pk_bf16_f32 v81, v134, v135
  v_mfma_f32_16x16x32_bf16 v[140:143], a[232:235], v[200:203], v[140:143]
  ds_write_b64 v12, v[80:81] offset:2880
  v_mfma_f32_16x16x32_bf16 v[140:143], a[236:239], v[204:207], v[140:143]
  v_cvt_pk_bf16_f32 v82, v136, v137
  v_cvt_pk_bf16_f32 v83, v138, v139
  ds_write_b64 v12, v[82:83] offset:2912
  s_nop 4
  v_cvt_pk_bf16_f32 v80, v140, v141
  v_cvt_pk_bf16_f32 v81, v142, v143
  ds_write_b64 v12, v[80:81] offset:2944
  ds_read_b128 v[92:95], v28
  ds_read_b128 v[96:99], v29
  ds_read_b128 v[100:103], v30
  s_waitcnt lgkmcnt(2)
  v_bfi_b32 v92, 1, s84, v92
  buffer_store_dwordx4 v[92:95], v1, s[4:7], s60 offen offset:2048
  s_waitcnt lgkmcnt(1)
  v_bfi_b32 v96, 1, s84, v96
  buffer_store_dwordx4 v[96:99], v1, s[4:7], s60 offen offset:3072
  s_waitcnt lgkmcnt(0)
  v_bfi_b32 v100, 1, s84, v100
  buffer_store_dwordx4 v[100:103], v1, s[4:7], s61 offen offset:0
  buffer_load_dword v18, v156, s[4:7], s88 offen sc1
  s_cmp_eq_u32 s82, 0
  s_cselect_b32 s30, 0x10000000, s93
  s_cselect_b32 s46, 0, 40960
  s_add_u32 s91, s91, s46
  s_add_u32 s93, s93, 4096
  s_mov_b32 s2, s84
  s_mov_b32 s1, s95
  s_mov_b32 s0, s92
  s_add_u32 s92, s92, 40960
  s_mov_b32 s98, s56
  s_mov_b32 s99, s57
  s_add_u32 s82, s82, 1
  v_add_u32 v92, s94, v3
  v_add_u32 v93, s94, v1
  v_add_u32 v94, s94, v4
  ds_read_b128 v[32:35], v92 offset:0
  ds_read_b128 v[160:163], v93 offset:12288
  ds_read_b128 v[176:179], v93 offset:13312
  ds_read_b128 v[36:39], v92 offset:3072
  ds_read_b128 v[164:167], v93 offset:15360
  ds_read_b128 v[180:183], v93 offset:16384
  ds_read_b128 v[40:43], v92 offset:6144
  ds_read_b128 v[168:171], v93 offset:18432
  ds_read_b128 v[184:187], v93 offset:19456
  ds_read_b128 v[44:47], v92 offset:9216
  ds_read_b128 v[172:175], v93 offset:21504
  ds_read_b128 v[188:191], v93 offset:22528
  s_waitcnt lgkmcnt(9)
  v_mfma_f32_16x16x32_bf16 v[80:83], v[160:163], v[32:35], 0
  v_mfma_f32_16x16x32_bf16 v[84:87], v[176:179], v[32:35], 0
  ds_read_b64 v[48:49], v94 offset:2048
  ds_read_b128 v[192:195], v93 offset:14336
  s_waitcnt lgkmcnt(8)
  v_mfma_f32_16x16x32_bf16 v[80:83], v[164:167], v[36:39], v[80:83]
  v_mfma_f32_16x16x32_bf16 v[84:87], v[180:183], v[36:39], v[84:87]
  ds_read_b64 v[50:51], v94 offset:5120
  ds_read_b128 v[196:199], v93 offset:17408
  s_waitcnt lgkmcnt(7)
  v_mfma_f32_16x16x32_bf16 v[80:83], v[168:171], v[40:43], v[80:83]
  v_mfma_f32_16x16x32_bf16 v[84:87], v[184:187], v[40:43], v[84:87]
  ds_read_b64 v[52:53], v94 offset:8192
  ds_read_b128 v[200:203], v93 offset:20480
  s_waitcnt lgkmcnt(6)
  v_mfma_f32_16x16x32_bf16 v[80:83], v[172:175], v[44:47], v[80:83]
  v_mfma_f32_16x16x32_bf16 v[84:87], v[188:191], v[44:47], v[84:87]
  ds_read_b64 v[54:55], v94 offset:11264
  ds_read_b128 v[204:207], v93 offset:23552
  s_nop 1
  s_waitcnt lgkmcnt(6)
  v_mfma_f32_16x16x16_bf16 v[96:99], v[192:193], v[48:49], 0
  v_mfma_f32_16x16x16_bf16 v[100:103], v[194:195], v[48:49], 0
  s_waitcnt lgkmcnt(4)
  v_mfma_f32_16x16x16_bf16 v[96:99], v[196:197], v[50:51], v[96:99]
  v_mfma_f32_16x16x16_bf16 v[100:103], v[198:199], v[50:51], v[100:103]
  s_waitcnt lgkmcnt(2)
  v_mfma_f32_16x16x16_bf16 v[96:99], v[200:201], v[52:53], v[96:99]
  v_mfma_f32_16x16x16_bf16 v[100:103], v[202:203], v[52:53], v[100:103]
  s_waitcnt lgkmcnt(0)
  v_mfma_f32_16x16x16_bf16 v[96:99], v[204:205], v[54:55], v[96:99]
  v_mfma_f32_16x16x16_bf16 v[100:103], v[206:207], v[54:55], v[100:103]
  s_cmp_lt_u32 s82, 64
  s_cbranch_scc1 topF_52
  s_waitcnt vmcnt(0)
  s_barrier
  v_mov_b32 v92, 1
  s_waitcnt vmcnt(63)
  buffer_store_dword v92, off, s[4:7], s30 sc1
  s_mov_b32 s30, 0x10000000
  buffer_load_dwordx2 v[24:25], v15, s[12:15], s91 offen sc1
  s_mov_b32 s46, s1
  buffer_load_dwordx4 v[160:163], v14, s[4:7], s46 offen sc1
  s_add_u32 s46, s1, 81920
  buffer_load_dwordx4 v[164:167], v14, s[4:7], s46 offen sc1
  s_add_u32 s46, s1, 163840
  buffer_load_dwordx4 v[168:171], v14, s[4:7], s46 offen sc1
  s_add_u32 s46, s1, 245760
  buffer_load_dwordx4 v[172:175], v14, s[4:7], s46 offen sc1
  s_add_u32 s46, s1, 327680
  buffer_load_dwordx4 v[176:179], v14, s[4:7], s46 offen sc1
  s_add_u32 s46, s1, 409600
  buffer_load_dwordx4 v[180:183], v14, s[4:7], s46 offen sc1
  s_add_u32 s46, s1, 491520
  buffer_load_dwordx4 v[184:187], v14, s[4:7], s46 offen sc1
  s_add_u32 s46, s1, 573440
  buffer_load_dwordx4 v[188:191], v14, s[4:7], s46 offen sc1
  s_waitcnt vmcnt(0)
bF_66:
  v_mfma_f32_16x16x32_bf16 v[208:211], v[20:23], v[160:163], 0
  v_bitop3_b32 v238, v160, v164, s2 bitop3:0x7e
  v_mfma_f32_16x16x32_bf16 v[208:211], v[20:23], v[164:167], v[208:211]
  v_bitop3_b32 v238, v238, v168, s2 bitop3:0xf6
  v_mfma_f32_16x16x32_bf16 v[208:211], v[20:23], v[168:171], v[208:211]
  v_bitop3_b32 v238, v238, v172, s2 bitop3:0xf6
  v_mfma_f32_16x16x32_bf16 v[208:211], v[20:23], v[172:175], v[208:211]
  v_bitop3_b32 v238, v238, v176, s2 bitop3:0xf6
  v_mfma_f32_16x16x32_bf16 v[208:211], v[20:23], v[176:179], v[208:211]
  v_bitop3_b32 v238, v238, v180, s2 bitop3:0xf6
  v_mfma_f32_16x16x32_bf16 v[208:211], v[20:23], v[180:183], v[208:211]
  v_bitop3_b32 v238, v238, v184, s2 bitop3:0xf6
  v_mfma_f32_16x16x32_bf16 v[208:211], v[20:23], v[184:187], v[208:211]
  v_bitop3_b32 v238, v238, v188, s2 bitop3:0xf6
  v_mfma_f32_16x16x32_bf16 v[208:211], v[20:23], v[188:191], v[208:211]
  v_and_b32 v238, 1, v238
  v_cmp_ne_u32 vcc, 0, v238
  s_and_b64 vcc, vcc, s[56:57]
  s_cbranch_vccz okF_67
  s_nop 7
  s_mov_b32 s46, s1
  buffer_load_dwordx4 v[160:163], v14, s[4:7], s46 offen sc1
  s_add_u32 s46, s1, 81920
  buffer_load_dwordx4 v[164:167], v14, s[4:7], s46 offen sc1
  s_add_u32 s46, s1, 163840
  buffer_load_dwordx4 v[168:171], v14, s[4:7], s46 offen sc1
  s_add_u32 s46, s1, 245760
  buffer_load_dwordx4 v[172:175], v14, s[4:7], s46 offen sc1
  s_add_u32 s46, s1, 327680
  buffer_load_dwordx4 v[176:179], v14, s[4:7], s46 offen sc1
  s_add_u32 s46, s1, 409600
  buffer_load_dwordx4 v[180:183], v14, s[4:7], s46 offen sc1
  s_add_u32 s46, s1, 491520
  buffer_load_dwordx4 v[184:187], v14, s[4:7], s46 offen sc1
  s_add_u32 s46, s1, 573440
  buffer_load_dwordx4 v[188:191], v14, s[4:7], s46 offen sc1
  s_add_u32 s45, s45, 1
  s_cmp_gt_u32 s45, 1048576
  s_cbranch_scc1 failaF_43
  s_waitcnt vmcnt(0)
  s_branch bF_66
okF_67:
  s_nop 0
  v_lshlrev_b32 v216, 16, v24
  v_and_b32 v217, 0xffff0000, v24
  v_lshlrev_b32 v218, 16, v25
  v_and_b32 v219, 0xffff0000, v25
  v_cvt_pk_bf16_f32 v232, v208, v209
  v_cvt_pk_bf16_f32 v233, v210, v211
  v_lshlrev_b32 v208, 16, v232
  v_and_b32 v209, 0xffff0000, v232
  v_lshlrev_b32 v210, 16, v233
  v_and_b32 v211, 0xffff0000, v233
  v_pk_add_f32 v[216:217], v[216:217], v[208:209]
  v_pk_add_f32 v[218:219], v[218:219], v[210:211]
  v_cvt_pk_bf16_f32 v224, v216, v217
  v_cvt_pk_bf16_f32 v225, v218, v219
  v_lshlrev_b32 v216, 16, v224
  v_and_b32 v217, 0xffff0000, v224
  v_lshlrev_b32 v218, 16, v225
  v_and_b32 v219, 0xffff0000, v225
  v_add_f32 v236, v216, v217
  v_mul_f32 v237, v216, v216
  v_fmac_f32 v237, v217, v217
  v_add_f32 v236, v236, v218
  v_fmac_f32 v237, v218, v218
  v_add_f32 v236, v236, v219
  v_fmac_f32 v237, v219, v219
  s_nop 0
  v_add_f32_dpp v236, v236, v236 quad_perm:[1,0,3,2] row_mask:0xf bank_mask:0xf
  v_add_f32_dpp v237, v237, v237 quad_perm:[1,0,3,2] row_mask:0xf bank_mask:0xf
  s_nop 0
  v_add_f32_dpp v236, v236, v236 quad_perm:[2,3,0,1] row_mask:0xf bank_mask:0xf
  v_add_f32_dpp v237, v237, v237 quad_perm:[2,3,0,1] row_mask:0xf bank_mask:0xf
  s_nop 0
  v_add_f32_dpp v236, v236, v236 row_half_mirror row_mask:0xf bank_mask:0xf
  v_add_f32_dpp v237, v237, v237 row_half_mirror row_mask:0xf bank_mask:0xf
  s_nop 0
  v_add_f32_dpp v236, v236, v236 row_mirror row_mask:0xf bank_mask:0xf
  v_add_f32_dpp v237, v237, v237 row_mirror row_mask:0xf bank_mask:0xf
  v_mov_b32 v208, v236
  v_mov_b32 v209, v237
  s_nop 0
  v_permlane16_swap_b32 v236, v208
  v_permlane16_swap_b32 v237, v209
  v_pk_add_f32 v[236:237], v[236:237], v[208:209]
  v_mov_b32 v208, v236
  v_mov_b32 v209, v237
  s_nop 0
  v_permlane32_swap_b32 v236, v208
  v_permlane32_swap_b32 v237, v209
  v_pk_add_f32 v[236:237], v[236:237], v[208:209]
  ds_write_b64 v16, v[236:237]
  s_waitcnt lgkmcnt(0)
  s_barrier
  ds_read_b128 v[208:211], v17
  ds_read_b128 v[212:215], v17 offset:16
  s_waitcnt lgkmcnt(0)
  v_pk_add_f32 v[208:209], v[208:209], v[210:211]
  v_pk_add_f32 v[212:213], v[212:213], v[214:215]
  v_pk_add_f32 v[236:237], v[208:209], v[212:213]
  v_mul_f32 v236, 0x3acccccd, v236
  v_mul_f32 v237, 0x3acccccd, v237
  v_fma_f32 v237, -v236, v236, v237
  v_max_f32 v237, 0, v237
  v_cvt_pk_bf16_f32 v236, v236, v236
  v_and_b32 v236, 0xffff0000, v236
  v_cvt_pk_bf16_f32 v237, v237, v237
  v_and_b32 v237, 0xffff0000, v237
  v_add_f32 v237, 0x3727c5ac, v237
  v_cvt_pk_bf16_f32 v237, v237, v237
  v_and_b32 v237, 0xffff0000, v237
  v_pk_add_f32 v[216:217], v[216:217], v[236:237] op_sel_hi:[1,0] neg_lo:[0,1] neg_hi:[0,1]
  v_pk_add_f32 v[218:219], v[218:219], v[236:237] op_sel_hi:[1,0] neg_lo:[0,1] neg_hi:[0,1]
  v_sqrt_f32 v237, v237
  v_cvt_pk_bf16_f32 v232, v216, v217
  v_cvt_pk_bf16_f32 v233, v218, v219
  v_cvt_pk_bf16_f32 v237, v237, v237
  v_and_b32 v237, 0xffff0000, v237
  v_rcp_f32 v237, v237
  v_lshlrev_b32 v216, 16, v232
  v_and_b32 v217, 0xffff0000, v232
  v_lshlrev_b32 v218, 16, v233
  v_and_b32 v219, 0xffff0000, v233
  v_pk_mul_f32 v[216:217], v[216:217], v[236:237] op_sel:[0,1] op_sel_hi:[1,1]
  v_pk_mul_f32 v[218:219], v[218:219], v[236:237] op_sel:[0,1] op_sel_hi:[1,1]
  v_cvt_pk_bf16_f32 v240, v216, v217
  v_cvt_pk_bf16_f32 v241, v218, v219
  v_mov_b32 v242, v240
  v_mov_b32 v243, v241
  s_nop 0
  v_permlane16_swap_b32 v240, v242
  v_permlane16_swap_b32 v241, v243
  v_mov_b32 v226, v224
  v_mov_b32 v227, v225
  s_nop 0
  v_permlane16_swap_b32 v224, v226
  v_permlane16_swap_b32 v225, v227
  s_sub_u32 s55, s0, 5242880
  buffer_store_dwordx4 v[240:243], v31, s[4:7], s55 offen sc1
  buffer_store_dwordx4 v[224:227], v31, s[4:7], s0 offen sc1
  v_mov_b32 v18, 1
  s_waitcnt vmcnt(0)
  s_barrier
  buffer_store_dword v18, off, s[4:7], s93 sc1
  s_endpgm
failaF_43:
  s_mov_b64 exec, 1
  v_mov_b32 v150, 224
  v_mov_b32 v151, 2
  buffer_atomic_or v151, v150, s[8:11], 0 offen sc1
  s_endpgm
  .p2align 6
R_ffnF:
  s_lshr_b32 s52, s43, 4
  s_and_b32 s53, s43, 15
  v_add_u32 v40, 0, v0
  v_mul_u32_u24 v41, 87382, v40
  v_lshrrev_b32 v41, 20, v41
  v_mul_u32_u24 v42, 12, v41
  v_sub_u32 v40, v40, v42
  v_lshlrev_b32 v40, 4, v40
  v_mul_u32_u24 v41, 3072, v41
  v_add_u32 v16, v40, v41
  v_add_u32 v40, 64, v0
  v_mul_u32_u24 v41, 87382, v40
  v_lshrrev_b32 v41, 20, v41
  v_mul_u32_u24 v42, 12, v41
  v_sub_u32 v40, v40, v42
  v_lshlrev_b32 v40, 4, v40
  v_mul_u32_u24 v41, 3072, v41
  v_add_u32 v17, v40, v41
  v_add_u32 v40, 128, v0
  v_mul_u32_u24 v41, 87382, v40
  v_lshrrev_b32 v41, 20, v41
  v_mul_u32_u24 v42, 12, v41
  v_sub_u32 v40, v40, v42
  v_lshlrev_b32 v40, 4, v40
  v_mul_u32_u24 v41, 3072, v41
  v_add_u32 v18, v40, v41
  s_mul_i32 s46, s3, 49152
  v_add_u32 v16, s46, v16
  v_add_u32 v17, s46, v17
  v_add_u32 v18, s46, v18
  s_mul_i32 s46, s53, 192
  v_add_u32 v16, s46, v16
  v_add_u32 v17, s46, v17
  v_add_u32 v18, s46, v18
  v_add_u32 v40, 0, v0
  v_mul_u32_u24 v41, 26215, v40
  v_lshrrev_b32 v41, 20, v41
  v_mul_u32_u24 v42, 40, v41
  v_sub_u32 v40, v40, v42
  v_lshlrev_b32 v40, 4, v40
  v_mul_u32_u24 v41, 1280, v41
  v_add_u32 v20, v40, v41
  v_add_u32 v40, 64, v0
  v_mul_u32_u24 v41, 26215, v40
  v_lshrrev_b32 v41, 20, v41
  v_mul_u32_u24 v42, 40, v41
  v_sub_u32 v40, v40, v42
  v_lshlrev_b32 v40, 4, v40
  v_mul_u32_u24 v41, 1280, v41
  v_add_u32 v21, v40, v41
  v_add_u32 v40, 128, v0
  v_mul_u32_u24 v41, 26215, v40
  v_lshrrev_b32 v41, 20, v41
  v_mul_u32_u24 v42, 40, v41
  v_sub_u32 v40, v40, v42
  v_lshlrev_b32 v40, 4, v40
  v_mul_u32_u24 v41, 1280, v41
  v_add_u32 v22, v40, v41
  v_add_u32 v40, 192, v0
  v_mul_u32_u24 v41, 26215, v40
  v_lshrrev_b32 v41, 20, v41
  v_mul_u32_u24 v42, 40, v41
  v_sub_u32 v40, v40, v42
  v_lshlrev_b32 v40, 4, v40
  v_mul_u32_u24 v41, 1280, v41
  v_add_u32 v23, v40, v41
  v_add_u32 v40, 256, v0
  v_mul_u32_u24 v41, 26215, v40
  v_lshrrev_b32 v41, 20, v41
  v_mul_u32_u24 v42, 40, v41
  v_sub_u32 v40, v40, v42
  v_lshlrev_b32 v40, 4, v40
  v_mul_u32_u24 v41, 1280, v41
  v_add_u32 v24, v40, v41
  s_mul_i32 s46, s3, 10240
  v_add_u32 v20, s46, v20
  v_add_u32 v21, s46, v21
  v_add_u32 v22, s46, v22
  v_add_u32 v23, s46, v23
  v_add_u32 v24, s46, v24
  s_mul_i32 s46, s53, 122880
  s_and_b32 s47, s53, 1
  s_mul_i32 s57, s47, 640
  s_add_u32 s46, s46, s57
  v_add_u32 v20, s46, v20
  v_add_u32 v21, s46, v21
  v_add_u32 v22, s46, v22
  v_add_u32 v23, s46, v23
  v_add_u32 v24, s46, v24
  s_mul_i32 s57, s47, 245760
  s_sub_u32 s57, 122880, s57
  v_add_u32 v52, s57, v20
  v_add_u32 v53, s57, v21
  v_add_u32 v54, s57, v22
  v_add_u32 v55, s57, v23
  v_add_u32 v56, s57, v24
  v_lshrrev_b32 v40, 4, v0
  v_mul_u32_u24 v40, 8, v40
  v_bfe_u32 v41, v0, 2, 2
  v_add_u32 v40, v40, v41
  v_mul_u32_u24 v40, 192, v40
  v_and_b32 v41, 3, v0
  v_mul_u32_u24 v41, 8, v41
  v_add_u32 v26, v40, v41
  s_lshr_b32 s46, s3, 1
  s_mul_i32 s57, s46, 40960
  s_mul_i32 s46, s46, 96
  v_add_u32 v26, s46, v26
  v_add_u32 v27, 0x10000, v26
  v_add_u32 v28, 0x20000, v26
  v_lshrrev_b32 v40, 4, v0
  v_mul_u32_u24 v40, 4, v40
  v_bfe_u32 v41, v0, 2, 2
  v_add_u32 v40, v40, v41
  v_mul_u32_u24 v40, 640, v40
  v_and_b32 v41, 3, v0
  v_mul_u32_u24 v41, 8, v41
  v_add_u32 v29, v40, v41
  s_mul_i32 s46, s3, 160
  v_add_u32 v29, s46, v29
  v_add_u32 v30, 0x10000, v29
  v_add_u32 v31, 0x20000, v29
  s_mul_i32 s55, s3, 3072
  s_mul_i32 s56, s3, 5120
  s_mov_b32 s60, s32
  s_and_b32 s61, s33, 0xffff
  s_mov_b32 s62, 1966080
  s_mov_b32 s63, 0x20000
  s_mov_b32 s64, s34
  s_and_b32 s65, s35, 0xffff
  s_mov_b32 s66, 1966080
  s_mov_b32 s67, 0x20000
  s_waitcnt vmcnt(0)
  s_barrier
  s_cmp_eq_u32 s3, 0
  s_cbranch_scc0 arrF_69
  s_mov_b64 exec, 1
  v_mov_b32 v150, 140
  v_mov_b32 v149, 1
  buffer_atomic_add v149, v150, s[8:11], 0 offen sc0 sc1
  s_mov_b64 exec, -1
arrF_69:
  s_sleep 127
  s_sleep 127
  s_sleep 127
  s_mov_b32 s46, 0
  s_add_u32 m0, s55, 0
  s_nop 0
  buffer_load_dwordx4 v16, s[60:63], s46 offen lds
  s_mov_b32 s46, 0
  s_add_u32 m0, s55, 1024
  s_nop 0
  buffer_load_dwordx4 v17, s[60:63], s46 offen lds
  s_mov_b32 s46, 0
  s_add_u32 m0, s55, 2048
  s_nop 0
  buffer_load_dwordx4 v18, s[60:63], s46 offen lds
  s_mov_b32 s46, 196608
  s_add_u32 m0, s55, 12288
  s_nop 0
  buffer_load_dwordx4 v16, s[60:63], s46 offen lds
  s_mov_b32 s46, 196608
  s_add_u32 m0, s55, 13312
  s_nop 0
  buffer_load_dwordx4 v17, s[60:63], s46 offen lds
  s_mov_b32 s46, 196608
  s_add_u32 m0, s55, 14336
  s_nop 0
  buffer_load_dwordx4 v18, s[60:63], s46 offen lds
  s_mov_b32 s46, 393216
  s_add_u32 m0, s55, 24576
  s_nop 0
  buffer_load_dwordx4 v16, s[60:63], s46 offen lds
  s_mov_b32 s46, 393216
  s_add_u32 m0, s55, 25600
  s_nop 0
  buffer_load_dwordx4 v17, s[60:63], s46 offen lds
  s_mov_b32 s46, 393216
  s_add_u32 m0, s55, 26624
  s_nop 0
  buffer_load_dwordx4 v18, s[60:63], s46 offen lds
  s_mov_b32 s46, 589824
  s_add_u32 m0, s55, 36864
  s_nop 0
  buffer_load_dwordx4 v16, s[60:63], s46 offen lds
  s_mov_b32 s46, 589824
  s_add_u32 m0, s55, 37888
  s_nop 0
  buffer_load_dwordx4 v17, s[60:63], s46 offen lds
  s_mov_b32 s46, 589824
  s_add_u32 m0, s55, 38912
  s_nop 0
  buffer_load_dwordx4 v18, s[60:63], s46 offen lds
  s_mov_b32 s46, 786432
  s_add_u32 m0, s55, 49152
  s_nop 0
  buffer_load_dwordx4 v16, s[60:63], s46 offen lds
  s_mov_b32 s46, 786432
  s_add_u32 m0, s55, 50176
  s_nop 0
  buffer_load_dwordx4 v17, s[60:63], s46 offen lds
  s_mov_b32 s46, 786432
  s_add_u32 m0, s55, 51200
  s_nop 0
  buffer_load_dwordx4 v18, s[60:63], s46 offen lds
  s_mov_b32 s46, 983040
  s_add_u32 m0, s55, 61440
  s_nop 0
  buffer_load_dwordx4 v16, s[60:63], s46 offen lds
  s_mov_b32 s46, 983040
  s_add_u32 m0, s55, 62464
  s_nop 0
  buffer_load_dwordx4 v17, s[60:63], s46 offen lds
  s_mov_b32 s46, 983040
  s_add_u32 m0, s55, 63488
  s_nop 0
  buffer_load_dwordx4 v18, s[60:63], s46 offen lds
  s_mov_b32 s46, 1179648
  s_add_u32 m0, s55, 73728
  s_nop 0
  buffer_load_dwordx4 v16, s[60:63], s46 offen lds
  s_mov_b32 s46, 1179648
  s_add_u32 m0, s55, 74752
  s_nop 0
  buffer_load_dwordx4 v17, s[60:63], s46 offen lds
  s_mov_b32 s46, 1179648
  s_add_u32 m0, s55, 75776
  s_nop 0
  buffer_load_dwordx4 v18, s[60:63], s46 offen lds
  s_mov_b32 s46, 1376256
  s_add_u32 m0, s55, 86016
  s_nop 0
  buffer_load_dwordx4 v16, s[60:63], s46 offen lds
  s_mov_b32 s46, 1376256
  s_add_u32 m0, s55, 87040
  s_nop 0
  buffer_load_dwordx4 v17, s[60:63], s46 offen lds
  s_mov_b32 s46, 1376256
  s_add_u32 m0, s55, 88064
  s_nop 0
  buffer_load_dwordx4 v18, s[60:63], s46 offen lds
  s_mov_b32 s46, 1572864
  s_add_u32 m0, s55, 98304
  s_nop 0
  buffer_load_dwordx4 v16, s[60:63], s46 offen lds
  s_mov_b32 s46, 1572864
  s_add_u32 m0, s55, 99328
  s_nop 0
  buffer_load_dwordx4 v17, s[60:63], s46 offen lds
  s_mov_b32 s46, 1572864
  s_add_u32 m0, s55, 100352
  s_nop 0
  buffer_load_dwordx4 v18, s[60:63], s46 offen lds
  s_mov_b32 s46, 1769472
  s_add_u32 m0, s55, 110592
  s_nop 0
  buffer_load_dwordx4 v16, s[60:63], s46 offen lds
  s_mov_b32 s46, 1769472
  s_add_u32 m0, s55, 111616
  s_nop 0
  buffer_load_dwordx4 v17, s[60:63], s46 offen lds
  s_mov_b32 s46, 1769472
  s_add_u32 m0, s55, 112640
  s_nop 0
  buffer_load_dwordx4 v18, s[60:63], s46 offen lds
  s_mov_b32 s46, 0
  s_add_u32 m0, s56, 122880
  s_nop 0
  buffer_load_dwordx4 v20, s[64:67], s46 offen lds
  s_mov_b32 s46, 0
  s_add_u32 m0, s56, 123904
  s_nop 0
  buffer_load_dwordx4 v21, s[64:67], s46 offen lds
  s_mov_b32 s46, 0
  s_add_u32 m0, s56, 124928
  s_nop 0
  buffer_load_dwordx4 v22, s[64:67], s46 offen lds
  s_mov_b32 s46, 0
  s_add_u32 m0, s56, 125952
  s_nop 0
  buffer_load_dwordx4 v23, s[64:67], s46 offen lds
  s_mov_b32 s46, 0
  s_add_u32 m0, s56, 126976
  s_nop 0
  buffer_load_dwordx4 v24, s[64:67], s46 offen lds
  s_mov_b32 s46, 61440
  s_add_u32 m0, s56, 143360
  s_nop 0
  buffer_load_dwordx4 v20, s[64:67], s46 offen lds
  s_mov_b32 s46, 61440
  s_add_u32 m0, s56, 144384
  s_nop 0
  buffer_load_dwordx4 v21, s[64:67], s46 offen lds
  s_mov_b32 s46, 61440
  s_add_u32 m0, s56, 145408
  s_nop 0
  buffer_load_dwordx4 v22, s[64:67], s46 offen lds
  s_mov_b32 s46, 61440
  s_add_u32 m0, s56, 146432
  s_nop 0
  buffer_load_dwordx4 v23, s[64:67], s46 offen lds
  s_mov_b32 s46, 61440
  s_add_u32 m0, s56, 147456
  s_nop 0
  buffer_load_dwordx4 v24, s[64:67], s46 offen lds
  s_waitcnt vmcnt(37)
  s_barrier
  ds_read_b64_tr_b16 a[0:1], v26 offset:0
  ds_read_b64_tr_b16 a[2:3], v26 offset:768
  ds_read_b64_tr_b16 a[80:81], v26 offset:32
  ds_read_b64_tr_b16 a[82:83], v26 offset:800
  ds_read_b64_tr_b16 a[160:161], v26 offset:64
  ds_read_b64_tr_b16 a[162:163], v26 offset:832
  ds_read_b64_tr_b16 a[4:5], v26 offset:6144
  ds_read_b64_tr_b16 a[6:7], v26 offset:6912
  ds_read_b64_tr_b16 a[84:85], v26 offset:6176
  ds_read_b64_tr_b16 a[86:87], v26 offset:6944
  ds_read_b64_tr_b16 a[164:165], v26 offset:6208
  ds_read_b64_tr_b16 a[166:167], v26 offset:6976
  s_waitcnt lgkmcnt(0)
  s_waitcnt vmcnt(34)
  s_barrier
  ds_read_b64_tr_b16 a[8:9], v26 offset:12288
  ds_read_b64_tr_b16 a[10:11], v26 offset:13056
  ds_read_b64_tr_b16 a[88:89], v26 offset:12320
  ds_read_b64_tr_b16 a[90:91], v26 offset:13088
  ds_read_b64_tr_b16 a[168:169], v26 offset:12352
  ds_read_b64_tr_b16 a[170:171], v26 offset:13120
  ds_read_b64_tr_b16 a[12:13], v26 offset:18432
  ds_read_b64_tr_b16 a[14:15], v26 offset:19200
  ds_read_b64_tr_b16 a[92:93], v26 offset:18464
  ds_read_b64_tr_b16 a[94:95], v26 offset:19232
  ds_read_b64_tr_b16 a[172:173], v26 offset:18496
  ds_read_b64_tr_b16 a[174:175], v26 offset:19264
  s_waitcnt lgkmcnt(0)
  s_waitcnt vmcnt(31)
  s_barrier
  s_add_u32 s46, s57, 40960
  s_add_u32 m0, s56, 0
  s_nop 0
  buffer_load_dwordx4 v20, s[64:67], s46 offen lds
  s_add_u32 s46, s57, 40960
  s_add_u32 m0, s56, 1024
  s_nop 0
  buffer_load_dwordx4 v21, s[64:67], s46 offen lds
  s_add_u32 s46, s57, 40960
  s_add_u32 m0, s56, 2048
  s_nop 0
  buffer_load_dwordx4 v22, s[64:67], s46 offen lds
  s_add_u32 s46, s57, 40960
  s_add_u32 m0, s56, 3072
  s_nop 0
  buffer_load_dwordx4 v23, s[64:67], s46 offen lds
  s_add_u32 s46, s57, 40960
  s_add_u32 m0, s56, 4096
  s_nop 0
  buffer_load_dwordx4 v24, s[64:67], s46 offen lds
  ds_read_b64_tr_b16 a[16:17], v26 offset:24576
  ds_read_b64_tr_b16 a[18:19], v26 offset:25344
  ds_read_b64_tr_b16 a[96:97], v26 offset:24608
  ds_read_b64_tr_b16 a[98:99], v26 offset:25376
  ds_read_b64_tr_b16 a[176:177], v26 offset:24640
  ds_read_b64_tr_b16 a[178:179], v26 offset:25408
  ds_read_b64_tr_b16 a[20:21], v26 offset:30720
  ds_read_b64_tr_b16 a[22:23], v26 offset:31488
  ds_read_b64_tr_b16 a[100:101], v26 offset:30752
  ds_read_b64_tr_b16 a[102:103], v26 offset:31520
  ds_read_b64_tr_b16 a[180:181], v26 offset:30784
  ds_read_b64_tr_b16 a[182:183], v26 offset:31552
  s_waitcnt lgkmcnt(0)
  s_waitcnt vmcnt(33)
  s_barrier
  ds_read_b64_tr_b16 a[24:25], v26 offset:36864
  ds_read_b64_tr_b16 a[26:27], v26 offset:37632
  ds_read_b64_tr_b16 a[104:105], v26 offset:36896
  ds_read_b64_tr_b16 a[106:107], v26 offset:37664
  ds_read_b64_tr_b16 a[184:185], v26 offset:36928
  ds_read_b64_tr_b16 a[186:187], v26 offset:37696
  ds_read_b64_tr_b16 a[28:29], v26 offset:43008
  ds_read_b64_tr_b16 a[30:31], v26 offset:43776
  ds_read_b64_tr_b16 a[108:109], v26 offset:43040
  ds_read_b64_tr_b16 a[110:111], v26 offset:43808
  ds_read_b64_tr_b16 a[188:189], v26 offset:43072
  ds_read_b64_tr_b16 a[190:191], v26 offset:43840
  s_waitcnt lgkmcnt(0)
  s_waitcnt vmcnt(30)
  s_barrier
  s_mov_b32 s46, 0
  s_add_u32 m0, s56, 20480
  s_nop 0
  buffer_load_dwordx4 v52, s[64:67], s46 offen lds
  s_mov_b32 s46, 0
  s_add_u32 m0, s56, 21504
  s_nop 0
  buffer_load_dwordx4 v53, s[64:67], s46 offen lds
  s_mov_b32 s46, 0
  s_add_u32 m0, s56, 22528
  s_nop 0
  buffer_load_dwordx4 v54, s[64:67], s46 offen lds
  s_mov_b32 s46, 0
  s_add_u32 m0, s56, 23552
  s_nop 0
  buffer_load_dwordx4 v55, s[64:67], s46 offen lds
  s_mov_b32 s46, 0
  s_add_u32 m0, s56, 24576
  s_nop 0
  buffer_load_dwordx4 v56, s[64:67], s46 offen lds
  ds_read_b64_tr_b16 a[32:33], v26 offset:49152
  ds_read_b64_tr_b16 a[34:35], v26 offset:49920
  ds_read_b64_tr_b16 a[112:113], v26 offset:49184
  ds_read_b64_tr_b16 a[114:115], v26 offset:49952
  ds_read_b64_tr_b16 a[192:193], v26 offset:49216
  ds_read_b64_tr_b16 a[194:195], v26 offset:49984
  ds_read_b64_tr_b16 a[36:37], v26 offset:55296
  ds_read_b64_tr_b16 a[38:39], v26 offset:56064
  ds_read_b64_tr_b16 a[116:117], v26 offset:55328
  ds_read_b64_tr_b16 a[118:119], v26 offset:56096
  ds_read_b64_tr_b16 a[196:197], v26 offset:55360
  ds_read_b64_tr_b16 a[198:199], v26 offset:56128
  s_waitcnt lgkmcnt(0)
  s_waitcnt vmcnt(32)
  s_barrier
  s_mov_b32 s46, 61440
  s_add_u32 m0, s56, 40960
  s_nop 0
  buffer_load_dwordx4 v52, s[64:67], s46 offen lds
  s_mov_b32 s46, 61440
  s_add_u32 m0, s56, 41984
  s_nop 0
  buffer_load_dwordx4 v53, s[64:67], s46 offen lds
  s_mov_b32 s46, 61440
  s_add_u32 m0, s56, 43008
  s_nop 0
  buffer_load_dwordx4 v54, s[64:67], s46 offen lds
  s_mov_b32 s46, 61440
  s_add_u32 m0, s56, 44032
  s_nop 0
  buffer_load_dwordx4 v55, s[64:67], s46 offen lds
  s_mov_b32 s46, 61440
  s_add_u32 m0, s56, 45056
  s_nop 0
  buffer_load_dwordx4 v56, s[64:67], s46 offen lds
  ds_read_b64_tr_b16 a[40:41], v26 offset:61440
  ds_read_b64_tr_b16 a[42:43], v26 offset:62208
  ds_read_b64_tr_b16 a[120:121], v26 offset:61472
  ds_read_b64_tr_b16 a[122:123], v26 offset:62240
  ds_read_b64_tr_b16 a[200:201], v26 offset:61504
  ds_read_b64_tr_b16 a[202:203], v26 offset:62272
  ds_read_b64_tr_b16 a[44:45], v27 offset:2048
  ds_read_b64_tr_b16 a[46:47], v27 offset:2816
  ds_read_b64_tr_b16 a[124:125], v27 offset:2080
  ds_read_b64_tr_b16 a[126:127], v27 offset:2848
  ds_read_b64_tr_b16 a[204:205], v27 offset:2112
  ds_read_b64_tr_b16 a[206:207], v27 offset:2880
  s_waitcnt lgkmcnt(0)
  s_waitcnt vmcnt(34)
  s_barrier
  ds_read_b64_tr_b16 a[48:49], v27 offset:8192
  ds_read_b64_tr_b16 a[50:51], v27 offset:8960
  ds_read_b64_tr_b16 a[128:129], v27 offset:8224
  ds_read_b64_tr_b16 a[130:131], v27 offset:8992
  ds_read_b64_tr_b16 a[208:209], v27 offset:8256
  ds_read_b64_tr_b16 a[210:211], v27 offset:9024
  ds_read_b64_tr_b16 a[52:53], v27 offset:14336
  ds_read_b64_tr_b16 a[54:55], v27 offset:15104
  ds_read_b64_tr_b16 a[132:133], v27 offset:14368
  ds_read_b64_tr_b16 a[134:135], v27 offset:15136
  ds_read_b64_tr_b16 a[212:213], v27 offset:14400
  ds_read_b64_tr_b16 a[214:215], v27 offset:15168
  s_waitcnt lgkmcnt(0)
  s_waitcnt vmcnt(31)
  s_barrier
  s_add_u32 s46, s57, 40960
  s_add_u32 m0, s56, 61440
  s_nop 0
  buffer_load_dwordx4 v52, s[64:67], s46 offen lds
  s_add_u32 s46, s57, 40960
  s_add_u32 m0, s56, 62464
  s_nop 0
  buffer_load_dwordx4 v53, s[64:67], s46 offen lds
  s_add_u32 s46, s57, 40960
  s_add_u32 m0, s56, 63488
  s_nop 0
  buffer_load_dwordx4 v54, s[64:67], s46 offen lds
  s_add_u32 s46, s57, 40960
  s_add_u32 m0, s56, 64512
  s_nop 0
  buffer_load_dwordx4 v55, s[64:67], s46 offen lds
  s_add_u32 s46, s57, 40960
  s_add_u32 m0, s56, 65536
  s_nop 0
  buffer_load_dwordx4 v56, s[64:67], s46 offen lds
  ds_read_b64_tr_b16 a[56:57], v27 offset:20480
  ds_read_b64_tr_b16 a[58:59], v27 offset:21248
  ds_read_b64_tr_b16 a[136:137], v27 offset:20512
  ds_read_b64_tr_b16 a[138:139], v27 offset:21280
  ds_read_b64_tr_b16 a[216:217], v27 offset:20544
  ds_read_b64_tr_b16 a[218:219], v27 offset:21312
  ds_read_b64_tr_b16 a[60:61], v27 offset:26624
  ds_read_b64_tr_b16 a[62:63], v27 offset:27392
  ds_read_b64_tr_b16 a[140:141], v27 offset:26656
  ds_read_b64_tr_b16 a[142:143], v27 offset:27424
  ds_read_b64_tr_b16 a[220:221], v27 offset:26688
  ds_read_b64_tr_b16 a[222:223], v27 offset:27456
  s_waitcnt lgkmcnt(0)
  s_waitcnt vmcnt(33)
  s_barrier
  ds_read_b64_tr_b16 a[64:65], v27 offset:32768
  ds_read_b64_tr_b16 a[66:67], v27 offset:33536
  ds_read_b64_tr_b16 a[144:145], v27 offset:32800
  ds_read_b64_tr_b16 a[146:147], v27 offset:33568
  ds_read_b64_tr_b16 a[224:225], v27 offset:32832
  ds_read_b64_tr_b16 a[226:227], v27 offset:33600
  ds_read_b64_tr_b16 a[68:69], v27 offset:38912
  ds_read_b64_tr_b16 a[70:71], v27 offset:39680
  ds_read_b64_tr_b16 a[148:149], v27 offset:38944
  ds_read_b64_tr_b16 a[150:151], v27 offset:39712
  ds_read_b64_tr_b16 a[228:229], v27 offset:38976
  ds_read_b64_tr_b16 a[230:231], v27 offset:39744
  s_waitcnt lgkmcnt(0)
  s_waitcnt vmcnt(30)
  s_barrier
  ds_read_b64_tr_b16 a[72:73], v27 offset:45056
  ds_read_b64_tr_b16 a[74:75], v27 offset:45824
  ds_read_b64_tr_b16 a[152:153], v27 offset:45088
  ds_read_b64_tr_b16 a[154:155], v27 offset:45856
  ds_read_b64_tr_b16 a[232:233], v27 offset:45120
  ds_read_b64_tr_b16 a[234:235], v27 offset:45888
  ds_read_b64_tr_b16 a[76:77], v27 offset:51200
  ds_read_b64_tr_b16 a[78:79], v27 offset:51968
  ds_read_b64_tr_b16 a[156:157], v27 offset:51232
  ds_read_b64_tr_b16 a[158:159], v27 offset:52000
  ds_read_b64_tr_b16 a[236:237], v27 offset:51264
  ds_read_b64_tr_b16 a[238:239], v27 offset:52032
  s_waitcnt lgkmcnt(0)
  s_waitcnt vmcnt(25)
  s_barrier
  ds_read_b64_tr_b16 a[240:241], v30 offset:57344
  ds_read_b64_tr_b16 a[242:243], v31 offset:2048
  ds_read_b64_tr_b16 v[160:161], v30 offset:57376
  ds_read_b64_tr_b16 v[162:163], v31 offset:2080
  ds_read_b64_tr_b16 v[184:185], v30 offset:57408
  ds_read_b64_tr_b16 v[186:187], v31 offset:2112
  ds_read_b64_tr_b16 v[208:209], v30 offset:57440
  ds_read_b64_tr_b16 v[210:211], v31 offset:2144
  ds_read_b64_tr_b16 v[232:233], v30 offset:57472
  ds_read_b64_tr_b16 v[234:235], v31 offset:2176
  s_waitcnt lgkmcnt(0)
  s_waitcnt vmcnt(20)
  s_barrier
  ds_read_b64_tr_b16 a[244:245], v31 offset:12288
  ds_read_b64_tr_b16 a[246:247], v31 offset:22528
  ds_read_b64_tr_b16 v[164:165], v31 offset:12320
  ds_read_b64_tr_b16 v[166:167], v31 offset:22560
  ds_read_b64_tr_b16 v[188:189], v31 offset:12352
  ds_read_b64_tr_b16 v[190:191], v31 offset:22592
  ds_read_b64_tr_b16 v[212:213], v31 offset:12384
  ds_read_b64_tr_b16 v[214:215], v31 offset:22624
  ds_read_b64_tr_b16 v[236:237], v31 offset:12416
  ds_read_b64_tr_b16 v[238:239], v31 offset:22656
  s_waitcnt lgkmcnt(0)
  s_waitcnt vmcnt(15)
  s_barrier
  ds_read_b64_tr_b16 a[248:249], v29 offset:0
  ds_read_b64_tr_b16 a[250:251], v29 offset:10240
  ds_read_b64_tr_b16 v[168:169], v29 offset:32
  ds_read_b64_tr_b16 v[170:171], v29 offset:10272
  ds_read_b64_tr_b16 v[192:193], v29 offset:64
  ds_read_b64_tr_b16 v[194:195], v29 offset:10304
  ds_read_b64_tr_b16 v[216:217], v29 offset:96
  ds_read_b64_tr_b16 v[218:219], v29 offset:10336
  ds_read_b64_tr_b16 v[240:241], v29 offset:128
  ds_read_b64_tr_b16 v[242:243], v29 offset:10368
  s_waitcnt lgkmcnt(0)
  s_waitcnt vmcnt(10)
  s_barrier
  ds_read_b64_tr_b16 a[252:253], v29 offset:20480
  ds_read_b64_tr_b16 a[254:255], v29 offset:30720
  ds_read_b64_tr_b16 v[172:173], v29 offset:20512
  ds_read_b64_tr_b16 v[174:175], v29 offset:30752
  ds_read_b64_tr_b16 v[196:197], v29 offset:20544
  ds_read_b64_tr_b16 v[198:199], v29 offset:30784
  ds_read_b64_tr_b16 v[220:221], v29 offset:20576
  ds_read_b64_tr_b16 v[222:223], v29 offset:30816
  ds_read_b64_tr_b16 v[244:245], v29 offset:20608
  ds_read_b64_tr_b16 v[246:247], v29 offset:30848
  s_waitcnt lgkmcnt(0)
  s_waitcnt vmcnt(5)
  s_barrier
  ds_read_b64_tr_b16 v[152:153], v29 offset:40960
  ds_read_b64_tr_b16 v[154:155], v29 offset:51200
  ds_read_b64_tr_b16 v[176:177], v29 offset:40992
  ds_read_b64_tr_b16 v[178:179], v29 offset:51232
  ds_read_b64_tr_b16 v[200:201], v29 offset:41024
  ds_read_b64_tr_b16 v[202:203], v29 offset:51264
  ds_read_b64_tr_b16 v[224:225], v29 offset:41056
  ds_read_b64_tr_b16 v[226:227], v29 offset:51296
  ds_read_b64_tr_b16 v[248:249], v29 offset:41088
  ds_read_b64_tr_b16 v[250:251], v29 offset:51328
  s_waitcnt lgkmcnt(0)
  s_waitcnt vmcnt(0)
  s_barrier
  ds_read_b64_tr_b16 v[156:157], v29 offset:61440
  ds_read_b64_tr_b16 v[158:159], v30 offset:6144
  ds_read_b64_tr_b16 v[180:181], v29 offset:61472
  ds_read_b64_tr_b16 v[182:183], v30 offset:6176
  ds_read_b64_tr_b16 v[204:205], v29 offset:61504
  ds_read_b64_tr_b16 v[206:207], v30 offset:6208
  ds_read_b64_tr_b16 v[228:229], v29 offset:61536
  ds_read_b64_tr_b16 v[230:231], v30 offset:6240
  ds_read_b64_tr_b16 v[252:253], v29 offset:61568
  ds_read_b64_tr_b16 v[254:255], v30 offset:6272
  s_waitcnt lgkmcnt(0)
  s_barrier
  s_mov_b32 s48, 0x00ff00ff
  s_mov_b32 s49, 0x00ff00ff
  s_mov_b32 s50, 0x00ff00ff
  s_mov_b32 s51, 0xff00ff00
  v_and_b32 v30, 1, v0
  v_lshlrev_b32 v30, 4, v30
  v_mov_b32 v31, 0x3f80
  v_lshlrev_b32 v30, v30, v31
  v_bfe_u32 v31, v0, 1, 2
  v_cmp_eq_u32 vcc, 0, v31
  s_nop 1
  v_cndmask_b32 v24, 0, v30, vcc
  v_cmp_eq_u32 vcc, 1, v31
  s_nop 1
  v_cndmask_b32 v25, 0, v30, vcc
  v_cmp_eq_u32 vcc, 2, v31
  s_nop 1
  v_cndmask_b32 v26, 0, v30, vcc
  v_cmp_eq_u32 vcc, 3, v31
  s_nop 1
  v_cndmask_b32 v27, 0, v30, vcc
  v_cndmask_b32 v16, 0, v24, s[50:51]
  v_cndmask_b32 v17, 0, v25, s[50:51]
  v_cndmask_b32 v18, 0, v26, s[50:51]
  v_cndmask_b32 v19, 0, v27, s[50:51]
  s_mov_b32 s56, 0x03ff03ff
  s_mov_b32 s57, 0x03ff03ff
  v_lshrrev_b32 v40, 3, v0
  s_lshl_b32 s46, s3, 3
  v_add_u32 v40, s46, v40
  v_bfe_u32 v41, v40, 1, 3
  v_and_b32 v42, 7, v0
  v_xor_b32 v41, v41, v42
  v_lshlrev_b32 v41, 4, v41
  v_mul_u32_u24 v40, 1280, v40
  v_add_u32 v2, v40, v41
  v_bfe_u32 v40, v0, 3, 1
  v_mul_u32_u24 v40, 10240, v40
  v_and_b32 v41, 7, v0
  v_lshlrev_b32 v41, 7, v41
  v_add_u32 v40, v40, v41
  v_bfe_u32 v41, v0, 1, 3
  v_lshrrev_b32 v42, 4, v0
  v_xor_b32 v41, v41, v42
  v_lshlrev_b32 v41, 4, v41
  v_add_u32 v4, v40, v41
  v_xor_b32 v5, 64, v4
  s_and_b32 s54, s3, 1
  s_lshr_b32 s55, s3, 1
  v_lshlrev_b32 v1, 3, v0
  v_lshlrev_b32 v30, 4, v0
  s_mul_i32 s46, s54, 20480
  v_add_u32 v4, s46, v4
  v_add_u32 v5, s46, v5
  v_add_u32 v7, 40960, v30
  s_mul_i32 s46, s54, 3072
  s_lshl_b32 s47, s55, 10
  s_add_u32 s47, s47, s46
  v_add_u32 v3, s47, v7
  s_lshl_b32 s47, s55, 3
  s_add_u32 s47, s47, s46
  v_add_u32 v6, s47, v7
  s_mul_i32 s46, s3, 5632
  s_add_u32 s46, s46, 54272
  v_and_b32 v33, 15, v0
  v_mul_u32_u24 v33, 176, v33
  v_lshrrev_b32 v34, 4, v0
  v_lshlrev_b32 v34, 3, v34
  v_add3_u32 v8, v33, v34, s46
  v_add_u32 v33, 0, v0
  v_mul_u32_u24 v34, 6554, v33
  v_lshrrev_b32 v34, 16, v34
  v_add_u32 v33, v33, v34
  v_lshlrev_b32 v33, 4, v33
  v_add_u32 v144, s46, v33
  v_add_u32 v33, 64, v0
  v_mul_u32_u24 v34, 6554, v33
  v_lshrrev_b32 v34, 16, v34
  v_add_u32 v33, v33, v34
  v_lshlrev_b32 v33, 4, v33
  v_add_u32 v145, s46, v33
  v_add_u32 v33, 128, v0
  v_mul_u32_u24 v34, 6554, v33
  v_lshrrev_b32 v34, 16, v34
  v_add_u32 v33, v33, v34
  v_lshlrev_b32 v33, 4, v33
  v_add_u32 v146, s46, v33
  v_add_u32 v33, 192, v0
  v_mul_u32_u24 v34, 6554, v33
  v_lshrrev_b32 v34, 16, v34
  v_add_u32 v33, v33, v34
  v_lshlrev_b32 v33, 4, v33
  v_add_u32 v147, s46, v33
  v_add_u32 v33, 256, v0
  v_mul_u32_u24 v34, 6554, v33
  v_lshrrev_b32 v34, 16, v34
  v_add_u32 v33, v33, v34
  v_lshlrev_b32 v33, 4, v33
  v_add_u32 v148, s46, v33
  v_and_b32 v31, 15, v0
  v_lshrrev_b32 v32, 4, v0
  v_mov_b32 v9, v30
  v_lshrrev_b32 v36, 5, v0
  v_lshlrev_b32 v34, 4, v31
  v_mov_b32 v35, 0x40000000
  v_cndmask_b32 v35, v35, 0, s[56:57]
  v_add_u32 v33, v34, v35
  v_and_b32 v34, 1, v32
  v_mul_u32_u24 v35, 40960, v34
  v_mul_u32_u24 v37, 160, v36
  v_add3_u32 v10, v33, v35, v37
  v_lshlrev_b32 v34, 3, v34
  v_mul_u32_u24 v37, 1280, v36
  v_add3_u32 v33, v33, v34, v37
  s_mul_i32 s46, s3, 320
  v_add_u32 v11, s46, v33
  v_mov_b32 v33, 85504
  v_add_u32 v143, 79872, v11
  v_cndmask_b32 v143, v33, v143, s[56:57]
  v_and_b32 v142, 31, v0
  v_lshlrev_b32 v142, 5, v142
  v_lshlrev_b32 v34, 27, v34
  v_add_u32 v15, v34, v11
  v_lshlrev_b32 v36, 5, v36
  v_add_u32 v13, 53248, v36
  s_lshl_b32 s46, s3, 3
  v_add_u32 v12, s46, v13
  s_lshl_b32 s72, s52, 18
  s_add_u32 s72, s72, 262144
  s_mul_i32 s73, s52, 2621440
  s_add_u32 s73, s73, 24117248
  s_mul_i32 s75, s52, 655360
  s_add_u32 s75, s75, 5767168
  s_mul_i32 s79, s53, 20480
  s_add_u32 s74, s75, s79
  s_mul_i32 s79, s3, 5120
  s_add_u32 s74, s74, s79
  s_mul_i32 s79, s53, 320
  s_add_u32 s75, s75, s79
  s_mul_i32 s79, s55, 20480
  s_add_u32 s75, s75, s79
  s_mul_i32 s79, s54, 10240
  s_add_u32 s75, s75, s79
  s_mul_i32 s77, s53, 2560
  s_lshl_b32 s62, s52, 5
  s_add_u32 s62, s62, s53
  s_xor_b32 s63, s62, 1
  s_mul_i32 s62, s62, 6144
  s_mul_i32 s63, s63, 6144
  s_mul_i32 s79, s3, 1536
  s_add_u32 s79, s79, 11272192
  s_add_u32 s62, s62, s79
  s_add_u32 s63, s63, s79
  s_add_u32 s76, s73, 5242880
  s_add_u32 s76, s76, s77
  s_lshl_b32 s78, s53, 5
  s_add_u32 s78, s78, 131072
  s_mul_i32 s80, s3, 10240
  s_mov_b32 s70, 0
  s_mov_b32 s81, 0x10000000
  s_mov_b32 s31, 0
  s_waitcnt vmcnt(0)
  v_readfirstlane_b32 s44, v149
  v_mov_b32 v150, 0
  s_mov_b32 s46, 64
  v_writelane_b32 v150, s46, 1
  s_mov_b32 s46, 128
  v_writelane_b32 v150, s46, 2
  s_mov_b32 s46, 132
  v_writelane_b32 v150, s46, 3
  s_mov_b32 s46, 136
  v_writelane_b32 v150, s46, 4
  s_mov_b32 s46, 192
  v_writelane_b32 v150, s46, 5
  s_mov_b32 s46, 196
  v_writelane_b32 v150, s46, 6
  s_mov_b32 s46, 200
  v_writelane_b32 v150, s46, 7
  s_mov_b32 s46, 140
  v_writelane_b32 v150, s46, 8
  s_mov_b64 exec, 0x1ff
gsF_70:
  buffer_load_dword v151, v150, s[8:11], 0 offen sc1
  s_waitcnt vmcnt(0)
  s_nop 0
  v_readlane_b32 s46, v151, 8
  s_cmp_ge_u32 s46, 256
  s_cbranch_scc1 gsokF_71
  s_add_u32 s45, s45, 1
  s_cmp_gt_u32 s45, 1048576
  s_cbranch_scc1 failfF_68
  s_sleep 4
  s_branch gsF_70
gsokF_71:
  buffer_load_dword v151, v150, s[8:11], 0 offen sc1
  s_waitcnt vmcnt(0)
  s_mov_b64 exec, 0xff
  v_cmp_ne_u32 vcc, 32, v151
  s_mov_b64 exec, -1
  s_cbranch_vccz balF_72
  s_getpc_b64 s[46:47]
pcF_73:
  s_add_u32 s46, s46, L_SAFE-pcF_73
  s_addc_u32 s47, s47, 0
  s_setpc_b64 s[46:47]
balF_72:
  s_cmp_eq_u32 s52, 0
  s_cselect_b32 s12, s40, s36
  s_cselect_b32 s13, s41, s37
  s_mov_b32 s14, 2621440
  s_cselect_b32 s14, 0x10000000, s14
  s_and_b32 s13, s13, 0xffff
  s_mov_b32 s15, 0x20000
  s_cmp_eq_u32 s52, 0
  s_cselect_b32 s86, 34603008, 0
  s_mov_b32 s87, 0x20000000
  s_cselect_b32 s87, 21495808, s87
  s_mov_b32 s88, 0x10000000
  s_cselect_b32 s78, s78, s88
  s_cselect_b32 s89, 2048, 0
  s_mov_b32 s30, 0
  s_mov_b32 s59, s75
  s_mov_b32 s82, 0x20000000
  s_mov_b32 s83, 0x20000000
  s_mov_b64 s[84:85], 0
  v_add_u32 v151, 79872, v9
  v_add_u32 v150, 2048, v9
  v_mov_b32 v33, 0x40000000
  v_cmp_gt_u32 vcc, 32, v0
  s_nop 1
  v_cndmask_b32 v150, v33, v150, vcc
  buffer_load_dword v149, v142, s[4:7], s72 offen sc1
  .p2align 6
topF_74:
  s_lshr_b32 s71, s70, 1
  s_and_b32 s71, s71, 1
  s_xor_b32 s71, s71, 1
  s_and_b32 s79, s70, 1
  s_mul_i32 s28, s79, 98304
  s_add_u32 s29, s28, s63
  s_add_u32 s28, s28, s62
  s_mul_i32 s79, s79, 327680
  s_add_u32 s60, s74, s79
  s_add_u32 s61, s60, 4096
  s_add_u32 s79, s75, s79
  s_waitcnt vmcnt(0)
  s_cmp_eq_u32 s31, 1
  s_cbranch_scc1 e2F_76
  v_cmp_eq_u32 vcc, 0, v149
  s_cbranch_vccnz e2F_76
  s_mov_b32 s31, 1
  s_mov_b32 m0, s80
  s_nop 0
  buffer_load_dwordx4 v2, s[4:7], s73 offen offset:0 sc1 lds
  s_add_u32 m0, m0, 896
  s_nop 0
  buffer_load_dwordx4 v2, s[4:7], s73 offen offset:128 sc1 lds
  s_add_u32 m0, m0, 896
  s_nop 0
  buffer_load_dwordx4 v2, s[4:7], s73 offen offset:256 sc1 lds
  s_add_u32 m0, m0, 896
  s_nop 0
  buffer_load_dwordx4 v2, s[4:7], s73 offen offset:384 sc1 lds
  s_add_u32 m0, m0, 896
  s_nop 0
  buffer_load_dwordx4 v2, s[4:7], s73 offen offset:512 sc1 lds
  s_add_u32 m0, m0, 896
  s_nop 0
  buffer_load_dwordx4 v2, s[4:7], s73 offen offset:640 sc1 lds
  s_add_u32 m0, m0, 896
  s_nop 0
  buffer_load_dwordx4 v2, s[4:7], s73 offen offset:768 sc1 lds
  s_add_u32 m0, m0, 896
  s_nop 0
  buffer_load_dwordx4 v2, s[4:7], s73 offen offset:896 sc1 lds
  s_add_u32 m0, m0, 896
  s_nop 0
  buffer_load_dwordx4 v2, s[4:7], s73 offen offset:1024 sc1 lds
  s_add_u32 m0, m0, 896
  s_nop 0
  buffer_load_dwordx4 v2, s[4:7], s73 offen offset:1152 sc1 lds
e2F_76:
bF_77:
  v_mfma_f32_16x16x32_bf16 v[68:71], v[16:19], v[24:27], 0
  v_bitop3_b32 v98, v24, v28, s30 bitop3:0x7e
  v_mfma_f32_16x16x32_bf16 v[68:71], v[16:19], v[28:31], v[68:71]
  v_bitop3_b32 v98, v98, v32, s30 bitop3:0xf6
  v_mfma_f32_16x16x32_bf16 v[68:71], v[16:19], v[32:35], v[68:71]
  v_bitop3_b32 v98, v98, v36, s30 bitop3:0xf6
  v_mfma_f32_16x16x32_bf16 v[68:71], v[16:19], v[36:39], v[68:71]
  v_bitop3_b32 v98, v98, v40, s30 bitop3:0xf6
  v_mfma_f32_16x16x32_bf16 v[72:75], v[16:19], v[40:43], 0
  v_bitop3_b32 v98, v98, v44, s30 bitop3:0xf6
  v_mfma_f32_16x16x32_bf16 v[72:75], v[16:19], v[44:47], v[72:75]
  v_bitop3_b32 v98, v98, v48, s30 bitop3:0xf6
  v_mfma_f32_16x16x32_bf16 v[72:75], v[16:19], v[48:51], v[72:75]
  v_bitop3_b32 v98, v98, v52, s30 bitop3:0xf6
  v_mfma_f32_16x16x32_bf16 v[72:75], v[16:19], v[52:55], v[72:75]
  v_and_b32 v98, 1, v98
  v_cmp_ne_u32 vcc, 0, v98
  s_and_b64 vcc, vcc, s[84:85]
  s_cbranch_vccz okF_78
  s_add_u32 s46, s59, 0
  buffer_load_dwordx4 v[24:27], v10, s[4:7], s46 offen sc1
  s_add_u32 s46, s59, 81920
  buffer_load_dwordx4 v[28:31], v10, s[4:7], s46 offen sc1
  s_add_u32 s46, s59, 163840
  buffer_load_dwordx4 v[32:35], v10, s[4:7], s46 offen sc1
  s_add_u32 s46, s59, 245760
  buffer_load_dwordx4 v[36:39], v10, s[4:7], s46 offen sc1
  s_add_u32 s46, s59, 5120
  buffer_load_dwordx4 v[40:43], v10, s[4:7], s46 offen sc1
  s_add_u32 s46, s59, 87040
  buffer_load_dwordx4 v[44:47], v10, s[4:7], s46 offen sc1
  s_add_u32 s46, s59, 168960
  buffer_load_dwordx4 v[48:51], v10, s[4:7], s46 offen sc1
  s_add_u32 s46, s59, 250880
  buffer_load_dwordx4 v[52:55], v10, s[4:7], s46 offen sc1
  s_add_u32 s45, s45, 1
  s_cmp_gt_u32 s45, 1048576
  s_cbranch_scc1 failfF_68
  s_waitcnt vmcnt(0)
  s_branch bF_77
okF_78:
  v_lshlrev_b32 v76, 16, v20
  v_and_b32 v77, 0xffff0000, v20
  v_lshlrev_b32 v78, 16, v21
  v_and_b32 v79, 0xffff0000, v21
  v_lshlrev_b32 v80, 16, v22
  v_and_b32 v81, 0xffff0000, v22
  v_lshlrev_b32 v82, 16, v23
  v_and_b32 v83, 0xffff0000, v23
  v_cvt_pk_bf16_f32 v92, v68, v69
  v_cvt_pk_bf16_f32 v93, v70, v71
  v_cvt_pk_bf16_f32 v94, v72, v73
  v_cvt_pk_bf16_f32 v95, v74, v75
  v_lshlrev_b32 v68, 16, v92
  v_and_b32 v69, 0xffff0000, v92
  v_lshlrev_b32 v70, 16, v93
  v_and_b32 v71, 0xffff0000, v93
  v_lshlrev_b32 v72, 16, v94
  v_and_b32 v73, 0xffff0000, v94
  v_lshlrev_b32 v74, 16, v95
  v_and_b32 v75, 0xffff0000, v95
  v_pk_add_f32 v[76:77], v[76:77], v[68:69]
  v_pk_add_f32 v[78:79], v[78:79], v[70:71]
  v_pk_add_f32 v[80:81], v[80:81], v[72:73]
  v_pk_add_f32 v[82:83], v[82:83], v[74:75]
  v_cvt_pk_bf16_f32 v120, v76, v77
  v_cvt_pk_bf16_f32 v121, v78, v79
  v_cvt_pk_bf16_f32 v124, v80, v81
  v_cvt_pk_bf16_f32 v125, v82, v83
  v_lshlrev_b32 v76, 16, v120
  v_and_b32 v77, 0xffff0000, v120
  v_lshlrev_b32 v78, 16, v121
  v_and_b32 v79, 0xffff0000, v121
  v_lshlrev_b32 v80, 16, v124
  v_and_b32 v81, 0xffff0000, v124
  v_lshlrev_b32 v82, 16, v125
  v_and_b32 v83, 0xffff0000, v125
  v_add_f32 v96, v76, v77
  v_mul_f32 v97, v76, v76
  v_fmac_f32 v97, v77, v77
  v_add_f32 v96, v96, v78
  v_fmac_f32 v97, v78, v78
  v_add_f32 v96, v96, v79
  v_fmac_f32 v97, v79, v79
  v_add_f32 v96, v96, v80
  v_fmac_f32 v97, v80, v80
  v_add_f32 v96, v96, v81
  v_fmac_f32 v97, v81, v81
  v_add_f32 v96, v96, v82
  v_fmac_f32 v97, v82, v82
  v_add_f32 v96, v96, v83
  v_fmac_f32 v97, v83, v83
  s_nop 0
  v_add_f32_dpp v96, v96, v96 quad_perm:[1,0,3,2] row_mask:0xf bank_mask:0xf
  v_add_f32_dpp v97, v97, v97 quad_perm:[1,0,3,2] row_mask:0xf bank_mask:0xf
  s_nop 0
  v_add_f32_dpp v96, v96, v96 quad_perm:[2,3,0,1] row_mask:0xf bank_mask:0xf
  v_add_f32_dpp v97, v97, v97 quad_perm:[2,3,0,1] row_mask:0xf bank_mask:0xf
  s_nop 0
  v_add_f32_dpp v96, v96, v96 row_half_mirror row_mask:0xf bank_mask:0xf
  v_add_f32_dpp v97, v97, v97 row_half_mirror row_mask:0xf bank_mask:0xf
  s_nop 0
  v_add_f32_dpp v96, v96, v96 row_mirror row_mask:0xf bank_mask:0xf
  v_add_f32_dpp v97, v97, v97 row_mirror row_mask:0xf bank_mask:0xf
  v_mov_b32 v68, v96
  v_mov_b32 v69, v97
  s_nop 0
  v_permlane16_swap_b32 v96, v68
  v_permlane16_swap_b32 v97, v69
  v_pk_add_f32 v[96:97], v[96:97], v[68:69]
  ds_write_b64 v12, v[96:97]
  s_cmp_eq_u32 s31, 1
  s_cbranch_scc1 haveF_75
fwF_79:
  buffer_load_dword v149, v142, s[4:7], s72 offen sc1
  s_waitcnt vmcnt(0)
fcF_81:
  v_cmp_eq_u32 vcc, 0, v149
  s_cbranch_vccz foF_80
  s_add_u32 s45, s45, 1
  s_cmp_gt_u32 s45, 1048576
  s_cbranch_scc1 failfF_68
  s_sleep 1
  s_branch fwF_79
foF_80:
  s_mov_b32 m0, s80
  s_nop 0
  buffer_load_dwordx4 v2, s[4:7], s73 offen offset:0 sc1 lds
  s_add_u32 m0, m0, 896
  s_nop 0
  buffer_load_dwordx4 v2, s[4:7], s73 offen offset:128 sc1 lds
  s_add_u32 m0, m0, 896
  s_nop 0
  buffer_load_dwordx4 v2, s[4:7], s73 offen offset:256 sc1 lds
  s_add_u32 m0, m0, 896
  s_nop 0
  buffer_load_dwordx4 v2, s[4:7], s73 offen offset:384 sc1 lds
  s_add_u32 m0, m0, 896
  s_nop 0
  buffer_load_dwordx4 v2, s[4:7], s73 offen offset:512 sc1 lds
  s_add_u32 m0, m0, 896
  s_nop 0
  buffer_load_dwordx4 v2, s[4:7], s73 offen offset:640 sc1 lds
  s_add_u32 m0, m0, 896
  s_nop 0
  buffer_load_dwordx4 v2, s[4:7], s73 offen offset:768 sc1 lds
  s_add_u32 m0, m0, 896
  s_nop 0
  buffer_load_dwordx4 v2, s[4:7], s73 offen offset:896 sc1 lds
  s_add_u32 m0, m0, 896
  s_nop 0
  buffer_load_dwordx4 v2, s[4:7], s73 offen offset:1024 sc1 lds
  s_add_u32 m0, m0, 896
  s_nop 0
  buffer_load_dwordx4 v2, s[4:7], s73 offen offset:1152 sc1 lds
haveF_75:
  s_waitcnt vmcnt(0) lgkmcnt(0)
  s_barrier
  ds_read_b128 v[68:71], v13
  ds_read_b128 v[72:75], v13 offset:16
  ds_read_b128 v[24:27], v4 offset:0
  ds_read_b128 v[28:31], v5 offset:0
  ds_read_b128 v[32:35], v4 offset:1024
  ds_read_b128 v[36:39], v5 offset:1024
  ds_read_b128 v[40:43], v4 offset:2048
  ds_read_b128 v[44:47], v5 offset:2048
  ds_read_b128 v[48:51], v4 offset:3072
  s_waitcnt lgkmcnt(6)
  v_mfma_f32_16x16x32_bf16 v[56:59], a[0:3], v[24:27], 0
  ds_read_b128 v[52:55], v5 offset:3072
  v_add_f32 v68, v68, v70
  v_mfma_f32_16x16x32_bf16 v[60:63], a[80:83], v[24:27], 0
  v_add_f32 v69, v69, v71
  v_add_f32 v72, v72, v74
  v_mfma_f32_16x16x32_bf16 v[64:67], a[160:163], v[24:27], 0
  v_add_f32 v73, v73, v75
  v_add_f32 v96, v68, v72
  s_waitcnt lgkmcnt(6)
  v_mfma_f32_16x16x32_bf16 v[56:59], a[4:7], v[28:31], v[56:59]
  ds_read_b128 v[24:27], v4 offset:4096
  v_add_f32 v97, v69, v73
  v_mfma_f32_16x16x32_bf16 v[60:63], a[84:87], v[28:31], v[60:63]
  v_mul_f32 v96, 0x3acccccd, v96
  v_mul_f32 v97, 0x3acccccd, v97
  v_mfma_f32_16x16x32_bf16 v[64:67], a[164:167], v[28:31], v[64:67]
  v_fma_f32 v97, -v96, v96, v97
  v_max_f32 v97, 0, v97
  s_waitcnt lgkmcnt(6)
  v_mfma_f32_16x16x32_bf16 v[56:59], a[8:11], v[32:35], v[56:59]
  ds_read_b128 v[28:31], v5 offset:4096
  v_cvt_pk_bf16_f32 v96, v96, v96
  v_mfma_f32_16x16x32_bf16 v[60:63], a[88:91], v[32:35], v[60:63]
  v_and_b32 v96, 0xffff0000, v96
  v_cvt_pk_bf16_f32 v97, v97, v97
  v_mfma_f32_16x16x32_bf16 v[64:67], a[168:171], v[32:35], v[64:67]
  v_and_b32 v97, 0xffff0000, v97
  v_add_f32 v97, 0x3727c5ac, v97
  s_waitcnt lgkmcnt(6)
  v_mfma_f32_16x16x32_bf16 v[56:59], a[12:15], v[36:39], v[56:59]
  ds_read_b128 v[32:35], v4 offset:5120
  v_cvt_pk_bf16_f32 v97, v97, v97
  v_mfma_f32_16x16x32_bf16 v[60:63], a[92:95], v[36:39], v[60:63]
  v_and_b32 v97, 0xffff0000, v97
  v_sub_f32 v76, v76, v96
  v_mfma_f32_16x16x32_bf16 v[64:67], a[172:175], v[36:39], v[64:67]
  v_sub_f32 v77, v77, v96
  v_sub_f32 v78, v78, v96
  s_waitcnt lgkmcnt(6)
  v_mfma_f32_16x16x32_bf16 v[56:59], a[16:19], v[40:43], v[56:59]
  ds_read_b128 v[36:39], v5 offset:5120
  v_sub_f32 v79, v79, v96
  v_mfma_f32_16x16x32_bf16 v[60:63], a[96:99], v[40:43], v[60:63]
  v_sub_f32 v80, v80, v96
  v_sub_f32 v81, v81, v96
  v_mfma_f32_16x16x32_bf16 v[64:67], a[176:179], v[40:43], v[64:67]
  v_sub_f32 v82, v82, v96
  v_sub_f32 v83, v83, v96
  s_waitcnt lgkmcnt(6)
  v_mfma_f32_16x16x32_bf16 v[56:59], a[20:23], v[44:47], v[56:59]
  ds_read_b128 v[40:43], v4 offset:6144
  v_sqrt_f32 v97, v97
  v_mfma_f32_16x16x32_bf16 v[60:63], a[100:103], v[44:47], v[60:63]
  v_cvt_pk_bf16_f32 v92, v76, v77
  v_cvt_pk_bf16_f32 v93, v78, v79
  v_mfma_f32_16x16x32_bf16 v[64:67], a[180:183], v[44:47], v[64:67]
  v_cvt_pk_bf16_f32 v94, v80, v81
  v_cvt_pk_bf16_f32 v95, v82, v83
  s_waitcnt lgkmcnt(6)
  v_mfma_f32_16x16x32_bf16 v[56:59], a[24:27], v[48:51], v[56:59]
  ds_read_b128 v[44:47], v5 offset:6144
  v_cvt_pk_bf16_f32 v97, v97, v97
  v_mfma_f32_16x16x32_bf16 v[60:63], a[104:107], v[48:51], v[60:63]
  v_and_b32 v97, 0xffff0000, v97
  v_rcp_f32 v97, v97
  v_mfma_f32_16x16x32_bf16 v[64:67], a[184:187], v[48:51], v[64:67]
  v_lshlrev_b32 v76, 16, v92
  v_and_b32 v77, 0xffff0000, v92
  s_waitcnt lgkmcnt(6)
  v_mfma_f32_16x16x32_bf16 v[56:59], a[28:31], v[52:55], v[56:59]
  ds_read_b128 v[48:51], v4 offset:7168
  v_lshlrev_b32 v78, 16, v93
  v_mfma_f32_16x16x32_bf16 v[60:63], a[108:111], v[52:55], v[60:63]
  v_and_b32 v79, 0xffff0000, v93
  v_lshlrev_b32 v80, 16, v94
  v_mfma_f32_16x16x32_bf16 v[64:67], a[188:191], v[52:55], v[64:67]
  v_and_b32 v81, 0xffff0000, v94
  v_lshlrev_b32 v82, 16, v95
  s_waitcnt lgkmcnt(6)
  v_mfma_f32_16x16x32_bf16 v[56:59], a[32:35], v[24:27], v[56:59]
  ds_read_b128 v[52:55], v5 offset:7168
  v_and_b32 v83, 0xffff0000, v95
  v_mfma_f32_16x16x32_bf16 v[60:63], a[112:115], v[24:27], v[60:63]
  v_mul_f32 v76, v76, v97
  v_mul_f32 v77, v77, v97
  v_mfma_f32_16x16x32_bf16 v[64:67], a[192:195], v[24:27], v[64:67]
  v_mul_f32 v78, v78, v97
  v_mul_f32 v79, v79, v97
  s_waitcnt lgkmcnt(6)
  v_mfma_f32_16x16x32_bf16 v[56:59], a[36:39], v[28:31], v[56:59]
  ds_read_b128 v[24:27], v4 offset:8192
  v_mul_f32 v80, v80, v97
  v_mfma_f32_16x16x32_bf16 v[60:63], a[116:119], v[28:31], v[60:63]
  v_mul_f32 v81, v81, v97
  v_mul_f32 v82, v82, v97
  v_mfma_f32_16x16x32_bf16 v[64:67], a[196:199], v[28:31], v[64:67]
  v_mul_f32 v83, v83, v97
  v_cvt_pk_bf16_f32 v128, v76, v77
  s_waitcnt lgkmcnt(6)
  v_mfma_f32_16x16x32_bf16 v[56:59], a[40:43], v[32:35], v[56:59]
  ds_read_b128 v[28:31], v5 offset:8192
  v_cvt_pk_bf16_f32 v129, v78, v79
  v_mfma_f32_16x16x32_bf16 v[60:63], a[120:123], v[32:35], v[60:63]
  v_cvt_pk_bf16_f32 v132, v80, v81
  v_cvt_pk_bf16_f32 v133, v82, v83
  v_mfma_f32_16x16x32_bf16 v[64:67], a[200:203], v[32:35], v[64:67]
  ds_write_b64 v143, v[128:129] offset:0
  s_waitcnt lgkmcnt(6)
  v_mfma_f32_16x16x32_bf16 v[56:59], a[44:47], v[36:39], v[56:59]
  ds_read_b128 v[32:35], v4 offset:9216
  v_mfma_f32_16x16x32_bf16 v[60:63], a[124:127], v[36:39], v[60:63]
  v_mfma_f32_16x16x32_bf16 v[64:67], a[204:207], v[36:39], v[64:67]
  ds_write_b64 v143, v[132:133] offset:160
  s_waitcnt lgkmcnt(6)
  v_mfma_f32_16x16x32_bf16 v[56:59], a[48:51], v[40:43], v[56:59]
  ds_read_b128 v[36:39], v5 offset:9216
  v_mfma_f32_16x16x32_bf16 v[60:63], a[128:131], v[40:43], v[60:63]
  v_mfma_f32_16x16x32_bf16 v[64:67], a[208:211], v[40:43], v[64:67]
  ds_write_b64 v143, v[120:121] offset:2560
  s_waitcnt lgkmcnt(6)
  v_mfma_f32_16x16x32_bf16 v[56:59], a[52:55], v[44:47], v[56:59]
  v_mfma_f32_16x16x32_bf16 v[60:63], a[132:135], v[44:47], v[60:63]
  v_mfma_f32_16x16x32_bf16 v[64:67], a[212:215], v[44:47], v[64:67]
  ds_write_b64 v143, v[124:125] offset:2720
  s_waitcnt lgkmcnt(5)
  v_mfma_f32_16x16x32_bf16 v[56:59], a[56:59], v[48:51], v[56:59]
  v_mfma_f32_16x16x32_bf16 v[60:63], a[136:139], v[48:51], v[60:63]
  v_mfma_f32_16x16x32_bf16 v[64:67], a[216:219], v[48:51], v[64:67]
  s_waitcnt lgkmcnt(4)
  v_mfma_f32_16x16x32_bf16 v[56:59], a[60:63], v[52:55], v[56:59]
  v_mfma_f32_16x16x32_bf16 v[60:63], a[140:143], v[52:55], v[60:63]
  v_mfma_f32_16x16x32_bf16 v[64:67], a[220:223], v[52:55], v[64:67]
  s_waitcnt lgkmcnt(3)
  v_mfma_f32_16x16x32_bf16 v[56:59], a[64:67], v[24:27], v[56:59]
  v_mfma_f32_16x16x32_bf16 v[60:63], a[144:147], v[24:27], v[60:63]
  v_mfma_f32_16x16x32_bf16 v[64:67], a[224:227], v[24:27], v[64:67]
  s_waitcnt lgkmcnt(2)
  v_mfma_f32_16x16x32_bf16 v[56:59], a[68:71], v[28:31], v[56:59]
  v_mfma_f32_16x16x32_bf16 v[60:63], a[148:151], v[28:31], v[60:63]
  v_mfma_f32_16x16x32_bf16 v[64:67], a[228:231], v[28:31], v[64:67]
  s_waitcnt lgkmcnt(1)
  v_mfma_f32_16x16x32_bf16 v[56:59], a[72:75], v[32:35], v[56:59]
  v_mfma_f32_16x16x32_bf16 v[60:63], a[152:155], v[32:35], v[60:63]
  v_mfma_f32_16x16x32_bf16 v[64:67], a[232:235], v[32:35], v[64:67]
  s_waitcnt lgkmcnt(0)
  v_mfma_f32_16x16x32_bf16 v[56:59], a[76:79], v[36:39], v[56:59]
  v_mfma_f32_16x16x32_bf16 v[60:63], a[156:159], v[36:39], v[60:63]
  v_mfma_f32_16x16x32_bf16 v[64:67], a[236:239], v[36:39], v[64:67]
  s_nop 5
  v_max_f32 v56, 0, v56
  v_max_f32 v57, 0, v57
  v_max_f32 v58, 0, v58
  v_max_f32 v59, 0, v59
  v_max_f32 v60, 0, v60
  v_max_f32 v61, 0, v61
  v_max_f32 v62, 0, v62
  v_max_f32 v63, 0, v63
  v_max_f32 v64, 0, v64
  v_max_f32 v65, 0, v65
  v_max_f32 v66, 0, v66
  v_max_f32 v67, 0, v67
  v_cvt_pk_bf16_f32 v112, v56, v57
  v_cvt_pk_bf16_f32 v113, v58, v59
  v_cvt_pk_bf16_f32 v114, v60, v61
  v_cvt_pk_bf16_f32 v115, v62, v63
  v_cvt_pk_bf16_f32 v116, v64, v65
  v_cvt_pk_bf16_f32 v117, v66, v67
  ds_write_b128 v3, v[112:115]
  ds_write_b64 v6, v[116:117] offset:2048
  v_bfi_b32 v112, 1, s71, v112
  v_bfi_b32 v116, 1, s71, v116
  buffer_store_dwordx4 v[112:115], v9, s[4:7], s28 offen
  buffer_store_dwordx2 v[116:117], v1, s[4:7], s28 offen offset:1024
  s_waitcnt lgkmcnt(0)
  s_barrier
  s_cmp_eq_u32 s3, 3
  s_cbranch_scc0 w3F_82
  ds_read_b128 v[116:119], v151 offset:0
  ds_read_b128 v[120:123], v151 offset:1024
  ds_read_b128 v[124:127], v151 offset:2048
  ds_read_b128 v[128:131], v151 offset:2560
  ds_read_b128 v[132:135], v151 offset:3584
  ds_read_b128 v[48:51], v151 offset:4608
w3F_82:
  ds_read_b128 v[24:27], v7 offset:0
  ds_read_b128 v[28:31], v7 offset:1024
  ds_read_b128 v[32:35], v7 offset:2048
  ds_read_b128 v[36:39], v7 offset:3072
  ds_read_b128 v[40:43], v7 offset:4096
  ds_read_b128 v[44:47], v7 offset:5120
  s_add_u32 s72, s72, 4096
  s_add_u32 s73, s73, 40960
  s_waitcnt lgkmcnt(3)
  v_mfma_f32_16x16x32_bf16 v[72:75], a[240:243], v[24:27], 0
  v_mfma_f32_16x16x32_bf16 v[76:79], v[160:163], v[24:27], 0
  v_mfma_f32_16x16x32_bf16 v[80:83], v[184:187], v[24:27], 0
  v_mfma_f32_16x16x32_bf16 v[84:87], v[208:211], v[24:27], 0
  v_mfma_f32_16x16x32_bf16 v[88:91], v[232:235], v[24:27], 0
  v_mfma_f32_16x16x32_bf16 v[72:75], a[244:247], v[28:31], v[72:75]
  v_mfma_f32_16x16x32_bf16 v[76:79], v[164:167], v[28:31], v[76:79]
  v_mfma_f32_16x16x32_bf16 v[80:83], v[188:191], v[28:31], v[80:83]
  v_mfma_f32_16x16x32_bf16 v[84:87], v[212:215], v[28:31], v[84:87]
  buffer_load_dwordx4 v[136:139], v9, s[4:7], s29 offen sc1
  v_mfma_f32_16x16x32_bf16 v[88:91], v[236:239], v[28:31], v[88:91]
  buffer_load_dwordx2 v[140:141], v1, s[4:7], s29 offen offset:1024 sc1
  v_mfma_f32_16x16x32_bf16 v[72:75], a[248:251], v[32:35], v[72:75]
  s_cmp_eq_u32 s3, 3
  s_cbranch_scc0 w3F_83
  buffer_store_dwordx4 v[116:119], v9, s[4:7], s83 offen offset:0 sc1
  buffer_store_dwordx4 v[120:123], v9, s[4:7], s83 offen offset:1024 sc1
  buffer_store_dwordx4 v[124:127], v150, s[4:7], s83 offen offset:0 sc1
  buffer_store_dwordx4 v[128:131], v9, s[12:15], s82 offen offset:0 sc1
  buffer_store_dwordx4 v[132:135], v9, s[12:15], s82 offen offset:1024 sc1
  buffer_store_dwordx4 v[48:51], v150, s[12:15], s82 offen offset:0 sc1
w3F_83:
  v_mfma_f32_16x16x32_bf16 v[76:79], v[168:171], v[32:35], v[76:79]
  v_mfma_f32_16x16x32_bf16 v[80:83], v[192:195], v[32:35], v[80:83]
  v_mfma_f32_16x16x32_bf16 v[84:87], v[216:219], v[32:35], v[84:87]
  v_mfma_f32_16x16x32_bf16 v[88:91], v[240:243], v[32:35], v[88:91]
  s_waitcnt lgkmcnt(0)
  v_mfma_f32_16x16x32_bf16 v[92:95], a[240:243], v[36:39], 0
  v_mfma_f32_16x16x32_bf16 v[96:99], v[160:163], v[36:39], 0
  v_mfma_f32_16x16x32_bf16 v[100:103], v[184:187], v[36:39], 0
  v_mfma_f32_16x16x32_bf16 v[104:107], v[208:211], v[36:39], 0
  v_mfma_f32_16x16x32_bf16 v[108:111], v[232:235], v[36:39], 0
  v_mfma_f32_16x16x32_bf16 v[92:95], a[244:247], v[40:43], v[92:95]
  v_mfma_f32_16x16x32_bf16 v[96:99], v[164:167], v[40:43], v[96:99]
  v_mfma_f32_16x16x32_bf16 v[100:103], v[188:191], v[40:43], v[100:103]
  v_mfma_f32_16x16x32_bf16 v[104:107], v[212:215], v[40:43], v[104:107]
  v_mfma_f32_16x16x32_bf16 v[108:111], v[236:239], v[40:43], v[108:111]
  s_waitcnt vmcnt(6)
  s_cmp_eq_u32 s3, 3
  s_cbranch_scc1 w3F_86
  s_waitcnt vmcnt(0)
w3F_86:
bF_84:
  v_bitop3_b32 v14, v136, v140, s71 bitop3:0x7e
  v_and_b32 v14, 1, v14
  v_cmp_ne_u32 vcc, 0, v14
  s_cbranch_vccz okF_85
  buffer_load_dwordx4 v[136:139], v9, s[4:7], s29 offen sc1
  buffer_load_dwordx2 v[140:141], v1, s[4:7], s29 offen offset:1024 sc1
  s_add_u32 s45, s45, 1
  s_cmp_gt_u32 s45, 1048576
  s_cbranch_scc1 failfF_68
  s_waitcnt vmcnt(0)
  s_branch bF_84
okF_85:
  v_mfma_f32_16x16x32_bf16 v[92:95], a[248:251], v[44:47], v[92:95]
  ds_write_b128 v3, v[136:139] offset:6144
  v_mfma_f32_16x16x32_bf16 v[96:99], v[168:171], v[44:47], v[96:99]
  ds_write_b64 v6, v[140:141] offset:8192
  v_mfma_f32_16x16x32_bf16 v[100:103], v[192:195], v[44:47], v[100:103]
  v_mfma_f32_16x16x32_bf16 v[104:107], v[216:219], v[44:47], v[104:107]
  s_waitcnt lgkmcnt(0)
  s_barrier
  v_mfma_f32_16x16x32_bf16 v[108:111], v[240:243], v[44:47], v[108:111]
  ds_read_b128 v[48:51], v7 offset:6144
  ds_read_b128 v[52:55], v7 offset:7168
  ds_read_b128 v[56:59], v7 offset:8192
  ds_read_b128 v[60:63], v7 offset:9216
  ds_read_b128 v[64:67], v7 offset:10240
  ds_read_b128 v[68:71], v7 offset:11264
  s_waitcnt lgkmcnt(3)
  v_mfma_f32_16x16x32_bf16 v[72:75], a[252:255], v[48:51], v[72:75]
  buffer_load_dword v149, v142, s[4:7], s72 offen sc1
  v_mfma_f32_16x16x32_bf16 v[72:75], v[152:155], v[52:55], v[72:75]
  v_mfma_f32_16x16x32_bf16 v[72:75], v[156:159], v[56:59], v[72:75]
  v_mfma_f32_16x16x32_bf16 v[76:79], v[172:175], v[48:51], v[76:79]
  v_mfma_f32_16x16x32_bf16 v[76:79], v[176:179], v[52:55], v[76:79]
  v_mfma_f32_16x16x32_bf16 v[76:79], v[180:183], v[56:59], v[76:79]
  v_mfma_f32_16x16x32_bf16 v[80:83], v[196:199], v[48:51], v[80:83]
  v_mfma_f32_16x16x32_bf16 v[80:83], v[200:203], v[52:55], v[80:83]
  v_mfma_f32_16x16x32_bf16 v[80:83], v[204:207], v[56:59], v[80:83]
  v_mfma_f32_16x16x32_bf16 v[84:87], v[220:223], v[48:51], v[84:87]
  v_mfma_f32_16x16x32_bf16 v[84:87], v[224:227], v[52:55], v[84:87]
  v_cvt_pk_bf16_f32 v112, v72, v73
  v_mfma_f32_16x16x32_bf16 v[84:87], v[228:231], v[56:59], v[84:87]
  v_cvt_pk_bf16_f32 v113, v74, v75
  v_mfma_f32_16x16x32_bf16 v[88:91], v[244:247], v[48:51], v[88:91]
  ds_write_b64 v8, v[112:113] offset:0
  v_mfma_f32_16x16x32_bf16 v[88:91], v[248:251], v[52:55], v[88:91]
  v_cvt_pk_bf16_f32 v114, v76, v77
  s_waitcnt lgkmcnt(0)
  v_mfma_f32_16x16x32_bf16 v[88:91], v[252:255], v[56:59], v[88:91]
  v_cvt_pk_bf16_f32 v115, v78, v79
  v_mfma_f32_16x16x32_bf16 v[92:95], a[252:255], v[60:63], v[92:95]
  ds_write_b64 v8, v[114:115] offset:32
  v_mfma_f32_16x16x32_bf16 v[92:95], v[152:155], v[64:67], v[92:95]
  v_cvt_pk_bf16_f32 v112, v80, v81
  v_mfma_f32_16x16x32_bf16 v[92:95], v[156:159], v[68:71], v[92:95]
  v_cvt_pk_bf16_f32 v113, v82, v83
  v_mfma_f32_16x16x32_bf16 v[96:99], v[172:175], v[60:63], v[96:99]
  ds_write_b64 v8, v[112:113] offset:64
  v_mfma_f32_16x16x32_bf16 v[96:99], v[176:179], v[64:67], v[96:99]
  v_cvt_pk_bf16_f32 v114, v84, v85
  v_mfma_f32_16x16x32_bf16 v[96:99], v[180:183], v[68:71], v[96:99]
  v_cvt_pk_bf16_f32 v115, v86, v87
  v_mfma_f32_16x16x32_bf16 v[100:103], v[196:199], v[60:63], v[100:103]
  ds_write_b64 v8, v[114:115] offset:96
  v_mfma_f32_16x16x32_bf16 v[100:103], v[200:203], v[64:67], v[100:103]
  s_cmp_eq_u32 s3, 3
  s_cbranch_scc0 w3F_87
  v_mov_b32 v14, 1
  s_waitcnt vmcnt(1)
  buffer_store_dword v14, off, s[4:7], s81 sc1
w3F_87:
  v_cvt_pk_bf16_f32 v112, v88, v89
  v_mfma_f32_16x16x32_bf16 v[100:103], v[204:207], v[68:71], v[100:103]
  v_cvt_pk_bf16_f32 v113, v90, v91
  v_mfma_f32_16x16x32_bf16 v[104:107], v[220:223], v[60:63], v[104:107]
  ds_write_b64 v8, v[112:113] offset:128
  v_mfma_f32_16x16x32_bf16 v[104:107], v[224:227], v[64:67], v[104:107]
  ds_read_b128 v[116:119], v144
  v_mfma_f32_16x16x32_bf16 v[104:107], v[228:231], v[68:71], v[104:107]
  ds_read_b128 v[120:123], v145
  v_mfma_f32_16x16x32_bf16 v[108:111], v[244:247], v[60:63], v[108:111]
  v_cvt_pk_bf16_f32 v112, v92, v93
  v_mfma_f32_16x16x32_bf16 v[108:111], v[248:251], v[64:67], v[108:111]
  s_waitcnt lgkmcnt(1)
  v_bfi_b32 v116, 1, s71, v116
  buffer_store_dwordx4 v[116:119], v9, s[4:7], s60 offen offset:0
  v_mfma_f32_16x16x32_bf16 v[108:111], v[252:255], v[68:71], v[108:111]
  v_cvt_pk_bf16_f32 v113, v94, v95
  s_waitcnt lgkmcnt(0)
  v_bfi_b32 v120, 1, s71, v120
  buffer_store_dwordx4 v[120:123], v9, s[4:7], s60 offen offset:1024
  ds_write_b64 v8, v[112:113] offset:2816
  v_cvt_pk_bf16_f32 v114, v96, v97
  v_cvt_pk_bf16_f32 v115, v98, v99
  ds_write_b64 v8, v[114:115] offset:2848
  v_cvt_pk_bf16_f32 v112, v100, v101
  v_cvt_pk_bf16_f32 v113, v102, v103
  ds_write_b64 v8, v[112:113] offset:2880
  v_cvt_pk_bf16_f32 v114, v104, v105
  v_cvt_pk_bf16_f32 v115, v106, v107
  ds_write_b64 v8, v[114:115] offset:2912
  v_cvt_pk_bf16_f32 v112, v108, v109
  v_cvt_pk_bf16_f32 v113, v110, v111
  ds_write_b64 v8, v[112:113] offset:2944
  ds_read_b128 v[124:127], v146
  ds_read_b128 v[128:131], v147
  ds_read_b128 v[132:135], v148
  s_waitcnt lgkmcnt(2)
  v_bfi_b32 v124, 1, s71, v124
  buffer_store_dwordx4 v[124:127], v9, s[4:7], s60 offen offset:2048
  s_waitcnt lgkmcnt(1)
  v_bfi_b32 v128, 1, s71, v128
  buffer_store_dwordx4 v[128:131], v9, s[4:7], s60 offen offset:3072
  s_waitcnt lgkmcnt(0)
  v_bfi_b32 v132, 1, s71, v132
  buffer_store_dwordx4 v[132:135], v9, s[4:7], s61 offen offset:0
  s_waitcnt vmcnt(5)
  s_mov_b32 s31, 0
  v_cmp_eq_u32 vcc, 0, v149
  s_cbranch_vccnz neF_88
  s_cmp_eq_u32 s70, 63
  s_cbranch_scc1 neF_88
  s_mov_b32 s31, 1
  s_mov_b32 m0, s80
  s_nop 0
  buffer_load_dwordx4 v2, s[4:7], s73 offen offset:0 sc1 lds
  s_add_u32 m0, m0, 896
  s_nop 0
  buffer_load_dwordx4 v2, s[4:7], s73 offen offset:128 sc1 lds
  s_add_u32 m0, m0, 896
  s_nop 0
  buffer_load_dwordx4 v2, s[4:7], s73 offen offset:256 sc1 lds
  s_add_u32 m0, m0, 896
  s_nop 0
  buffer_load_dwordx4 v2, s[4:7], s73 offen offset:384 sc1 lds
  s_add_u32 m0, m0, 896
  s_nop 0
  buffer_load_dwordx4 v2, s[4:7], s73 offen offset:512 sc1 lds
  s_add_u32 m0, m0, 896
  s_nop 0
  buffer_load_dwordx4 v2, s[4:7], s73 offen offset:640 sc1 lds
  s_add_u32 m0, m0, 896
  s_nop 0
  buffer_load_dwordx4 v2, s[4:7], s73 offen offset:768 sc1 lds
  s_add_u32 m0, m0, 896
  s_nop 0
  buffer_load_dwordx4 v2, s[4:7], s73 offen offset:896 sc1 lds
  s_add_u32 m0, m0, 896
  s_nop 0
  buffer_load_dwordx4 v2, s[4:7], s73 offen offset:1024 sc1 lds
  s_add_u32 m0, m0, 896
  s_nop 0
  buffer_load_dwordx4 v2, s[4:7], s73 offen offset:1152 sc1 lds
neF_88:
  s_mov_b32 s81, s78
  s_add_u32 s78, s78, s89
  s_mov_b32 s30, s71
  s_mov_b32 s59, s79
  s_add_u32 s82, s77, s86
  s_add_u32 s83, s77, s87
  s_add_u32 s77, s77, 40960
  s_mov_b64 s[84:85], s[56:57]
  s_add_u32 s70, s70, 1
  buffer_load_dwordx2 v[20:21], v11, s[4:7], s76 offen offset:0 sc1
  buffer_load_dwordx2 v[22:23], v11, s[4:7], s76 offen offset:160 sc1
  s_add_u32 s76, s76, 40960
  s_sleep 4
  s_add_u32 s46, s59, 0
  buffer_load_dwordx4 v[24:27], v10, s[4:7], s46 offen sc1
  s_add_u32 s46, s59, 81920
  buffer_load_dwordx4 v[28:31], v10, s[4:7], s46 offen sc1
  s_add_u32 s46, s59, 163840
  buffer_load_dwordx4 v[32:35], v10, s[4:7], s46 offen sc1
  s_add_u32 s46, s59, 245760
  buffer_load_dwordx4 v[36:39], v10, s[4:7], s46 offen sc1
  s_add_u32 s46, s59, 5120
  buffer_load_dwordx4 v[40:43], v10, s[4:7], s46 offen sc1
  s_add_u32 s46, s59, 87040
  buffer_load_dwordx4 v[44:47], v10, s[4:7], s46 offen sc1
  s_add_u32 s46, s59, 168960
  buffer_load_dwordx4 v[48:51], v10, s[4:7], s46 offen sc1
  s_add_u32 s46, s59, 250880
  buffer_load_dwordx4 v[52:55], v10, s[4:7], s46 offen sc1
  buffer_load_dword v149, v142, s[4:7], s72 offen sc1
  s_cmp_lt_u32 s70, 64
  s_cbranch_scc1 topF_74
  s_waitcnt vmcnt(0)
  s_add_u32 s46, s59, 0
  buffer_load_dwordx4 v[24:27], v10, s[4:7], s46 offen sc1
  s_add_u32 s46, s59, 81920
  buffer_load_dwordx4 v[28:31], v10, s[4:7], s46 offen sc1
  s_add_u32 s46, s59, 163840
  buffer_load_dwordx4 v[32:35], v10, s[4:7], s46 offen sc1
  s_add_u32 s46, s59, 245760
  buffer_load_dwordx4 v[36:39], v10, s[4:7], s46 offen sc1
  s_add_u32 s46, s59, 5120
  buffer_load_dwordx4 v[40:43], v10, s[4:7], s46 offen sc1
  s_add_u32 s46, s59, 87040
  buffer_load_dwordx4 v[44:47], v10, s[4:7], s46 offen sc1
  s_add_u32 s46, s59, 168960
  buffer_load_dwordx4 v[48:51], v10, s[4:7], s46 offen sc1
  s_add_u32 s46, s59, 250880
  buffer_load_dwordx4 v[52:55], v10, s[4:7], s46 offen sc1
  s_waitcnt vmcnt(0)
bF_89:
  v_mfma_f32_16x16x32_bf16 v[68:71], v[16:19], v[24:27], 0
  v_bitop3_b32 v98, v24, v28, s30 bitop3:0x7e
  v_mfma_f32_16x16x32_bf16 v[68:71], v[16:19], v[28:31], v[68:71]
  v_bitop3_b32 v98, v98, v32, s30 bitop3:0xf6
  v_mfma_f32_16x16x32_bf16 v[68:71], v[16:19], v[32:35], v[68:71]
  v_bitop3_b32 v98, v98, v36, s30 bitop3:0xf6
  v_mfma_f32_16x16x32_bf16 v[68:71], v[16:19], v[36:39], v[68:71]
  v_bitop3_b32 v98, v98, v40, s30 bitop3:0xf6
  v_mfma_f32_16x16x32_bf16 v[72:75], v[16:19], v[40:43], 0
  v_bitop3_b32 v98, v98, v44, s30 bitop3:0xf6
  v_mfma_f32_16x16x32_bf16 v[72:75], v[16:19], v[44:47], v[72:75]
  v_bitop3_b32 v98, v98, v48, s30 bitop3:0xf6
  v_mfma_f32_16x16x32_bf16 v[72:75], v[16:19], v[48:51], v[72:75]
  v_bitop3_b32 v98, v98, v52, s30 bitop3:0xf6
  v_mfma_f32_16x16x32_bf16 v[72:75], v[16:19], v[52:55], v[72:75]
  v_and_b32 v98, 1, v98
  v_cmp_ne_u32 vcc, 0, v98
  s_and_b64 vcc, vcc, s[56:57]
  s_cbranch_vccz okF_90
  s_nop 7
  s_add_u32 s46, s59, 0
  buffer_load_dwordx4 v[24:27], v10, s[4:7], s46 offen sc1
  s_add_u32 s46, s59, 81920
  buffer_load_dwordx4 v[28:31], v10, s[4:7], s46 offen sc1
  s_add_u32 s46, s59, 163840
  buffer_load_dwordx4 v[32:35], v10, s[4:7], s46 offen sc1
  s_add_u32 s46, s59, 245760
  buffer_load_dwordx4 v[36:39], v10, s[4:7], s46 offen sc1
  s_add_u32 s46, s59, 5120
  buffer_load_dwordx4 v[40:43], v10, s[4:7], s46 offen sc1
  s_add_u32 s46, s59, 87040
  buffer_load_dwordx4 v[44:47], v10, s[4:7], s46 offen sc1
  s_add_u32 s46, s59, 168960
  buffer_load_dwordx4 v[48:51], v10, s[4:7], s46 offen sc1
  s_add_u32 s46, s59, 250880
  buffer_load_dwordx4 v[52:55], v10, s[4:7], s46 offen sc1
  s_add_u32 s45, s45, 1
  s_cmp_gt_u32 s45, 1048576
  s_cbranch_scc1 failfF_68
  s_waitcnt vmcnt(0)
  s_branch bF_89
okF_90:
  s_nop 0
  v_lshlrev_b32 v76, 16, v20
  v_and_b32 v77, 0xffff0000, v20
  v_lshlrev_b32 v78, 16, v21
  v_and_b32 v79, 0xffff0000, v21
  v_lshlrev_b32 v80, 16, v22
  v_and_b32 v81, 0xffff0000, v22
  v_lshlrev_b32 v82, 16, v23
  v_and_b32 v83, 0xffff0000, v23
  v_cvt_pk_bf16_f32 v92, v68, v69
  v_cvt_pk_bf16_f32 v93, v70, v71
  v_cvt_pk_bf16_f32 v94, v72, v73
  v_cvt_pk_bf16_f32 v95, v74, v75
  v_lshlrev_b32 v68, 16, v92
  v_and_b32 v69, 0xffff0000, v92
  v_lshlrev_b32 v70, 16, v93
  v_and_b32 v71, 0xffff0000, v93
  v_lshlrev_b32 v72, 16, v94
  v_and_b32 v73, 0xffff0000, v94
  v_lshlrev_b32 v74, 16, v95
  v_and_b32 v75, 0xffff0000, v95
  v_pk_add_f32 v[76:77], v[76:77], v[68:69]
  v_pk_add_f32 v[78:79], v[78:79], v[70:71]
  v_pk_add_f32 v[80:81], v[80:81], v[72:73]
  v_pk_add_f32 v[82:83], v[82:83], v[74:75]
  v_cvt_pk_bf16_f32 v84, v76, v77
  v_cvt_pk_bf16_f32 v85, v78, v79
  v_cvt_pk_bf16_f32 v88, v80, v81
  v_cvt_pk_bf16_f32 v89, v82, v83
  v_lshlrev_b32 v76, 16, v84
  v_and_b32 v77, 0xffff0000, v84
  v_lshlrev_b32 v78, 16, v85
  v_and_b32 v79, 0xffff0000, v85
  v_lshlrev_b32 v80, 16, v88
  v_and_b32 v81, 0xffff0000, v88
  v_lshlrev_b32 v82, 16, v89
  v_and_b32 v83, 0xffff0000, v89
  v_add_f32 v96, v76, v77
  v_mul_f32 v97, v76, v76
  v_fmac_f32 v97, v77, v77
  v_add_f32 v96, v96, v78
  v_fmac_f32 v97, v78, v78
  v_add_f32 v96, v96, v79
  v_fmac_f32 v97, v79, v79
  v_add_f32 v96, v96, v80
  v_fmac_f32 v97, v80, v80
  v_add_f32 v96, v96, v81
  v_fmac_f32 v97, v81, v81
  v_add_f32 v96, v96, v82
  v_fmac_f32 v97, v82, v82
  v_add_f32 v96, v96, v83
  v_fmac_f32 v97, v83, v83
  s_nop 0
  v_add_f32_dpp v96, v96, v96 quad_perm:[1,0,3,2] row_mask:0xf bank_mask:0xf
  v_add_f32_dpp v97, v97, v97 quad_perm:[1,0,3,2] row_mask:0xf bank_mask:0xf
  s_nop 0
  v_add_f32_dpp v96, v96, v96 quad_perm:[2,3,0,1] row_mask:0xf bank_mask:0xf
  v_add_f32_dpp v97, v97, v97 quad_perm:[2,3,0,1] row_mask:0xf bank_mask:0xf
  s_nop 0
  v_add_f32_dpp v96, v96, v96 row_half_mirror row_mask:0xf bank_mask:0xf
  v_add_f32_dpp v97, v97, v97 row_half_mirror row_mask:0xf bank_mask:0xf
  s_nop 0
  v_add_f32_dpp v96, v96, v96 row_mirror row_mask:0xf bank_mask:0xf
  v_add_f32_dpp v97, v97, v97 row_mirror row_mask:0xf bank_mask:0xf
  v_mov_b32 v68, v96
  v_mov_b32 v69, v97
  s_nop 0
  v_permlane16_swap_b32 v96, v68
  v_permlane16_swap_b32 v97, v69
  v_pk_add_f32 v[96:97], v[96:97], v[68:69]
  ds_write_b64 v12, v[96:97]
  s_waitcnt lgkmcnt(0)
  s_barrier
  ds_read_b128 v[68:71], v13
  ds_read_b128 v[72:75], v13 offset:16
  s_waitcnt lgkmcnt(0)
  v_pk_add_f32 v[68:69], v[68:69], v[70:71]
  v_pk_add_f32 v[72:73], v[72:73], v[74:75]
  v_pk_add_f32 v[96:97], v[68:69], v[72:73]
  v_mul_f32 v96, 0x3acccccd, v96
  v_mul_f32 v97, 0x3acccccd, v97
  v_fma_f32 v97, -v96, v96, v97
  v_max_f32 v97, 0, v97
  v_cvt_pk_bf16_f32 v96, v96, v96
  v_and_b32 v96, 0xffff0000, v96
  v_cvt_pk_bf16_f32 v97, v97, v97
  v_and_b32 v97, 0xffff0000, v97
  v_add_f32 v97, 0x3727c5ac, v97
  v_cvt_pk_bf16_f32 v97, v97, v97
  v_and_b32 v97, 0xffff0000, v97
  v_pk_add_f32 v[76:77], v[76:77], v[96:97] op_sel_hi:[1,0] neg_lo:[0,1] neg_hi:[0,1]
  v_pk_add_f32 v[78:79], v[78:79], v[96:97] op_sel_hi:[1,0] neg_lo:[0,1] neg_hi:[0,1]
  v_pk_add_f32 v[80:81], v[80:81], v[96:97] op_sel_hi:[1,0] neg_lo:[0,1] neg_hi:[0,1]
  v_pk_add_f32 v[82:83], v[82:83], v[96:97] op_sel_hi:[1,0] neg_lo:[0,1] neg_hi:[0,1]
  v_sqrt_f32 v97, v97
  v_cvt_pk_bf16_f32 v92, v76, v77
  v_cvt_pk_bf16_f32 v93, v78, v79
  v_cvt_pk_bf16_f32 v94, v80, v81
  v_cvt_pk_bf16_f32 v95, v82, v83
  v_cvt_pk_bf16_f32 v97, v97, v97
  v_and_b32 v97, 0xffff0000, v97
  v_rcp_f32 v97, v97
  v_lshlrev_b32 v76, 16, v92
  v_and_b32 v77, 0xffff0000, v92
  v_lshlrev_b32 v78, 16, v93
  v_and_b32 v79, 0xffff0000, v93
  v_lshlrev_b32 v80, 16, v94
  v_and_b32 v81, 0xffff0000, v94
  v_lshlrev_b32 v82, 16, v95
  v_and_b32 v83, 0xffff0000, v95
  v_pk_mul_f32 v[76:77], v[76:77], v[96:97] op_sel:[0,1] op_sel_hi:[1,1]
  v_pk_mul_f32 v[78:79], v[78:79], v[96:97] op_sel:[0,1] op_sel_hi:[1,1]
  v_pk_mul_f32 v[80:81], v[80:81], v[96:97] op_sel:[0,1] op_sel_hi:[1,1]
  v_pk_mul_f32 v[82:83], v[82:83], v[96:97] op_sel:[0,1] op_sel_hi:[1,1]
  v_cvt_pk_bf16_f32 v100, v76, v77
  v_cvt_pk_bf16_f32 v101, v78, v79
  v_cvt_pk_bf16_f32 v104, v80, v81
  v_cvt_pk_bf16_f32 v105, v82, v83
  v_mov_b32 v102, v100
  v_mov_b32 v103, v101
  v_mov_b32 v106, v104
  v_mov_b32 v107, v105
  v_permlane16_swap_b32 v100, v102
  v_permlane16_swap_b32 v101, v103
  v_permlane16_swap_b32 v104, v106
  v_permlane16_swap_b32 v105, v107
  v_mov_b32 v86, v84
  v_mov_b32 v87, v85
  v_mov_b32 v90, v88
  v_mov_b32 v91, v89
  v_permlane16_swap_b32 v84, v86
  v_permlane16_swap_b32 v85, v87
  v_permlane16_swap_b32 v88, v90
  v_permlane16_swap_b32 v89, v91
  buffer_store_dwordx4 v[100:103], v15, s[4:7], s83 offen offset:0 sc1
  buffer_store_dwordx4 v[104:107], v15, s[4:7], s83 offen offset:160 sc1
  buffer_store_dwordx4 v[84:87], v15, s[12:15], s82 offen offset:0 sc1
  buffer_store_dwordx4 v[88:91], v15, s[12:15], s82 offen offset:160 sc1
  v_mov_b32 v14, 1
  s_waitcnt vmcnt(0)
  s_barrier
  buffer_store_dword v14, off, s[4:7], s81 sc1
  s_endpgm
failfF_68:
  s_mov_b64 exec, 1
  v_mov_b32 v150, 224
  v_mov_b32 v151, 4
  buffer_atomic_or v151, v150, s[8:11], 0 offen sc1
  s_endpgm
  .p2align 6
R_qkvF:
  s_sub_u32 s52, s42, 5
  s_cmp_eq_u32 s52, 1
  s_cselect_b32 s60, s22, s20
  s_cselect_b32 s61, s23, s21
  s_cmp_eq_u32 s52, 2
  s_cselect_b32 s60, s24, s60
  s_cselect_b32 s61, s25, s61
  s_and_b32 s61, s61, 0xffff
  s_mov_b32 s62, 7864320
  s_mov_b32 s63, 0x20000
  v_add_u32 v40, 0, v0
  v_mul_u32_u24 v41, 43691, v40
  v_lshrrev_b32 v41, 20, v41
  v_mul_u32_u24 v42, 24, v41
  v_sub_u32 v40, v40, v42
  v_lshlrev_b32 v40, 4, v40
  v_mul_u32_u24 v41, 12288, v41
  v_add_u32 v16, v40, v41
  v_add_u32 v40, 64, v0
  v_mul_u32_u24 v41, 43691, v40
  v_lshrrev_b32 v41, 20, v41
  v_mul_u32_u24 v42, 24, v41
  v_sub_u32 v40, v40, v42
  v_lshlrev_b32 v40, 4, v40
  v_mul_u32_u24 v41, 12288, v41
  v_add_u32 v17, v40, v41
  v_add_u32 v40, 128, v0
  v_mul_u32_u24 v41, 43691, v40
  v_lshrrev_b32 v41, 20, v41
  v_mul_u32_u24 v42, 24, v41
  v_sub_u32 v40, v40, v42
  v_lshlrev_b32 v40, 4, v40
  v_mul_u32_u24 v41, 12288, v41
  v_add_u32 v18, v40, v41
  s_mul_i32 s46, s3, 98304
  v_add_u32 v16, s46, v16
  v_add_u32 v17, s46, v17
  v_add_u32 v18, s46, v18
  s_mul_i32 s46, s43, 384
  v_add_u32 v16, s46, v16
  v_add_u32 v17, s46, v17
  v_add_u32 v18, s46, v18
  v_lshrrev_b32 v40, 4, v0
  v_mul_u32_u24 v40, 8, v40
  v_bfe_u32 v41, v0, 2, 2
  v_add_u32 v40, v40, v41
  v_mul_u32_u24 v40, 384, v40
  v_and_b32 v41, 3, v0
  v_mul_u32_u24 v41, 8, v41
  v_add_u32 v26, v40, v41
  s_mul_i32 s46, s3, 96
  v_add_u32 v26, s46, v26
  v_add_u32 v27, 0x10000, v26
  v_add_u32 v28, 0x20000, v26
  s_mul_i32 s55, s3, 3072
  s_mov_b32 s46, 0
  s_add_u32 m0, s55, 0
  s_nop 0
  buffer_load_dwordx4 v16, s[60:63], s46 offen lds
  s_mov_b32 s46, 0
  s_add_u32 m0, s55, 1024
  s_nop 0
  buffer_load_dwordx4 v17, s[60:63], s46 offen lds
  s_mov_b32 s46, 0
  s_add_u32 m0, s55, 2048
  s_nop 0
  buffer_load_dwordx4 v18, s[60:63], s46 offen lds
  s_mov_b32 s46, 393216
  s_add_u32 m0, s55, 12288
  s_nop 0
  buffer_load_dwordx4 v16, s[60:63], s46 offen lds
  s_mov_b32 s46, 393216
  s_add_u32 m0, s55, 13312
  s_nop 0
  buffer_load_dwordx4 v17, s[60:63], s46 offen lds
  s_mov_b32 s46, 393216
  s_add_u32 m0, s55, 14336
  s_nop 0
  buffer_load_dwordx4 v18, s[60:63], s46 offen lds
  s_mov_b32 s46, 786432
  s_add_u32 m0, s55, 24576
  s_nop 0
  buffer_load_dwordx4 v16, s[60:63], s46 offen lds
  s_mov_b32 s46, 786432
  s_add_u32 m0, s55, 25600
  s_nop 0
  buffer_load_dwordx4 v17, s[60:63], s46 offen lds
  s_mov_b32 s46, 786432
  s_add_u32 m0, s55, 26624
  s_nop 0
  buffer_load_dwordx4 v18, s[60:63], s46 offen lds
  s_mov_b32 s46, 1179648
  s_add_u32 m0, s55, 36864
  s_nop 0
  buffer_load_dwordx4 v16, s[60:63], s46 offen lds
  s_mov_b32 s46, 1179648
  s_add_u32 m0, s55, 37888
  s_nop 0
  buffer_load_dwordx4 v17, s[60:63], s46 offen lds
  s_mov_b32 s46, 1179648
  s_add_u32 m0, s55, 38912
  s_nop 0
  buffer_load_dwordx4 v18, s[60:63], s46 offen lds
  s_mov_b32 s46, 1572864
  s_add_u32 m0, s55, 49152
  s_nop 0
  buffer_load_dwordx4 v16, s[60:63], s46 offen lds
  s_mov_b32 s46, 1572864
  s_add_u32 m0, s55, 50176
  s_nop 0
  buffer_load_dwordx4 v17, s[60:63], s46 offen lds
  s_mov_b32 s46, 1572864
  s_add_u32 m0, s55, 51200
  s_nop 0
  buffer_load_dwordx4 v18, s[60:63], s46 offen lds
  s_mov_b32 s46, 1966080
  s_add_u32 m0, s55, 61440
  s_nop 0
  buffer_load_dwordx4 v16, s[60:63], s46 offen lds
  s_mov_b32 s46, 1966080
  s_add_u32 m0, s55, 62464
  s_nop 0
  buffer_load_dwordx4 v17, s[60:63], s46 offen lds
  s_mov_b32 s46, 1966080
  s_add_u32 m0, s55, 63488
  s_nop 0
  buffer_load_dwordx4 v18, s[60:63], s46 offen lds
  s_mov_b32 s46, 2359296
  s_add_u32 m0, s55, 73728
  s_nop 0
  buffer_load_dwordx4 v16, s[60:63], s46 offen lds
  s_mov_b32 s46, 2359296
  s_add_u32 m0, s55, 74752
  s_nop 0
  buffer_load_dwordx4 v17, s[60:63], s46 offen lds
  s_mov_b32 s46, 2359296
  s_add_u32 m0, s55, 75776
  s_nop 0
  buffer_load_dwordx4 v18, s[60:63], s46 offen lds
  s_mov_b32 s46, 2752512
  s_add_u32 m0, s55, 86016
  s_nop 0
  buffer_load_dwordx4 v16, s[60:63], s46 offen lds
  s_mov_b32 s46, 2752512
  s_add_u32 m0, s55, 87040
  s_nop 0
  buffer_load_dwordx4 v17, s[60:63], s46 offen lds
  s_mov_b32 s46, 2752512
  s_add_u32 m0, s55, 88064
  s_nop 0
  buffer_load_dwordx4 v18, s[60:63], s46 offen lds
  s_mov_b32 s46, 3145728
  s_add_u32 m0, s55, 98304
  s_nop 0
  buffer_load_dwordx4 v16, s[60:63], s46 offen lds
  s_mov_b32 s46, 3145728
  s_add_u32 m0, s55, 99328
  s_nop 0
  buffer_load_dwordx4 v17, s[60:63], s46 offen lds
  s_mov_b32 s46, 3145728
  s_add_u32 m0, s55, 100352
  s_nop 0
  buffer_load_dwordx4 v18, s[60:63], s46 offen lds
  s_mov_b32 s46, 3538944
  s_add_u32 m0, s55, 110592
  s_nop 0
  buffer_load_dwordx4 v16, s[60:63], s46 offen lds
  s_mov_b32 s46, 3538944
  s_add_u32 m0, s55, 111616
  s_nop 0
  buffer_load_dwordx4 v17, s[60:63], s46 offen lds
  s_mov_b32 s46, 3538944
  s_add_u32 m0, s55, 112640
  s_nop 0
  buffer_load_dwordx4 v18, s[60:63], s46 offen lds
  s_mov_b32 s46, 3932160
  s_add_u32 m0, s55, 122880
  s_nop 0
  buffer_load_dwordx4 v16, s[60:63], s46 offen lds
  s_mov_b32 s46, 3932160
  s_add_u32 m0, s55, 123904
  s_nop 0
  buffer_load_dwordx4 v17, s[60:63], s46 offen lds
  s_mov_b32 s46, 3932160
  s_add_u32 m0, s55, 124928
  s_nop 0
  buffer_load_dwordx4 v18, s[60:63], s46 offen lds
  s_mov_b32 s46, 4325376
  s_add_u32 m0, s55, 135168
  s_nop 0
  buffer_load_dwordx4 v16, s[60:63], s46 offen lds
  s_mov_b32 s46, 4325376
  s_add_u32 m0, s55, 136192
  s_nop 0
  buffer_load_dwordx4 v17, s[60:63], s46 offen lds
  s_mov_b32 s46, 4325376
  s_add_u32 m0, s55, 137216
  s_nop 0
  buffer_load_dwordx4 v18, s[60:63], s46 offen lds
  s_mov_b32 s46, 4718592
  s_add_u32 m0, s55, 147456
  s_nop 0
  buffer_load_dwordx4 v16, s[60:63], s46 offen lds
  s_mov_b32 s46, 4718592
  s_add_u32 m0, s55, 148480
  s_nop 0
  buffer_load_dwordx4 v17, s[60:63], s46 offen lds
  s_mov_b32 s46, 4718592
  s_add_u32 m0, s55, 149504
  s_nop 0
  buffer_load_dwordx4 v18, s[60:63], s46 offen lds
  s_waitcnt vmcnt(36)
  s_barrier
  s_cmp_eq_u32 s3, 0
  s_cbranch_scc0 arrF_92
  s_mov_b64 exec, 1
  v_mov_b32 v150, 140
  v_mov_b32 v149, 1
  buffer_atomic_add v149, v150, s[8:11], 0 offen sc0 sc1
  s_mov_b64 exec, -1
arrF_92:
  ds_read_b64_tr_b16 a[0:1], v26 offset:0
  ds_read_b64_tr_b16 a[2:3], v26 offset:1536
  ds_read_b64_tr_b16 a[80:81], v26 offset:32
  ds_read_b64_tr_b16 a[82:83], v26 offset:1568
  ds_read_b64_tr_b16 a[160:161], v26 offset:64
  ds_read_b64_tr_b16 a[162:163], v26 offset:1600
  s_waitcnt lgkmcnt(0)
  s_waitcnt vmcnt(33)
  s_barrier
  s_mov_b32 s46, 5111808
  s_add_u32 m0, s55, 0
  s_nop 0
  buffer_load_dwordx4 v16, s[60:63], s46 offen lds
  s_mov_b32 s46, 5111808
  s_add_u32 m0, s55, 1024
  s_nop 0
  buffer_load_dwordx4 v17, s[60:63], s46 offen lds
  s_mov_b32 s46, 5111808
  s_add_u32 m0, s55, 2048
  s_nop 0
  buffer_load_dwordx4 v18, s[60:63], s46 offen lds
  ds_read_b64_tr_b16 a[4:5], v26 offset:12288
  ds_read_b64_tr_b16 a[6:7], v26 offset:13824
  ds_read_b64_tr_b16 a[84:85], v26 offset:12320
  ds_read_b64_tr_b16 a[86:87], v26 offset:13856
  ds_read_b64_tr_b16 a[164:165], v26 offset:12352
  ds_read_b64_tr_b16 a[166:167], v26 offset:13888
  s_waitcnt lgkmcnt(0)
  s_waitcnt vmcnt(33)
  s_barrier
  s_mov_b32 s46, 5505024
  s_add_u32 m0, s55, 12288
  s_nop 0
  buffer_load_dwordx4 v16, s[60:63], s46 offen lds
  s_mov_b32 s46, 5505024
  s_add_u32 m0, s55, 13312
  s_nop 0
  buffer_load_dwordx4 v17, s[60:63], s46 offen lds
  s_mov_b32 s46, 5505024
  s_add_u32 m0, s55, 14336
  s_nop 0
  buffer_load_dwordx4 v18, s[60:63], s46 offen lds
  ds_read_b64_tr_b16 a[8:9], v26 offset:24576
  ds_read_b64_tr_b16 a[10:11], v26 offset:26112
  ds_read_b64_tr_b16 a[88:89], v26 offset:24608
  ds_read_b64_tr_b16 a[90:91], v26 offset:26144
  ds_read_b64_tr_b16 a[168:169], v26 offset:24640
  ds_read_b64_tr_b16 a[170:171], v26 offset:26176
  s_waitcnt lgkmcnt(0)
  s_waitcnt vmcnt(33)
  s_barrier
  s_mov_b32 s46, 5898240
  s_add_u32 m0, s55, 24576
  s_nop 0
  buffer_load_dwordx4 v16, s[60:63], s46 offen lds
  s_mov_b32 s46, 5898240
  s_add_u32 m0, s55, 25600
  s_nop 0
  buffer_load_dwordx4 v17, s[60:63], s46 offen lds
  s_mov_b32 s46, 5898240
  s_add_u32 m0, s55, 26624
  s_nop 0
  buffer_load_dwordx4 v18, s[60:63], s46 offen lds
  ds_read_b64_tr_b16 a[12:13], v26 offset:36864
  ds_read_b64_tr_b16 a[14:15], v26 offset:38400
  ds_read_b64_tr_b16 a[92:93], v26 offset:36896
  ds_read_b64_tr_b16 a[94:95], v26 offset:38432
  ds_read_b64_tr_b16 a[172:173], v26 offset:36928
  ds_read_b64_tr_b16 a[174:175], v26 offset:38464
  s_waitcnt lgkmcnt(0)
  s_waitcnt vmcnt(33)
  s_barrier
  s_mov_b32 s46, 6291456
  s_add_u32 m0, s55, 36864
  s_nop 0
  buffer_load_dwordx4 v16, s[60:63], s46 offen lds
  s_mov_b32 s46, 6291456
  s_add_u32 m0, s55, 37888
  s_nop 0
  buffer_load_dwordx4 v17, s[60:63], s46 offen lds
  s_mov_b32 s46, 6291456
  s_add_u32 m0, s55, 38912
  s_nop 0
  buffer_load_dwordx4 v18, s[60:63], s46 offen lds
  ds_read_b64_tr_b16 a[16:17], v26 offset:49152
  ds_read_b64_tr_b16 a[18:19], v26 offset:50688
  ds_read_b64_tr_b16 a[96:97], v26 offset:49184
  ds_read_b64_tr_b16 a[98:99], v26 offset:50720
  ds_read_b64_tr_b16 a[176:177], v26 offset:49216
  ds_read_b64_tr_b16 a[178:179], v26 offset:50752
  s_waitcnt lgkmcnt(0)
  s_waitcnt vmcnt(33)
  s_barrier
  s_mov_b32 s46, 6684672
  s_add_u32 m0, s55, 49152
  s_nop 0
  buffer_load_dwordx4 v16, s[60:63], s46 offen lds
  s_mov_b32 s46, 6684672
  s_add_u32 m0, s55, 50176
  s_nop 0
  buffer_load_dwordx4 v17, s[60:63], s46 offen lds
  s_mov_b32 s46, 6684672
  s_add_u32 m0, s55, 51200
  s_nop 0
  buffer_load_dwordx4 v18, s[60:63], s46 offen lds
  ds_read_b64_tr_b16 a[20:21], v26 offset:61440
  ds_read_b64_tr_b16 a[22:23], v26 offset:62976
  ds_read_b64_tr_b16 a[100:101], v26 offset:61472
  ds_read_b64_tr_b16 a[102:103], v26 offset:63008
  ds_read_b64_tr_b16 a[180:181], v26 offset:61504
  ds_read_b64_tr_b16 a[182:183], v26 offset:63040
  s_waitcnt lgkmcnt(0)
  s_waitcnt vmcnt(33)
  s_barrier
  s_mov_b32 s46, 7077888
  s_add_u32 m0, s55, 61440
  s_nop 0
  buffer_load_dwordx4 v16, s[60:63], s46 offen lds
  s_mov_b32 s46, 7077888
  s_add_u32 m0, s55, 62464
  s_nop 0
  buffer_load_dwordx4 v17, s[60:63], s46 offen lds
  s_mov_b32 s46, 7077888
  s_add_u32 m0, s55, 63488
  s_nop 0
  buffer_load_dwordx4 v18, s[60:63], s46 offen lds
  ds_read_b64_tr_b16 a[24:25], v27 offset:8192
  ds_read_b64_tr_b16 a[26:27], v27 offset:9728
  ds_read_b64_tr_b16 a[104:105], v27 offset:8224
  ds_read_b64_tr_b16 a[106:107], v27 offset:9760
  ds_read_b64_tr_b16 a[184:185], v27 offset:8256
  ds_read_b64_tr_b16 a[186:187], v27 offset:9792
  s_waitcnt lgkmcnt(0)
  s_waitcnt vmcnt(33)
  s_barrier
  s_mov_b32 s46, 7471104
  s_add_u32 m0, s55, 73728
  s_nop 0
  buffer_load_dwordx4 v16, s[60:63], s46 offen lds
  s_mov_b32 s46, 7471104
  s_add_u32 m0, s55, 74752
  s_nop 0
  buffer_load_dwordx4 v17, s[60:63], s46 offen lds
  s_mov_b32 s46, 7471104
  s_add_u32 m0, s55, 75776
  s_nop 0
  buffer_load_dwordx4 v18, s[60:63], s46 offen lds
  ds_read_b64_tr_b16 a[28:29], v27 offset:20480
  ds_read_b64_tr_b16 a[30:31], v27 offset:22016
  ds_read_b64_tr_b16 a[108:109], v27 offset:20512
  ds_read_b64_tr_b16 a[110:111], v27 offset:22048
  ds_read_b64_tr_b16 a[188:189], v27 offset:20544
  ds_read_b64_tr_b16 a[190:191], v27 offset:22080
  s_waitcnt lgkmcnt(0)
  s_waitcnt vmcnt(33)
  s_barrier
  ds_read_b64_tr_b16 a[32:33], v27 offset:32768
  ds_read_b64_tr_b16 a[34:35], v27 offset:34304
  ds_read_b64_tr_b16 a[112:113], v27 offset:32800
  ds_read_b64_tr_b16 a[114:115], v27 offset:34336
  ds_read_b64_tr_b16 a[192:193], v27 offset:32832
  ds_read_b64_tr_b16 a[194:195], v27 offset:34368
  s_waitcnt lgkmcnt(0)
  s_waitcnt vmcnt(30)
  s_barrier
  ds_read_b64_tr_b16 a[36:37], v27 offset:45056
  ds_read_b64_tr_b16 a[38:39], v27 offset:46592
  ds_read_b64_tr_b16 a[116:117], v27 offset:45088
  ds_read_b64_tr_b16 a[118:119], v27 offset:46624
  ds_read_b64_tr_b16 a[196:197], v27 offset:45120
  ds_read_b64_tr_b16 a[198:199], v27 offset:46656
  s_waitcnt lgkmcnt(0)
  s_waitcnt vmcnt(27)
  s_barrier
  ds_read_b64_tr_b16 a[40:41], v27 offset:57344
  ds_read_b64_tr_b16 a[42:43], v27 offset:58880
  ds_read_b64_tr_b16 a[120:121], v27 offset:57376
  ds_read_b64_tr_b16 a[122:123], v27 offset:58912
  ds_read_b64_tr_b16 a[200:201], v27 offset:57408
  ds_read_b64_tr_b16 a[202:203], v27 offset:58944
  s_waitcnt lgkmcnt(0)
  s_waitcnt vmcnt(24)
  s_barrier
  ds_read_b64_tr_b16 a[44:45], v28 offset:4096
  ds_read_b64_tr_b16 a[46:47], v28 offset:5632
  ds_read_b64_tr_b16 a[124:125], v28 offset:4128
  ds_read_b64_tr_b16 a[126:127], v28 offset:5664
  ds_read_b64_tr_b16 a[204:205], v28 offset:4160
  ds_read_b64_tr_b16 a[206:207], v28 offset:5696
  s_waitcnt lgkmcnt(0)
  s_waitcnt vmcnt(21)
  s_barrier
  ds_read_b64_tr_b16 a[48:49], v28 offset:16384
  ds_read_b64_tr_b16 a[50:51], v28 offset:17920
  ds_read_b64_tr_b16 a[128:129], v28 offset:16416
  ds_read_b64_tr_b16 a[130:131], v28 offset:17952
  ds_read_b64_tr_b16 a[208:209], v28 offset:16448
  ds_read_b64_tr_b16 a[210:211], v28 offset:17984
  s_waitcnt lgkmcnt(0)
  s_waitcnt vmcnt(18)
  s_barrier
  ds_read_b64_tr_b16 a[52:53], v26 offset:0
  ds_read_b64_tr_b16 a[54:55], v26 offset:1536
  ds_read_b64_tr_b16 a[132:133], v26 offset:32
  ds_read_b64_tr_b16 a[134:135], v26 offset:1568
  ds_read_b64_tr_b16 a[212:213], v26 offset:64
  ds_read_b64_tr_b16 a[214:215], v26 offset:1600
  s_waitcnt lgkmcnt(0)
  s_waitcnt vmcnt(15)
  s_barrier
  ds_read_b64_tr_b16 a[56:57], v26 offset:12288
  ds_read_b64_tr_b16 a[58:59], v26 offset:13824
  ds_read_b64_tr_b16 a[136:137], v26 offset:12320
  ds_read_b64_tr_b16 a[138:139], v26 offset:13856
  ds_read_b64_tr_b16 a[216:217], v26 offset:12352
  ds_read_b64_tr_b16 a[218:219], v26 offset:13888
  s_waitcnt lgkmcnt(0)
  s_waitcnt vmcnt(12)
  s_barrier
  ds_read_b64_tr_b16 a[60:61], v26 offset:24576
  ds_read_b64_tr_b16 a[62:63], v26 offset:26112
  ds_read_b64_tr_b16 a[140:141], v26 offset:24608
  ds_read_b64_tr_b16 a[142:143], v26 offset:26144
  ds_read_b64_tr_b16 a[220:221], v26 offset:24640
  ds_read_b64_tr_b16 a[222:223], v26 offset:26176
  s_waitcnt lgkmcnt(0)
  s_waitcnt vmcnt(9)
  s_barrier
  ds_read_b64_tr_b16 a[64:65], v26 offset:36864
  ds_read_b64_tr_b16 a[66:67], v26 offset:38400
  ds_read_b64_tr_b16 a[144:145], v26 offset:36896
  ds_read_b64_tr_b16 a[146:147], v26 offset:38432
  ds_read_b64_tr_b16 a[224:225], v26 offset:36928
  ds_read_b64_tr_b16 a[226:227], v26 offset:38464
  s_waitcnt lgkmcnt(0)
  s_waitcnt vmcnt(6)
  s_barrier
  ds_read_b64_tr_b16 a[68:69], v26 offset:49152
  ds_read_b64_tr_b16 a[70:71], v26 offset:50688
  ds_read_b64_tr_b16 a[148:149], v26 offset:49184
  ds_read_b64_tr_b16 a[150:151], v26 offset:50720
  ds_read_b64_tr_b16 a[228:229], v26 offset:49216
  ds_read_b64_tr_b16 a[230:231], v26 offset:50752
  s_waitcnt lgkmcnt(0)
  s_waitcnt vmcnt(3)
  s_barrier
  ds_read_b64_tr_b16 a[72:73], v26 offset:61440
  ds_read_b64_tr_b16 a[74:75], v26 offset:62976
  ds_read_b64_tr_b16 a[152:153], v26 offset:61472
  ds_read_b64_tr_b16 a[154:155], v26 offset:63008
  ds_read_b64_tr_b16 a[232:233], v26 offset:61504
  ds_read_b64_tr_b16 a[234:235], v26 offset:63040
  s_waitcnt lgkmcnt(0)
  s_waitcnt vmcnt(0)
  s_barrier
  ds_read_b64_tr_b16 a[76:77], v27 offset:8192
  ds_read_b64_tr_b16 a[78:79], v27 offset:9728
  ds_read_b64_tr_b16 a[156:157], v27 offset:8224
  ds_read_b64_tr_b16 a[158:159], v27 offset:9760
  ds_read_b64_tr_b16 a[236:237], v27 offset:8256
  ds_read_b64_tr_b16 a[238:239], v27 offset:9792
  s_waitcnt lgkmcnt(0)
  s_barrier
  v_lshlrev_b32 v1, 4, v0
  v_and_b32 v2, 15, v0
  v_lshlrev_b32 v2, 5, v2
  v_lshrrev_b32 v40, 3, v0
  s_lshl_b32 s46, s3, 3
  v_add_u32 v40, s46, v40
  v_bfe_u32 v41, v40, 1, 3
  v_and_b32 v42, 7, v0
  v_xor_b32 v41, v41, v42
  v_lshlrev_b32 v41, 4, v41
  v_mul_u32_u24 v40, 1280, v40
  v_add_u32 v3, v40, v41
  v_bfe_u32 v40, v0, 3, 1
  v_mul_u32_u24 v40, 10240, v40
  v_and_b32 v41, 7, v0
  v_lshlrev_b32 v41, 7, v41
  v_add_u32 v40, v40, v41
  v_bfe_u32 v41, v0, 1, 3
  v_lshrrev_b32 v42, 4, v0
  v_xor_b32 v41, v41, v42
  v_lshlrev_b32 v41, 4, v41
  v_add_u32 v4, v40, v41
  v_xor_b32 v5, 64, v4
  s_mul_i32 s70, s52, 50331648
  s_mul_i32 s46, s43, 12288
  s_add_u32 s70, s70, s46
  s_mul_i32 s46, s3, 3072
  s_add_u32 s70, s70, s46
  s_add_u32 s70, s70, 69206016
  s_lshl_b32 s71, s43, 9
  s_lshl_b32 s46, s52, 7
  s_add_u32 s71, s71, s46
  s_lshl_b32 s46, s3, 5
  s_add_u32 s71, s71, s46
  s_add_u32 s71, s71, 1441792
  s_mul_i32 s72, s3, 10240
  s_waitcnt vmcnt(0)
  v_readfirstlane_b32 s44, v149
  v_mov_b32 v150, 0
  s_mov_b32 s46, 64
  v_writelane_b32 v150, s46, 1
  s_mov_b32 s46, 128
  v_writelane_b32 v150, s46, 2
  s_mov_b32 s46, 132
  v_writelane_b32 v150, s46, 3
  s_mov_b32 s46, 136
  v_writelane_b32 v150, s46, 4
  s_mov_b32 s46, 192
  v_writelane_b32 v150, s46, 5
  s_mov_b32 s46, 196
  v_writelane_b32 v150, s46, 6
  s_mov_b32 s46, 200
  v_writelane_b32 v150, s46, 7
  s_mov_b32 s46, 140
  v_writelane_b32 v150, s46, 8
  s_mov_b64 exec, 0x1ff
gsF_93:
  buffer_load_dword v151, v150, s[8:11], 0 offen sc1
  s_waitcnt vmcnt(0)
  s_nop 0
  v_readlane_b32 s46, v151, 8
  s_cmp_ge_u32 s46, 256
  s_cbranch_scc1 gsokF_94
  s_add_u32 s45, s45, 1
  s_cmp_gt_u32 s45, 1048576
  s_cbranch_scc1 failqF_91
  s_sleep 4
  s_branch gsF_93
gsokF_94:
  buffer_load_dword v151, v150, s[8:11], 0 offen sc1
  s_waitcnt vmcnt(0)
  s_mov_b64 exec, 0xff
  v_cmp_ne_u32 vcc, 32, v151
  s_mov_b64 exec, -1
  s_cbranch_vccz balF_95
  s_getpc_b64 s[46:47]
pcF_96:
  s_add_u32 s46, s46, L_SAFE-pcF_96
  s_addc_u32 s47, s47, 0
  s_setpc_b64 s[46:47]
balF_95:
  v_lshlrev_b32 v16, 9, v0
  s_mov_b32 s73, 0
fwF_97:
  buffer_load_dword v8, v16, s[4:7], s73 offen sc1
  s_waitcnt vmcnt(0)
fcF_99:
  v_cmp_eq_u32 vcc, 0, v8
  s_cbranch_vccz foF_98
  s_add_u32 s45, s45, 1
  s_cmp_gt_u32 s45, 1048576
  s_cbranch_scc1 failqF_91
  s_sleep 2
  s_branch fwF_97
foF_98:
  s_mov_b32 s73, 32768
fwF_100:
  buffer_load_dword v8, v16, s[4:7], s73 offen sc1
  s_waitcnt vmcnt(0)
fcF_102:
  v_cmp_eq_u32 vcc, 0, v8
  s_cbranch_vccz foF_101
  s_add_u32 s45, s45, 1
  s_cmp_gt_u32 s45, 1048576
  s_cbranch_scc1 failqF_91
  s_sleep 2
  s_branch fwF_100
foF_101:
  s_mov_b32 s73, 65536
fwF_103:
  buffer_load_dword v8, v16, s[4:7], s73 offen sc1
  s_waitcnt vmcnt(0)
fcF_105:
  v_cmp_eq_u32 vcc, 0, v8
  s_cbranch_vccz foF_104
  s_add_u32 s45, s45, 1
  s_cmp_gt_u32 s45, 1048576
  s_cbranch_scc1 failqF_91
  s_sleep 2
  s_branch fwF_103
foF_104:
  s_mov_b32 s73, 98304
fwF_106:
  buffer_load_dword v8, v16, s[4:7], s73 offen sc1
  s_waitcnt vmcnt(0)
fcF_108:
  v_cmp_eq_u32 vcc, 0, v8
  s_cbranch_vccz foF_107
  s_add_u32 s45, s45, 1
  s_cmp_gt_u32 s45, 1048576
  s_cbranch_scc1 failqF_91
  s_sleep 2
  s_branch fwF_106
foF_107:
  s_mov_b32 s64, 1
  s_mov_b32 s65, 0
  s_mov_b32 s66, 0
  s_mov_b32 s68, 0
  s_mov_b32 s75, 0x10000000
  s_mov_b32 s69, 0
  s_mul_i32 s73, s66, 40960
  s_add_u32 s73, s73, 18874368
  s_add_u32 s74, s68, s72
  s_mov_b32 m0, s74
  s_nop 0
  buffer_load_dwordx4 v3, s[4:7], s73 offen offset:0 sc1 lds
  s_add_u32 m0, m0, 896
  s_nop 0
  buffer_load_dwordx4 v3, s[4:7], s73 offen offset:128 sc1 lds
  s_add_u32 m0, m0, 896
  s_nop 0
  buffer_load_dwordx4 v3, s[4:7], s73 offen offset:256 sc1 lds
  s_add_u32 m0, m0, 896
  s_nop 0
  buffer_load_dwordx4 v3, s[4:7], s73 offen offset:384 sc1 lds
  s_add_u32 m0, m0, 896
  s_nop 0
  buffer_load_dwordx4 v3, s[4:7], s73 offen offset:512 sc1 lds
  s_add_u32 m0, m0, 896
  s_nop 0
  buffer_load_dwordx4 v3, s[4:7], s73 offen offset:640 sc1 lds
  s_add_u32 m0, m0, 896
  s_nop 0
  buffer_load_dwordx4 v3, s[4:7], s73 offen offset:768 sc1 lds
  s_add_u32 m0, m0, 896
  s_nop 0
  buffer_load_dwordx4 v3, s[4:7], s73 offen offset:896 sc1 lds
  s_add_u32 m0, m0, 896
  s_nop 0
  buffer_load_dwordx4 v3, s[4:7], s73 offen offset:1024 sc1 lds
  s_add_u32 m0, m0, 896
  s_nop 0
  buffer_load_dwordx4 v3, s[4:7], s73 offen offset:1152 sc1 lds
  s_cmp_eq_u32 s52, 2
  s_cbranch_scc1 isvF_109
topF_110:
  s_waitcnt vmcnt(0)
top3F_111:
  s_waitcnt vmcnt(3)
  s_barrier
  v_add_u32 v6, s68, v4
  v_add_u32 v7, s68, v5
  ds_read_b128 v[16:19], v6 offset:0
  ds_read_b128 v[20:23], v6 offset:20480
  ds_read_b128 v[24:27], v7 offset:0
  ds_read_b128 v[28:31], v7 offset:20480
  ds_read_b128 v[32:35], v6 offset:1024
  ds_read_b128 v[36:39], v6 offset:21504
  s_add_u32 s46, s65, 10
  s_min_u32 s46, s46, 64
  s_cmp_lt_u32 s64, s46
  s_cbranch_scc0 n2F_112
  s_mov_b32 s67, s64
  s_add_u32 s64, s64, 1
  s_mov_b32 s69, 1
  s_sub_u32 s47, 40960, s68
  s_mul_i32 s73, s67, 40960
  s_add_u32 s73, s73, 18874368
  s_add_u32 s74, s47, s72
  s_branch cmpF_113
n2F_112:
  s_add_u32 s67, s65, 64
  s_add_u32 s65, s65, 1
  s_mov_b32 s69, 0
cmpF_113:
  s_waitcnt lgkmcnt(4)
  v_mfma_f32_16x16x32_bf16 v[48:51], a[0:3], v[16:19], 0
  ds_read_b128 v[40:43], v7 offset:1024
  v_mfma_f32_16x16x32_bf16 v[52:55], a[80:83], v[16:19], 0
  v_mov_b32 v8, 1
  v_mfma_f32_16x16x32_bf16 v[56:59], a[160:163], v[16:19], 0
  v_mfma_f32_16x16x32_bf16 v[60:63], a[0:3], v[20:23], 0
  ds_read_b128 v[44:47], v7 offset:21504
  v_mfma_f32_16x16x32_bf16 v[64:67], a[80:83], v[20:23], 0
  v_mfma_f32_16x16x32_bf16 v[68:71], a[160:163], v[20:23], 0
  s_waitcnt lgkmcnt(4)
  v_mfma_f32_16x16x32_bf16 v[48:51], a[4:7], v[24:27], v[48:51]
  ds_read_b128 v[16:19], v6 offset:2048
  v_mfma_f32_16x16x32_bf16 v[52:55], a[84:87], v[24:27], v[52:55]
  v_mfma_f32_16x16x32_bf16 v[56:59], a[164:167], v[24:27], v[56:59]
  v_mfma_f32_16x16x32_bf16 v[60:63], a[4:7], v[28:31], v[60:63]
  ds_read_b128 v[20:23], v6 offset:22528
  v_mfma_f32_16x16x32_bf16 v[64:67], a[84:87], v[28:31], v[64:67]
  v_mfma_f32_16x16x32_bf16 v[68:71], a[164:167], v[28:31], v[68:71]
  s_waitcnt lgkmcnt(4)
  v_mfma_f32_16x16x32_bf16 v[48:51], a[8:11], v[32:35], v[48:51]
  ds_read_b128 v[24:27], v7 offset:2048
  v_mfma_f32_16x16x32_bf16 v[52:55], a[88:91], v[32:35], v[52:55]
  v_mfma_f32_16x16x32_bf16 v[56:59], a[168:171], v[32:35], v[56:59]
  v_mfma_f32_16x16x32_bf16 v[60:63], a[8:11], v[36:39], v[60:63]
  ds_read_b128 v[28:31], v7 offset:22528
  v_mfma_f32_16x16x32_bf16 v[64:67], a[88:91], v[36:39], v[64:67]
  v_mfma_f32_16x16x32_bf16 v[68:71], a[168:171], v[36:39], v[68:71]
  s_waitcnt lgkmcnt(4)
  v_mfma_f32_16x16x32_bf16 v[48:51], a[12:15], v[40:43], v[48:51]
  ds_read_b128 v[32:35], v6 offset:3072
  v_mfma_f32_16x16x32_bf16 v[52:55], a[92:95], v[40:43], v[52:55]
  v_mfma_f32_16x16x32_bf16 v[56:59], a[172:175], v[40:43], v[56:59]
  v_mfma_f32_16x16x32_bf16 v[60:63], a[12:15], v[44:47], v[60:63]
  ds_read_b128 v[36:39], v6 offset:23552
  v_mfma_f32_16x16x32_bf16 v[64:67], a[92:95], v[44:47], v[64:67]
  v_mfma_f32_16x16x32_bf16 v[68:71], a[172:175], v[44:47], v[68:71]
  s_waitcnt lgkmcnt(4)
  v_mfma_f32_16x16x32_bf16 v[48:51], a[16:19], v[16:19], v[48:51]
  ds_read_b128 v[40:43], v7 offset:3072
  v_mfma_f32_16x16x32_bf16 v[52:55], a[96:99], v[16:19], v[52:55]
  v_mfma_f32_16x16x32_bf16 v[56:59], a[176:179], v[16:19], v[56:59]
  v_mfma_f32_16x16x32_bf16 v[60:63], a[16:19], v[20:23], v[60:63]
  ds_read_b128 v[44:47], v7 offset:23552
  v_mfma_f32_16x16x32_bf16 v[64:67], a[96:99], v[20:23], v[64:67]
  v_mfma_f32_16x16x32_bf16 v[68:71], a[176:179], v[20:23], v[68:71]
  s_waitcnt lgkmcnt(4)
  v_mfma_f32_16x16x32_bf16 v[48:51], a[20:23], v[24:27], v[48:51]
  ds_read_b128 v[16:19], v6 offset:4096
  v_mfma_f32_16x16x32_bf16 v[52:55], a[100:103], v[24:27], v[52:55]
  v_mfma_f32_16x16x32_bf16 v[56:59], a[180:183], v[24:27], v[56:59]
  v_mfma_f32_16x16x32_bf16 v[60:63], a[20:23], v[28:31], v[60:63]
  ds_read_b128 v[20:23], v6 offset:24576
  v_mfma_f32_16x16x32_bf16 v[64:67], a[100:103], v[28:31], v[64:67]
  v_mfma_f32_16x16x32_bf16 v[68:71], a[180:183], v[28:31], v[68:71]
  s_waitcnt lgkmcnt(4)
  v_mfma_f32_16x16x32_bf16 v[48:51], a[24:27], v[32:35], v[48:51]
  ds_read_b128 v[24:27], v7 offset:4096
  v_mfma_f32_16x16x32_bf16 v[52:55], a[104:107], v[32:35], v[52:55]
  v_mfma_f32_16x16x32_bf16 v[56:59], a[184:187], v[32:35], v[56:59]
  v_mfma_f32_16x16x32_bf16 v[60:63], a[24:27], v[36:39], v[60:63]
  ds_read_b128 v[28:31], v7 offset:24576
  v_mfma_f32_16x16x32_bf16 v[64:67], a[104:107], v[36:39], v[64:67]
  v_mfma_f32_16x16x32_bf16 v[68:71], a[184:187], v[36:39], v[68:71]
  s_waitcnt lgkmcnt(4)
  v_mfma_f32_16x16x32_bf16 v[48:51], a[28:31], v[40:43], v[48:51]
  ds_read_b128 v[32:35], v6 offset:5120
  v_mfma_f32_16x16x32_bf16 v[52:55], a[108:111], v[40:43], v[52:55]
  v_mfma_f32_16x16x32_bf16 v[56:59], a[188:191], v[40:43], v[56:59]
  v_mfma_f32_16x16x32_bf16 v[60:63], a[28:31], v[44:47], v[60:63]
  ds_read_b128 v[36:39], v6 offset:25600
  v_mfma_f32_16x16x32_bf16 v[64:67], a[108:111], v[44:47], v[64:67]
  v_mfma_f32_16x16x32_bf16 v[68:71], a[188:191], v[44:47], v[68:71]
  s_waitcnt vmcnt(0)
  buffer_store_dword v8, off, s[4:7], s75 sc1
  s_cmp_eq_u32 s69, 1
  s_cbranch_scc0 nopfF_115
  s_waitcnt lgkmcnt(4)
  v_mfma_f32_16x16x32_bf16 v[48:51], a[32:35], v[16:19], v[48:51]
  ds_read_b128 v[40:43], v7 offset:5120
  v_mfma_f32_16x16x32_bf16 v[52:55], a[112:115], v[16:19], v[52:55]
  s_mov_b32 m0, s74
  v_mfma_f32_16x16x32_bf16 v[56:59], a[192:195], v[16:19], v[56:59]
  buffer_load_dwordx4 v3, s[4:7], s73 offen offset:0 sc1 lds
  v_mfma_f32_16x16x32_bf16 v[60:63], a[32:35], v[20:23], v[60:63]
  ds_read_b128 v[44:47], v7 offset:25600
  v_mfma_f32_16x16x32_bf16 v[64:67], a[112:115], v[20:23], v[64:67]
  v_mfma_f32_16x16x32_bf16 v[68:71], a[192:195], v[20:23], v[68:71]
  s_waitcnt lgkmcnt(4)
  v_mfma_f32_16x16x32_bf16 v[48:51], a[36:39], v[24:27], v[48:51]
  ds_read_b128 v[16:19], v6 offset:6144
  v_mfma_f32_16x16x32_bf16 v[52:55], a[116:119], v[24:27], v[52:55]
  s_add_u32 m0, m0, 896
  v_mfma_f32_16x16x32_bf16 v[56:59], a[196:199], v[24:27], v[56:59]
  buffer_load_dwordx4 v3, s[4:7], s73 offen offset:128 sc1 lds
  v_mfma_f32_16x16x32_bf16 v[60:63], a[36:39], v[28:31], v[60:63]
  ds_read_b128 v[20:23], v6 offset:26624
  v_mfma_f32_16x16x32_bf16 v[64:67], a[116:119], v[28:31], v[64:67]
  v_mfma_f32_16x16x32_bf16 v[68:71], a[196:199], v[28:31], v[68:71]
  s_waitcnt lgkmcnt(4)
  v_mfma_f32_16x16x32_bf16 v[48:51], a[40:43], v[32:35], v[48:51]
  ds_read_b128 v[24:27], v7 offset:6144
  v_mfma_f32_16x16x32_bf16 v[52:55], a[120:123], v[32:35], v[52:55]
  s_add_u32 m0, m0, 896
  v_mfma_f32_16x16x32_bf16 v[56:59], a[200:203], v[32:35], v[56:59]
  buffer_load_dwordx4 v3, s[4:7], s73 offen offset:256 sc1 lds
  v_mfma_f32_16x16x32_bf16 v[60:63], a[40:43], v[36:39], v[60:63]
  ds_read_b128 v[28:31], v7 offset:26624
  v_mfma_f32_16x16x32_bf16 v[64:67], a[120:123], v[36:39], v[64:67]
  v_mfma_f32_16x16x32_bf16 v[68:71], a[200:203], v[36:39], v[68:71]
  s_waitcnt lgkmcnt(4)
  v_mfma_f32_16x16x32_bf16 v[48:51], a[44:47], v[40:43], v[48:51]
  ds_read_b128 v[32:35], v6 offset:7168
  v_mfma_f32_16x16x32_bf16 v[52:55], a[124:127], v[40:43], v[52:55]
  s_add_u32 m0, m0, 896
  v_mfma_f32_16x16x32_bf16 v[56:59], a[204:207], v[40:43], v[56:59]
  buffer_load_dwordx4 v3, s[4:7], s73 offen offset:384 sc1 lds
  v_mfma_f32_16x16x32_bf16 v[60:63], a[44:47], v[44:47], v[60:63]
  ds_read_b128 v[36:39], v6 offset:27648
  v_mfma_f32_16x16x32_bf16 v[64:67], a[124:127], v[44:47], v[64:67]
  v_mfma_f32_16x16x32_bf16 v[68:71], a[204:207], v[44:47], v[68:71]
  s_waitcnt lgkmcnt(4)
  v_mfma_f32_16x16x32_bf16 v[48:51], a[48:51], v[16:19], v[48:51]
  ds_read_b128 v[40:43], v7 offset:7168
  v_mfma_f32_16x16x32_bf16 v[52:55], a[128:131], v[16:19], v[52:55]
  s_add_u32 m0, m0, 896
  v_mfma_f32_16x16x32_bf16 v[56:59], a[208:211], v[16:19], v[56:59]
  buffer_load_dwordx4 v3, s[4:7], s73 offen offset:512 sc1 lds
  v_mfma_f32_16x16x32_bf16 v[60:63], a[48:51], v[20:23], v[60:63]
  ds_read_b128 v[44:47], v7 offset:27648
  v_mfma_f32_16x16x32_bf16 v[64:67], a[128:131], v[20:23], v[64:67]
  v_mfma_f32_16x16x32_bf16 v[68:71], a[208:211], v[20:23], v[68:71]
  s_waitcnt lgkmcnt(4)
  v_mfma_f32_16x16x32_bf16 v[48:51], a[52:55], v[24:27], v[48:51]
  ds_read_b128 v[16:19], v6 offset:8192
  v_mfma_f32_16x16x32_bf16 v[52:55], a[132:135], v[24:27], v[52:55]
  s_add_u32 m0, m0, 896
  v_mfma_f32_16x16x32_bf16 v[56:59], a[212:215], v[24:27], v[56:59]
  buffer_load_dwordx4 v3, s[4:7], s73 offen offset:640 sc1 lds
  v_mfma_f32_16x16x32_bf16 v[60:63], a[52:55], v[28:31], v[60:63]
  ds_read_b128 v[20:23], v6 offset:28672
  v_mfma_f32_16x16x32_bf16 v[64:67], a[132:135], v[28:31], v[64:67]
  v_mfma_f32_16x16x32_bf16 v[68:71], a[212:215], v[28:31], v[68:71]
  s_waitcnt lgkmcnt(4)
  v_mfma_f32_16x16x32_bf16 v[48:51], a[56:59], v[32:35], v[48:51]
  ds_read_b128 v[24:27], v7 offset:8192
  v_mfma_f32_16x16x32_bf16 v[52:55], a[136:139], v[32:35], v[52:55]
  s_add_u32 m0, m0, 896
  v_mfma_f32_16x16x32_bf16 v[56:59], a[216:219], v[32:35], v[56:59]
  buffer_load_dwordx4 v3, s[4:7], s73 offen offset:768 sc1 lds
  v_mfma_f32_16x16x32_bf16 v[60:63], a[56:59], v[36:39], v[60:63]
  ds_read_b128 v[28:31], v7 offset:28672
  v_mfma_f32_16x16x32_bf16 v[64:67], a[136:139], v[36:39], v[64:67]
  v_mfma_f32_16x16x32_bf16 v[68:71], a[216:219], v[36:39], v[68:71]
  s_waitcnt lgkmcnt(4)
  v_mfma_f32_16x16x32_bf16 v[48:51], a[60:63], v[40:43], v[48:51]
  ds_read_b128 v[32:35], v6 offset:9216
  v_mfma_f32_16x16x32_bf16 v[52:55], a[140:143], v[40:43], v[52:55]
  s_add_u32 m0, m0, 896
  v_mfma_f32_16x16x32_bf16 v[56:59], a[220:223], v[40:43], v[56:59]
  buffer_load_dwordx4 v3, s[4:7], s73 offen offset:896 sc1 lds
  v_mfma_f32_16x16x32_bf16 v[60:63], a[60:63], v[44:47], v[60:63]
  ds_read_b128 v[36:39], v6 offset:29696
  v_mfma_f32_16x16x32_bf16 v[64:67], a[140:143], v[44:47], v[64:67]
  v_mfma_f32_16x16x32_bf16 v[68:71], a[220:223], v[44:47], v[68:71]
  s_waitcnt lgkmcnt(4)
  v_mfma_f32_16x16x32_bf16 v[48:51], a[64:67], v[16:19], v[48:51]
  ds_read_b128 v[40:43], v7 offset:9216
  v_mfma_f32_16x16x32_bf16 v[52:55], a[144:147], v[16:19], v[52:55]
  s_add_u32 m0, m0, 896
  v_mfma_f32_16x16x32_bf16 v[56:59], a[224:227], v[16:19], v[56:59]
  buffer_load_dwordx4 v3, s[4:7], s73 offen offset:1024 sc1 lds
  v_mfma_f32_16x16x32_bf16 v[60:63], a[64:67], v[20:23], v[60:63]
  ds_read_b128 v[44:47], v7 offset:29696
  v_mfma_f32_16x16x32_bf16 v[64:67], a[144:147], v[20:23], v[64:67]
  v_mfma_f32_16x16x32_bf16 v[68:71], a[224:227], v[20:23], v[68:71]
  s_waitcnt lgkmcnt(4)
  v_mfma_f32_16x16x32_bf16 v[48:51], a[68:71], v[24:27], v[48:51]
  v_mfma_f32_16x16x32_bf16 v[52:55], a[148:151], v[24:27], v[52:55]
  s_add_u32 m0, m0, 896
  v_mfma_f32_16x16x32_bf16 v[56:59], a[228:231], v[24:27], v[56:59]
  buffer_load_dwordx4 v3, s[4:7], s73 offen offset:1152 sc1 lds
  v_mfma_f32_16x16x32_bf16 v[60:63], a[68:71], v[28:31], v[60:63]
  v_mfma_f32_16x16x32_bf16 v[64:67], a[148:151], v[28:31], v[64:67]
  v_mfma_f32_16x16x32_bf16 v[68:71], a[228:231], v[28:31], v[68:71]
  s_waitcnt lgkmcnt(2)
  v_mfma_f32_16x16x32_bf16 v[48:51], a[72:75], v[32:35], v[48:51]
  v_mfma_f32_16x16x32_bf16 v[52:55], a[152:155], v[32:35], v[52:55]
  v_mfma_f32_16x16x32_bf16 v[56:59], a[232:235], v[32:35], v[56:59]
  v_mfma_f32_16x16x32_bf16 v[60:63], a[72:75], v[36:39], v[60:63]
  v_mfma_f32_16x16x32_bf16 v[64:67], a[152:155], v[36:39], v[64:67]
  v_mfma_f32_16x16x32_bf16 v[68:71], a[232:235], v[36:39], v[68:71]
  s_waitcnt lgkmcnt(0)
  v_mfma_f32_16x16x32_bf16 v[48:51], a[76:79], v[40:43], v[48:51]
  v_mfma_f32_16x16x32_bf16 v[52:55], a[156:159], v[40:43], v[52:55]
  v_mfma_f32_16x16x32_bf16 v[56:59], a[236:239], v[40:43], v[56:59]
  v_mfma_f32_16x16x32_bf16 v[60:63], a[76:79], v[44:47], v[60:63]
  v_mfma_f32_16x16x32_bf16 v[64:67], a[156:159], v[44:47], v[64:67]
  v_mfma_f32_16x16x32_bf16 v[68:71], a[236:239], v[44:47], v[68:71]
  s_branch joinF_116
nopfF_115:
  s_min_u32 s47, s67, 127
  s_lshl_b32 s47, s47, 11
  s_add_u32 s47, s47, 0
  buffer_load_dword v8, v2, s[4:7], s47 offen sc1
  s_waitcnt lgkmcnt(4)
  v_mfma_f32_16x16x32_bf16 v[48:51], a[32:35], v[16:19], v[48:51]
  ds_read_b128 v[40:43], v7 offset:5120
  v_mfma_f32_16x16x32_bf16 v[52:55], a[112:115], v[16:19], v[52:55]
  v_mfma_f32_16x16x32_bf16 v[56:59], a[192:195], v[16:19], v[56:59]
  v_mfma_f32_16x16x32_bf16 v[60:63], a[32:35], v[20:23], v[60:63]
  ds_read_b128 v[44:47], v7 offset:25600
  v_mfma_f32_16x16x32_bf16 v[64:67], a[112:115], v[20:23], v[64:67]
  v_mfma_f32_16x16x32_bf16 v[68:71], a[192:195], v[20:23], v[68:71]
  s_waitcnt lgkmcnt(4)
  v_mfma_f32_16x16x32_bf16 v[48:51], a[36:39], v[24:27], v[48:51]
  ds_read_b128 v[16:19], v6 offset:6144
  v_mfma_f32_16x16x32_bf16 v[52:55], a[116:119], v[24:27], v[52:55]
  v_mfma_f32_16x16x32_bf16 v[56:59], a[196:199], v[24:27], v[56:59]
  v_mfma_f32_16x16x32_bf16 v[60:63], a[36:39], v[28:31], v[60:63]
  ds_read_b128 v[20:23], v6 offset:26624
  v_mfma_f32_16x16x32_bf16 v[64:67], a[116:119], v[28:31], v[64:67]
  v_mfma_f32_16x16x32_bf16 v[68:71], a[196:199], v[28:31], v[68:71]
  s_waitcnt lgkmcnt(4)
  v_mfma_f32_16x16x32_bf16 v[48:51], a[40:43], v[32:35], v[48:51]
  ds_read_b128 v[24:27], v7 offset:6144
  v_mfma_f32_16x16x32_bf16 v[52:55], a[120:123], v[32:35], v[52:55]
  v_mfma_f32_16x16x32_bf16 v[56:59], a[200:203], v[32:35], v[56:59]
  v_mfma_f32_16x16x32_bf16 v[60:63], a[40:43], v[36:39], v[60:63]
  ds_read_b128 v[28:31], v7 offset:26624
  v_mfma_f32_16x16x32_bf16 v[64:67], a[120:123], v[36:39], v[64:67]
  v_mfma_f32_16x16x32_bf16 v[68:71], a[200:203], v[36:39], v[68:71]
  s_waitcnt lgkmcnt(4)
  v_mfma_f32_16x16x32_bf16 v[48:51], a[44:47], v[40:43], v[48:51]
  ds_read_b128 v[32:35], v6 offset:7168
  v_mfma_f32_16x16x32_bf16 v[52:55], a[124:127], v[40:43], v[52:55]
  v_mfma_f32_16x16x32_bf16 v[56:59], a[204:207], v[40:43], v[56:59]
  v_mfma_f32_16x16x32_bf16 v[60:63], a[44:47], v[44:47], v[60:63]
  ds_read_b128 v[36:39], v6 offset:27648
  v_mfma_f32_16x16x32_bf16 v[64:67], a[124:127], v[44:47], v[64:67]
  v_mfma_f32_16x16x32_bf16 v[68:71], a[204:207], v[44:47], v[68:71]
  s_waitcnt vmcnt(0)
  v_cmp_eq_u32 vcc, 0, v8
  s_cbranch_vccnz neF_117
  s_cmp_ge_u32 s67, 128
  s_cbranch_scc1 neF_117
  s_mov_b32 s69, 1
  s_sub_u32 s47, 40960, s68
  s_mul_i32 s73, s67, 40960
  s_add_u32 s73, s73, 18874368
  s_add_u32 s74, s47, s72
  s_waitcnt lgkmcnt(4)
  v_mfma_f32_16x16x32_bf16 v[48:51], a[48:51], v[16:19], v[48:51]
  ds_read_b128 v[40:43], v7 offset:7168
  v_mfma_f32_16x16x32_bf16 v[52:55], a[128:131], v[16:19], v[52:55]
  s_mov_b32 m0, s74
  v_mfma_f32_16x16x32_bf16 v[56:59], a[208:211], v[16:19], v[56:59]
  buffer_load_dwordx4 v3, s[4:7], s73 offen offset:0 sc1 lds
  v_mfma_f32_16x16x32_bf16 v[60:63], a[48:51], v[20:23], v[60:63]
  ds_read_b128 v[44:47], v7 offset:27648
  v_mfma_f32_16x16x32_bf16 v[64:67], a[128:131], v[20:23], v[64:67]
  s_add_u32 m0, m0, 896
  v_mfma_f32_16x16x32_bf16 v[68:71], a[208:211], v[20:23], v[68:71]
  buffer_load_dwordx4 v3, s[4:7], s73 offen offset:128 sc1 lds
  s_waitcnt lgkmcnt(4)
  v_mfma_f32_16x16x32_bf16 v[48:51], a[52:55], v[24:27], v[48:51]
  ds_read_b128 v[16:19], v6 offset:8192
  v_mfma_f32_16x16x32_bf16 v[52:55], a[132:135], v[24:27], v[52:55]
  s_add_u32 m0, m0, 896
  v_mfma_f32_16x16x32_bf16 v[56:59], a[212:215], v[24:27], v[56:59]
  buffer_load_dwordx4 v3, s[4:7], s73 offen offset:256 sc1 lds
  v_mfma_f32_16x16x32_bf16 v[60:63], a[52:55], v[28:31], v[60:63]
  ds_read_b128 v[20:23], v6 offset:28672
  v_mfma_f32_16x16x32_bf16 v[64:67], a[132:135], v[28:31], v[64:67]
  s_add_u32 m0, m0, 896
  v_mfma_f32_16x16x32_bf16 v[68:71], a[212:215], v[28:31], v[68:71]
  buffer_load_dwordx4 v3, s[4:7], s73 offen offset:384 sc1 lds
  s_waitcnt lgkmcnt(4)
  v_mfma_f32_16x16x32_bf16 v[48:51], a[56:59], v[32:35], v[48:51]
  ds_read_b128 v[24:27], v7 offset:8192
  v_mfma_f32_16x16x32_bf16 v[52:55], a[136:139], v[32:35], v[52:55]
  s_add_u32 m0, m0, 896
  v_mfma_f32_16x16x32_bf16 v[56:59], a[216:219], v[32:35], v[56:59]
  buffer_load_dwordx4 v3, s[4:7], s73 offen offset:512 sc1 lds
  v_mfma_f32_16x16x32_bf16 v[60:63], a[56:59], v[36:39], v[60:63]
  ds_read_b128 v[28:31], v7 offset:28672
  v_mfma_f32_16x16x32_bf16 v[64:67], a[136:139], v[36:39], v[64:67]
  v_mfma_f32_16x16x32_bf16 v[68:71], a[216:219], v[36:39], v[68:71]
  s_waitcnt lgkmcnt(4)
  v_mfma_f32_16x16x32_bf16 v[48:51], a[60:63], v[40:43], v[48:51]
  ds_read_b128 v[32:35], v6 offset:9216
  v_mfma_f32_16x16x32_bf16 v[52:55], a[140:143], v[40:43], v[52:55]
  s_add_u32 m0, m0, 896
  v_mfma_f32_16x16x32_bf16 v[56:59], a[220:223], v[40:43], v[56:59]
  buffer_load_dwordx4 v3, s[4:7], s73 offen offset:640 sc1 lds
  v_mfma_f32_16x16x32_bf16 v[60:63], a[60:63], v[44:47], v[60:63]
  ds_read_b128 v[36:39], v6 offset:29696
  v_mfma_f32_16x16x32_bf16 v[64:67], a[140:143], v[44:47], v[64:67]
  v_mfma_f32_16x16x32_bf16 v[68:71], a[220:223], v[44:47], v[68:71]
  s_waitcnt lgkmcnt(4)
  v_mfma_f32_16x16x32_bf16 v[48:51], a[64:67], v[16:19], v[48:51]
  ds_read_b128 v[40:43], v7 offset:9216
  v_mfma_f32_16x16x32_bf16 v[52:55], a[144:147], v[16:19], v[52:55]
  s_add_u32 m0, m0, 896
  v_mfma_f32_16x16x32_bf16 v[56:59], a[224:227], v[16:19], v[56:59]
  buffer_load_dwordx4 v3, s[4:7], s73 offen offset:768 sc1 lds
  v_mfma_f32_16x16x32_bf16 v[60:63], a[64:67], v[20:23], v[60:63]
  ds_read_b128 v[44:47], v7 offset:29696
  v_mfma_f32_16x16x32_bf16 v[64:67], a[144:147], v[20:23], v[64:67]
  v_mfma_f32_16x16x32_bf16 v[68:71], a[224:227], v[20:23], v[68:71]
  s_waitcnt lgkmcnt(4)
  v_mfma_f32_16x16x32_bf16 v[48:51], a[68:71], v[24:27], v[48:51]
  v_mfma_f32_16x16x32_bf16 v[52:55], a[148:151], v[24:27], v[52:55]
  s_add_u32 m0, m0, 896
  v_mfma_f32_16x16x32_bf16 v[56:59], a[228:231], v[24:27], v[56:59]
  buffer_load_dwordx4 v3, s[4:7], s73 offen offset:896 sc1 lds
  v_mfma_f32_16x16x32_bf16 v[60:63], a[68:71], v[28:31], v[60:63]
  v_mfma_f32_16x16x32_bf16 v[64:67], a[148:151], v[28:31], v[64:67]
  v_mfma_f32_16x16x32_bf16 v[68:71], a[228:231], v[28:31], v[68:71]
  s_waitcnt lgkmcnt(2)
  v_mfma_f32_16x16x32_bf16 v[48:51], a[72:75], v[32:35], v[48:51]
  v_mfma_f32_16x16x32_bf16 v[52:55], a[152:155], v[32:35], v[52:55]
  s_add_u32 m0, m0, 896
  v_mfma_f32_16x16x32_bf16 v[56:59], a[232:235], v[32:35], v[56:59]
  buffer_load_dwordx4 v3, s[4:7], s73 offen offset:1024 sc1 lds
  v_mfma_f32_16x16x32_bf16 v[60:63], a[72:75], v[36:39], v[60:63]
  v_mfma_f32_16x16x32_bf16 v[64:67], a[152:155], v[36:39], v[64:67]
  v_mfma_f32_16x16x32_bf16 v[68:71], a[232:235], v[36:39], v[68:71]
  s_waitcnt lgkmcnt(0)
  v_mfma_f32_16x16x32_bf16 v[48:51], a[76:79], v[40:43], v[48:51]
  v_mfma_f32_16x16x32_bf16 v[52:55], a[156:159], v[40:43], v[52:55]
  s_add_u32 m0, m0, 896
  v_mfma_f32_16x16x32_bf16 v[56:59], a[236:239], v[40:43], v[56:59]
  buffer_load_dwordx4 v3, s[4:7], s73 offen offset:1152 sc1 lds
  v_mfma_f32_16x16x32_bf16 v[60:63], a[76:79], v[44:47], v[60:63]
  v_mfma_f32_16x16x32_bf16 v[64:67], a[156:159], v[44:47], v[64:67]
  v_mfma_f32_16x16x32_bf16 v[68:71], a[236:239], v[44:47], v[68:71]
  s_branch joinF_116
neF_117:
  s_waitcnt lgkmcnt(4)
  v_mfma_f32_16x16x32_bf16 v[48:51], a[48:51], v[16:19], v[48:51]
  ds_read_b128 v[40:43], v7 offset:7168
  v_mfma_f32_16x16x32_bf16 v[52:55], a[128:131], v[16:19], v[52:55]
  v_mfma_f32_16x16x32_bf16 v[56:59], a[208:211], v[16:19], v[56:59]
  v_mfma_f32_16x16x32_bf16 v[60:63], a[48:51], v[20:23], v[60:63]
  ds_read_b128 v[44:47], v7 offset:27648
  v_mfma_f32_16x16x32_bf16 v[64:67], a[128:131], v[20:23], v[64:67]
  v_mfma_f32_16x16x32_bf16 v[68:71], a[208:211], v[20:23], v[68:71]
  s_waitcnt lgkmcnt(4)
  v_mfma_f32_16x16x32_bf16 v[48:51], a[52:55], v[24:27], v[48:51]
  ds_read_b128 v[16:19], v6 offset:8192
  v_mfma_f32_16x16x32_bf16 v[52:55], a[132:135], v[24:27], v[52:55]
  v_mfma_f32_16x16x32_bf16 v[56:59], a[212:215], v[24:27], v[56:59]
  v_mfma_f32_16x16x32_bf16 v[60:63], a[52:55], v[28:31], v[60:63]
  ds_read_b128 v[20:23], v6 offset:28672
  v_mfma_f32_16x16x32_bf16 v[64:67], a[132:135], v[28:31], v[64:67]
  v_mfma_f32_16x16x32_bf16 v[68:71], a[212:215], v[28:31], v[68:71]
  s_waitcnt lgkmcnt(4)
  v_mfma_f32_16x16x32_bf16 v[48:51], a[56:59], v[32:35], v[48:51]
  ds_read_b128 v[24:27], v7 offset:8192
  v_mfma_f32_16x16x32_bf16 v[52:55], a[136:139], v[32:35], v[52:55]
  v_mfma_f32_16x16x32_bf16 v[56:59], a[216:219], v[32:35], v[56:59]
  v_mfma_f32_16x16x32_bf16 v[60:63], a[56:59], v[36:39], v[60:63]
  ds_read_b128 v[28:31], v7 offset:28672
  v_mfma_f32_16x16x32_bf16 v[64:67], a[136:139], v[36:39], v[64:67]
  v_mfma_f32_16x16x32_bf16 v[68:71], a[216:219], v[36:39], v[68:71]
  s_waitcnt lgkmcnt(4)
  v_mfma_f32_16x16x32_bf16 v[48:51], a[60:63], v[40:43], v[48:51]
  ds_read_b128 v[32:35], v6 offset:9216
  v_mfma_f32_16x16x32_bf16 v[52:55], a[140:143], v[40:43], v[52:55]
  v_mfma_f32_16x16x32_bf16 v[56:59], a[220:223], v[40:43], v[56:59]
  v_mfma_f32_16x16x32_bf16 v[60:63], a[60:63], v[44:47], v[60:63]
  ds_read_b128 v[36:39], v6 offset:29696
  v_mfma_f32_16x16x32_bf16 v[64:67], a[140:143], v[44:47], v[64:67]
  v_mfma_f32_16x16x32_bf16 v[68:71], a[220:223], v[44:47], v[68:71]
  s_waitcnt lgkmcnt(4)
  v_mfma_f32_16x16x32_bf16 v[48:51], a[64:67], v[16:19], v[48:51]
  ds_read_b128 v[40:43], v7 offset:9216
  v_mfma_f32_16x16x32_bf16 v[52:55], a[144:147], v[16:19], v[52:55]
  v_mfma_f32_16x16x32_bf16 v[56:59], a[224:227], v[16:19], v[56:59]
  v_mfma_f32_16x16x32_bf16 v[60:63], a[64:67], v[20:23], v[60:63]
  ds_read_b128 v[44:47], v7 offset:29696
  v_mfma_f32_16x16x32_bf16 v[64:67], a[144:147], v[20:23], v[64:67]
  v_mfma_f32_16x16x32_bf16 v[68:71], a[224:227], v[20:23], v[68:71]
  s_waitcnt lgkmcnt(4)
  v_mfma_f32_16x16x32_bf16 v[48:51], a[68:71], v[24:27], v[48:51]
  v_mfma_f32_16x16x32_bf16 v[52:55], a[148:151], v[24:27], v[52:55]
  v_mfma_f32_16x16x32_bf16 v[56:59], a[228:231], v[24:27], v[56:59]
  v_mfma_f32_16x16x32_bf16 v[60:63], a[68:71], v[28:31], v[60:63]
  v_mfma_f32_16x16x32_bf16 v[64:67], a[148:151], v[28:31], v[64:67]
  v_mfma_f32_16x16x32_bf16 v[68:71], a[228:231], v[28:31], v[68:71]
  s_waitcnt lgkmcnt(2)
  v_mfma_f32_16x16x32_bf16 v[48:51], a[72:75], v[32:35], v[48:51]
  v_mfma_f32_16x16x32_bf16 v[52:55], a[152:155], v[32:35], v[52:55]
  v_mfma_f32_16x16x32_bf16 v[56:59], a[232:235], v[32:35], v[56:59]
  v_mfma_f32_16x16x32_bf16 v[60:63], a[72:75], v[36:39], v[60:63]
  v_mfma_f32_16x16x32_bf16 v[64:67], a[152:155], v[36:39], v[64:67]
  v_mfma_f32_16x16x32_bf16 v[68:71], a[232:235], v[36:39], v[68:71]
  s_waitcnt lgkmcnt(0)
  v_mfma_f32_16x16x32_bf16 v[48:51], a[76:79], v[40:43], v[48:51]
  v_mfma_f32_16x16x32_bf16 v[52:55], a[156:159], v[40:43], v[52:55]
  v_mfma_f32_16x16x32_bf16 v[56:59], a[236:239], v[40:43], v[56:59]
  v_mfma_f32_16x16x32_bf16 v[60:63], a[76:79], v[44:47], v[60:63]
  v_mfma_f32_16x16x32_bf16 v[64:67], a[156:159], v[44:47], v[64:67]
  v_mfma_f32_16x16x32_bf16 v[68:71], a[236:239], v[44:47], v[68:71]
joinF_116:
  s_mul_i32 s73, s66, 393216
  s_add_u32 s73, s73, s70
  s_lshl_b32 s75, s66, 14
  s_add_u32 s75, s75, s71
  s_sub_u32 s68, 40960, s68
  s_nop 1
  v_cvt_pk_bf16_f32 v72, v48, v49
  v_cvt_pk_bf16_f32 v73, v50, v51
  v_cvt_pk_bf16_f32 v74, v52, v53
  v_cvt_pk_bf16_f32 v75, v54, v55
  buffer_store_dwordx4 v[72:75], v1, s[4:7], s73 offen offset:0 sc1
  v_cvt_pk_bf16_f32 v76, v60, v61
  v_cvt_pk_bf16_f32 v77, v62, v63
  v_cvt_pk_bf16_f32 v78, v64, v65
  v_cvt_pk_bf16_f32 v79, v66, v67
  buffer_store_dwordx4 v[76:79], v1, s[4:7], s73 offen offset:1024 sc1
  v_cvt_pk_bf16_f32 v80, v56, v57
  v_cvt_pk_bf16_f32 v81, v58, v59
  v_cvt_pk_bf16_f32 v82, v68, v69
  v_cvt_pk_bf16_f32 v83, v70, v71
  buffer_store_dwordx4 v[80:83], v1, s[4:7], s73 offen offset:2048 sc1
  s_mov_b32 s66, s67
  s_cmp_eq_u32 s69, 1
  s_cbranch_scc1 top3F_111
  s_cmp_ge_u32 s66, 128
  s_cbranch_scc1 endF_114
  s_lshl_b32 s47, s66, 11
  s_add_u32 s47, s47, 0
  buffer_load_dword v8, v2, s[4:7], s47 offen sc1
  v_mov_b32 v9, 1
  s_waitcnt vmcnt(0)
  buffer_store_dword v9, off, s[4:7], s75 sc1
  s_mov_b32 s75, 0x10000000
  s_waitcnt vmcnt(1)
  s_branch fcF_120
fwF_118:
  buffer_load_dword v8, v2, s[4:7], s47 offen sc1
  s_waitcnt vmcnt(0)
fcF_120:
  v_cmp_eq_u32 vcc, 0, v8
  s_cbranch_vccz foF_119
  s_add_u32 s45, s45, 1
  s_cmp_gt_u32 s45, 1048576
  s_cbranch_scc1 failqF_91
  s_sleep 1
  s_branch fwF_118
foF_119:
  s_mul_i32 s73, s66, 40960
  s_add_u32 s73, s73, 18874368
  s_add_u32 s74, s68, s72
  s_mov_b32 m0, s74
  s_nop 0
  buffer_load_dwordx4 v3, s[4:7], s73 offen offset:0 sc1 lds
  s_add_u32 m0, m0, 896
  s_nop 0
  buffer_load_dwordx4 v3, s[4:7], s73 offen offset:128 sc1 lds
  s_add_u32 m0, m0, 896
  s_nop 0
  buffer_load_dwordx4 v3, s[4:7], s73 offen offset:256 sc1 lds
  s_add_u32 m0, m0, 896
  s_nop 0
  buffer_load_dwordx4 v3, s[4:7], s73 offen offset:384 sc1 lds
  s_add_u32 m0, m0, 896
  s_nop 0
  buffer_load_dwordx4 v3, s[4:7], s73 offen offset:512 sc1 lds
  s_add_u32 m0, m0, 896
  s_nop 0
  buffer_load_dwordx4 v3, s[4:7], s73 offen offset:640 sc1 lds
  s_add_u32 m0, m0, 896
  s_nop 0
  buffer_load_dwordx4 v3, s[4:7], s73 offen offset:768 sc1 lds
  s_add_u32 m0, m0, 896
  s_nop 0
  buffer_load_dwordx4 v3, s[4:7], s73 offen offset:896 sc1 lds
  s_add_u32 m0, m0, 896
  s_nop 0
  buffer_load_dwordx4 v3, s[4:7], s73 offen offset:1024 sc1 lds
  s_add_u32 m0, m0, 896
  s_nop 0
  buffer_load_dwordx4 v3, s[4:7], s73 offen offset:1152 sc1 lds
  s_branch topF_110
endF_114:
  v_mov_b32 v8, 1
  s_waitcnt vmcnt(0)
  buffer_store_dword v8, off, s[4:7], s75 sc1
  s_endpgm
isvF_109:
topF_121:
  s_waitcnt vmcnt(0)
top3F_122:
  s_waitcnt vmcnt(3)
  s_barrier
  v_add_u32 v6, s68, v4
  v_add_u32 v7, s68, v5
  ds_read_b128 v[16:19], v6 offset:0
  ds_read_b128 v[20:23], v6 offset:20480
  ds_read_b128 v[24:27], v7 offset:0
  ds_read_b128 v[28:31], v7 offset:20480
  ds_read_b128 v[32:35], v6 offset:1024
  ds_read_b128 v[36:39], v6 offset:21504
  s_add_u32 s46, s65, 10
  s_min_u32 s46, s46, 64
  s_cmp_lt_u32 s64, s46
  s_cbranch_scc0 n2F_123
  s_mov_b32 s67, s64
  s_add_u32 s64, s64, 1
  s_mov_b32 s69, 1
  s_sub_u32 s47, 40960, s68
  s_mul_i32 s73, s67, 40960
  s_add_u32 s73, s73, 18874368
  s_add_u32 s74, s47, s72
  s_branch cmpF_124
n2F_123:
  s_add_u32 s67, s65, 64
  s_add_u32 s65, s65, 1
  s_mov_b32 s69, 0
cmpF_124:
  s_waitcnt lgkmcnt(4)
  v_mfma_f32_16x16x32_bf16 v[48:51], v[16:19], a[0:3], 0
  ds_read_b128 v[40:43], v7 offset:1024
  v_mfma_f32_16x16x32_bf16 v[52:55], v[16:19], a[80:83], 0
  v_mov_b32 v8, 1
  v_mfma_f32_16x16x32_bf16 v[56:59], v[16:19], a[160:163], 0
  v_mfma_f32_16x16x32_bf16 v[60:63], v[20:23], a[0:3], 0
  ds_read_b128 v[44:47], v7 offset:21504
  v_mfma_f32_16x16x32_bf16 v[64:67], v[20:23], a[80:83], 0
  v_mfma_f32_16x16x32_bf16 v[68:71], v[20:23], a[160:163], 0
  s_waitcnt lgkmcnt(4)
  v_mfma_f32_16x16x32_bf16 v[48:51], v[24:27], a[4:7], v[48:51]
  ds_read_b128 v[16:19], v6 offset:2048
  v_mfma_f32_16x16x32_bf16 v[52:55], v[24:27], a[84:87], v[52:55]
  v_mfma_f32_16x16x32_bf16 v[56:59], v[24:27], a[164:167], v[56:59]
  v_mfma_f32_16x16x32_bf16 v[60:63], v[28:31], a[4:7], v[60:63]
  ds_read_b128 v[20:23], v6 offset:22528
  v_mfma_f32_16x16x32_bf16 v[64:67], v[28:31], a[84:87], v[64:67]
  v_mfma_f32_16x16x32_bf16 v[68:71], v[28:31], a[164:167], v[68:71]
  s_waitcnt lgkmcnt(4)
  v_mfma_f32_16x16x32_bf16 v[48:51], v[32:35], a[8:11], v[48:51]
  ds_read_b128 v[24:27], v7 offset:2048
  v_mfma_f32_16x16x32_bf16 v[52:55], v[32:35], a[88:91], v[52:55]
  v_mfma_f32_16x16x32_bf16 v[56:59], v[32:35], a[168:171], v[56:59]
  v_mfma_f32_16x16x32_bf16 v[60:63], v[36:39], a[8:11], v[60:63]
  ds_read_b128 v[28:31], v7 offset:22528
  v_mfma_f32_16x16x32_bf16 v[64:67], v[36:39], a[88:91], v[64:67]
  v_mfma_f32_16x16x32_bf16 v[68:71], v[36:39], a[168:171], v[68:71]
  s_waitcnt lgkmcnt(4)
  v_mfma_f32_16x16x32_bf16 v[48:51], v[40:43], a[12:15], v[48:51]
  ds_read_b128 v[32:35], v6 offset:3072
  v_mfma_f32_16x16x32_bf16 v[52:55], v[40:43], a[92:95], v[52:55]
  v_mfma_f32_16x16x32_bf16 v[56:59], v[40:43], a[172:175], v[56:59]
  v_mfma_f32_16x16x32_bf16 v[60:63], v[44:47], a[12:15], v[60:63]
  ds_read_b128 v[36:39], v6 offset:23552
  v_mfma_f32_16x16x32_bf16 v[64:67], v[44:47], a[92:95], v[64:67]
  v_mfma_f32_16x16x32_bf16 v[68:71], v[44:47], a[172:175], v[68:71]
  s_waitcnt lgkmcnt(4)
  v_mfma_f32_16x16x32_bf16 v[48:51], v[16:19], a[16:19], v[48:51]
  ds_read_b128 v[40:43], v7 offset:3072
  v_mfma_f32_16x16x32_bf16 v[52:55], v[16:19], a[96:99], v[52:55]
  v_mfma_f32_16x16x32_bf16 v[56:59], v[16:19], a[176:179], v[56:59]
  v_mfma_f32_16x16x32_bf16 v[60:63], v[20:23], a[16:19], v[60:63]
  ds_read_b128 v[44:47], v7 offset:23552
  v_mfma_f32_16x16x32_bf16 v[64:67], v[20:23], a[96:99], v[64:67]
  v_mfma_f32_16x16x32_bf16 v[68:71], v[20:23], a[176:179], v[68:71]
  s_waitcnt lgkmcnt(4)
  v_mfma_f32_16x16x32_bf16 v[48:51], v[24:27], a[20:23], v[48:51]
  ds_read_b128 v[16:19], v6 offset:4096
  v_mfma_f32_16x16x32_bf16 v[52:55], v[24:27], a[100:103], v[52:55]
  v_mfma_f32_16x16x32_bf16 v[56:59], v[24:27], a[180:183], v[56:59]
  v_mfma_f32_16x16x32_bf16 v[60:63], v[28:31], a[20:23], v[60:63]
  ds_read_b128 v[20:23], v6 offset:24576
  v_mfma_f32_16x16x32_bf16 v[64:67], v[28:31], a[100:103], v[64:67]
  v_mfma_f32_16x16x32_bf16 v[68:71], v[28:31], a[180:183], v[68:71]
  s_waitcnt lgkmcnt(4)
  v_mfma_f32_16x16x32_bf16 v[48:51], v[32:35], a[24:27], v[48:51]
  ds_read_b128 v[24:27], v7 offset:4096
  v_mfma_f32_16x16x32_bf16 v[52:55], v[32:35], a[104:107], v[52:55]
  v_mfma_f32_16x16x32_bf16 v[56:59], v[32:35], a[184:187], v[56:59]
  v_mfma_f32_16x16x32_bf16 v[60:63], v[36:39], a[24:27], v[60:63]
  ds_read_b128 v[28:31], v7 offset:24576
  v_mfma_f32_16x16x32_bf16 v[64:67], v[36:39], a[104:107], v[64:67]
  v_mfma_f32_16x16x32_bf16 v[68:71], v[36:39], a[184:187], v[68:71]
  s_waitcnt lgkmcnt(4)
  v_mfma_f32_16x16x32_bf16 v[48:51], v[40:43], a[28:31], v[48:51]
  ds_read_b128 v[32:35], v6 offset:5120
  v_mfma_f32_16x16x32_bf16 v[52:55], v[40:43], a[108:111], v[52:55]
  v_mfma_f32_16x16x32_bf16 v[56:59], v[40:43], a[188:191], v[56:59]
  v_mfma_f32_16x16x32_bf16 v[60:63], v[44:47], a[28:31], v[60:63]
  ds_read_b128 v[36:39], v6 offset:25600
  v_mfma_f32_16x16x32_bf16 v[64:67], v[44:47], a[108:111], v[64:67]
  v_mfma_f32_16x16x32_bf16 v[68:71], v[44:47], a[188:191], v[68:71]
  s_waitcnt vmcnt(0)
  buffer_store_dword v8, off, s[4:7], s75 sc1
  s_cmp_eq_u32 s69, 1
  s_cbranch_scc0 nopfF_126
  s_waitcnt lgkmcnt(4)
  v_mfma_f32_16x16x32_bf16 v[48:51], v[16:19], a[32:35], v[48:51]
  ds_read_b128 v[40:43], v7 offset:5120
  v_mfma_f32_16x16x32_bf16 v[52:55], v[16:19], a[112:115], v[52:55]
  s_mov_b32 m0, s74
  v_mfma_f32_16x16x32_bf16 v[56:59], v[16:19], a[192:195], v[56:59]
  buffer_load_dwordx4 v3, s[4:7], s73 offen offset:0 sc1 lds
  v_mfma_f32_16x16x32_bf16 v[60:63], v[20:23], a[32:35], v[60:63]
  ds_read_b128 v[44:47], v7 offset:25600
  v_mfma_f32_16x16x32_bf16 v[64:67], v[20:23], a[112:115], v[64:67]
  v_mfma_f32_16x16x32_bf16 v[68:71], v[20:23], a[192:195], v[68:71]
  s_waitcnt lgkmcnt(4)
  v_mfma_f32_16x16x32_bf16 v[48:51], v[24:27], a[36:39], v[48:51]
  ds_read_b128 v[16:19], v6 offset:6144
  v_mfma_f32_16x16x32_bf16 v[52:55], v[24:27], a[116:119], v[52:55]
  s_add_u32 m0, m0, 896
  v_mfma_f32_16x16x32_bf16 v[56:59], v[24:27], a[196:199], v[56:59]
  buffer_load_dwordx4 v3, s[4:7], s73 offen offset:128 sc1 lds
  v_mfma_f32_16x16x32_bf16 v[60:63], v[28:31], a[36:39], v[60:63]
  ds_read_b128 v[20:23], v6 offset:26624
  v_mfma_f32_16x16x32_bf16 v[64:67], v[28:31], a[116:119], v[64:67]
  v_mfma_f32_16x16x32_bf16 v[68:71], v[28:31], a[196:199], v[68:71]
  s_waitcnt lgkmcnt(4)
  v_mfma_f32_16x16x32_bf16 v[48:51], v[32:35], a[40:43], v[48:51]
  ds_read_b128 v[24:27], v7 offset:6144
  v_mfma_f32_16x16x32_bf16 v[52:55], v[32:35], a[120:123], v[52:55]
  s_add_u32 m0, m0, 896
  v_mfma_f32_16x16x32_bf16 v[56:59], v[32:35], a[200:203], v[56:59]
  buffer_load_dwordx4 v3, s[4:7], s73 offen offset:256 sc1 lds
  v_mfma_f32_16x16x32_bf16 v[60:63], v[36:39], a[40:43], v[60:63]
  ds_read_b128 v[28:31], v7 offset:26624
  v_mfma_f32_16x16x32_bf16 v[64:67], v[36:39], a[120:123], v[64:67]
  v_mfma_f32_16x16x32_bf16 v[68:71], v[36:39], a[200:203], v[68:71]
  s_waitcnt lgkmcnt(4)
  v_mfma_f32_16x16x32_bf16 v[48:51], v[40:43], a[44:47], v[48:51]
  ds_read_b128 v[32:35], v6 offset:7168
  v_mfma_f32_16x16x32_bf16 v[52:55], v[40:43], a[124:127], v[52:55]
  s_add_u32 m0, m0, 896
  v_mfma_f32_16x16x32_bf16 v[56:59], v[40:43], a[204:207], v[56:59]
  buffer_load_dwordx4 v3, s[4:7], s73 offen offset:384 sc1 lds
  v_mfma_f32_16x16x32_bf16 v[60:63], v[44:47], a[44:47], v[60:63]
  ds_read_b128 v[36:39], v6 offset:27648
  v_mfma_f32_16x16x32_bf16 v[64:67], v[44:47], a[124:127], v[64:67]
  v_mfma_f32_16x16x32_bf16 v[68:71], v[44:47], a[204:207], v[68:71]
  s_waitcnt lgkmcnt(4)
  v_mfma_f32_16x16x32_bf16 v[48:51], v[16:19], a[48:51], v[48:51]
  ds_read_b128 v[40:43], v7 offset:7168
  v_mfma_f32_16x16x32_bf16 v[52:55], v[16:19], a[128:131], v[52:55]
  s_add_u32 m0, m0, 896
  v_mfma_f32_16x16x32_bf16 v[56:59], v[16:19], a[208:211], v[56:59]
  buffer_load_dwordx4 v3, s[4:7], s73 offen offset:512 sc1 lds
  v_mfma_f32_16x16x32_bf16 v[60:63], v[20:23], a[48:51], v[60:63]
  ds_read_b128 v[44:47], v7 offset:27648
  v_mfma_f32_16x16x32_bf16 v[64:67], v[20:23], a[128:131], v[64:67]
  v_mfma_f32_16x16x32_bf16 v[68:71], v[20:23], a[208:211], v[68:71]
  s_waitcnt lgkmcnt(4)
  v_mfma_f32_16x16x32_bf16 v[48:51], v[24:27], a[52:55], v[48:51]
  ds_read_b128 v[16:19], v6 offset:8192
  v_mfma_f32_16x16x32_bf16 v[52:55], v[24:27], a[132:135], v[52:55]
  s_add_u32 m0, m0, 896
  v_mfma_f32_16x16x32_bf16 v[56:59], v[24:27], a[212:215], v[56:59]
  buffer_load_dwordx4 v3, s[4:7], s73 offen offset:640 sc1 lds
  v_mfma_f32_16x16x32_bf16 v[60:63], v[28:31], a[52:55], v[60:63]
  ds_read_b128 v[20:23], v6 offset:28672
  v_mfma_f32_16x16x32_bf16 v[64:67], v[28:31], a[132:135], v[64:67]
  v_mfma_f32_16x16x32_bf16 v[68:71], v[28:31], a[212:215], v[68:71]
  s_waitcnt lgkmcnt(4)
  v_mfma_f32_16x16x32_bf16 v[48:51], v[32:35], a[56:59], v[48:51]
  ds_read_b128 v[24:27], v7 offset:8192
  v_mfma_f32_16x16x32_bf16 v[52:55], v[32:35], a[136:139], v[52:55]
  s_add_u32 m0, m0, 896
  v_mfma_f32_16x16x32_bf16 v[56:59], v[32:35], a[216:219], v[56:59]
  buffer_load_dwordx4 v3, s[4:7], s73 offen offset:768 sc1 lds
  v_mfma_f32_16x16x32_bf16 v[60:63], v[36:39], a[56:59], v[60:63]
  ds_read_b128 v[28:31], v7 offset:28672
  v_mfma_f32_16x16x32_bf16 v[64:67], v[36:39], a[136:139], v[64:67]
  v_mfma_f32_16x16x32_bf16 v[68:71], v[36:39], a[216:219], v[68:71]
  s_waitcnt lgkmcnt(4)
  v_mfma_f32_16x16x32_bf16 v[48:51], v[40:43], a[60:63], v[48:51]
  ds_read_b128 v[32:35], v6 offset:9216
  v_mfma_f32_16x16x32_bf16 v[52:55], v[40:43], a[140:143], v[52:55]
  s_add_u32 m0, m0, 896
  v_mfma_f32_16x16x32_bf16 v[56:59], v[40:43], a[220:223], v[56:59]
  buffer_load_dwordx4 v3, s[4:7], s73 offen offset:896 sc1 lds
  v_mfma_f32_16x16x32_bf16 v[60:63], v[44:47], a[60:63], v[60:63]
  ds_read_b128 v[36:39], v6 offset:29696
  v_mfma_f32_16x16x32_bf16 v[64:67], v[44:47], a[140:143], v[64:67]
  v_mfma_f32_16x16x32_bf16 v[68:71], v[44:47], a[220:223], v[68:71]
  s_waitcnt lgkmcnt(4)
  v_mfma_f32_16x16x32_bf16 v[48:51], v[16:19], a[64:67], v[48:51]
  ds_read_b128 v[40:43], v7 offset:9216
  v_mfma_f32_16x16x32_bf16 v[52:55], v[16:19], a[144:147], v[52:55]
  s_add_u32 m0, m0, 896
  v_mfma_f32_16x16x32_bf16 v[56:59], v[16:19], a[224:227], v[56:59]
  buffer_load_dwordx4 v3, s[4:7], s73 offen offset:1024 sc1 lds
  v_mfma_f32_16x16x32_bf16 v[60:63], v[20:23], a[64:67], v[60:63]
  ds_read_b128 v[44:47], v7 offset:29696
  v_mfma_f32_16x16x32_bf16 v[64:67], v[20:23], a[144:147], v[64:67]
  v_mfma_f32_16x16x32_bf16 v[68:71], v[20:23], a[224:227], v[68:71]
  s_waitcnt lgkmcnt(4)
  v_mfma_f32_16x16x32_bf16 v[48:51], v[24:27], a[68:71], v[48:51]
  v_mfma_f32_16x16x32_bf16 v[52:55], v[24:27], a[148:151], v[52:55]
  s_add_u32 m0, m0, 896
  v_mfma_f32_16x16x32_bf16 v[56:59], v[24:27], a[228:231], v[56:59]
  buffer_load_dwordx4 v3, s[4:7], s73 offen offset:1152 sc1 lds
  v_mfma_f32_16x16x32_bf16 v[60:63], v[28:31], a[68:71], v[60:63]
  v_mfma_f32_16x16x32_bf16 v[64:67], v[28:31], a[148:151], v[64:67]
  v_mfma_f32_16x16x32_bf16 v[68:71], v[28:31], a[228:231], v[68:71]
  s_waitcnt lgkmcnt(2)
  v_mfma_f32_16x16x32_bf16 v[48:51], v[32:35], a[72:75], v[48:51]
  v_mfma_f32_16x16x32_bf16 v[52:55], v[32:35], a[152:155], v[52:55]
  v_mfma_f32_16x16x32_bf16 v[56:59], v[32:35], a[232:235], v[56:59]
  v_mfma_f32_16x16x32_bf16 v[60:63], v[36:39], a[72:75], v[60:63]
  v_mfma_f32_16x16x32_bf16 v[64:67], v[36:39], a[152:155], v[64:67]
  v_mfma_f32_16x16x32_bf16 v[68:71], v[36:39], a[232:235], v[68:71]
  s_waitcnt lgkmcnt(0)
  v_mfma_f32_16x16x32_bf16 v[48:51], v[40:43], a[76:79], v[48:51]
  v_mfma_f32_16x16x32_bf16 v[52:55], v[40:43], a[156:159], v[52:55]
  v_mfma_f32_16x16x32_bf16 v[56:59], v[40:43], a[236:239], v[56:59]
  v_mfma_f32_16x16x32_bf16 v[60:63], v[44:47], a[76:79], v[60:63]
  v_mfma_f32_16x16x32_bf16 v[64:67], v[44:47], a[156:159], v[64:67]
  v_mfma_f32_16x16x32_bf16 v[68:71], v[44:47], a[236:239], v[68:71]
  s_branch joinF_127
nopfF_126:
  s_min_u32 s47, s67, 127
  s_lshl_b32 s47, s47, 11
  s_add_u32 s47, s47, 0
  buffer_load_dword v8, v2, s[4:7], s47 offen sc1
  s_waitcnt lgkmcnt(4)
  v_mfma_f32_16x16x32_bf16 v[48:51], v[16:19], a[32:35], v[48:51]
  ds_read_b128 v[40:43], v7 offset:5120
  v_mfma_f32_16x16x32_bf16 v[52:55], v[16:19], a[112:115], v[52:55]
  v_mfma_f32_16x16x32_bf16 v[56:59], v[16:19], a[192:195], v[56:59]
  v_mfma_f32_16x16x32_bf16 v[60:63], v[20:23], a[32:35], v[60:63]
  ds_read_b128 v[44:47], v7 offset:25600
  v_mfma_f32_16x16x32_bf16 v[64:67], v[20:23], a[112:115], v[64:67]
  v_mfma_f32_16x16x32_bf16 v[68:71], v[20:23], a[192:195], v[68:71]
  s_waitcnt lgkmcnt(4)
  v_mfma_f32_16x16x32_bf16 v[48:51], v[24:27], a[36:39], v[48:51]
  ds_read_b128 v[16:19], v6 offset:6144
  v_mfma_f32_16x16x32_bf16 v[52:55], v[24:27], a[116:119], v[52:55]
  v_mfma_f32_16x16x32_bf16 v[56:59], v[24:27], a[196:199], v[56:59]
  v_mfma_f32_16x16x32_bf16 v[60:63], v[28:31], a[36:39], v[60:63]
  ds_read_b128 v[20:23], v6 offset:26624
  v_mfma_f32_16x16x32_bf16 v[64:67], v[28:31], a[116:119], v[64:67]
  v_mfma_f32_16x16x32_bf16 v[68:71], v[28:31], a[196:199], v[68:71]
  s_waitcnt lgkmcnt(4)
  v_mfma_f32_16x16x32_bf16 v[48:51], v[32:35], a[40:43], v[48:51]
  ds_read_b128 v[24:27], v7 offset:6144
  v_mfma_f32_16x16x32_bf16 v[52:55], v[32:35], a[120:123], v[52:55]
  v_mfma_f32_16x16x32_bf16 v[56:59], v[32:35], a[200:203], v[56:59]
  v_mfma_f32_16x16x32_bf16 v[60:63], v[36:39], a[40:43], v[60:63]
  ds_read_b128 v[28:31], v7 offset:26624
  v_mfma_f32_16x16x32_bf16 v[64:67], v[36:39], a[120:123], v[64:67]
  v_mfma_f32_16x16x32_bf16 v[68:71], v[36:39], a[200:203], v[68:71]
  s_waitcnt lgkmcnt(4)
  v_mfma_f32_16x16x32_bf16 v[48:51], v[40:43], a[44:47], v[48:51]
  ds_read_b128 v[32:35], v6 offset:7168
  v_mfma_f32_16x16x32_bf16 v[52:55], v[40:43], a[124:127], v[52:55]
  v_mfma_f32_16x16x32_bf16 v[56:59], v[40:43], a[204:207], v[56:59]
  v_mfma_f32_16x16x32_bf16 v[60:63], v[44:47], a[44:47], v[60:63]
  ds_read_b128 v[36:39], v6 offset:27648
  v_mfma_f32_16x16x32_bf16 v[64:67], v[44:47], a[124:127], v[64:67]
  v_mfma_f32_16x16x32_bf16 v[68:71], v[44:47], a[204:207], v[68:71]
  s_waitcnt vmcnt(0)
  v_cmp_eq_u32 vcc, 0, v8
  s_cbranch_vccnz neF_128
  s_cmp_ge_u32 s67, 128
  s_cbranch_scc1 neF_128
  s_mov_b32 s69, 1
  s_sub_u32 s47, 40960, s68
  s_mul_i32 s73, s67, 40960
  s_add_u32 s73, s73, 18874368
  s_add_u32 s74, s47, s72
  s_waitcnt lgkmcnt(4)
  v_mfma_f32_16x16x32_bf16 v[48:51], v[16:19], a[48:51], v[48:51]
  ds_read_b128 v[40:43], v7 offset:7168
  v_mfma_f32_16x16x32_bf16 v[52:55], v[16:19], a[128:131], v[52:55]
  s_mov_b32 m0, s74
  v_mfma_f32_16x16x32_bf16 v[56:59], v[16:19], a[208:211], v[56:59]
  buffer_load_dwordx4 v3, s[4:7], s73 offen offset:0 sc1 lds
  v_mfma_f32_16x16x32_bf16 v[60:63], v[20:23], a[48:51], v[60:63]
  ds_read_b128 v[44:47], v7 offset:27648
  v_mfma_f32_16x16x32_bf16 v[64:67], v[20:23], a[128:131], v[64:67]
  s_add_u32 m0, m0, 896
  v_mfma_f32_16x16x32_bf16 v[68:71], v[20:23], a[208:211], v[68:71]
  buffer_load_dwordx4 v3, s[4:7], s73 offen offset:128 sc1 lds
  s_waitcnt lgkmcnt(4)
  v_mfma_f32_16x16x32_bf16 v[48:51], v[24:27], a[52:55], v[48:51]
  ds_read_b128 v[16:19], v6 offset:8192
  v_mfma_f32_16x16x32_bf16 v[52:55], v[24:27], a[132:135], v[52:55]
  s_add_u32 m0, m0, 896
  v_mfma_f32_16x16x32_bf16 v[56:59], v[24:27], a[212:215], v[56:59]
  buffer_load_dwordx4 v3, s[4:7], s73 offen offset:256 sc1 lds
  v_mfma_f32_16x16x32_bf16 v[60:63], v[28:31], a[52:55], v[60:63]
  ds_read_b128 v[20:23], v6 offset:28672
  v_mfma_f32_16x16x32_bf16 v[64:67], v[28:31], a[132:135], v[64:67]
  s_add_u32 m0, m0, 896
  v_mfma_f32_16x16x32_bf16 v[68:71], v[28:31], a[212:215], v[68:71]
  buffer_load_dwordx4 v3, s[4:7], s73 offen offset:384 sc1 lds
  s_waitcnt lgkmcnt(4)
  v_mfma_f32_16x16x32_bf16 v[48:51], v[32:35], a[56:59], v[48:51]
  ds_read_b128 v[24:27], v7 offset:8192
  v_mfma_f32_16x16x32_bf16 v[52:55], v[32:35], a[136:139], v[52:55]
  s_add_u32 m0, m0, 896
  v_mfma_f32_16x16x32_bf16 v[56:59], v[32:35], a[216:219], v[56:59]
  buffer_load_dwordx4 v3, s[4:7], s73 offen offset:512 sc1 lds
  v_mfma_f32_16x16x32_bf16 v[60:63], v[36:39], a[56:59], v[60:63]
  ds_read_b128 v[28:31], v7 offset:28672
  v_mfma_f32_16x16x32_bf16 v[64:67], v[36:39], a[136:139], v[64:67]
  v_mfma_f32_16x16x32_bf16 v[68:71], v[36:39], a[216:219], v[68:71]
  s_waitcnt lgkmcnt(4)
  v_mfma_f32_16x16x32_bf16 v[48:51], v[40:43], a[60:63], v[48:51]
  ds_read_b128 v[32:35], v6 offset:9216
  v_mfma_f32_16x16x32_bf16 v[52:55], v[40:43], a[140:143], v[52:55]
  s_add_u32 m0, m0, 896
  v_mfma_f32_16x16x32_bf16 v[56:59], v[40:43], a[220:223], v[56:59]
  buffer_load_dwordx4 v3, s[4:7], s73 offen offset:640 sc1 lds
  v_mfma_f32_16x16x32_bf16 v[60:63], v[44:47], a[60:63], v[60:63]
  ds_read_b128 v[36:39], v6 offset:29696
  v_mfma_f32_16x16x32_bf16 v[64:67], v[44:47], a[140:143], v[64:67]
  v_mfma_f32_16x16x32_bf16 v[68:71], v[44:47], a[220:223], v[68:71]
  s_waitcnt lgkmcnt(4)
  v_mfma_f32_16x16x32_bf16 v[48:51], v[16:19], a[64:67], v[48:51]
  ds_read_b128 v[40:43], v7 offset:9216
  v_mfma_f32_16x16x32_bf16 v[52:55], v[16:19], a[144:147], v[52:55]
  s_add_u32 m0, m0, 896
  v_mfma_f32_16x16x32_bf16 v[56:59], v[16:19], a[224:227], v[56:59]
  buffer_load_dwordx4 v3, s[4:7], s73 offen offset:768 sc1 lds
  v_mfma_f32_16x16x32_bf16 v[60:63], v[20:23], a[64:67], v[60:63]
  ds_read_b128 v[44:47], v7 offset:29696
  v_mfma_f32_16x16x32_bf16 v[64:67], v[20:23], a[144:147], v[64:67]
  v_mfma_f32_16x16x32_bf16 v[68:71], v[20:23], a[224:227], v[68:71]
  s_waitcnt lgkmcnt(4)
  v_mfma_f32_16x16x32_bf16 v[48:51], v[24:27], a[68:71], v[48:51]
  v_mfma_f32_16x16x32_bf16 v[52:55], v[24:27], a[148:151], v[52:55]
  s_add_u32 m0, m0, 896
  v_mfma_f32_16x16x32_bf16 v[56:59], v[24:27], a[228:231], v[56:59]
  buffer_load_dwordx4 v3, s[4:7], s73 offen offset:896 sc1 lds
  v_mfma_f32_16x16x32_bf16 v[60:63], v[28:31], a[68:71], v[60:63]
  v_mfma_f32_16x16x32_bf16 v[64:67], v[28:31], a[148:151], v[64:67]
  v_mfma_f32_16x16x32_bf16 v[68:71], v[28:31], a[228:231], v[68:71]
  s_waitcnt lgkmcnt(2)
  v_mfma_f32_16x16x32_bf16 v[48:51], v[32:35], a[72:75], v[48:51]
  v_mfma_f32_16x16x32_bf16 v[52:55], v[32:35], a[152:155], v[52:55]
  s_add_u32 m0, m0, 896
  v_mfma_f32_16x16x32_bf16 v[56:59], v[32:35], a[232:235], v[56:59]
  buffer_load_dwordx4 v3, s[4:7], s73 offen offset:1024 sc1 lds
  v_mfma_f32_16x16x32_bf16 v[60:63], v[36:39], a[72:75], v[60:63]
  v_mfma_f32_16x16x32_bf16 v[64:67], v[36:39], a[152:155], v[64:67]
  v_mfma_f32_16x16x32_bf16 v[68:71], v[36:39], a[232:235], v[68:71]
  s_waitcnt lgkmcnt(0)
  v_mfma_f32_16x16x32_bf16 v[48:51], v[40:43], a[76:79], v[48:51]
  v_mfma_f32_16x16x32_bf16 v[52:55], v[40:43], a[156:159], v[52:55]
  s_add_u32 m0, m0, 896
  v_mfma_f32_16x16x32_bf16 v[56:59], v[40:43], a[236:239], v[56:59]
  buffer_load_dwordx4 v3, s[4:7], s73 offen offset:1152 sc1 lds
  v_mfma_f32_16x16x32_bf16 v[60:63], v[44:47], a[76:79], v[60:63]
  v_mfma_f32_16x16x32_bf16 v[64:67], v[44:47], a[156:159], v[64:67]
  v_mfma_f32_16x16x32_bf16 v[68:71], v[44:47], a[236:239], v[68:71]
  s_branch joinF_127
neF_128:
  s_waitcnt lgkmcnt(4)
  v_mfma_f32_16x16x32_bf16 v[48:51], v[16:19], a[48:51], v[48:51]
  ds_read_b128 v[40:43], v7 offset:7168
  v_mfma_f32_16x16x32_bf16 v[52:55], v[16:19], a[128:131], v[52:55]
  v_mfma_f32_16x16x32_bf16 v[56:59], v[16:19], a[208:211], v[56:59]
  v_mfma_f32_16x16x32_bf16 v[60:63], v[20:23], a[48:51], v[60:63]
  ds_read_b128 v[44:47], v7 offset:27648
  v_mfma_f32_16x16x32_bf16 v[64:67], v[20:23], a[128:131], v[64:67]
  v_mfma_f32_16x16x32_bf16 v[68:71], v[20:23], a[208:211], v[68:71]
  s_waitcnt lgkmcnt(4)
  v_mfma_f32_16x16x32_bf16 v[48:51], v[24:27], a[52:55], v[48:51]
  ds_read_b128 v[16:19], v6 offset:8192
  v_mfma_f32_16x16x32_bf16 v[52:55], v[24:27], a[132:135], v[52:55]
  v_mfma_f32_16x16x32_bf16 v[56:59], v[24:27], a[212:215], v[56:59]
  v_mfma_f32_16x16x32_bf16 v[60:63], v[28:31], a[52:55], v[60:63]
  ds_read_b128 v[20:23], v6 offset:28672
  v_mfma_f32_16x16x32_bf16 v[64:67], v[28:31], a[132:135], v[64:67]
  v_mfma_f32_16x16x32_bf16 v[68:71], v[28:31], a[212:215], v[68:71]
  s_waitcnt lgkmcnt(4)
  v_mfma_f32_16x16x32_bf16 v[48:51], v[32:35], a[56:59], v[48:51]
  ds_read_b128 v[24:27], v7 offset:8192
  v_mfma_f32_16x16x32_bf16 v[52:55], v[32:35], a[136:139], v[52:55]
  v_mfma_f32_16x16x32_bf16 v[56:59], v[32:35], a[216:219], v[56:59]
  v_mfma_f32_16x16x32_bf16 v[60:63], v[36:39], a[56:59], v[60:63]
  ds_read_b128 v[28:31], v7 offset:28672
  v_mfma_f32_16x16x32_bf16 v[64:67], v[36:39], a[136:139], v[64:67]
  v_mfma_f32_16x16x32_bf16 v[68:71], v[36:39], a[216:219], v[68:71]
  s_waitcnt lgkmcnt(4)
  v_mfma_f32_16x16x32_bf16 v[48:51], v[40:43], a[60:63], v[48:51]
  ds_read_b128 v[32:35], v6 offset:9216
  v_mfma_f32_16x16x32_bf16 v[52:55], v[40:43], a[140:143], v[52:55]
  v_mfma_f32_16x16x32_bf16 v[56:59], v[40:43], a[220:223], v[56:59]
  v_mfma_f32_16x16x32_bf16 v[60:63], v[44:47], a[60:63], v[60:63]
  ds_read_b128 v[36:39], v6 offset:29696
  v_mfma_f32_16x16x32_bf16 v[64:67], v[44:47], a[140:143], v[64:67]
  v_mfma_f32_16x16x32_bf16 v[68:71], v[44:47], a[220:223], v[68:71]
  s_waitcnt lgkmcnt(4)
  v_mfma_f32_16x16x32_bf16 v[48:51], v[16:19], a[64:67], v[48:51]
  ds_read_b128 v[40:43], v7 offset:9216
  v_mfma_f32_16x16x32_bf16 v[52:55], v[16:19], a[144:147], v[52:55]
  v_mfma_f32_16x16x32_bf16 v[56:59], v[16:19], a[224:227], v[56:59]
  v_mfma_f32_16x16x32_bf16 v[60:63], v[20:23], a[64:67], v[60:63]
  ds_read_b128 v[44:47], v7 offset:29696
  v_mfma_f32_16x16x32_bf16 v[64:67], v[20:23], a[144:147], v[64:67]
  v_mfma_f32_16x16x32_bf16 v[68:71], v[20:23], a[224:227], v[68:71]
  s_waitcnt lgkmcnt(4)
  v_mfma_f32_16x16x32_bf16 v[48:51], v[24:27], a[68:71], v[48:51]
  v_mfma_f32_16x16x32_bf16 v[52:55], v[24:27], a[148:151], v[52:55]
  v_mfma_f32_16x16x32_bf16 v[56:59], v[24:27], a[228:231], v[56:59]
  v_mfma_f32_16x16x32_bf16 v[60:63], v[28:31], a[68:71], v[60:63]
  v_mfma_f32_16x16x32_bf16 v[64:67], v[28:31], a[148:151], v[64:67]
  v_mfma_f32_16x16x32_bf16 v[68:71], v[28:31], a[228:231], v[68:71]
  s_waitcnt lgkmcnt(2)
  v_mfma_f32_16x16x32_bf16 v[48:51], v[32:35], a[72:75], v[48:51]
  v_mfma_f32_16x16x32_bf16 v[52:55], v[32:35], a[152:155], v[52:55]
  v_mfma_f32_16x16x32_bf16 v[56:59], v[32:35], a[232:235], v[56:59]
  v_mfma_f32_16x16x32_bf16 v[60:63], v[36:39], a[72:75], v[60:63]
  v_mfma_f32_16x16x32_bf16 v[64:67], v[36:39], a[152:155], v[64:67]
  v_mfma_f32_16x16x32_bf16 v[68:71], v[36:39], a[232:235], v[68:71]
  s_waitcnt lgkmcnt(0)
  v_mfma_f32_16x16x32_bf16 v[48:51], v[40:43], a[76:79], v[48:51]
  v_mfma_f32_16x16x32_bf16 v[52:55], v[40:43], a[156:159], v[52:55]
  v_mfma_f32_16x16x32_bf16 v[56:59], v[40:43], a[236:239], v[56:59]
  v_mfma_f32_16x16x32_bf16 v[60:63], v[44:47], a[76:79], v[60:63]
  v_mfma_f32_16x16x32_bf16 v[64:67], v[44:47], a[156:159], v[64:67]
  v_mfma_f32_16x16x32_bf16 v[68:71], v[44:47], a[236:239], v[68:71]
joinF_127:
  s_mul_i32 s73, s66, 393216
  s_add_u32 s73, s73, s70
  s_lshl_b32 s75, s66, 14
  s_add_u32 s75, s75, s71
  s_sub_u32 s68, 40960, s68
  s_nop 1
  v_cvt_pk_bf16_f32 v72, v48, v49
  v_cvt_pk_bf16_f32 v73, v50, v51
  v_cvt_pk_bf16_f32 v74, v60, v61
  v_cvt_pk_bf16_f32 v75, v62, v63
  buffer_store_dwordx4 v[72:75], v1, s[4:7], s73 offen offset:0 sc1
  v_cvt_pk_bf16_f32 v76, v52, v53
  v_cvt_pk_bf16_f32 v77, v54, v55
  v_cvt_pk_bf16_f32 v78, v64, v65
  v_cvt_pk_bf16_f32 v79, v66, v67
  buffer_store_dwordx4 v[76:79], v1, s[4:7], s73 offen offset:1024 sc1
  v_cvt_pk_bf16_f32 v80, v56, v57
  v_cvt_pk_bf16_f32 v81, v58, v59
  v_cvt_pk_bf16_f32 v82, v68, v69
  v_cvt_pk_bf16_f32 v83, v70, v71
  buffer_store_dwordx4 v[80:83], v1, s[4:7], s73 offen offset:2048 sc1
  s_mov_b32 s66, s67
  s_cmp_eq_u32 s69, 1
  s_cbranch_scc1 top3F_122
  s_cmp_ge_u32 s66, 128
  s_cbranch_scc1 endF_125
  s_lshl_b32 s47, s66, 11
  s_add_u32 s47, s47, 0
  buffer_load_dword v8, v2, s[4:7], s47 offen sc1
  v_mov_b32 v9, 1
  s_waitcnt vmcnt(0)
  buffer_store_dword v9, off, s[4:7], s75 sc1
  s_mov_b32 s75, 0x10000000
  s_waitcnt vmcnt(1)
  s_branch fcF_131
fwF_129:
  buffer_load_dword v8, v2, s[4:7], s47 offen sc1
  s_waitcnt vmcnt(0)
fcF_131:
  v_cmp_eq_u32 vcc, 0, v8
  s_cbranch_vccz foF_130
  s_add_u32 s45, s45, 1
  s_cmp_gt_u32 s45, 1048576
  s_cbranch_scc1 failqF_91
  s_sleep 1
  s_branch fwF_129
foF_130:
  s_mul_i32 s73, s66, 40960
  s_add_u32 s73, s73, 18874368
  s_add_u32 s74, s68, s72
  s_mov_b32 m0, s74
  s_nop 0
  buffer_load_dwordx4 v3, s[4:7], s73 offen offset:0 sc1 lds
  s_add_u32 m0, m0, 896
  s_nop 0
  buffer_load_dwordx4 v3, s[4:7], s73 offen offset:128 sc1 lds
  s_add_u32 m0, m0, 896
  s_nop 0
  buffer_load_dwordx4 v3, s[4:7], s73 offen offset:256 sc1 lds
  s_add_u32 m0, m0, 896
  s_nop 0
  buffer_load_dwordx4 v3, s[4:7], s73 offen offset:384 sc1 lds
  s_add_u32 m0, m0, 896
  s_nop 0
  buffer_load_dwordx4 v3, s[4:7], s73 offen offset:512 sc1 lds
  s_add_u32 m0, m0, 896
  s_nop 0
  buffer_load_dwordx4 v3, s[4:7], s73 offen offset:640 sc1 lds
  s_add_u32 m0, m0, 896
  s_nop 0
  buffer_load_dwordx4 v3, s[4:7], s73 offen offset:768 sc1 lds
  s_add_u32 m0, m0, 896
  s_nop 0
  buffer_load_dwordx4 v3, s[4:7], s73 offen offset:896 sc1 lds
  s_add_u32 m0, m0, 896
  s_nop 0
  buffer_load_dwordx4 v3, s[4:7], s73 offen offset:1024 sc1 lds
  s_add_u32 m0, m0, 896
  s_nop 0
  buffer_load_dwordx4 v3, s[4:7], s73 offen offset:1152 sc1 lds
  s_branch topF_121
endF_125:
  v_mov_b32 v8, 1
  s_waitcnt vmcnt(0)
  buffer_store_dword v8, off, s[4:7], s75 sc1
  s_endpgm
failqF_91:
  s_mov_b64 exec, 1
  v_mov_b32 v150, 224
  v_mov_b32 v151, 8
  buffer_atomic_or v151, v150, s[8:11], 0 offen sc1
  s_endpgm
L_SAFE:
  s_waitcnt vmcnt(0) lgkmcnt(0)
  s_barrier
  s_cmp_eq_u32 s3, 0
  s_cbranch_scc0 L_s1
  v_mov_b32 v2, 0
  v_mov_b32 v3, s44
  ds_write_b32 v2, v3
  s_waitcnt lgkmcnt(0)
L_s1:
  s_barrier
  v_mov_b32 v2, 0
  ds_read_b32 v3, v2
  s_waitcnt lgkmcnt(0)
  s_nop 0
  v_readfirstlane_b32 s44, v3
  s_barrier
  s_lshr_b32 s42, s44, 5
  s_and_b32 s42, s42, 7
  s_and_b32 s43, s44, 31
  s_mov_b32 s12, s16
  s_and_b32 s13, s17, 0xffff
  s_mov_b32 s14, 2621440
  s_mov_b32 s15, 0x20000
  s_cmp_lt_u32 s42, 2
  s_cbranch_scc0 nxS_1
  s_getpc_b64 s[46:47]
LJchainS:
  s_add_u32 s46, s46, R_chainS-LJchainS
  s_addc_u32 s47, s47, 0
  s_setpc_b64 s[46:47]
nxS_1:
  s_cmp_lt_u32 s42, 4
  s_cbranch_scc0 nxS_2
  s_getpc_b64 s[46:47]
LJattS:
  s_add_u32 s46, s46, R_attS-LJattS
  s_addc_u32 s47, s47, 0
  s_setpc_b64 s[46:47]
nxS_2:
  s_cmp_lt_u32 s42, 5
  s_cbranch_scc0 nxS_3
  s_getpc_b64 s[46:47]
LJffnS:
  s_add_u32 s46, s46, R_ffnS-LJffnS
  s_addc_u32 s47, s47, 0
  s_setpc_b64 s[46:47]
nxS_3:
  s_cmp_lt_u32 s42, 8
  s_cbranch_scc0 nxS_4
  s_getpc_b64 s[46:47]
LJqkvS:
  s_add_u32 s46, s46, R_qkvS-LJqkvS
  s_addc_u32 s47, s47, 0
  s_setpc_b64 s[46:47]
nxS_4:
  s_endpgm
  .p2align 6
R_chainS:
  s_lshr_b32 s52, s43, 1
  s_lshl_b32 s46, s42, 4
  s_add_u32 s52, s52, s46
  s_and_b32 s53, s43, 1
  s_lshl_b32 s54, s42, 5
  s_add_u32 s54, s54, s43
  v_add_u32 v40, 0, v0
  v_mul_u32_u24 v41, 43691, v40
  v_lshrrev_b32 v41, 20, v41
  v_mul_u32_u24 v42, 24, v41
  v_sub_u32 v40, v40, v42
  v_lshlrev_b32 v40, 4, v40
  v_mul_u32_u24 v41, 12288, v41
  v_add_u32 v16, v40, v41
  v_add_u32 v40, 64, v0
  v_mul_u32_u24 v41, 43691, v40
  v_lshrrev_b32 v41, 20, v41
  v_mul_u32_u24 v42, 24, v41
  v_sub_u32 v40, v40, v42
  v_lshlrev_b32 v40, 4, v40
  v_mul_u32_u24 v41, 12288, v41
  v_add_u32 v17, v40, v41
  v_add_u32 v40, 128, v0
  v_mul_u32_u24 v41, 43691, v40
  v_lshrrev_b32 v41, 20, v41
  v_mul_u32_u24 v42, 24, v41
  v_sub_u32 v40, v40, v42
  v_lshlrev_b32 v40, 4, v40
  v_mul_u32_u24 v41, 12288, v41
  v_add_u32 v18, v40, v41
  s_mul_i32 s46, s3, 98304
  v_add_u32 v16, s46, v16
  v_add_u32 v17, s46, v17
  v_add_u32 v18, s46, v18
  s_mul_i32 s46, s53, 3932160
  s_mul_i32 s47, s52, 384
  s_add_u32 s46, s46, s47
  v_add_u32 v16, s46, v16
  v_add_u32 v17, s46, v17
  v_add_u32 v18, s46, v18
  v_add_u32 v40, 0, v0
  v_mul_u32_u24 v41, 26215, v40
  v_lshrrev_b32 v41, 20, v41
  v_mul_u32_u24 v42, 40, v41
  v_sub_u32 v40, v40, v42
  v_lshlrev_b32 v40, 4, v40
  v_mul_u32_u24 v41, 1280, v41
  v_add_u32 v20, v40, v41
  v_add_u32 v40, 64, v0
  v_mul_u32_u24 v41, 26215, v40
  v_lshrrev_b32 v41, 20, v41
  v_mul_u32_u24 v42, 40, v41
  v_sub_u32 v40, v40, v42
  v_lshlrev_b32 v40, 4, v40
  v_mul_u32_u24 v41, 1280, v41
  v_add_u32 v21, v40, v41
  v_add_u32 v40, 128, v0
  v_mul_u32_u24 v41, 26215, v40
  v_lshrrev_b32 v41, 20, v41
  v_mul_u32_u24 v42, 40, v41
  v_sub_u32 v40, v40, v42
  v_lshlrev_b32 v40, 4, v40
  v_mul_u32_u24 v41, 1280, v41
  v_add_u32 v22, v40, v41
  v_add_u32 v40, 192, v0
  v_mul_u32_u24 v41, 26215, v40
  v_lshrrev_b32 v41, 20, v41
  v_mul_u32_u24 v42, 40, v41
  v_sub_u32 v40, v40, v42
  v_lshlrev_b32 v40, 4, v40
  v_mul_u32_u24 v41, 1280, v41
  v_add_u32 v23, v40, v41
  v_add_u32 v40, 256, v0
  v_mul_u32_u24 v41, 26215, v40
  v_lshrrev_b32 v41, 20, v41
  v_mul_u32_u24 v42, 40, v41
  v_sub_u32 v40, v40, v42
  v_lshlrev_b32 v40, 4, v40
  v_mul_u32_u24 v41, 1280, v41
  v_add_u32 v24, v40, v41
  s_mul_i32 s46, s3, 10240
  v_add_u32 v20, s46, v20
  v_add_u32 v21, s46, v21
  v_add_u32 v22, s46, v22
  v_add_u32 v23, s46, v23
  v_add_u32 v24, s46, v24
  s_mul_i32 s46, s52, 245760
  s_mul_i32 s47, s53, 640
  s_add_u32 s46, s46, s47
  v_add_u32 v20, s46, v20
  v_add_u32 v21, s46, v21
  v_add_u32 v22, s46, v22
  v_add_u32 v23, s46, v23
  v_add_u32 v24, s46, v24
  v_lshrrev_b32 v40, 4, v0
  v_mul_u32_u24 v40, 8, v40
  v_bfe_u32 v41, v0, 2, 2
  v_add_u32 v40, v40, v41
  v_mul_u32_u24 v40, 384, v40
  v_and_b32 v41, 3, v0
  v_mul_u32_u24 v41, 8, v41
  v_add_u32 v26, v40, v41
  s_mul_i32 s46, s3, 96
  v_add_u32 v26, s46, v26
  v_add_u32 v27, 0x10000, v26
  v_add_u32 v28, 0x20000, v26
  v_lshrrev_b32 v40, 4, v0
  v_mul_u32_u24 v40, 4, v40
  v_bfe_u32 v41, v0, 2, 2
  v_add_u32 v40, v40, v41
  v_mul_u32_u24 v40, 640, v40
  v_and_b32 v41, 3, v0
  v_mul_u32_u24 v41, 16, v41
  v_add_u32 v29, v40, v41
  s_lshl_b32 s46, s3, 7
  v_add_u32 v29, s46, v29
  v_add_u32 v30, 0x10000, v29
  v_add_u32 v31, 0x20000, v29
  v_lshrrev_b32 v40, 4, v0
  v_mul_u32_u24 v40, 4, v40
  v_bfe_u32 v41, v0, 2, 2
  v_add_u32 v40, v40, v41
  v_mul_u32_u24 v40, 640, v40
  v_and_b32 v41, 3, v0
  v_mul_u32_u24 v41, 8, v41
  v_add_u32 v32, v40, v41
  s_lshl_b32 s46, s3, 5
  s_add_u32 s46, s46, 512
  v_add_u32 v32, s46, v32
  v_add_u32 v33, 0x10000, v32
  v_add_u32 v34, 0x20000, v32
  s_mul_i32 s55, s3, 3072
  s_mul_i32 s56, s3, 5120
  s_lshr_b32 s57, s3, 1
  s_mul_i32 s57, s57, 40960
  s_mov_b32 s60, s20
  s_and_b32 s61, s21, 0xffff
  s_mov_b32 s62, 7864320
  s_mov_b32 s63, 0x20000
  s_mov_b32 s64, s22
  s_and_b32 s65, s23, 0xffff
  s_mov_b32 s66, 7864320
  s_mov_b32 s67, 0x20000
  s_mov_b32 s68, s24
  s_and_b32 s69, s25, 0xffff
  s_mov_b32 s70, 7864320
  s_mov_b32 s71, 0x20000
  s_mov_b32 s72, s26
  s_and_b32 s73, s27, 0xffff
  s_mov_b32 s74, 7864320
  s_mov_b32 s75, 0x20000
  s_mov_b32 s46, 0
  s_add_u32 m0, s55, 0
  s_nop 0
  buffer_load_dwordx4 v16, s[60:63], s46 offen lds
  s_mov_b32 s46, 0
  s_add_u32 m0, s55, 1024
  s_nop 0
  buffer_load_dwordx4 v17, s[60:63], s46 offen lds
  s_mov_b32 s46, 0
  s_add_u32 m0, s55, 2048
  s_nop 0
  buffer_load_dwordx4 v18, s[60:63], s46 offen lds
  s_mov_b32 s46, 393216
  s_add_u32 m0, s55, 12288
  s_nop 0
  buffer_load_dwordx4 v16, s[60:63], s46 offen lds
  s_mov_b32 s46, 393216
  s_add_u32 m0, s55, 13312
  s_nop 0
  buffer_load_dwordx4 v17, s[60:63], s46 offen lds
  s_mov_b32 s46, 393216
  s_add_u32 m0, s55, 14336
  s_nop 0
  buffer_load_dwordx4 v18, s[60:63], s46 offen lds
  s_mov_b32 s46, 786432
  s_add_u32 m0, s55, 24576
  s_nop 0
  buffer_load_dwordx4 v16, s[60:63], s46 offen lds
  s_mov_b32 s46, 786432
  s_add_u32 m0, s55, 25600
  s_nop 0
  buffer_load_dwordx4 v17, s[60:63], s46 offen lds
  s_mov_b32 s46, 786432
  s_add_u32 m0, s55, 26624
  s_nop 0
  buffer_load_dwordx4 v18, s[60:63], s46 offen lds
  s_mov_b32 s46, 1179648
  s_add_u32 m0, s55, 36864
  s_nop 0
  buffer_load_dwordx4 v16, s[60:63], s46 offen lds
  s_mov_b32 s46, 1179648
  s_add_u32 m0, s55, 37888
  s_nop 0
  buffer_load_dwordx4 v17, s[60:63], s46 offen lds
  s_mov_b32 s46, 1179648
  s_add_u32 m0, s55, 38912
  s_nop 0
  buffer_load_dwordx4 v18, s[60:63], s46 offen lds
  s_mov_b32 s46, 1572864
  s_add_u32 m0, s55, 49152
  s_nop 0
  buffer_load_dwordx4 v16, s[60:63], s46 offen lds
  s_mov_b32 s46, 1572864
  s_add_u32 m0, s55, 50176
  s_nop 0
  buffer_load_dwordx4 v17, s[60:63], s46 offen lds
  s_mov_b32 s46, 1572864
  s_add_u32 m0, s55, 51200
  s_nop 0
  buffer_load_dwordx4 v18, s[60:63], s46 offen lds
  s_mov_b32 s46, 1966080
  s_add_u32 m0, s55, 61440
  s_nop 0
  buffer_load_dwordx4 v16, s[60:63], s46 offen lds
  s_mov_b32 s46, 1966080
  s_add_u32 m0, s55, 62464
  s_nop 0
  buffer_load_dwordx4 v17, s[60:63], s46 offen lds
  s_mov_b32 s46, 1966080
  s_add_u32 m0, s55, 63488
  s_nop 0
  buffer_load_dwordx4 v18, s[60:63], s46 offen lds
  s_mov_b32 s46, 2359296
  s_add_u32 m0, s55, 73728
  s_nop 0
  buffer_load_dwordx4 v16, s[60:63], s46 offen lds
  s_mov_b32 s46, 2359296
  s_add_u32 m0, s55, 74752
  s_nop 0
  buffer_load_dwordx4 v17, s[60:63], s46 offen lds
  s_mov_b32 s46, 2359296
  s_add_u32 m0, s55, 75776
  s_nop 0
  buffer_load_dwordx4 v18, s[60:63], s46 offen lds
  s_mov_b32 s46, 2752512
  s_add_u32 m0, s55, 86016
  s_nop 0
  buffer_load_dwordx4 v16, s[60:63], s46 offen lds
  s_mov_b32 s46, 2752512
  s_add_u32 m0, s55, 87040
  s_nop 0
  buffer_load_dwordx4 v17, s[60:63], s46 offen lds
  s_mov_b32 s46, 2752512
  s_add_u32 m0, s55, 88064
  s_nop 0
  buffer_load_dwordx4 v18, s[60:63], s46 offen lds
  s_mov_b32 s46, 3145728
  s_add_u32 m0, s55, 98304
  s_nop 0
  buffer_load_dwordx4 v16, s[60:63], s46 offen lds
  s_mov_b32 s46, 3145728
  s_add_u32 m0, s55, 99328
  s_nop 0
  buffer_load_dwordx4 v17, s[60:63], s46 offen lds
  s_mov_b32 s46, 3145728
  s_add_u32 m0, s55, 100352
  s_nop 0
  buffer_load_dwordx4 v18, s[60:63], s46 offen lds
  s_mov_b32 s46, 3538944
  s_add_u32 m0, s55, 110592
  s_nop 0
  buffer_load_dwordx4 v16, s[60:63], s46 offen lds
  s_mov_b32 s46, 3538944
  s_add_u32 m0, s55, 111616
  s_nop 0
  buffer_load_dwordx4 v17, s[60:63], s46 offen lds
  s_mov_b32 s46, 3538944
  s_add_u32 m0, s55, 112640
  s_nop 0
  buffer_load_dwordx4 v18, s[60:63], s46 offen lds
  s_mov_b32 s46, 0
  s_add_u32 m0, s55, 122880
  s_nop 0
  buffer_load_dwordx4 v16, s[64:67], s46 offen lds
  s_mov_b32 s46, 0
  s_add_u32 m0, s55, 123904
  s_nop 0
  buffer_load_dwordx4 v17, s[64:67], s46 offen lds
  s_mov_b32 s46, 0
  s_add_u32 m0, s55, 124928
  s_nop 0
  buffer_load_dwordx4 v18, s[64:67], s46 offen lds
  s_mov_b32 s46, 393216
  s_add_u32 m0, s55, 135168
  s_nop 0
  buffer_load_dwordx4 v16, s[64:67], s46 offen lds
  s_mov_b32 s46, 393216
  s_add_u32 m0, s55, 136192
  s_nop 0
  buffer_load_dwordx4 v17, s[64:67], s46 offen lds
  s_mov_b32 s46, 393216
  s_add_u32 m0, s55, 137216
  s_nop 0
  buffer_load_dwordx4 v18, s[64:67], s46 offen lds
  s_mov_b32 s46, 786432
  s_add_u32 m0, s55, 147456
  s_nop 0
  buffer_load_dwordx4 v16, s[64:67], s46 offen lds
  s_mov_b32 s46, 786432
  s_add_u32 m0, s55, 148480
  s_nop 0
  buffer_load_dwordx4 v17, s[64:67], s46 offen lds
  s_mov_b32 s46, 786432
  s_add_u32 m0, s55, 149504
  s_nop 0
  buffer_load_dwordx4 v18, s[64:67], s46 offen lds
  s_waitcnt vmcnt(36)
  s_barrier
  ds_read_b64_tr_b16 a[0:1], v26 offset:0
  ds_read_b64_tr_b16 a[2:3], v26 offset:1536
  ds_read_b64_tr_b16 a[40:41], v26 offset:32
  ds_read_b64_tr_b16 a[42:43], v26 offset:1568
  ds_read_b64_tr_b16 a[80:81], v26 offset:64
  ds_read_b64_tr_b16 a[82:83], v26 offset:1600
  s_waitcnt lgkmcnt(0)
  s_waitcnt vmcnt(33)
  s_barrier
  s_mov_b32 s46, 1179648
  s_add_u32 m0, s55, 0
  s_nop 0
  buffer_load_dwordx4 v16, s[64:67], s46 offen lds
  s_mov_b32 s46, 1179648
  s_add_u32 m0, s55, 1024
  s_nop 0
  buffer_load_dwordx4 v17, s[64:67], s46 offen lds
  s_mov_b32 s46, 1179648
  s_add_u32 m0, s55, 2048
  s_nop 0
  buffer_load_dwordx4 v18, s[64:67], s46 offen lds
  ds_read_b64_tr_b16 a[4:5], v26 offset:12288
  ds_read_b64_tr_b16 a[6:7], v26 offset:13824
  ds_read_b64_tr_b16 a[44:45], v26 offset:12320
  ds_read_b64_tr_b16 a[46:47], v26 offset:13856
  ds_read_b64_tr_b16 a[84:85], v26 offset:12352
  ds_read_b64_tr_b16 a[86:87], v26 offset:13888
  s_waitcnt lgkmcnt(0)
  s_waitcnt vmcnt(33)
  s_barrier
  s_mov_b32 s46, 1572864
  s_add_u32 m0, s55, 12288
  s_nop 0
  buffer_load_dwordx4 v16, s[64:67], s46 offen lds
  s_mov_b32 s46, 1572864
  s_add_u32 m0, s55, 13312
  s_nop 0
  buffer_load_dwordx4 v17, s[64:67], s46 offen lds
  s_mov_b32 s46, 1572864
  s_add_u32 m0, s55, 14336
  s_nop 0
  buffer_load_dwordx4 v18, s[64:67], s46 offen lds
  ds_read_b64_tr_b16 a[8:9], v26 offset:24576
  ds_read_b64_tr_b16 a[10:11], v26 offset:26112
  ds_read_b64_tr_b16 a[48:49], v26 offset:24608
  ds_read_b64_tr_b16 a[50:51], v26 offset:26144
  ds_read_b64_tr_b16 a[88:89], v26 offset:24640
  ds_read_b64_tr_b16 a[90:91], v26 offset:26176
  s_waitcnt lgkmcnt(0)
  s_waitcnt vmcnt(33)
  s_barrier
  s_mov_b32 s46, 1966080
  s_add_u32 m0, s55, 24576
  s_nop 0
  buffer_load_dwordx4 v16, s[64:67], s46 offen lds
  s_mov_b32 s46, 1966080
  s_add_u32 m0, s55, 25600
  s_nop 0
  buffer_load_dwordx4 v17, s[64:67], s46 offen lds
  s_mov_b32 s46, 1966080
  s_add_u32 m0, s55, 26624
  s_nop 0
  buffer_load_dwordx4 v18, s[64:67], s46 offen lds
  ds_read_b64_tr_b16 a[12:13], v26 offset:36864
  ds_read_b64_tr_b16 a[14:15], v26 offset:38400
  ds_read_b64_tr_b16 a[52:53], v26 offset:36896
  ds_read_b64_tr_b16 a[54:55], v26 offset:38432
  ds_read_b64_tr_b16 a[92:93], v26 offset:36928
  ds_read_b64_tr_b16 a[94:95], v26 offset:38464
  s_waitcnt lgkmcnt(0)
  s_waitcnt vmcnt(33)
  s_barrier
  s_mov_b32 s46, 2359296
  s_add_u32 m0, s55, 36864
  s_nop 0
  buffer_load_dwordx4 v16, s[64:67], s46 offen lds
  s_mov_b32 s46, 2359296
  s_add_u32 m0, s55, 37888
  s_nop 0
  buffer_load_dwordx4 v17, s[64:67], s46 offen lds
  s_mov_b32 s46, 2359296
  s_add_u32 m0, s55, 38912
  s_nop 0
  buffer_load_dwordx4 v18, s[64:67], s46 offen lds
  ds_read_b64_tr_b16 a[16:17], v26 offset:49152
  ds_read_b64_tr_b16 a[18:19], v26 offset:50688
  ds_read_b64_tr_b16 a[56:57], v26 offset:49184
  ds_read_b64_tr_b16 a[58:59], v26 offset:50720
  ds_read_b64_tr_b16 a[96:97], v26 offset:49216
  ds_read_b64_tr_b16 a[98:99], v26 offset:50752
  s_waitcnt lgkmcnt(0)
  s_waitcnt vmcnt(33)
  s_barrier
  s_mov_b32 s46, 2752512
  s_add_u32 m0, s55, 49152
  s_nop 0
  buffer_load_dwordx4 v16, s[64:67], s46 offen lds
  s_mov_b32 s46, 2752512
  s_add_u32 m0, s55, 50176
  s_nop 0
  buffer_load_dwordx4 v17, s[64:67], s46 offen lds
  s_mov_b32 s46, 2752512
  s_add_u32 m0, s55, 51200
  s_nop 0
  buffer_load_dwordx4 v18, s[64:67], s46 offen lds
  ds_read_b64_tr_b16 a[20:21], v26 offset:61440
  ds_read_b64_tr_b16 a[22:23], v26 offset:62976
  ds_read_b64_tr_b16 a[60:61], v26 offset:61472
  ds_read_b64_tr_b16 a[62:63], v26 offset:63008
  ds_read_b64_tr_b16 a[100:101], v26 offset:61504
  ds_read_b64_tr_b16 a[102:103], v26 offset:63040
  s_waitcnt lgkmcnt(0)
  s_waitcnt vmcnt(33)
  s_barrier
  s_mov_b32 s46, 3145728
  s_add_u32 m0, s55, 61440
  s_nop 0
  buffer_load_dwordx4 v16, s[64:67], s46 offen lds
  s_mov_b32 s46, 3145728
  s_add_u32 m0, s55, 62464
  s_nop 0
  buffer_load_dwordx4 v17, s[64:67], s46 offen lds
  s_mov_b32 s46, 3145728
  s_add_u32 m0, s55, 63488
  s_nop 0
  buffer_load_dwordx4 v18, s[64:67], s46 offen lds
  ds_read_b64_tr_b16 a[24:25], v27 offset:8192
  ds_read_b64_tr_b16 a[26:27], v27 offset:9728
  ds_read_b64_tr_b16 a[64:65], v27 offset:8224
  ds_read_b64_tr_b16 a[66:67], v27 offset:9760
  ds_read_b64_tr_b16 a[104:105], v27 offset:8256
  ds_read_b64_tr_b16 a[106:107], v27 offset:9792
  s_waitcnt lgkmcnt(0)
  s_waitcnt vmcnt(33)
  s_barrier
  s_mov_b32 s46, 3538944
  s_add_u32 m0, s55, 73728
  s_nop 0
  buffer_load_dwordx4 v16, s[64:67], s46 offen lds
  s_mov_b32 s46, 3538944
  s_add_u32 m0, s55, 74752
  s_nop 0
  buffer_load_dwordx4 v17, s[64:67], s46 offen lds
  s_mov_b32 s46, 3538944
  s_add_u32 m0, s55, 75776
  s_nop 0
  buffer_load_dwordx4 v18, s[64:67], s46 offen lds
  ds_read_b64_tr_b16 a[28:29], v27 offset:20480
  ds_read_b64_tr_b16 a[30:31], v27 offset:22016
  ds_read_b64_tr_b16 a[68:69], v27 offset:20512
  ds_read_b64_tr_b16 a[70:71], v27 offset:22048
  ds_read_b64_tr_b16 a[108:109], v27 offset:20544
  ds_read_b64_tr_b16 a[110:111], v27 offset:22080
  s_waitcnt lgkmcnt(0)
  s_waitcnt vmcnt(33)
  s_barrier
  ds_read_b64_tr_b16 a[32:33], v27 offset:32768
  ds_read_b64_tr_b16 a[34:35], v27 offset:34304
  ds_read_b64_tr_b16 a[72:73], v27 offset:32800
  ds_read_b64_tr_b16 a[74:75], v27 offset:34336
  ds_read_b64_tr_b16 a[112:113], v27 offset:32832
  ds_read_b64_tr_b16 a[114:115], v27 offset:34368
  s_waitcnt lgkmcnt(0)
  s_waitcnt vmcnt(30)
  s_barrier
  s_mov_b32 s46, 0
  s_add_u32 m0, s56, 86016
  s_nop 0
  buffer_load_dwordx4 v20, s[72:75], s46 offen lds
  s_mov_b32 s46, 0
  s_add_u32 m0, s56, 87040
  s_nop 0
  buffer_load_dwordx4 v21, s[72:75], s46 offen lds
  s_mov_b32 s46, 0
  s_add_u32 m0, s56, 88064
  s_nop 0
  buffer_load_dwordx4 v22, s[72:75], s46 offen lds
  s_mov_b32 s46, 0
  s_add_u32 m0, s56, 89088
  s_nop 0
  buffer_load_dwordx4 v23, s[72:75], s46 offen lds
  s_mov_b32 s46, 0
  s_add_u32 m0, s56, 90112
  s_nop 0
  buffer_load_dwordx4 v24, s[72:75], s46 offen lds
  ds_read_b64_tr_b16 a[36:37], v27 offset:45056
  ds_read_b64_tr_b16 a[38:39], v27 offset:46592
  ds_read_b64_tr_b16 a[76:77], v27 offset:45088
  ds_read_b64_tr_b16 a[78:79], v27 offset:46624
  ds_read_b64_tr_b16 a[116:117], v27 offset:45120
  ds_read_b64_tr_b16 a[118:119], v27 offset:46656
  s_waitcnt lgkmcnt(0)
  s_waitcnt vmcnt(32)
  s_barrier
  ds_read_b64_tr_b16 a[120:121], v27 offset:57344
  ds_read_b64_tr_b16 a[122:123], v27 offset:58880
  ds_read_b64_tr_b16 a[160:161], v27 offset:57376
  ds_read_b64_tr_b16 a[162:163], v27 offset:58912
  ds_read_b64_tr_b16 a[200:201], v27 offset:57408
  ds_read_b64_tr_b16 a[202:203], v27 offset:58944
  s_waitcnt lgkmcnt(0)
  s_waitcnt vmcnt(29)
  s_barrier
  s_mov_b32 s46, 61440
  s_add_u32 m0, s56, 106496
  s_nop 0
  buffer_load_dwordx4 v20, s[72:75], s46 offen lds
  s_mov_b32 s46, 61440
  s_add_u32 m0, s56, 107520
  s_nop 0
  buffer_load_dwordx4 v21, s[72:75], s46 offen lds
  s_mov_b32 s46, 61440
  s_add_u32 m0, s56, 108544
  s_nop 0
  buffer_load_dwordx4 v22, s[72:75], s46 offen lds
  s_mov_b32 s46, 61440
  s_add_u32 m0, s56, 109568
  s_nop 0
  buffer_load_dwordx4 v23, s[72:75], s46 offen lds
  s_mov_b32 s46, 61440
  s_add_u32 m0, s56, 110592
  s_nop 0
  buffer_load_dwordx4 v24, s[72:75], s46 offen lds
  ds_read_b64_tr_b16 a[124:125], v28 offset:4096
  ds_read_b64_tr_b16 a[126:127], v28 offset:5632
  ds_read_b64_tr_b16 a[164:165], v28 offset:4128
  ds_read_b64_tr_b16 a[166:167], v28 offset:5664
  ds_read_b64_tr_b16 a[204:205], v28 offset:4160
  ds_read_b64_tr_b16 a[206:207], v28 offset:5696
  s_waitcnt lgkmcnt(0)
  s_waitcnt vmcnt(31)
  s_barrier
  s_mov_b32 s46, 122880
  s_add_u32 m0, s56, 126976
  s_nop 0
  buffer_load_dwordx4 v20, s[72:75], s46 offen lds
  s_mov_b32 s46, 122880
  s_add_u32 m0, s56, 128000
  s_nop 0
  buffer_load_dwordx4 v21, s[72:75], s46 offen lds
  s_mov_b32 s46, 122880
  s_add_u32 m0, s56, 129024
  s_nop 0
  buffer_load_dwordx4 v22, s[72:75], s46 offen lds
  s_mov_b32 s46, 122880
  s_add_u32 m0, s56, 130048
  s_nop 0
  buffer_load_dwordx4 v23, s[72:75], s46 offen lds
  s_mov_b32 s46, 122880
  s_add_u32 m0, s56, 131072
  s_nop 0
  buffer_load_dwordx4 v24, s[72:75], s46 offen lds
  ds_read_b64_tr_b16 a[128:129], v28 offset:16384
  ds_read_b64_tr_b16 a[130:131], v28 offset:17920
  ds_read_b64_tr_b16 a[168:169], v28 offset:16416
  ds_read_b64_tr_b16 a[170:171], v28 offset:17952
  ds_read_b64_tr_b16 a[208:209], v28 offset:16448
  ds_read_b64_tr_b16 a[210:211], v28 offset:17984
  s_waitcnt lgkmcnt(0)
  s_waitcnt vmcnt(33)
  s_barrier
  ds_read_b64_tr_b16 a[132:133], v26 offset:0
  ds_read_b64_tr_b16 a[134:135], v26 offset:1536
  ds_read_b64_tr_b16 a[172:173], v26 offset:32
  ds_read_b64_tr_b16 a[174:175], v26 offset:1568
  ds_read_b64_tr_b16 a[212:213], v26 offset:64
  ds_read_b64_tr_b16 a[214:215], v26 offset:1600
  s_waitcnt lgkmcnt(0)
  s_waitcnt vmcnt(30)
  s_barrier
  ds_read_b64_tr_b16 a[136:137], v26 offset:12288
  ds_read_b64_tr_b16 a[138:139], v26 offset:13824
  ds_read_b64_tr_b16 a[176:177], v26 offset:12320
  ds_read_b64_tr_b16 a[178:179], v26 offset:13856
  ds_read_b64_tr_b16 a[216:217], v26 offset:12352
  ds_read_b64_tr_b16 a[218:219], v26 offset:13888
  s_waitcnt lgkmcnt(0)
  s_waitcnt vmcnt(27)
  s_barrier
  s_mov_b32 s46, 184320
  s_add_u32 m0, s56, 0
  s_nop 0
  buffer_load_dwordx4 v20, s[72:75], s46 offen lds
  s_mov_b32 s46, 184320
  s_add_u32 m0, s56, 1024
  s_nop 0
  buffer_load_dwordx4 v21, s[72:75], s46 offen lds
  s_mov_b32 s46, 184320
  s_add_u32 m0, s56, 2048
  s_nop 0
  buffer_load_dwordx4 v22, s[72:75], s46 offen lds
  s_mov_b32 s46, 184320
  s_add_u32 m0, s56, 3072
  s_nop 0
  buffer_load_dwordx4 v23, s[72:75], s46 offen lds
  s_mov_b32 s46, 184320
  s_add_u32 m0, s56, 4096
  s_nop 0
  buffer_load_dwordx4 v24, s[72:75], s46 offen lds
  ds_read_b64_tr_b16 a[140:141], v26 offset:24576
  ds_read_b64_tr_b16 a[142:143], v26 offset:26112
  ds_read_b64_tr_b16 a[180:181], v26 offset:24608
  ds_read_b64_tr_b16 a[182:183], v26 offset:26144
  ds_read_b64_tr_b16 a[220:221], v26 offset:24640
  ds_read_b64_tr_b16 a[222:223], v26 offset:26176
  s_waitcnt lgkmcnt(0)
  s_waitcnt vmcnt(29)
  s_barrier
  ds_read_b64_tr_b16 a[144:145], v26 offset:36864
  ds_read_b64_tr_b16 a[146:147], v26 offset:38400
  ds_read_b64_tr_b16 a[184:185], v26 offset:36896
  ds_read_b64_tr_b16 a[186:187], v26 offset:38432
  ds_read_b64_tr_b16 a[224:225], v26 offset:36928
  ds_read_b64_tr_b16 a[226:227], v26 offset:38464
  s_waitcnt lgkmcnt(0)
  s_waitcnt vmcnt(26)
  s_barrier
  s_add_u32 s46, s57, 40960
  s_add_u32 m0, s56, 20480
  s_nop 0
  buffer_load_dwordx4 v20, s[72:75], s46 offen lds
  s_add_u32 s46, s57, 40960
  s_add_u32 m0, s56, 21504
  s_nop 0
  buffer_load_dwordx4 v21, s[72:75], s46 offen lds
  s_add_u32 s46, s57, 40960
  s_add_u32 m0, s56, 22528
  s_nop 0
  buffer_load_dwordx4 v22, s[72:75], s46 offen lds
  s_add_u32 s46, s57, 40960
  s_add_u32 m0, s56, 23552
  s_nop 0
  buffer_load_dwordx4 v23, s[72:75], s46 offen lds
  s_add_u32 s46, s57, 40960
  s_add_u32 m0, s56, 24576
  s_nop 0
  buffer_load_dwordx4 v24, s[72:75], s46 offen lds
  ds_read_b64_tr_b16 a[148:149], v26 offset:49152
  ds_read_b64_tr_b16 a[150:151], v26 offset:50688
  ds_read_b64_tr_b16 a[188:189], v26 offset:49184
  ds_read_b64_tr_b16 a[190:191], v26 offset:50720
  ds_read_b64_tr_b16 a[228:229], v26 offset:49216
  ds_read_b64_tr_b16 a[230:231], v26 offset:50752
  s_waitcnt lgkmcnt(0)
  s_waitcnt vmcnt(28)
  s_barrier
  s_add_u32 s46, s57, 163840
  s_add_u32 m0, s56, 40960
  s_nop 0
  buffer_load_dwordx4 v20, s[72:75], s46 offen lds
  s_add_u32 s46, s57, 163840
  s_add_u32 m0, s56, 41984
  s_nop 0
  buffer_load_dwordx4 v21, s[72:75], s46 offen lds
  s_add_u32 s46, s57, 163840
  s_add_u32 m0, s56, 43008
  s_nop 0
  buffer_load_dwordx4 v22, s[72:75], s46 offen lds
  s_add_u32 s46, s57, 163840
  s_add_u32 m0, s56, 44032
  s_nop 0
  buffer_load_dwordx4 v23, s[72:75], s46 offen lds
  s_add_u32 s46, s57, 163840
  s_add_u32 m0, s56, 45056
  s_nop 0
  buffer_load_dwordx4 v24, s[72:75], s46 offen lds
  ds_read_b64_tr_b16 a[152:153], v26 offset:61440
  ds_read_b64_tr_b16 a[154:155], v26 offset:62976
  ds_read_b64_tr_b16 a[192:193], v26 offset:61472
  ds_read_b64_tr_b16 a[194:195], v26 offset:63008
  ds_read_b64_tr_b16 a[232:233], v26 offset:61504
  ds_read_b64_tr_b16 a[234:235], v26 offset:63040
  s_waitcnt lgkmcnt(0)
  s_waitcnt vmcnt(30)
  s_barrier
  s_mov_b32 s46, 0
  s_add_u32 m0, s55, 61440
  s_nop 0
  buffer_load_dwordx4 v16, s[68:71], s46 offen lds
  s_mov_b32 s46, 0
  s_add_u32 m0, s55, 62464
  s_nop 0
  buffer_load_dwordx4 v17, s[68:71], s46 offen lds
  s_mov_b32 s46, 0
  s_add_u32 m0, s55, 63488
  s_nop 0
  buffer_load_dwordx4 v18, s[68:71], s46 offen lds
  ds_read_b64_tr_b16 a[156:157], v27 offset:8192
  ds_read_b64_tr_b16 a[158:159], v27 offset:9728
  ds_read_b64_tr_b16 a[196:197], v27 offset:8224
  ds_read_b64_tr_b16 a[198:199], v27 offset:9760
  ds_read_b64_tr_b16 a[236:237], v27 offset:8256
  ds_read_b64_tr_b16 a[238:239], v27 offset:9792
  s_waitcnt lgkmcnt(0)
  s_waitcnt vmcnt(28)
  s_barrier
  s_mov_b32 s46, 393216
  s_add_u32 m0, s55, 73728
  s_nop 0
  buffer_load_dwordx4 v16, s[68:71], s46 offen lds
  s_mov_b32 s46, 393216
  s_add_u32 m0, s55, 74752
  s_nop 0
  buffer_load_dwordx4 v17, s[68:71], s46 offen lds
  s_mov_b32 s46, 393216
  s_add_u32 m0, s55, 75776
  s_nop 0
  buffer_load_dwordx4 v18, s[68:71], s46 offen lds
  ds_read_b64_tr_b16 a[240:241], v30 offset:20480
  ds_read_b64_tr_b16 a[242:243], v30 offset:30720
  ds_read_b64_tr_b16 v[160:161], v30 offset:20488
  ds_read_b64_tr_b16 v[162:163], v30 offset:30728
  ds_read_b64_tr_b16 v[184:185], v30 offset:20544
  ds_read_b64_tr_b16 v[186:187], v30 offset:30784
  ds_read_b64_tr_b16 v[208:209], v30 offset:20552
  ds_read_b64_tr_b16 v[210:211], v30 offset:30792
  ds_read_b64_tr_b16 v[232:233], v33 offset:20480
  ds_read_b64_tr_b16 v[234:235], v33 offset:30720
  s_waitcnt lgkmcnt(0)
  s_waitcnt vmcnt(26)
  s_barrier
  s_mov_b32 s46, 786432
  s_add_u32 m0, s55, 86016
  s_nop 0
  buffer_load_dwordx4 v16, s[68:71], s46 offen lds
  s_mov_b32 s46, 786432
  s_add_u32 m0, s55, 87040
  s_nop 0
  buffer_load_dwordx4 v17, s[68:71], s46 offen lds
  s_mov_b32 s46, 786432
  s_add_u32 m0, s55, 88064
  s_nop 0
  buffer_load_dwordx4 v18, s[68:71], s46 offen lds
  ds_read_b64_tr_b16 a[244:245], v30 offset:40960
  ds_read_b64_tr_b16 a[246:247], v30 offset:51200
  ds_read_b64_tr_b16 v[164:165], v30 offset:40968
  ds_read_b64_tr_b16 v[166:167], v30 offset:51208
  ds_read_b64_tr_b16 v[188:189], v30 offset:41024
  ds_read_b64_tr_b16 v[190:191], v30 offset:51264
  ds_read_b64_tr_b16 v[212:213], v30 offset:41032
  ds_read_b64_tr_b16 v[214:215], v30 offset:51272
  ds_read_b64_tr_b16 v[236:237], v33 offset:40960
  ds_read_b64_tr_b16 v[238:239], v33 offset:51200
  s_waitcnt lgkmcnt(0)
  s_waitcnt vmcnt(24)
  s_barrier
  s_mov_b32 s46, 1179648
  s_add_u32 m0, s55, 98304
  s_nop 0
  buffer_load_dwordx4 v16, s[68:71], s46 offen lds
  s_mov_b32 s46, 1179648
  s_add_u32 m0, s55, 99328
  s_nop 0
  buffer_load_dwordx4 v17, s[68:71], s46 offen lds
  s_mov_b32 s46, 1179648
  s_add_u32 m0, s55, 100352
  s_nop 0
  buffer_load_dwordx4 v18, s[68:71], s46 offen lds
  s_mov_b32 s46, 1572864
  s_add_u32 m0, s55, 110592
  s_nop 0
  buffer_load_dwordx4 v16, s[68:71], s46 offen lds
  s_mov_b32 s46, 1572864
  s_add_u32 m0, s55, 111616
  s_nop 0
  buffer_load_dwordx4 v17, s[68:71], s46 offen lds
  s_mov_b32 s46, 1572864
  s_add_u32 m0, s55, 112640
  s_nop 0
  buffer_load_dwordx4 v18, s[68:71], s46 offen lds
  ds_read_b64_tr_b16 a[248:249], v30 offset:61440
  ds_read_b64_tr_b16 a[250:251], v31 offset:6144
  ds_read_b64_tr_b16 v[168:169], v30 offset:61448
  ds_read_b64_tr_b16 v[170:171], v31 offset:6152
  ds_read_b64_tr_b16 v[192:193], v30 offset:61504
  ds_read_b64_tr_b16 v[194:195], v31 offset:6208
  ds_read_b64_tr_b16 v[216:217], v30 offset:61512
  ds_read_b64_tr_b16 v[218:219], v31 offset:6216
  ds_read_b64_tr_b16 v[240:241], v33 offset:61440
  ds_read_b64_tr_b16 v[242:243], v34 offset:6144
  s_waitcnt lgkmcnt(0)
  s_waitcnt vmcnt(25)
  s_barrier
  s_mov_b32 s46, 1966080
  s_add_u32 m0, s55, 122880
  s_nop 0
  buffer_load_dwordx4 v16, s[68:71], s46 offen lds
  s_mov_b32 s46, 1966080
  s_add_u32 m0, s55, 123904
  s_nop 0
  buffer_load_dwordx4 v17, s[68:71], s46 offen lds
  s_mov_b32 s46, 1966080
  s_add_u32 m0, s55, 124928
  s_nop 0
  buffer_load_dwordx4 v18, s[68:71], s46 offen lds
  s_mov_b32 s46, 2359296
  s_add_u32 m0, s55, 135168
  s_nop 0
  buffer_load_dwordx4 v16, s[68:71], s46 offen lds
  s_mov_b32 s46, 2359296
  s_add_u32 m0, s55, 136192
  s_nop 0
  buffer_load_dwordx4 v17, s[68:71], s46 offen lds
  s_mov_b32 s46, 2359296
  s_add_u32 m0, s55, 137216
  s_nop 0
  buffer_load_dwordx4 v18, s[68:71], s46 offen lds
  s_mov_b32 s46, 2752512
  s_add_u32 m0, s55, 147456
  s_nop 0
  buffer_load_dwordx4 v16, s[68:71], s46 offen lds
  s_mov_b32 s46, 2752512
  s_add_u32 m0, s55, 148480
  s_nop 0
  buffer_load_dwordx4 v17, s[68:71], s46 offen lds
  s_mov_b32 s46, 2752512
  s_add_u32 m0, s55, 149504
  s_nop 0
  buffer_load_dwordx4 v18, s[68:71], s46 offen lds
  ds_read_b64_tr_b16 a[252:253], v29 offset:0
  ds_read_b64_tr_b16 a[254:255], v29 offset:10240
  ds_read_b64_tr_b16 v[172:173], v29 offset:8
  ds_read_b64_tr_b16 v[174:175], v29 offset:10248
  ds_read_b64_tr_b16 v[196:197], v29 offset:64
  ds_read_b64_tr_b16 v[198:199], v29 offset:10304
  ds_read_b64_tr_b16 v[220:221], v29 offset:72
  ds_read_b64_tr_b16 v[222:223], v29 offset:10312
  ds_read_b64_tr_b16 v[244:245], v32 offset:0
  ds_read_b64_tr_b16 v[246:247], v32 offset:10240
  s_waitcnt lgkmcnt(0)
  s_waitcnt vmcnt(29)
  s_barrier
  s_mov_b32 s46, 3145728
  s_add_u32 m0, s55, 0
  s_nop 0
  buffer_load_dwordx4 v16, s[68:71], s46 offen lds
  s_mov_b32 s46, 3145728
  s_add_u32 m0, s55, 1024
  s_nop 0
  buffer_load_dwordx4 v17, s[68:71], s46 offen lds
  s_mov_b32 s46, 3145728
  s_add_u32 m0, s55, 2048
  s_nop 0
  buffer_load_dwordx4 v18, s[68:71], s46 offen lds
  ds_read_b64_tr_b16 v[152:153], v29 offset:20480
  ds_read_b64_tr_b16 v[154:155], v29 offset:30720
  ds_read_b64_tr_b16 v[176:177], v29 offset:20488
  ds_read_b64_tr_b16 v[178:179], v29 offset:30728
  ds_read_b64_tr_b16 v[200:201], v29 offset:20544
  ds_read_b64_tr_b16 v[202:203], v29 offset:30784
  ds_read_b64_tr_b16 v[224:225], v29 offset:20552
  ds_read_b64_tr_b16 v[226:227], v29 offset:30792
  ds_read_b64_tr_b16 v[248:249], v32 offset:20480
  ds_read_b64_tr_b16 v[250:251], v32 offset:30720
  s_waitcnt lgkmcnt(0)
  s_waitcnt vmcnt(27)
  s_barrier
  s_mov_b32 s46, 3538944
  s_add_u32 m0, s55, 12288
  s_nop 0
  buffer_load_dwordx4 v16, s[68:71], s46 offen lds
  s_mov_b32 s46, 3538944
  s_add_u32 m0, s55, 13312
  s_nop 0
  buffer_load_dwordx4 v17, s[68:71], s46 offen lds
  s_mov_b32 s46, 3538944
  s_add_u32 m0, s55, 14336
  s_nop 0
  buffer_load_dwordx4 v18, s[68:71], s46 offen lds
  ds_read_b64_tr_b16 v[156:157], v29 offset:40960
  ds_read_b64_tr_b16 v[158:159], v29 offset:51200
  ds_read_b64_tr_b16 v[180:181], v29 offset:40968
  ds_read_b64_tr_b16 v[182:183], v29 offset:51208
  ds_read_b64_tr_b16 v[204:205], v29 offset:41024
  ds_read_b64_tr_b16 v[206:207], v29 offset:51264
  ds_read_b64_tr_b16 v[228:229], v29 offset:41032
  ds_read_b64_tr_b16 v[230:231], v29 offset:51272
  ds_read_b64_tr_b16 v[252:253], v32 offset:40960
  ds_read_b64_tr_b16 v[254:255], v32 offset:51200
  s_waitcnt lgkmcnt(0)
  s_waitcnt vmcnt(27)
  s_barrier
  ds_read_b64_tr_b16 v[36:37], v26 offset:61440
  ds_read_b64_tr_b16 v[38:39], v26 offset:62976
  ds_read_b64_tr_b16 v[40:41], v26 offset:61472
  ds_read_b64_tr_b16 v[42:43], v26 offset:63008
  ds_read_b64_tr_b16 v[44:45], v26 offset:61504
  ds_read_b64_tr_b16 v[46:47], v26 offset:63040
  s_waitcnt lgkmcnt(0)
  s_waitcnt vmcnt(24)
  s_barrier
  ds_read_b64_tr_b16 v[48:49], v27 offset:8192
  ds_read_b64_tr_b16 v[50:51], v27 offset:9728
  ds_read_b64_tr_b16 v[52:53], v27 offset:8224
  ds_read_b64_tr_b16 v[54:55], v27 offset:9760
  ds_read_b64_tr_b16 v[56:57], v27 offset:8256
  ds_read_b64_tr_b16 v[58:59], v27 offset:9792
  s_waitcnt lgkmcnt(0)
  s_waitcnt vmcnt(21)
  s_barrier
  ds_read_b64_tr_b16 v[60:61], v27 offset:20480
  ds_read_b64_tr_b16 v[62:63], v27 offset:22016
  ds_read_b64_tr_b16 v[64:65], v27 offset:20512
  ds_read_b64_tr_b16 v[66:67], v27 offset:22048
  ds_read_b64_tr_b16 v[68:69], v27 offset:20544
  ds_read_b64_tr_b16 v[70:71], v27 offset:22080
  s_waitcnt lgkmcnt(0)
  s_waitcnt vmcnt(18)
  s_barrier
  ds_read_b64_tr_b16 v[72:73], v27 offset:32768
  ds_read_b64_tr_b16 v[74:75], v27 offset:34304
  ds_read_b64_tr_b16 v[76:77], v27 offset:32800
  ds_read_b64_tr_b16 v[78:79], v27 offset:34336
  ds_read_b64_tr_b16 v[80:81], v27 offset:32832
  ds_read_b64_tr_b16 v[82:83], v27 offset:34368
  s_waitcnt lgkmcnt(0)
  s_waitcnt vmcnt(15)
  s_barrier
  ds_read_b64_tr_b16 v[84:85], v27 offset:45056
  ds_read_b64_tr_b16 v[86:87], v27 offset:46592
  ds_read_b64_tr_b16 v[88:89], v27 offset:45088
  ds_read_b64_tr_b16 v[90:91], v27 offset:46624
  ds_read_b64_tr_b16 v[92:93], v27 offset:45120
  ds_read_b64_tr_b16 v[94:95], v27 offset:46656
  s_waitcnt lgkmcnt(0)
  s_waitcnt vmcnt(12)
  s_barrier
  ds_read_b64_tr_b16 v[96:97], v27 offset:57344
  ds_read_b64_tr_b16 v[98:99], v27 offset:58880
  ds_read_b64_tr_b16 v[100:101], v27 offset:57376
  ds_read_b64_tr_b16 v[102:103], v27 offset:58912
  ds_read_b64_tr_b16 v[104:105], v27 offset:57408
  ds_read_b64_tr_b16 v[106:107], v27 offset:58944
  s_waitcnt lgkmcnt(0)
  s_waitcnt vmcnt(9)
  s_barrier
  ds_read_b64_tr_b16 v[108:109], v28 offset:4096
  ds_read_b64_tr_b16 v[110:111], v28 offset:5632
  ds_read_b64_tr_b16 v[112:113], v28 offset:4128
  ds_read_b64_tr_b16 v[114:115], v28 offset:5664
  ds_read_b64_tr_b16 v[116:117], v28 offset:4160
  ds_read_b64_tr_b16 v[118:119], v28 offset:5696
  s_waitcnt lgkmcnt(0)
  s_waitcnt vmcnt(6)
  s_barrier
  ds_read_b64_tr_b16 v[120:121], v28 offset:16384
  ds_read_b64_tr_b16 v[122:123], v28 offset:17920
  ds_read_b64_tr_b16 v[124:125], v28 offset:16416
  ds_read_b64_tr_b16 v[126:127], v28 offset:17952
  ds_read_b64_tr_b16 v[128:129], v28 offset:16448
  ds_read_b64_tr_b16 v[130:131], v28 offset:17984
  s_waitcnt lgkmcnt(0)
  s_waitcnt vmcnt(3)
  s_barrier
  ds_read_b64_tr_b16 v[132:133], v26 offset:0
  ds_read_b64_tr_b16 v[134:135], v26 offset:1536
  ds_read_b64_tr_b16 v[136:137], v26 offset:32
  ds_read_b64_tr_b16 v[138:139], v26 offset:1568
  ds_read_b64_tr_b16 v[140:141], v26 offset:64
  ds_read_b64_tr_b16 v[142:143], v26 offset:1600
  s_waitcnt lgkmcnt(0)
  s_waitcnt vmcnt(0)
  s_barrier
  ds_read_b64_tr_b16 v[144:145], v26 offset:12288
  ds_read_b64_tr_b16 v[146:147], v26 offset:13824
  ds_read_b64_tr_b16 v[4:5], v26 offset:12320
  ds_read_b64_tr_b16 v[6:7], v26 offset:13856
  ds_read_b64_tr_b16 v[8:9], v26 offset:12352
  ds_read_b64_tr_b16 v[10:11], v26 offset:13888
  s_waitcnt lgkmcnt(0)
  s_barrier
  s_mul_i32 s46, s3, 30720
  v_lshlrev_b32 v1, 4, v0
  v_add_u32 v2, s46, v1
  ds_write_b128 v2, v[36:39] offset:0
  ds_write_b128 v2, v[40:43] offset:1024
  ds_write_b128 v2, v[44:47] offset:2048
  ds_write_b128 v2, v[48:51] offset:3072
  ds_write_b128 v2, v[52:55] offset:4096
  ds_write_b128 v2, v[56:59] offset:5120
  ds_write_b128 v2, v[60:63] offset:6144
  ds_write_b128 v2, v[64:67] offset:7168
  ds_write_b128 v2, v[68:71] offset:8192
  ds_write_b128 v2, v[72:75] offset:9216
  ds_write_b128 v2, v[76:79] offset:10240
  ds_write_b128 v2, v[80:83] offset:11264
  ds_write_b128 v2, v[84:87] offset:12288
  ds_write_b128 v2, v[88:91] offset:13312
  ds_write_b128 v2, v[92:95] offset:14336
  ds_write_b128 v2, v[96:99] offset:15360
  ds_write_b128 v2, v[100:103] offset:16384
  ds_write_b128 v2, v[104:107] offset:17408
  ds_write_b128 v2, v[108:111] offset:18432
  ds_write_b128 v2, v[112:115] offset:19456
  ds_write_b128 v2, v[116:119] offset:20480
  ds_write_b128 v2, v[120:123] offset:21504
  ds_write_b128 v2, v[124:127] offset:22528
  ds_write_b128 v2, v[128:131] offset:23552
  ds_write_b128 v2, v[132:135] offset:24576
  ds_write_b128 v2, v[136:139] offset:25600
  ds_write_b128 v2, v[140:143] offset:26624
  ds_write_b128 v2, v[144:147] offset:27648
  ds_write_b128 v2, v[4:7] offset:28672
  ds_write_b128 v2, v[8:11] offset:29696
  s_waitcnt lgkmcnt(0)
  v_mov_b32 v10, v2
  v_lshlrev_b32 v2, 3, v0
  v_add_u32 v11, 122880, v1
  s_mov_b32 s12, s18
  s_and_b32 s13, s19, 0xffff
  s_mov_b32 s14, 10240
  s_mov_b32 s15, 0x20000
  s_mov_b32 s48, 0x00ff00ff
  s_mov_b32 s49, 0x00ff00ff
  s_mov_b32 s50, 0x00ff00ff
  s_mov_b32 s51, 0xff00ff00
  v_and_b32 v30, 1, v0
  v_lshlrev_b32 v30, 4, v30
  v_mov_b32 v31, 0x3f80
  v_lshlrev_b32 v30, v30, v31
  v_bfe_u32 v31, v0, 1, 2
  v_cmp_eq_u32 vcc, 0, v31
  s_nop 1
  v_cndmask_b32 v16, 0, v30, vcc
  v_cmp_eq_u32 vcc, 1, v31
  s_nop 1
  v_cndmask_b32 v17, 0, v30, vcc
  v_cmp_eq_u32 vcc, 2, v31
  s_nop 1
  v_cndmask_b32 v18, 0, v30, vcc
  v_cmp_eq_u32 vcc, 3, v31
  s_nop 1
  v_cndmask_b32 v19, 0, v30, vcc
  v_cndmask_b32 v20, 0, v16, s[50:51]
  v_cndmask_b32 v21, 0, v17, s[50:51]
  v_cndmask_b32 v22, 0, v18, s[50:51]
  v_cndmask_b32 v23, 0, v19, s[50:51]
  v_lshrrev_b32 v30, 5, v0
  v_lshlrev_b32 v30, 8, v30
  v_and_b32 v31, 15, v0
  v_lshlrev_b32 v31, 4, v31
  v_add_u32 v30, v30, v31
  s_mul_i32 s46, s3, 2560
  v_add_u32 v30, s46, v30
  v_bfe_u32 v32, v0, 4, 1
  v_lshlrev_b32 v33, 3, v32
  v_add_u32 v4, v30, v33
  v_add_u32 v4, 147456, v4
  s_mul_i32 s46, s42, 20480
  s_add_u32 s46, s46, 11665408
  s_mul_i32 s47, s53, 10240
  s_add_u32 s46, s46, s47
  s_xor_b32 s58, s42, 1
  s_mul_i32 s58, s58, 20480
  s_add_u32 s58, s58, 14811136
  s_add_u32 s58, s58, s47
  s_sub_u32 s58, s58, s46
  v_mul_lo_u32 v32, s58, v32
  v_add_u32 v3, v30, v32
  v_add_u32 v3, s46, v3
  v_lshrrev_b32 v32, 4, v0
  v_mul_u32_u24 v5, 20480, v32
  v_add_u32 v5, v5, v31
  v_bfe_u32 v32, v0, 4, 1
  v_lshlrev_b32 v32, 30, v32
  v_lshrrev_b32 v33, 5, v0
  v_lshlrev_b32 v33, 8, v33
  v_add3_u32 v6, v31, v32, v33
  s_lshl_b32 s46, s3, 12
  s_add_u32 s46, s46, 8192
  v_add_u32 v7, s46, v11
  s_lshl_b32 s46, s3, 10
  v_add_u32 v8, s46, v11
  s_add_u32 s28, s46, 122880
  s_add_u32 s29, s46, 125952
  s_lshl_b32 s30, s3, 12
  s_add_u32 s30, s30, 132096
  s_lshr_b32 s46, s3, 1
  s_lshl_b32 s46, s46, 10
  s_and_b32 s47, s3, 1
  s_lshl_b32 s47, s47, 3
  s_add_u32 s46, s46, s47
  s_add_u32 s59, s46, 38912
  v_add_u32 v9, s59, v11
  s_lshl_b32 s60, s54, 2
  s_add_u32 s60, s60, s3
  s_xor_b32 s61, s60, 4
  s_mul_i32 s60, s60, 5120
  s_add_u32 s60, s60, 4456448
  s_mul_i32 s61, s61, 5120
  s_add_u32 s61, s61, 4456448
  s_mul_i32 s62, s54, 10240
  s_add_u32 s62, s62, 3801088
  s_lshl_b32 s46, s3, 9
  s_add_u32 s63, s62, s46
  s_add_u32 s63, s63, 8192
  s_lshl_b32 s46, s3, 11
  s_add_u32 s62, s62, s46
  s_lshl_b32 s70, s3, 5
  s_add_u32 s70, s70, s43
  s_cmp_ge_u32 s70, 40
  s_cselect_b32 s46, 10240-40*256, 0
  s_lshl_b32 s47, s70, 8
  s_add_u32 s47, s47, s46
  s_mul_i32 s46, s42, 327680
  s_add_u32 s46, s46, s47
  s_add_u32 s64, s46, 3801088
  s_add_u32 s65, s64, 81920
  s_add_u32 s66, s65, 81920
  s_add_u32 s67, s66, 81920
  s_mul_i32 s46, s42, 20480
  s_add_u32 s46, s46, s47
  s_add_u32 s68, s46, 11665408
  s_add_u32 s69, s46, 14811136
  s_mul_i32 s71, s52, 12288
  s_mul_i32 s46, s53, 6144
  s_add_u32 s71, s71, s46
  s_mul_i32 s46, s3, 1536
  s_add_u32 s71, s71, s46
  s_add_u32 s71, s71, 37748736
  s_lshl_b32 s72, s52, 8
  s_lshl_b32 s46, s53, 7
  s_add_u32 s72, s72, s46
  s_lshl_b32 s46, s3, 5
  s_add_u32 s72, s72, s46
  s_add_u32 s72, s72, 794624
  s_mul_i32 s83, s52, 12288
  s_mul_i32 s46, s3, 3072
  s_add_u32 s83, s83, s46
  s_add_u32 s83, s83, 119537664
  s_lshl_b32 s46, s52, 9
  s_lshl_b32 s47, s3, 5
  s_add_u32 s46, s46, s47
  s_add_u32 s94, s46, 1441920
  v_bfe_u32 v30, v0, 2, 2
  v_lshrrev_b32 v31, 4, v0
  v_cmp_eq_u32 vcc, v30, v31
  v_and_b32 v30, 1, v0
  v_lshlrev_b32 v30, 4, v30
  v_mov_b32 v31, 0x3f80
  v_lshlrev_b32 v30, v30, v31
  v_cndmask_b32 v30, 0, v30, vcc
  v_bfe_u32 v31, v0, 1, 1
  v_cmp_eq_u32 vcc, 0, v31
  s_nop 1
  v_cndmask_b32 v14, 0, v30, vcc
  v_cndmask_b32 v15, v30, 0, vcc
  s_mov_b32 s86, 0x00003f80
  s_mov_b32 s87, 0x3f800000
  s_mov_b32 s88, 1037384597
  s_mov_b32 s89, 0xff800000
  s_mov_b32 s56, 0x33333333
  s_mov_b32 s57, 0x33333333
  s_mov_b32 s16, 0xffff0000
  s_mov_b32 s17, 0xffff0000
  s_mov_b32 s18, 0
  s_mov_b32 s77, 0
  s_mov_b32 s78, 1
  s_min_u32 s81, s77, 63
  s_add_u32 s82, s77, 56
  s_min_u32 s82, s82, 127
  s_cmp_lt_u32 s77, 8
  s_cselect_b32 s82, s81, s82
  s_lshl_b32 s95, s81, 14
  s_add_u32 s95, s95, s94
  s_sub_u32 s46, s82, s81
  s_lshl_b32 s46, s46, 14
  v_mov_b32 v13, s46
  v_cndmask_b32 v13, v13, 0, s[56:57]
  v_and_b32 v12, 16, v1
  v_lshl_add_u32 v13, v12, 3, v13
  s_mov_b32 s73, s81
  s_mov_b32 s74, s82
  s_mul_i32 s73, s73, 393216
  s_add_u32 s73, s73, s83
  s_mul_i32 s74, s74, 393216
  s_add_u32 s74, s74, s83
fwS_6:
  s_sub_u32 s46, s82, s81
  s_lshl_b32 s46, s46, 14
  v_mov_b32 v13, s46
  v_cndmask_b32 v13, v13, 0, s[56:57]
  v_and_b32 v12, 16, v1
  v_lshl_add_u32 v13, v12, 3, v13
  buffer_load_dword v13, v13, s[4:7], s95 offen sc1
  s_waitcnt vmcnt(0)
  v_cmp_eq_u32 vcc, 0, v13
  s_cbranch_vccz foS_7
  s_add_u32 s45, s45, 1
  s_cmp_gt_u32 s45, 1048576
  s_cbranch_scc1 failcS_5
  s_sleep 2
  s_branch fwS_6
foS_7:
  buffer_load_dwordx4 v[100:103], v1, s[4:7], s73 offen offset:0 sc1
  buffer_load_dwordx4 v[104:107], v1, s[4:7], s73 offen offset:1024 sc1
  buffer_load_dwordx4 v[108:111], v1, s[4:7], s73 offen offset:2048 sc1
  buffer_load_dwordx4 v[112:115], v1, s[4:7], s74 offen offset:0 sc1
  buffer_load_dwordx4 v[116:119], v1, s[4:7], s74 offen offset:1024 sc1
  buffer_load_dwordx4 v[120:123], v1, s[4:7], s74 offen offset:2048 sc1
  s_add_u32 s75, s73, 50331648
  s_add_u32 s76, s74, 50331648
  v_bfe_u32 v30, v1, 4, 3
  v_mul_u32_u24 v30, 1280, v30
  v_lshrrev_b32 v31, 8, v1
  v_lshlrev_b32 v31, 4, v31
  v_add_u32 v30, v30, v31
  s_mul_i32 s46, s53, 640
  s_lshl_b32 s47, s3, 6
  s_add_u32 s46, s46, s47
  v_add_u32 v30, s46, v30
  s_lshl_b32 s46, s3, 10
  v_add_u32 v31, s46, v11
  buffer_load_dwordx4 v[64:67], v30, s[12:15], 0 offen offset:0
  buffer_load_dwordx4 v[68:71], v30, s[12:15], 0 offen offset:256
  buffer_load_dwordx4 v[72:75], v30, s[12:15], 0 offen offset:512
  s_waitcnt vmcnt(0)
  ds_write_b128 v31, v[64:67] offset:24576
  ds_write_b128 v31, v[68:71] offset:28672
  s_cmp_ge_u32 s3, 2
  s_cbranch_scc1 m0S_8
  ds_write_b128 v31, v[72:75] offset:32768
m0S_8:
  s_mov_b64 exec, -1
  v_mov_b32 v0, s89
  s_branch p1S_10
  .p2align 6
stepS_9:
  buffer_load_dwordx4 v[24:27], v3, s[4:7], s80 offen offset:0 sc1
  buffer_load_dwordx4 v[28:31], v3, s[4:7], s80 offen offset:512 sc1
  buffer_load_dwordx4 v[32:35], v3, s[4:7], s80 offen offset:1024 sc1
  buffer_load_dwordx4 v[36:39], v3, s[4:7], s80 offen offset:1536 sc1
  buffer_load_dwordx4 v[40:43], v3, s[4:7], s80 offen offset:2048 sc1
  s_waitcnt vmcnt(0)
bS_12:
  v_mfma_f32_16x16x32_bf16 v[64:67], v[20:23], v[24:27], 0
  v_xor_b32 v12, s79, v24
  v_mfma_f32_16x16x32_bf16 v[68:71], v[20:23], v[28:31], 0
  v_bitop3_b32 v12, v12, v28, s79 bitop3:0xf6
  v_mfma_f32_16x16x32_bf16 v[72:75], v[20:23], v[32:35], 0
  v_bitop3_b32 v12, v12, v32, s79 bitop3:0xf6
  v_mfma_f32_16x16x32_bf16 v[76:79], v[20:23], v[36:39], 0
  v_bitop3_b32 v12, v12, v36, s79 bitop3:0xf6
  v_mfma_f32_16x16x32_bf16 v[80:83], v[20:23], v[40:43], 0
  v_bitop3_b32 v12, v12, v40, s79 bitop3:0xf6
  v_and_b32 v12, 1, v12
  v_cmp_ne_u32 vcc, 0, v12
  s_cbranch_vccnz rtS_13
  v_cvt_pk_bf16_f32 v88, v64, v65
  v_cvt_pk_bf16_f32 v89, v66, v67
  ds_write_b64 v4, v[88:89] offset:0
  v_cvt_pk_bf16_f32 v90, v68, v69
  v_cvt_pk_bf16_f32 v91, v70, v71
  ds_write_b64 v4, v[90:91] offset:512
  v_cvt_pk_bf16_f32 v92, v72, v73
  v_cvt_pk_bf16_f32 v93, v74, v75
  ds_write_b64 v4, v[92:93] offset:1024
  v_cvt_pk_bf16_f32 v94, v76, v77
  v_cvt_pk_bf16_f32 v95, v78, v79
  ds_write_b64 v4, v[94:95] offset:1536
  v_cvt_pk_bf16_f32 v96, v80, v81
  v_cvt_pk_bf16_f32 v97, v82, v83
  ds_write_b64 v4, v[96:97] offset:2048
  s_cmp_eq_u32 s77, 8
  s_cbranch_scc1 p1S_10x
p1S_10:
  s_waitcnt vmcnt(0) lgkmcnt(0)
  s_barrier
  ds_read_b128 v[24:27], v11 offset:24576
  ds_read_b128 v[28:31], v11 offset:25600
  ds_read_b128 v[32:35], v11 offset:26624
  ds_read_b128 v[36:39], v11 offset:27648
  ds_read_b128 v[40:43], v11 offset:28672
  ds_read_b128 v[44:47], v11 offset:29696
  ds_read_b128 v[48:51], v11 offset:30720
  ds_read_b128 v[52:55], v11 offset:31744
  ds_read_b128 v[56:59], v11 offset:32768
  ds_read_b128 v[60:63], v11 offset:33792
  s_waitcnt lgkmcnt(9)
  v_mfma_f32_16x16x32_bf16 v[64:67], a[0:3], v[24:27], 0
  v_mov_b32 v12, 1
  buffer_load_dwordx4 v[124:127], v1, s[4:7], s75 offen offset:0 sc1
  v_mfma_f32_16x16x32_bf16 v[68:71], a[40:43], v[24:27], 0
  s_sub_u32 s46, s72, 8192
  s_waitcnt lgkmcnt(8)
  v_mfma_f32_16x16x32_bf16 v[64:67], a[4:7], v[28:31], v[64:67]
  buffer_store_dword v12, off, s[4:7], s46 sc1
  s_add_u32 s55, s77, 1
  buffer_load_dwordx4 v[128:131], v1, s[4:7], s75 offen offset:1024 sc1
  v_mfma_f32_16x16x32_bf16 v[68:71], a[44:47], v[28:31], v[68:71]
  s_min_u32 s81, s55, 63
  s_waitcnt lgkmcnt(7)
  v_mfma_f32_16x16x32_bf16 v[64:67], a[8:11], v[32:35], v[64:67]
  buffer_load_dwordx4 v[132:135], v1, s[4:7], s75 offen offset:2048 sc1
  v_mfma_f32_16x16x32_bf16 v[68:71], a[48:51], v[32:35], v[68:71]
  s_add_u32 s82, s55, 56
  s_waitcnt lgkmcnt(6)
  v_mfma_f32_16x16x32_bf16 v[64:67], a[12:15], v[36:39], v[64:67]
  s_mov_b32 m0, s28
  s_nop 0
  buffer_load_dwordx4 v1, s[4:7], s76 offen offset:0 sc1 lds
  v_mfma_f32_16x16x32_bf16 v[68:71], a[52:55], v[36:39], v[68:71]
  s_min_u32 s82, s82, 127
  s_waitcnt lgkmcnt(5)
  v_mfma_f32_16x16x32_bf16 v[64:67], a[16:19], v[40:43], v[64:67]
  s_mov_b32 m0, s29
  s_nop 0
  buffer_load_dwordx4 v1, s[4:7], s76 offen offset:1024 sc1 lds
  v_mfma_f32_16x16x32_bf16 v[68:71], a[56:59], v[40:43], v[68:71]
  s_cmp_lt_u32 s55, 8
  s_waitcnt lgkmcnt(4)
  v_mfma_f32_16x16x32_bf16 v[64:67], a[20:23], v[44:47], v[64:67]
  s_mov_b32 m0, s30
  s_nop 0
  buffer_load_dwordx4 v1, s[4:7], s76 offen offset:2048 sc1 lds
  v_mfma_f32_16x16x32_bf16 v[68:71], a[60:63], v[44:47], v[68:71]
  s_cselect_b32 s82, s81, s82
  s_waitcnt lgkmcnt(3)
  v_mfma_f32_16x16x32_bf16 v[64:67], a[24:27], v[48:51], v[64:67]
  s_lshl_b32 s95, s81, 14
  v_mfma_f32_16x16x32_bf16 v[68:71], a[64:67], v[48:51], v[68:71]
  s_add_u32 s95, s95, s94
  s_waitcnt lgkmcnt(2)
  v_mfma_f32_16x16x32_bf16 v[64:67], a[28:31], v[52:55], v[64:67]
  s_sub_u32 s46, s82, s81
  v_mfma_f32_16x16x32_bf16 v[68:71], a[68:71], v[52:55], v[68:71]
  s_lshl_b32 s46, s46, 14
  s_waitcnt lgkmcnt(1)
  v_mfma_f32_16x16x32_bf16 v[64:67], a[32:35], v[56:59], v[64:67]
  v_mov_b32 v13, s46
  v_mfma_f32_16x16x32_bf16 v[68:71], a[72:75], v[56:59], v[68:71]
  v_cndmask_b32 v13, v13, 0, s[56:57]
  s_waitcnt lgkmcnt(0)
  v_mfma_f32_16x16x32_bf16 v[64:67], a[36:39], v[60:63], v[64:67]
  v_and_b32 v12, 16, v1
  v_mfma_f32_16x16x32_bf16 v[68:71], a[76:79], v[60:63], v[68:71]
  v_lshl_add_u32 v13, v12, 3, v13
  v_mfma_f32_16x16x32_bf16 v[72:75], a[80:83], v[24:27], 0
  s_mov_b32 s73, s81
  v_mfma_f32_16x16x32_bf16 v[84:87], a[200:203], v[24:27], 0
  s_mov_b32 s74, s82
  v_mfma_f32_16x16x32_bf16 v[72:75], a[84:87], v[28:31], v[72:75]
  s_mul_i32 s73, s73, 393216
  v_mfma_f32_16x16x32_bf16 v[84:87], a[204:207], v[28:31], v[84:87]
  s_add_u32 s73, s73, s83
  v_mfma_f32_16x16x32_bf16 v[72:75], a[88:91], v[32:35], v[72:75]
  s_mul_i32 s74, s74, 393216
  v_mfma_f32_16x16x32_bf16 v[84:87], a[208:211], v[32:35], v[84:87]
  s_add_u32 s74, s74, s83
  v_mfma_f32_16x16x32_bf16 v[72:75], a[92:95], v[36:39], v[72:75]
  buffer_load_dword v13, v13, s[4:7], s95 offen sc1
  v_mfma_f32_16x16x32_bf16 v[84:87], a[212:215], v[36:39], v[84:87]
  v_cvt_pk_bf16_f32 v148, v64, v65
  v_mfma_f32_16x16x32_bf16 v[72:75], a[96:99], v[40:43], v[72:75]
  v_cvt_pk_bf16_f32 v149, v66, v67
  v_mfma_f32_16x16x32_bf16 v[84:87], a[216:219], v[40:43], v[84:87]
  v_cvt_pk_bf16_f32 v150, v68, v69
  v_mfma_f32_16x16x32_bf16 v[72:75], a[100:103], v[44:47], v[72:75]
  v_cvt_pk_bf16_f32 v151, v70, v71
  v_mfma_f32_16x16x32_bf16 v[84:87], a[220:223], v[44:47], v[84:87]
  v_bfi_b32 v148, 1, s78, v148
  v_mfma_f32_16x16x32_bf16 v[72:75], a[104:107], v[48:51], v[72:75]
  buffer_store_dwordx4 v[148:151], v1, s[4:7], s60 offen offset:1536 sc1
  v_mfma_f32_16x16x32_bf16 v[84:87], a[224:227], v[48:51], v[84:87]
  v_mfma_f32_16x16x32_bf16 v[72:75], a[108:111], v[52:55], v[72:75]
  v_mfma_f32_16x16x32_bf16 v[84:87], a[228:231], v[52:55], v[84:87]
  v_mfma_f32_16x16x32_bf16 v[72:75], a[112:115], v[56:59], v[72:75]
  v_mfma_f32_16x16x32_bf16 v[84:87], a[232:235], v[56:59], v[84:87]
  v_mfma_f32_16x16x32_bf16 v[72:75], a[116:119], v[60:63], v[72:75]
  v_mfma_f32_16x16x32_bf16 v[84:87], a[236:239], v[60:63], v[84:87]
  v_mfma_f32_16x16x32_bf16 v[76:79], a[120:123], v[24:27], 0
  v_mfma_f32_16x16x32_bf16 v[80:83], a[160:163], v[24:27], 0
  v_mfma_f32_16x16x32_bf16 v[76:79], a[124:127], v[28:31], v[76:79]
  v_mfma_f32_16x16x32_bf16 v[80:83], a[164:167], v[28:31], v[80:83]
  v_mfma_f32_16x16x32_bf16 v[76:79], a[128:131], v[32:35], v[76:79]
  v_mfma_f32_16x16x32_bf16 v[80:83], a[168:171], v[32:35], v[80:83]
  v_mfma_f32_16x16x32_bf16 v[76:79], a[132:135], v[36:39], v[76:79]
  v_mfma_f32_16x16x32_bf16 v[80:83], a[172:175], v[36:39], v[80:83]
  v_cvt_pk_bf16_f32 v148, v72, v73
  v_mfma_f32_16x16x32_bf16 v[76:79], a[136:139], v[40:43], v[76:79]
  v_cvt_pk_bf16_f32 v149, v74, v75
  v_mfma_f32_16x16x32_bf16 v[80:83], a[176:179], v[40:43], v[80:83]
  v_cvt_pk_bf16_f32 v150, v84, v85
  v_mfma_f32_16x16x32_bf16 v[76:79], a[140:143], v[44:47], v[76:79]
  v_cvt_pk_bf16_f32 v151, v86, v87
  v_mfma_f32_16x16x32_bf16 v[80:83], a[180:183], v[44:47], v[80:83]
  v_bfi_b32 v148, 1, s78, v148
  v_mfma_f32_16x16x32_bf16 v[76:79], a[144:147], v[48:51], v[76:79]
  buffer_store_dwordx4 v[148:151], v1, s[4:7], s60 offen offset:3584 sc1
  v_mfma_f32_16x16x32_bf16 v[80:83], a[184:187], v[48:51], v[80:83]
  ds_read_b128 v[24:27], v10 offset:12288
  v_mfma_f32_16x16x32_bf16 v[76:79], a[148:151], v[52:55], v[76:79]
  ds_read_b128 v[28:31], v10 offset:13312
  v_mfma_f32_16x16x32_bf16 v[80:83], a[188:191], v[52:55], v[80:83]
  ds_read_b128 v[32:35], v10 offset:14336
  v_mfma_f32_16x16x32_bf16 v[76:79], a[152:155], v[56:59], v[76:79]
  ds_read_b128 v[36:39], v10 offset:15360
  v_mfma_f32_16x16x32_bf16 v[80:83], a[192:195], v[56:59], v[80:83]
  ds_read_b128 v[136:139], v10 offset:16384
  v_mfma_f32_16x16x32_bf16 v[76:79], a[156:159], v[60:63], v[76:79]
  ds_read_b128 v[140:143], v10 offset:17408
  v_mfma_f32_16x16x32_bf16 v[80:83], a[196:199], v[60:63], v[80:83]
  s_waitcnt lgkmcnt(3)
  v_mfma_f32_16x16x32_bf16 v[88:91], v[40:43], v[24:27], 0
  ds_read_b128 v[24:27], v10 offset:18432
  v_mfma_f32_16x16x32_bf16 v[92:95], v[40:43], v[28:31], 0
  ds_read_b128 v[28:31], v10 offset:19456
  v_mfma_f32_16x16x32_bf16 v[96:99], v[40:43], v[32:35], 0
  ds_read_b128 v[32:35], v10 offset:20480
  v_cvt_pk_bf16_f32 v144, v76, v77
  s_waitcnt lgkmcnt(3)
  v_mfma_f32_16x16x32_bf16 v[88:91], v[44:47], v[36:39], v[88:91]
  ds_read_b128 v[36:39], v10 offset:21504
  v_cvt_pk_bf16_f32 v145, v78, v79
  v_mfma_f32_16x16x32_bf16 v[92:95], v[44:47], v[136:139], v[92:95]
  ds_read_b128 v[136:139], v10 offset:22528
  v_cvt_pk_bf16_f32 v146, v80, v81
  v_mfma_f32_16x16x32_bf16 v[96:99], v[44:47], v[140:143], v[96:99]
  ds_read_b128 v[140:143], v10 offset:23552
  v_cvt_pk_bf16_f32 v147, v82, v83
  s_waitcnt lgkmcnt(3)
  v_mfma_f32_16x16x32_bf16 v[88:91], v[48:51], v[24:27], v[88:91]
  ds_read_b128 v[24:27], v10 offset:24576
  v_bfi_b32 v144, 1, s78, v144
  buffer_load_dwordx4 v[40:43], v1, s[4:7], s61 offen offset:1536 sc1
  v_mfma_f32_16x16x32_bf16 v[92:95], v[48:51], v[28:31], v[92:95]
  ds_read_b128 v[28:31], v10 offset:25600
  buffer_store_dwordx4 v[144:147], v1, s[4:7], s60 offen offset:2560 sc1
  buffer_load_dwordx4 v[44:47], v1, s[4:7], s61 offen offset:3584 sc1
  v_mfma_f32_16x16x32_bf16 v[96:99], v[48:51], v[32:35], v[96:99]
  ds_read_b128 v[32:35], v10 offset:26624
  ds_read_b128 v[48:51], v10 offset:27648
  s_waitcnt lgkmcnt(4)
  v_mfma_f32_16x16x32_bf16 v[88:91], v[52:55], v[36:39], v[88:91]
  ds_read_b128 v[36:39], v10 offset:28672
  v_mfma_f32_16x16x32_bf16 v[92:95], v[52:55], v[136:139], v[92:95]
  ds_read_b128 v[136:139], v10 offset:29696
  v_mfma_f32_16x16x32_bf16 v[96:99], v[52:55], v[140:143], v[96:99]
  ds_read_b128 v[52:55], v11 offset:24576
  ds_read_b128 v[140:143], v10 offset:0
  s_waitcnt lgkmcnt(5)
  v_mfma_f32_16x16x32_bf16 v[88:91], v[56:59], v[24:27], v[88:91]
  ds_read_b128 v[24:27], v10 offset:1024
  v_mfma_f32_16x16x32_bf16 v[92:95], v[56:59], v[28:31], v[92:95]
  ds_read_b128 v[28:31], v10 offset:2048
  v_mfma_f32_16x16x32_bf16 v[96:99], v[56:59], v[32:35], v[96:99]
  ds_read_b128 v[32:35], v11 offset:25600
  ds_read_b128 v[56:59], v10 offset:3072
  s_waitcnt lgkmcnt(6)
  v_mfma_f32_16x16x32_bf16 v[88:91], v[60:63], v[48:51], v[88:91]
  ds_read_b128 v[48:51], v10 offset:4096
  v_mfma_f32_16x16x32_bf16 v[92:95], v[60:63], v[36:39], v[92:95]
  ds_read_b128 v[36:39], v10 offset:5120
  v_mfma_f32_16x16x32_bf16 v[96:99], v[60:63], v[136:139], v[96:99]
  ds_read_b128 v[60:63], v11 offset:26624
  ds_read_b128 v[136:139], v10 offset:6144
  s_waitcnt lgkmcnt(6)
  v_mfma_f32_16x16x32_bf16 v[88:91], v[52:55], v[140:143], v[88:91]
  ds_read_b128 v[140:143], v10 offset:7168
  v_mfma_f32_16x16x32_bf16 v[92:95], v[52:55], v[24:27], v[92:95]
  ds_read_b128 v[24:27], v10 offset:8192
  v_mfma_f32_16x16x32_bf16 v[96:99], v[52:55], v[28:31], v[96:99]
  ds_read_b128 v[28:31], v11 offset:27648
  ds_read_b128 v[52:55], v10 offset:9216
  s_waitcnt lgkmcnt(6)
  v_mfma_f32_16x16x32_bf16 v[88:91], v[32:35], v[56:59], v[88:91]
  ds_read_b128 v[56:59], v10 offset:10240
  v_mfma_f32_16x16x32_bf16 v[92:95], v[32:35], v[48:51], v[92:95]
  ds_read_b128 v[48:51], v10 offset:11264
  s_waitcnt vmcnt(0)
bS_14:
  v_bitop3_b32 v12, v40, v44, s78 bitop3:0x7e
  v_and_b32 v12, 1, v12
  v_cmp_ne_u32 vcc, 0, v12
  s_cbranch_vccnz rtS_15
  v_mfma_f32_16x16x16_bf16 v[72:75], v[14:15], v[44:45], v[72:75]
  v_mfma_f32_16x16x16_bf16 v[64:67], v[14:15], v[40:41], v[64:67]
  v_mfma_f32_16x16x16_bf16 v[68:71], v[14:15], v[42:43], v[68:71]
  v_mfma_f32_16x16x32_bf16 v[96:99], v[32:35], v[36:39], v[96:99]
  s_waitcnt lgkmcnt(4)
  v_mfma_f32_16x16x32_bf16 v[88:91], v[60:63], v[136:139], v[88:91]
  v_mfma_f32_16x16x32_bf16 v[92:95], v[60:63], v[140:143], v[92:95]
  v_mfma_f32_16x16x32_bf16 v[96:99], v[60:63], v[24:27], v[96:99]
  s_waitcnt lgkmcnt(0)
  v_mfma_f32_16x16x32_bf16 v[88:91], v[28:31], v[52:55], v[88:91]
  v_cvt_pk_bf16_f32 v72, v72, v73
  v_cvt_pk_bf16_f32 v73, v74, v75
  v_mfma_f32_16x16x32_bf16 v[92:95], v[28:31], v[56:59], v[92:95]
  v_cvt_pk_bf16_f32 v64, v64, v65
  v_cvt_pk_bf16_f32 v65, v66, v67
  v_mfma_f32_16x16x32_bf16 v[96:99], v[28:31], v[48:51], v[96:99]
  v_cvt_pk_bf16_f32 v66, v68, v69
  v_cvt_pk_bf16_f32 v67, v70, v71
  s_nop 1
  v_mfma_f32_16x16x16_bf16 v[28:31], v[108:109], v[72:73], 0
  v_cndmask_b32 v40, v0, 0, s[50:51]
  v_cndmask_b32 v41, v0, 0, s[50:51]
  v_mfma_f32_16x16x16_bf16 v[48:51], v[120:121], v[72:73], 0
  v_cndmask_b32 v42, v0, 0, s[50:51]
  v_cndmask_b32 v43, v0, 0, s[50:51]
  v_mfma_f32_16x16x16_bf16 v[32:35], v[110:111], v[72:73], 0
  buffer_load_dwordx4 v[24:27], v1, s[4:7], s61 offen offset:2560 sc1
  v_xor_b32 v74, 0x1000, v7
  v_xor_b32 v75, 0x2000, v7
  v_mfma_f32_16x16x16_bf16 v[52:55], v[122:123], v[72:73], 0
  v_cvt_pk_bf16_f32 v36, v88, v89
  v_mfma_f32_16x16x16_bf16 v[40:43], v[150:151], v[72:73], v[40:43]
  v_cvt_pk_bf16_f32 v37, v90, v91
  v_mfma_f32_16x16x16_bf16 v[40:43], v[46:47], v[72:73], v[40:43]
  v_cvt_pk_bf16_f32 v38, v92, v93
  v_mfma_f32_16x16x32_bf16 v[28:31], v[100:103], v[64:67], v[28:31]
  v_cvt_pk_bf16_f32 v39, v94, v95
  v_mfma_f32_16x16x32_bf16 v[48:51], v[112:115], v[64:67], v[48:51]
  v_bfi_b32 v36, 1, s78, v36
  v_mfma_f32_16x16x32_bf16 v[32:35], v[104:107], v[64:67], v[32:35]
  buffer_store_dwordx4 v[36:39], v1, s[4:7], s60 offen offset:512 sc1
  v_mfma_f32_16x16x32_bf16 v[52:55], v[116:119], v[64:67], v[52:55]
  v_cvt_pk_bf16_f32 v68, v96, v97
  v_mfma_f32_16x16x32_bf16 v[40:43], v[144:147], v[64:67], v[40:43]
  v_cvt_pk_bf16_f32 v69, v98, v99
  v_bfi_b32 v68, 1, s78, v68
  buffer_store_dwordx2 v[68:69], v2, s[4:7], s60 offen sc1
  v_cndmask_b32 v28, v48, v28, s[48:49]
  v_cndmask_b32 v29, v49, v29, s[48:49]
  v_cndmask_b32 v30, v50, v30, s[48:49]
  v_cndmask_b32 v31, v51, v31, s[48:49]
  ds_write_b128 v7, v[28:31]
  v_cndmask_b32 v32, v52, v32, s[48:49]
  v_cndmask_b32 v33, v53, v33, s[48:49]
  v_cndmask_b32 v34, v54, v34, s[48:49]
  v_cndmask_b32 v35, v55, v35, s[48:49]
  ds_write_b128 v7, v[32:35] offset:1024
  s_waitcnt vmcnt(2)
bS_16:
  v_mfma_f32_16x16x32_bf16 v[48:51], v[24:27], v[64:67], v[40:43]
  v_xor_b32 v12, s78, v24
  v_and_b32 v12, 1, v12
  v_cmp_ne_u32 vcc, 0, v12
  s_cbranch_vccnz rtS_17
  s_cmp_eq_u32 s53, 0
  v_xor_b32 v12, 0x3000, v7
  v_cvt_pk_bf16_f32 v56, v88, v89
  v_cvt_pk_bf16_f32 v57, v90, v91
  ds_write_b128 v7, v[48:51] offset:2048
  v_cvt_pk_bf16_f32 v60, v92, v93
  v_cvt_pk_bf16_f32 v61, v94, v95
  v_mfma_f32_16x16x16_bf16 v[76:79], v[14:15], v[24:25], v[76:79]
  v_mfma_f32_16x16x16_bf16 v[80:83], v[14:15], v[26:27], v[80:83]
  v_mfma_f32_16x16x16_bf16 v[84:87], v[14:15], v[46:47], v[84:87]
  s_waitcnt lgkmcnt(0)
  s_barrier
  ds_read_b128 v[100:103], v74 offset:0
  ds_read_b128 v[104:107], v75 offset:0
  ds_read_b128 v[108:111], v12 offset:0
  ds_read_b128 v[112:115], v74 offset:1024
  ds_read_b128 v[116:119], v75 offset:1024
  ds_read_b128 v[120:123], v12 offset:1024
  ds_read_b128 v[40:43], v74 offset:2048
  ds_read_b128 v[52:55], v75 offset:2048
  ds_read_b128 v[64:67], v12 offset:2048
  ds_read_b128 v[136:139], v8
  ds_read_b128 v[140:143], v8 offset:4096
  ds_read_b128 v[144:147], v7 offset:3072
  s_cbranch_scc0 nkS_19
  v_cvt_pk_bf16_f32 v88, v76, v77
  v_cvt_pk_bf16_f32 v89, v78, v79
  v_cvt_pk_bf16_f32 v90, v80, v81
  v_cvt_pk_bf16_f32 v91, v82, v83
  v_cvt_pk_bf16_f32 v92, v84, v85
  v_cvt_pk_bf16_f32 v93, v86, v87
nkS_19:
  v_mov_b32 v150, s88
  buffer_load_dwordx4 v[36:39], v1, s[4:7], s61 offen offset:512 sc1
  buffer_load_dwordx2 v[70:71], v2, s[4:7], s61 offen sc1
  s_waitcnt lgkmcnt(9)
  v_pk_add_f32 v[100:101], v[100:101], v[104:105]
  v_pk_add_f32 v[28:29], v[28:29], v[108:109]
  v_pk_add_f32 v[102:103], v[102:103], v[106:107]
  v_pk_add_f32 v[30:31], v[30:31], v[110:111]
  v_pk_add_f32 v[28:29], v[28:29], v[100:101]
  v_pk_add_f32 v[30:31], v[30:31], v[102:103]
  s_waitcnt lgkmcnt(6)
  v_pk_add_f32 v[112:113], v[112:113], v[116:117]
  v_pk_add_f32 v[32:33], v[32:33], v[120:121]
  v_pk_add_f32 v[114:115], v[114:115], v[118:119]
  v_pk_add_f32 v[34:35], v[34:35], v[122:123]
  v_pk_add_f32 v[32:33], v[32:33], v[112:113]
  v_pk_add_f32 v[34:35], v[34:35], v[114:115]
  v_max3_f32 v148, v28, v29, v30
  v_max3_f32 v149, v31, v32, v33
  v_max3_f32 v148, v148, v34, v35
  s_waitcnt lgkmcnt(3)
  v_pk_add_f32 v[40:41], v[40:41], v[52:53]
  v_pk_add_f32 v[48:49], v[48:49], v[64:65]
  v_pk_add_f32 v[42:43], v[42:43], v[54:55]
  v_pk_add_f32 v[50:51], v[50:51], v[66:67]
  v_pk_add_f32 v[48:49], v[48:49], v[40:41]
  v_pk_add_f32 v[50:51], v[50:51], v[42:43]
  v_max3_f32 v149, v149, v48, v49
  v_max3_f32 v148, v148, v50, v51
  v_max_f32 v148, v148, v149
  v_cmp_eq_u32 vcc, 0, v13
  s_cbranch_vccnz kwS_20
koS_21:
  v_mov_b32 v149, v148
  buffer_load_dwordx4 v[100:103], v1, s[4:7], s73 offen offset:0 sc1
  s_nop 0
  v_permlane16_swap_b32 v148, v149
  v_max_f32 v148, v148, v149
  v_mov_b32 v149, v148
  buffer_load_dwordx4 v[104:107], v1, s[4:7], s73 offen offset:1024 sc1
  s_nop 0
  v_permlane32_swap_b32 v148, v149
  v_max_f32 v148, v148, v149
  v_mul_f32 v148, s88, v148
  v_pk_fma_f32 v[28:29], v[28:29], v[150:151], v[148:149] op_sel_hi:[1,0,0] neg_lo:[0,0,1] neg_hi:[0,0,1]
  v_pk_fma_f32 v[30:31], v[30:31], v[150:151], v[148:149] op_sel_hi:[1,0,0] neg_lo:[0,0,1] neg_hi:[0,0,1]
  v_pk_fma_f32 v[32:33], v[32:33], v[150:151], v[148:149] op_sel_hi:[1,0,0] neg_lo:[0,0,1] neg_hi:[0,0,1]
  v_pk_fma_f32 v[34:35], v[34:35], v[150:151], v[148:149] op_sel_hi:[1,0,0] neg_lo:[0,0,1] neg_hi:[0,0,1]
  v_pk_fma_f32 v[48:49], v[48:49], v[150:151], v[148:149] op_sel_hi:[1,0,0] neg_lo:[0,0,1] neg_hi:[0,0,1]
  v_pk_fma_f32 v[50:51], v[50:51], v[150:151], v[148:149] op_sel_hi:[1,0,0] neg_lo:[0,0,1] neg_hi:[0,0,1]
  v_exp_f32 v28, v28
  buffer_load_dwordx4 v[108:111], v1, s[4:7], s73 offen offset:2048 sc1
  v_exp_f32 v29, v29
  v_exp_f32 v30, v30
  v_exp_f32 v31, v31
  v_exp_f32 v32, v32
  v_exp_f32 v33, v33
  v_exp_f32 v34, v34
  buffer_load_dwordx4 v[112:115], v1, s[4:7], s74 offen offset:0 sc1
  v_exp_f32 v35, v35
  v_exp_f32 v48, v48
  v_cvt_pk_bf16_f32 v64, v28, v29
  v_cvt_pk_bf16_f32 v65, v30, v31
  v_cvt_pk_bf16_f32 v66, v32, v33
  v_cvt_pk_bf16_f32 v67, v34, v35
  v_cndmask_b32 v76, 0, v64, s[48:49]
  v_cndmask_b32 v77, 0, v65, s[48:49]
  v_cndmask_b32 v78, 0, v66, s[48:49]
  v_cndmask_b32 v79, 0, v67, s[48:49]
  v_cndmask_b32 v80, v64, 0, s[48:49]
  v_cndmask_b32 v81, v65, 0, s[48:49]
  v_mfma_f32_16x16x32_bf16 v[24:27], v[124:127], v[76:79], 0
  v_cndmask_b32 v82, v66, 0, s[48:49]
  v_cndmask_b32 v83, v67, 0, s[48:49]
  v_mfma_f32_16x16x32_bf16 v[52:55], v[128:131], v[76:79], 0
  v_exp_f32 v49, v49
  v_exp_f32 v50, v50
  v_mfma_f32_16x16x32_bf16 v[44:47], v[132:135], v[76:79], 0
  v_exp_f32 v51, v51
  v_cvt_pk_bf16_f32 v84, v48, v49
  s_waitcnt lgkmcnt(0)
  v_mfma_f32_16x16x32_bf16 v[24:27], v[136:139], v[80:83], v[24:27]
  v_cvt_pk_bf16_f32 v86, v48, v49
  v_cvt_pk_bf16_f32 v85, v50, v51
  v_mfma_f32_16x16x32_bf16 v[52:55], v[140:143], v[80:83], v[52:55]
  v_cvt_pk_bf16_f32 v87, v50, v51
  buffer_load_dwordx4 v[116:119], v1, s[4:7], s74 offen offset:1024 sc1
  s_waitcnt vmcnt(5)
  v_mfma_f32_16x16x32_bf16 v[44:47], v[144:147], v[80:83], v[44:47]
bS_22:
  v_bitop3_b32 v12, v36, v70, s78 bitop3:0x7e
  v_and_b32 v12, 1, v12
  v_cmp_ne_u32 vcc, 0, v12
  s_cbranch_vccnz rtS_23
  v_mov_b32 v58, v36
  v_mov_b32 v59, v37
  v_mfma_f32_16x16x32_bf16 v[44:47], v[68:71], v[84:87], v[44:47]
  v_mov_b32 v62, v38
  v_mov_b32 v63, v39
  buffer_load_dwordx4 v[120:123], v1, s[4:7], s74 offen offset:2048 sc1
  v_mfma_f32_16x16x32_bf16 v[24:27], v[56:59], v[84:87], v[24:27]
  s_cmp_eq_u32 s77, 71
  s_cbranch_scc1 cendS_11
  v_mfma_f32_16x16x32_bf16 v[52:55], v[60:63], v[84:87], v[52:55]
  s_cmp_eq_u32 s53, 1
  v_add_f32 v148, v28, v30
  v_add_f32 v149, v29, v31
  v_add_f32 v150, v32, v34
  v_add_f32 v151, v33, v35
  v_pk_add_f32 v[148:149], v[148:149], v[48:49]
  v_pk_add_f32 v[150:151], v[150:151], v[50:51]
  v_pk_add_f32 v[148:149], v[148:149], v[150:151]
  v_add_f32 v148, v148, v149
  v_cvt_pk_bf16_f32 v32, v44, v45
  v_cvt_pk_bf16_f32 v33, v46, v47
  ds_write_b64 v9, v[32:33]
  v_cvt_pk_bf16_f32 v28, v24, v25
  v_cvt_pk_bf16_f32 v29, v26, v27
  v_cvt_pk_bf16_f32 v30, v52, v53
  v_cvt_pk_bf16_f32 v31, v54, v55
  ds_write_b128 v8, v[28:31] offset:34816
  s_cbranch_scc0 nvS_24
  v_mfma_f32_16x16x16_bf16 v[88:91], v[14:15], v[58:59], v[88:91]
  v_mfma_f32_16x16x16_bf16 v[92:95], v[14:15], v[62:63], v[92:95]
  v_mfma_f32_16x16x16_bf16 v[96:99], v[14:15], v[70:71], v[96:99]
nvS_24:
  s_waitcnt lgkmcnt(0)
  s_barrier
  ds_read_b128 v[28:31], v11 offset:34816
  ds_read_b128 v[32:35], v11 offset:35840
  ds_read_b128 v[36:39], v11 offset:36864
  ds_read_b128 v[40:43], v11 offset:37888
  ds_read_b128 v[48:51], v11 offset:38912
  ds_read_b128 v[56:59], v11 offset:39936
  s_cbranch_scc0 nvS_25
  v_cvt_pk_bf16_f32 v88, v88, v89
  v_cvt_pk_bf16_f32 v89, v90, v91
  v_cvt_pk_bf16_f32 v90, v92, v93
  v_cvt_pk_bf16_f32 v91, v94, v95
  v_cvt_pk_bf16_f32 v92, v96, v97
  v_cvt_pk_bf16_f32 v93, v98, v99
nvS_25:
  s_waitcnt lgkmcnt(5)
  v_mfma_f32_16x16x32_bf16 v[64:67], a[240:243], v[28:31], 0
  v_mov_b32 v149, v148
  v_mfma_f32_16x16x32_bf16 v[68:71], v[160:163], v[28:31], 0
  s_nop 0
  s_waitcnt lgkmcnt(4)
  v_mfma_f32_16x16x32_bf16 v[64:67], a[244:247], v[32:35], v[64:67]
  v_permlane16_swap_b32 v148, v149
  v_mfma_f32_16x16x32_bf16 v[68:71], v[164:167], v[32:35], v[68:71]
  v_add_f32 v148, v148, v149
  s_waitcnt lgkmcnt(3)
  v_mfma_f32_16x16x32_bf16 v[64:67], a[248:251], v[36:39], v[64:67]
  v_mov_b32 v149, v148
  v_mfma_f32_16x16x32_bf16 v[68:71], v[168:171], v[36:39], v[68:71]
  s_nop 0
  s_waitcnt lgkmcnt(2)
  v_mfma_f32_16x16x32_bf16 v[64:67], a[252:255], v[40:43], v[64:67]
  v_permlane32_swap_b32 v148, v149
  v_mfma_f32_16x16x32_bf16 v[68:71], v[172:175], v[40:43], v[68:71]
  v_add_f32 v148, v148, v149
  s_waitcnt lgkmcnt(1)
  v_mfma_f32_16x16x32_bf16 v[64:67], v[152:155], v[48:51], v[64:67]
  v_rcp_f32 v148, v148
  v_mfma_f32_16x16x32_bf16 v[68:71], v[176:179], v[48:51], v[68:71]
  s_waitcnt lgkmcnt(0)
  v_mfma_f32_16x16x32_bf16 v[64:67], v[156:159], v[56:59], v[64:67]
  v_mfma_f32_16x16x32_bf16 v[68:71], v[180:183], v[56:59], v[68:71]
  v_mfma_f32_16x16x32_bf16 v[80:83], v[232:235], v[28:31], 0
  s_mov_b32 s79, 1
  v_mfma_f32_16x16x32_bf16 v[80:83], v[236:239], v[32:35], v[80:83]
  s_nop 0
  v_mfma_f32_16x16x32_bf16 v[80:83], v[240:243], v[36:39], v[80:83]
  s_nop 0
  s_nop 0
  v_mul_f32 v64, v64, v148
  v_mul_f32 v65, v65, v148
  v_mfma_f32_16x16x32_bf16 v[80:83], v[244:247], v[40:43], v[80:83]
  s_mul_i32 s80, s77, 40960
  v_mul_f32 v66, v66, v148
  v_mul_f32 v67, v67, v148
  v_mfma_f32_16x16x32_bf16 v[80:83], v[248:251], v[48:51], v[80:83]
  s_add_u32 s84, s69, s80
  v_mul_f32 v68, v68, v148
  v_mul_f32 v69, v69, v148
  v_mfma_f32_16x16x32_bf16 v[80:83], v[252:255], v[56:59], v[80:83]
  s_add_u32 s85, s68, s80
  v_mul_f32 v70, v70, v148
  v_mul_f32 v71, v71, v148
  v_mfma_f32_16x16x32_bf16 v[72:75], v[184:187], v[28:31], 0
  v_cvt_pk_bf16_f32 v24, v64, v65
  v_cvt_pk_bf16_f32 v25, v66, v67
  v_mfma_f32_16x16x32_bf16 v[76:79], v[208:211], v[28:31], 0
  v_cvt_pk_bf16_f32 v26, v68, v69
  v_mfma_f32_16x16x32_bf16 v[72:75], v[188:191], v[32:35], v[72:75]
  v_cvt_pk_bf16_f32 v27, v70, v71
  v_bfi_b32 v24, 1, s78, v24
  v_mfma_f32_16x16x32_bf16 v[76:79], v[212:215], v[32:35], v[76:79]
  buffer_store_dwordx4 v[24:27], v1, s[4:7], s62 offen offset:0 sc1
  v_mfma_f32_16x16x32_bf16 v[72:75], v[192:195], v[36:39], v[72:75]
  v_mul_f32 v80, v80, v148
  v_mul_f32 v81, v81, v148
  v_mfma_f32_16x16x32_bf16 v[76:79], v[216:219], v[36:39], v[76:79]
  v_mul_f32 v82, v82, v148
  v_mfma_f32_16x16x32_bf16 v[72:75], v[196:199], v[40:43], v[72:75]
  v_mul_f32 v83, v83, v148
  v_cvt_pk_bf16_f32 v54, v80, v81
  v_mfma_f32_16x16x32_bf16 v[76:79], v[220:223], v[40:43], v[76:79]
  v_cvt_pk_bf16_f32 v55, v82, v83
  v_cvt_pk_bf16_f32 v52, v80, v81
  v_mfma_f32_16x16x32_bf16 v[72:75], v[200:203], v[48:51], v[72:75]
  v_cvt_pk_bf16_f32 v53, v82, v83
  v_permlane16_swap_b32 v52, v54
  v_mfma_f32_16x16x32_bf16 v[76:79], v[224:227], v[48:51], v[76:79]
  v_permlane16_swap_b32 v53, v55
  v_bfi_b32 v52, 1, s78, v52
  v_mfma_f32_16x16x32_bf16 v[72:75], v[204:207], v[56:59], v[72:75]
  buffer_store_dwordx4 v[52:55], v6, s[4:7], s63 offen sc1
  v_mfma_f32_16x16x32_bf16 v[76:79], v[228:231], v[56:59], v[76:79]
  s_cmp_ge_u32 s70, 80
  s_nop 5
  v_pk_mul_f32 v[72:73], v[72:73], v[148:149] op_sel_hi:[1,0]
  v_pk_mul_f32 v[74:75], v[74:75], v[148:149] op_sel_hi:[1,0]
  v_pk_mul_f32 v[76:77], v[76:77], v[148:149] op_sel_hi:[1,0]
  v_pk_mul_f32 v[78:79], v[78:79], v[148:149] op_sel_hi:[1,0]
  v_cvt_pk_bf16_f32 v44, v72, v73
  v_cvt_pk_bf16_f32 v45, v74, v75
  v_cvt_pk_bf16_f32 v46, v76, v77
  v_cvt_pk_bf16_f32 v47, v78, v79
  v_bfi_b32 v44, 1, s78, v44
  buffer_store_dwordx4 v[44:47], v1, s[4:7], s62 offen offset:1024 sc1
  s_cbranch_scc1 nrS_26
  s_sleep 5
  buffer_load_dwordx4 v[28:31], v5, s[4:7], s64 offen sc1
  buffer_load_dwordx4 v[32:35], v5, s[4:7], s65 offen sc1
  buffer_load_dwordx4 v[36:39], v5, s[4:7], s66 offen sc1
  buffer_load_dwordx4 v[40:43], v5, s[4:7], s67 offen sc1
  s_waitcnt vmcnt(0)
saS_27:
  v_mfma_f32_16x16x32_bf16 v[84:87], v[16:19], v[28:31], 0
  v_bitop3_b32 v12, v28, v32, s78 bitop3:0x7e
  v_mfma_f32_16x16x32_bf16 v[84:87], v[16:19], v[32:35], v[84:87]
  v_bitop3_b32 v12, v12, v36, s78 bitop3:0xf6
  v_mfma_f32_16x16x32_bf16 v[84:87], v[16:19], v[36:39], v[84:87]
  v_bitop3_b32 v12, v12, v40, s78 bitop3:0xf6
  v_mfma_f32_16x16x32_bf16 v[84:87], v[16:19], v[40:43], v[84:87]
  v_and_b32 v12, 1, v12
  v_cmp_ne_u32 vcc, 0, v12
  s_cbranch_vccnz sbS_28
  s_nop 4
  v_cvt_pk_bf16_f32 v150, v84, v85
  v_cvt_pk_bf16_f32 v151, v86, v87
  v_cvt_pk_bf16_f32 v148, v84, v85
  v_cvt_pk_bf16_f32 v149, v86, v87
  s_mov_b32 exec_hi, 0
  v_permlane16_swap_b32 v148, v150
  v_permlane16_swap_b32 v149, v151
  v_bfi_b32 v148, 1, s79, v148
  buffer_store_dwordx4 v[148:151], v6, s[4:7], s84 offen sc1
  buffer_store_dwordx4 v[148:151], v6, s[4:7], s85 offen sc1
  s_mov_b32 exec_hi, -1
  s_barrier
  buffer_store_dwordx4 v[88:91], v1, s[4:7], s71 offen sc1
  buffer_store_dwordx2 v[92:93], v2, s[4:7], s71 offen offset:1024 sc1
  s_add_u32 s75, s73, 50331648
  s_add_u32 s76, s74, 50331648
  s_mov_b32 s77, s55
  s_xor_b32 s78, s78, 1
  s_add_u32 s71, s71, 393216
  s_add_u32 s72, s72, 8192
  s_sleep 10
  s_branch stepS_9
nrS_26:
  s_waitcnt vmcnt(3)
  s_barrier
  buffer_store_dwordx4 v[88:91], v1, s[4:7], s71 offen sc1
  buffer_store_dwordx2 v[92:93], v2, s[4:7], s71 offen offset:1024 sc1
  s_add_u32 s75, s73, 50331648
  s_add_u32 s76, s74, 50331648
  s_mov_b32 s77, s55
  s_xor_b32 s78, s78, 1
  s_add_u32 s71, s71, 393216
  s_add_u32 s72, s72, 8192
  s_sleep 10
  s_branch stepS_9
p1S_10x:
  s_waitcnt vmcnt(0) lgkmcnt(0)
  s_barrier
  v_bfe_u32 v30, v1, 4, 3
  v_mul_u32_u24 v30, 1280, v30
  v_lshrrev_b32 v31, 8, v1
  v_lshlrev_b32 v31, 4, v31
  v_add_u32 v30, v30, v31
  s_mul_i32 s46, s53, 640
  s_lshl_b32 s47, s3, 6
  s_add_u32 s46, s46, s47
  v_add_u32 v30, s46, v30
  s_lshl_b32 s46, s3, 10
  v_add_u32 v31, s46, v11
  buffer_load_dwordx4 v[64:67], v30, s[12:15], 0 offen offset:0
  buffer_load_dwordx4 v[68:71], v30, s[12:15], 0 offen offset:256
  buffer_load_dwordx4 v[72:75], v30, s[12:15], 0 offen offset:512
  s_waitcnt vmcnt(0)
  s_mov_b32 exec_lo, 0xff00ff00
  s_mov_b32 exec_hi, 0xff00ff00
  ds_write_b128 v31, v[64:67] offset:24576
  ds_write_b128 v31, v[68:71] offset:28672
  s_cmp_ge_u32 s3, 2
  s_cbranch_scc1 m0S_34
  ds_write_b128 v31, v[72:75] offset:32768
m0S_34:
  s_mov_b64 exec, -1
  s_branch p1S_10
kwS_20:
fwS_35:
  s_sub_u32 s46, s82, s81
  s_lshl_b32 s46, s46, 14
  v_mov_b32 v13, s46
  v_cndmask_b32 v13, v13, 0, s[56:57]
  v_and_b32 v12, 16, v1
  v_lshl_add_u32 v13, v12, 3, v13
  buffer_load_dword v13, v13, s[4:7], s95 offen sc1
  s_waitcnt vmcnt(0)
  v_cmp_eq_u32 vcc, 0, v13
  s_cbranch_vccz foS_36
  s_add_u32 s45, s45, 1
  s_cmp_gt_u32 s45, 1048576
  s_cbranch_scc1 failcS_5
  s_sleep 1
  s_branch fwS_35
foS_36:
  s_branch koS_21
sbS_28:
  s_mov_b64 exec, vcc
  buffer_load_dwordx4 v[28:31], v5, s[4:7], s64 offen sc1
  buffer_load_dwordx4 v[32:35], v5, s[4:7], s65 offen sc1
  buffer_load_dwordx4 v[36:39], v5, s[4:7], s66 offen sc1
  buffer_load_dwordx4 v[40:43], v5, s[4:7], s67 offen sc1
  s_mov_b64 exec, -1
  s_add_u32 s45, s45, 1
  s_cmp_gt_u32 s45, 1048576
  s_cbranch_scc1 failcS_5
  s_mov_b32 s18, 1
  s_waitcnt vmcnt(0)
  s_branch saS_27
rtS_13:
  s_mov_b64 exec, vcc
  buffer_load_dwordx4 v[24:27], v3, s[4:7], s80 offen offset:0 sc1
  buffer_load_dwordx4 v[28:31], v3, s[4:7], s80 offen offset:512 sc1
  buffer_load_dwordx4 v[32:35], v3, s[4:7], s80 offen offset:1024 sc1
  buffer_load_dwordx4 v[36:39], v3, s[4:7], s80 offen offset:1536 sc1
  buffer_load_dwordx4 v[40:43], v3, s[4:7], s80 offen offset:2048 sc1
  s_mov_b64 exec, -1
  s_add_u32 s45, s45, 1
  s_cmp_gt_u32 s45, 1048576
  s_cbranch_scc1 failcS_5
  s_waitcnt vmcnt(0)
  s_branch bS_12
rtS_15:
  s_mov_b64 exec, vcc
  buffer_load_dwordx4 v[40:43], v1, s[4:7], s61 offen offset:1536 sc1
  buffer_load_dwordx4 v[44:47], v1, s[4:7], s61 offen offset:3584 sc1
  s_mov_b64 exec, -1
  s_add_u32 s45, s45, 1
  s_cmp_gt_u32 s45, 1048576
  s_cbranch_scc1 failcS_5
  s_waitcnt vmcnt(0)
  s_branch bS_14
rtS_17:
  s_mov_b64 exec, vcc
  buffer_load_dwordx4 v[24:27], v1, s[4:7], s61 offen offset:2560 sc1
  s_mov_b64 exec, -1
  s_add_u32 s45, s45, 1
  s_cmp_gt_u32 s45, 1048576
  s_cbranch_scc1 failcS_5
  s_waitcnt vmcnt(0)
  s_branch bS_16
rtS_23:
  s_mov_b64 exec, vcc
  buffer_load_dwordx4 v[36:39], v1, s[4:7], s61 offen offset:512 sc1
  buffer_load_dwordx2 v[70:71], v2, s[4:7], s61 offen sc1
  s_mov_b64 exec, -1
  s_add_u32 s45, s45, 1
  s_cmp_gt_u32 s45, 1048576
  s_cbranch_scc1 failcS_5
  s_waitcnt vmcnt(0)
  s_branch bS_22
cendS_11:
  s_cmp_eq_u32 s53, 1
  s_cbranch_scc0 nvS_37
  v_mfma_f32_16x16x16_bf16 v[88:91], v[14:15], v[58:59], v[88:91]
  v_mfma_f32_16x16x16_bf16 v[92:95], v[14:15], v[62:63], v[92:95]
  v_mfma_f32_16x16x16_bf16 v[96:99], v[14:15], v[70:71], v[96:99]
  s_nop 7
  v_cvt_pk_bf16_f32 v88, v88, v89
  v_cvt_pk_bf16_f32 v89, v90, v91
  v_cvt_pk_bf16_f32 v90, v92, v93
  v_cvt_pk_bf16_f32 v91, v94, v95
  v_cvt_pk_bf16_f32 v92, v96, v97
  v_cvt_pk_bf16_f32 v93, v98, v99
nvS_37:
  buffer_store_dwordx4 v[88:91], v1, s[4:7], s71 offen sc1
  buffer_store_dwordx2 v[92:93], v2, s[4:7], s71 offen offset:1024 sc1
  s_waitcnt vmcnt(0)
  v_mov_b32 v12, 1
  buffer_store_dword v12, off, s[4:7], s72 sc1
  s_endpgm
failcS_5:
  s_mov_b64 exec, 1
  v_mov_b32 v150, 224
  v_mov_b32 v151, 1
  buffer_atomic_or v151, v150, s[8:11], 0 offen sc1
  s_endpgm
  .p2align 6
R_attS:
  s_sub_u32 s52, s42, 2
  s_lshl_b32 s53, s43, 1
  s_add_u32 s53, s53, s52
  s_mul_i32 s54, s53, 40960
  s_mul_i32 s46, s3, 10240
  s_add_u32 s54, s54, s46
  v_mul_u32_u24 v1, 20, v0
  s_add_u32 s46, s54, 0
  buffer_load_dwordx4 v[8:11], v1, s[12:15], s46 offen
  buffer_load_dword v12, v1, s[12:15], s46 offen offset:16
  s_add_u32 s46, s54, 1280
  buffer_load_dwordx4 v[14:17], v1, s[12:15], s46 offen
  buffer_load_dword v18, v1, s[12:15], s46 offen offset:16
  s_add_u32 s46, s54, 2560
  buffer_load_dwordx4 v[20:23], v1, s[12:15], s46 offen
  buffer_load_dword v24, v1, s[12:15], s46 offen offset:16
  s_add_u32 s46, s54, 3840
  buffer_load_dwordx4 v[26:29], v1, s[12:15], s46 offen
  buffer_load_dword v30, v1, s[12:15], s46 offen offset:16
  s_add_u32 s46, s54, 5120
  buffer_load_dwordx4 v[32:35], v1, s[12:15], s46 offen
  buffer_load_dword v36, v1, s[12:15], s46 offen offset:16
  s_add_u32 s46, s54, 6400
  buffer_load_dwordx4 v[38:41], v1, s[12:15], s46 offen
  buffer_load_dword v42, v1, s[12:15], s46 offen offset:16
  s_add_u32 s46, s54, 7680
  buffer_load_dwordx4 v[44:47], v1, s[12:15], s46 offen
  buffer_load_dword v48, v1, s[12:15], s46 offen offset:16
  s_add_u32 s46, s54, 8960
  buffer_load_dwordx4 v[50:53], v1, s[12:15], s46 offen
  buffer_load_dword v54, v1, s[12:15], s46 offen offset:16
  s_waitcnt vmcnt(14)
  v_lshlrev_b32 v60, 16, v8
  v_and_b32 v61, 0xffff0000, v8
  v_lshlrev_b32 v62, 16, v9
  v_and_b32 v63, 0xffff0000, v9
  v_lshlrev_b32 v64, 16, v10
  v_and_b32 v65, 0xffff0000, v10
  v_lshlrev_b32 v66, 16, v11
  v_and_b32 v67, 0xffff0000, v11
  v_lshlrev_b32 v68, 16, v12
  v_and_b32 v69, 0xffff0000, v12
  v_add_f32 v70, v60, v61
  v_add_f32 v70, v70, v62
  v_add_f32 v70, v70, v63
  v_add_f32 v70, v70, v64
  v_add_f32 v70, v70, v65
  v_add_f32 v70, v70, v66
  v_add_f32 v70, v70, v67
  v_add_f32 v70, v70, v68
  v_add_f32 v70, v70, v69
  s_nop 1
  v_add_f32_dpp v70, v70, v70 quad_perm:[1,0,3,2] row_mask:0xf bank_mask:0xf
  s_nop 1
  v_add_f32_dpp v70, v70, v70 quad_perm:[2,3,0,1] row_mask:0xf bank_mask:0xf
  s_nop 1
  v_add_f32_dpp v70, v70, v70 row_half_mirror row_mask:0xf bank_mask:0xf
  s_nop 1
  v_add_f32_dpp v70, v70, v70 row_mirror row_mask:0xf bank_mask:0xf
  v_mov_b32 v72, v70
  s_nop 1
  v_permlane16_swap_b32 v70, v72
  v_add_f32 v70, v70, v72
  v_mov_b32 v72, v70
  s_nop 1
  v_permlane32_swap_b32 v70, v72
  v_add_f32 v70, v70, v72
  v_mul_f32 v70, 0x3acccccd, v70
  v_sub_f32 v80, v60, v70
  v_sub_f32 v81, v61, v70
  v_sub_f32 v82, v62, v70
  v_sub_f32 v83, v63, v70
  v_sub_f32 v84, v64, v70
  v_sub_f32 v85, v65, v70
  v_sub_f32 v86, v66, v70
  v_sub_f32 v87, v67, v70
  v_sub_f32 v88, v68, v70
  v_sub_f32 v89, v69, v70
  v_mul_f32 v71, v80, v80
  v_fmac_f32 v71, v81, v81
  v_fmac_f32 v71, v82, v82
  v_fmac_f32 v71, v83, v83
  v_fmac_f32 v71, v84, v84
  v_fmac_f32 v71, v85, v85
  v_fmac_f32 v71, v86, v86
  v_fmac_f32 v71, v87, v87
  v_fmac_f32 v71, v88, v88
  v_fmac_f32 v71, v89, v89
  s_nop 1
  v_add_f32_dpp v71, v71, v71 quad_perm:[1,0,3,2] row_mask:0xf bank_mask:0xf
  s_nop 1
  v_add_f32_dpp v71, v71, v71 quad_perm:[2,3,0,1] row_mask:0xf bank_mask:0xf
  s_nop 1
  v_add_f32_dpp v71, v71, v71 row_half_mirror row_mask:0xf bank_mask:0xf
  s_nop 1
  v_add_f32_dpp v71, v71, v71 row_mirror row_mask:0xf bank_mask:0xf
  v_mov_b32 v72, v71
  s_nop 1
  v_permlane16_swap_b32 v71, v72
  v_add_f32 v71, v71, v72
  v_mov_b32 v72, v71
  s_nop 1
  v_permlane32_swap_b32 v71, v72
  v_add_f32 v71, v71, v72
  v_mul_f32 v71, 0x3acccccd, v71
  v_cvt_pk_bf16_f32 v70, v70, v70
  v_and_b32 v70, 0xffff0000, v70
  v_cvt_pk_bf16_f32 v71, v71, v71
  v_and_b32 v71, 0xffff0000, v71
  v_add_f32 v71, 0x3727c5ac, v71
  v_cvt_pk_bf16_f32 v71, v71, v71
  v_and_b32 v71, 0xffff0000, v71
  v_pk_add_f32 v[60:61], v[60:61], v[70:71] op_sel_hi:[1,0] neg_lo:[0,1] neg_hi:[0,1]
  v_pk_add_f32 v[62:63], v[62:63], v[70:71] op_sel_hi:[1,0] neg_lo:[0,1] neg_hi:[0,1]
  v_pk_add_f32 v[64:65], v[64:65], v[70:71] op_sel_hi:[1,0] neg_lo:[0,1] neg_hi:[0,1]
  v_pk_add_f32 v[66:67], v[66:67], v[70:71] op_sel_hi:[1,0] neg_lo:[0,1] neg_hi:[0,1]
  v_pk_add_f32 v[68:69], v[68:69], v[70:71] op_sel_hi:[1,0] neg_lo:[0,1] neg_hi:[0,1]
  v_sqrt_f32 v71, v71
  v_cvt_pk_bf16_f32 v74, v60, v61
  v_cvt_pk_bf16_f32 v75, v62, v63
  v_cvt_pk_bf16_f32 v76, v64, v65
  v_cvt_pk_bf16_f32 v77, v66, v67
  v_cvt_pk_bf16_f32 v78, v68, v69
  v_cvt_pk_bf16_f32 v71, v71, v71
  v_and_b32 v71, 0xffff0000, v71
  v_rcp_f32 v71, v71
  v_lshlrev_b32 v60, 16, v74
  v_and_b32 v61, 0xffff0000, v74
  v_lshlrev_b32 v62, 16, v75
  v_and_b32 v63, 0xffff0000, v75
  v_lshlrev_b32 v64, 16, v76
  v_and_b32 v65, 0xffff0000, v76
  v_lshlrev_b32 v66, 16, v77
  v_and_b32 v67, 0xffff0000, v77
  v_lshlrev_b32 v68, 16, v78
  v_and_b32 v69, 0xffff0000, v78
  v_pk_mul_f32 v[60:61], v[60:61], v[70:71] op_sel:[0,1] op_sel_hi:[1,1]
  v_pk_mul_f32 v[62:63], v[62:63], v[70:71] op_sel:[0,1] op_sel_hi:[1,1]
  v_pk_mul_f32 v[64:65], v[64:65], v[70:71] op_sel:[0,1] op_sel_hi:[1,1]
  v_pk_mul_f32 v[66:67], v[66:67], v[70:71] op_sel:[0,1] op_sel_hi:[1,1]
  v_pk_mul_f32 v[68:69], v[68:69], v[70:71] op_sel:[0,1] op_sel_hi:[1,1]
  v_cvt_pk_bf16_f32 v92, v60, v61
  v_cvt_pk_bf16_f32 v93, v62, v63
  v_cvt_pk_bf16_f32 v94, v64, v65
  v_cvt_pk_bf16_f32 v95, v66, v67
  v_cvt_pk_bf16_f32 v96, v68, v69
  s_add_u32 s46, s54, 18874368
  buffer_store_dwordx4 v[92:95], v1, s[4:7], s46 offen sc1
  buffer_store_dword v96, v1, s[4:7], s46 offen offset:16 sc1
  s_waitcnt vmcnt(14)
  v_lshlrev_b32 v60, 16, v14
  v_and_b32 v61, 0xffff0000, v14
  v_lshlrev_b32 v62, 16, v15
  v_and_b32 v63, 0xffff0000, v15
  v_lshlrev_b32 v64, 16, v16
  v_and_b32 v65, 0xffff0000, v16
  v_lshlrev_b32 v66, 16, v17
  v_and_b32 v67, 0xffff0000, v17
  v_lshlrev_b32 v68, 16, v18
  v_and_b32 v69, 0xffff0000, v18
  v_add_f32 v70, v60, v61
  v_add_f32 v70, v70, v62
  v_add_f32 v70, v70, v63
  v_add_f32 v70, v70, v64
  v_add_f32 v70, v70, v65
  v_add_f32 v70, v70, v66
  v_add_f32 v70, v70, v67
  v_add_f32 v70, v70, v68
  v_add_f32 v70, v70, v69
  s_nop 1
  v_add_f32_dpp v70, v70, v70 quad_perm:[1,0,3,2] row_mask:0xf bank_mask:0xf
  s_nop 1
  v_add_f32_dpp v70, v70, v70 quad_perm:[2,3,0,1] row_mask:0xf bank_mask:0xf
  s_nop 1
  v_add_f32_dpp v70, v70, v70 row_half_mirror row_mask:0xf bank_mask:0xf
  s_nop 1
  v_add_f32_dpp v70, v70, v70 row_mirror row_mask:0xf bank_mask:0xf
  v_mov_b32 v72, v70
  s_nop 1
  v_permlane16_swap_b32 v70, v72
  v_add_f32 v70, v70, v72
  v_mov_b32 v72, v70
  s_nop 1
  v_permlane32_swap_b32 v70, v72
  v_add_f32 v70, v70, v72
  v_mul_f32 v70, 0x3acccccd, v70
  v_sub_f32 v80, v60, v70
  v_sub_f32 v81, v61, v70
  v_sub_f32 v82, v62, v70
  v_sub_f32 v83, v63, v70
  v_sub_f32 v84, v64, v70
  v_sub_f32 v85, v65, v70
  v_sub_f32 v86, v66, v70
  v_sub_f32 v87, v67, v70
  v_sub_f32 v88, v68, v70
  v_sub_f32 v89, v69, v70
  v_mul_f32 v71, v80, v80
  v_fmac_f32 v71, v81, v81
  v_fmac_f32 v71, v82, v82
  v_fmac_f32 v71, v83, v83
  v_fmac_f32 v71, v84, v84
  v_fmac_f32 v71, v85, v85
  v_fmac_f32 v71, v86, v86
  v_fmac_f32 v71, v87, v87
  v_fmac_f32 v71, v88, v88
  v_fmac_f32 v71, v89, v89
  s_nop 1
  v_add_f32_dpp v71, v71, v71 quad_perm:[1,0,3,2] row_mask:0xf bank_mask:0xf
  s_nop 1
  v_add_f32_dpp v71, v71, v71 quad_perm:[2,3,0,1] row_mask:0xf bank_mask:0xf
  s_nop 1
  v_add_f32_dpp v71, v71, v71 row_half_mirror row_mask:0xf bank_mask:0xf
  s_nop 1
  v_add_f32_dpp v71, v71, v71 row_mirror row_mask:0xf bank_mask:0xf
  v_mov_b32 v72, v71
  s_nop 1
  v_permlane16_swap_b32 v71, v72
  v_add_f32 v71, v71, v72
  v_mov_b32 v72, v71
  s_nop 1
  v_permlane32_swap_b32 v71, v72
  v_add_f32 v71, v71, v72
  v_mul_f32 v71, 0x3acccccd, v71
  v_cvt_pk_bf16_f32 v70, v70, v70
  v_and_b32 v70, 0xffff0000, v70
  v_cvt_pk_bf16_f32 v71, v71, v71
  v_and_b32 v71, 0xffff0000, v71
  v_add_f32 v71, 0x3727c5ac, v71
  v_cvt_pk_bf16_f32 v71, v71, v71
  v_and_b32 v71, 0xffff0000, v71
  v_pk_add_f32 v[60:61], v[60:61], v[70:71] op_sel_hi:[1,0] neg_lo:[0,1] neg_hi:[0,1]
  v_pk_add_f32 v[62:63], v[62:63], v[70:71] op_sel_hi:[1,0] neg_lo:[0,1] neg_hi:[0,1]
  v_pk_add_f32 v[64:65], v[64:65], v[70:71] op_sel_hi:[1,0] neg_lo:[0,1] neg_hi:[0,1]
  v_pk_add_f32 v[66:67], v[66:67], v[70:71] op_sel_hi:[1,0] neg_lo:[0,1] neg_hi:[0,1]
  v_pk_add_f32 v[68:69], v[68:69], v[70:71] op_sel_hi:[1,0] neg_lo:[0,1] neg_hi:[0,1]
  v_sqrt_f32 v71, v71
  v_cvt_pk_bf16_f32 v74, v60, v61
  v_cvt_pk_bf16_f32 v75, v62, v63
  v_cvt_pk_bf16_f32 v76, v64, v65
  v_cvt_pk_bf16_f32 v77, v66, v67
  v_cvt_pk_bf16_f32 v78, v68, v69
  v_cvt_pk_bf16_f32 v71, v71, v71
  v_and_b32 v71, 0xffff0000, v71
  v_rcp_f32 v71, v71
  v_lshlrev_b32 v60, 16, v74
  v_and_b32 v61, 0xffff0000, v74
  v_lshlrev_b32 v62, 16, v75
  v_and_b32 v63, 0xffff0000, v75
  v_lshlrev_b32 v64, 16, v76
  v_and_b32 v65, 0xffff0000, v76
  v_lshlrev_b32 v66, 16, v77
  v_and_b32 v67, 0xffff0000, v77
  v_lshlrev_b32 v68, 16, v78
  v_and_b32 v69, 0xffff0000, v78
  v_pk_mul_f32 v[60:61], v[60:61], v[70:71] op_sel:[0,1] op_sel_hi:[1,1]
  v_pk_mul_f32 v[62:63], v[62:63], v[70:71] op_sel:[0,1] op_sel_hi:[1,1]
  v_pk_mul_f32 v[64:65], v[64:65], v[70:71] op_sel:[0,1] op_sel_hi:[1,1]
  v_pk_mul_f32 v[66:67], v[66:67], v[70:71] op_sel:[0,1] op_sel_hi:[1,1]
  v_pk_mul_f32 v[68:69], v[68:69], v[70:71] op_sel:[0,1] op_sel_hi:[1,1]
  v_cvt_pk_bf16_f32 v92, v60, v61
  v_cvt_pk_bf16_f32 v93, v62, v63
  v_cvt_pk_bf16_f32 v94, v64, v65
  v_cvt_pk_bf16_f32 v95, v66, v67
  v_cvt_pk_bf16_f32 v96, v68, v69
  s_add_u32 s46, s54, 18875648
  buffer_store_dwordx4 v[92:95], v1, s[4:7], s46 offen sc1
  buffer_store_dword v96, v1, s[4:7], s46 offen offset:16 sc1
  s_waitcnt vmcnt(14)
  v_lshlrev_b32 v60, 16, v20
  v_and_b32 v61, 0xffff0000, v20
  v_lshlrev_b32 v62, 16, v21
  v_and_b32 v63, 0xffff0000, v21
  v_lshlrev_b32 v64, 16, v22
  v_and_b32 v65, 0xffff0000, v22
  v_lshlrev_b32 v66, 16, v23
  v_and_b32 v67, 0xffff0000, v23
  v_lshlrev_b32 v68, 16, v24
  v_and_b32 v69, 0xffff0000, v24
  v_add_f32 v70, v60, v61
  v_add_f32 v70, v70, v62
  v_add_f32 v70, v70, v63
  v_add_f32 v70, v70, v64
  v_add_f32 v70, v70, v65
  v_add_f32 v70, v70, v66
  v_add_f32 v70, v70, v67
  v_add_f32 v70, v70, v68
  v_add_f32 v70, v70, v69
  s_nop 1
  v_add_f32_dpp v70, v70, v70 quad_perm:[1,0,3,2] row_mask:0xf bank_mask:0xf
  s_nop 1
  v_add_f32_dpp v70, v70, v70 quad_perm:[2,3,0,1] row_mask:0xf bank_mask:0xf
  s_nop 1
  v_add_f32_dpp v70, v70, v70 row_half_mirror row_mask:0xf bank_mask:0xf
  s_nop 1
  v_add_f32_dpp v70, v70, v70 row_mirror row_mask:0xf bank_mask:0xf
  v_mov_b32 v72, v70
  s_nop 1
  v_permlane16_swap_b32 v70, v72
  v_add_f32 v70, v70, v72
  v_mov_b32 v72, v70
  s_nop 1
  v_permlane32_swap_b32 v70, v72
  v_add_f32 v70, v70, v72
  v_mul_f32 v70, 0x3acccccd, v70
  v_sub_f32 v80, v60, v70
  v_sub_f32 v81, v61, v70
  v_sub_f32 v82, v62, v70
  v_sub_f32 v83, v63, v70
  v_sub_f32 v84, v64, v70
  v_sub_f32 v85, v65, v70
  v_sub_f32 v86, v66, v70
  v_sub_f32 v87, v67, v70
  v_sub_f32 v88, v68, v70
  v_sub_f32 v89, v69, v70
  v_mul_f32 v71, v80, v80
  v_fmac_f32 v71, v81, v81
  v_fmac_f32 v71, v82, v82
  v_fmac_f32 v71, v83, v83
  v_fmac_f32 v71, v84, v84
  v_fmac_f32 v71, v85, v85
  v_fmac_f32 v71, v86, v86
  v_fmac_f32 v71, v87, v87
  v_fmac_f32 v71, v88, v88
  v_fmac_f32 v71, v89, v89
  s_nop 1
  v_add_f32_dpp v71, v71, v71 quad_perm:[1,0,3,2] row_mask:0xf bank_mask:0xf
  s_nop 1
  v_add_f32_dpp v71, v71, v71 quad_perm:[2,3,0,1] row_mask:0xf bank_mask:0xf
  s_nop 1
  v_add_f32_dpp v71, v71, v71 row_half_mirror row_mask:0xf bank_mask:0xf
  s_nop 1
  v_add_f32_dpp v71, v71, v71 row_mirror row_mask:0xf bank_mask:0xf
  v_mov_b32 v72, v71
  s_nop 1
  v_permlane16_swap_b32 v71, v72
  v_add_f32 v71, v71, v72
  v_mov_b32 v72, v71
  s_nop 1
  v_permlane32_swap_b32 v71, v72
  v_add_f32 v71, v71, v72
  v_mul_f32 v71, 0x3acccccd, v71
  v_cvt_pk_bf16_f32 v70, v70, v70
  v_and_b32 v70, 0xffff0000, v70
  v_cvt_pk_bf16_f32 v71, v71, v71
  v_and_b32 v71, 0xffff0000, v71
  v_add_f32 v71, 0x3727c5ac, v71
  v_cvt_pk_bf16_f32 v71, v71, v71
  v_and_b32 v71, 0xffff0000, v71
  v_pk_add_f32 v[60:61], v[60:61], v[70:71] op_sel_hi:[1,0] neg_lo:[0,1] neg_hi:[0,1]
  v_pk_add_f32 v[62:63], v[62:63], v[70:71] op_sel_hi:[1,0] neg_lo:[0,1] neg_hi:[0,1]
  v_pk_add_f32 v[64:65], v[64:65], v[70:71] op_sel_hi:[1,0] neg_lo:[0,1] neg_hi:[0,1]
  v_pk_add_f32 v[66:67], v[66:67], v[70:71] op_sel_hi:[1,0] neg_lo:[0,1] neg_hi:[0,1]
  v_pk_add_f32 v[68:69], v[68:69], v[70:71] op_sel_hi:[1,0] neg_lo:[0,1] neg_hi:[0,1]
  v_sqrt_f32 v71, v71
  v_cvt_pk_bf16_f32 v74, v60, v61
  v_cvt_pk_bf16_f32 v75, v62, v63
  v_cvt_pk_bf16_f32 v76, v64, v65
  v_cvt_pk_bf16_f32 v77, v66, v67
  v_cvt_pk_bf16_f32 v78, v68, v69
  v_cvt_pk_bf16_f32 v71, v71, v71
  v_and_b32 v71, 0xffff0000, v71
  v_rcp_f32 v71, v71
  v_lshlrev_b32 v60, 16, v74
  v_and_b32 v61, 0xffff0000, v74
  v_lshlrev_b32 v62, 16, v75
  v_and_b32 v63, 0xffff0000, v75
  v_lshlrev_b32 v64, 16, v76
  v_and_b32 v65, 0xffff0000, v76
  v_lshlrev_b32 v66, 16, v77
  v_and_b32 v67, 0xffff0000, v77
  v_lshlrev_b32 v68, 16, v78
  v_and_b32 v69, 0xffff0000, v78
  v_pk_mul_f32 v[60:61], v[60:61], v[70:71] op_sel:[0,1] op_sel_hi:[1,1]
  v_pk_mul_f32 v[62:63], v[62:63], v[70:71] op_sel:[0,1] op_sel_hi:[1,1]
  v_pk_mul_f32 v[64:65], v[64:65], v[70:71] op_sel:[0,1] op_sel_hi:[1,1]
  v_pk_mul_f32 v[66:67], v[66:67], v[70:71] op_sel:[0,1] op_sel_hi:[1,1]
  v_pk_mul_f32 v[68:69], v[68:69], v[70:71] op_sel:[0,1] op_sel_hi:[1,1]
  v_cvt_pk_bf16_f32 v92, v60, v61
  v_cvt_pk_bf16_f32 v93, v62, v63
  v_cvt_pk_bf16_f32 v94, v64, v65
  v_cvt_pk_bf16_f32 v95, v66, v67
  v_cvt_pk_bf16_f32 v96, v68, v69
  s_add_u32 s46, s54, 18876928
  buffer_store_dwordx4 v[92:95], v1, s[4:7], s46 offen sc1
  buffer_store_dword v96, v1, s[4:7], s46 offen offset:16 sc1
  s_waitcnt vmcnt(14)
  v_lshlrev_b32 v60, 16, v26
  v_and_b32 v61, 0xffff0000, v26
  v_lshlrev_b32 v62, 16, v27
  v_and_b32 v63, 0xffff0000, v27
  v_lshlrev_b32 v64, 16, v28
  v_and_b32 v65, 0xffff0000, v28
  v_lshlrev_b32 v66, 16, v29
  v_and_b32 v67, 0xffff0000, v29
  v_lshlrev_b32 v68, 16, v30
  v_and_b32 v69, 0xffff0000, v30
  v_add_f32 v70, v60, v61
  v_add_f32 v70, v70, v62
  v_add_f32 v70, v70, v63
  v_add_f32 v70, v70, v64
  v_add_f32 v70, v70, v65
  v_add_f32 v70, v70, v66
  v_add_f32 v70, v70, v67
  v_add_f32 v70, v70, v68
  v_add_f32 v70, v70, v69
  s_nop 1
  v_add_f32_dpp v70, v70, v70 quad_perm:[1,0,3,2] row_mask:0xf bank_mask:0xf
  s_nop 1
  v_add_f32_dpp v70, v70, v70 quad_perm:[2,3,0,1] row_mask:0xf bank_mask:0xf
  s_nop 1
  v_add_f32_dpp v70, v70, v70 row_half_mirror row_mask:0xf bank_mask:0xf
  s_nop 1
  v_add_f32_dpp v70, v70, v70 row_mirror row_mask:0xf bank_mask:0xf
  v_mov_b32 v72, v70
  s_nop 1
  v_permlane16_swap_b32 v70, v72
  v_add_f32 v70, v70, v72
  v_mov_b32 v72, v70
  s_nop 1
  v_permlane32_swap_b32 v70, v72
  v_add_f32 v70, v70, v72
  v_mul_f32 v70, 0x3acccccd, v70
  v_sub_f32 v80, v60, v70
  v_sub_f32 v81, v61, v70
  v_sub_f32 v82, v62, v70
  v_sub_f32 v83, v63, v70
  v_sub_f32 v84, v64, v70
  v_sub_f32 v85, v65, v70
  v_sub_f32 v86, v66, v70
  v_sub_f32 v87, v67, v70
  v_sub_f32 v88, v68, v70
  v_sub_f32 v89, v69, v70
  v_mul_f32 v71, v80, v80
  v_fmac_f32 v71, v81, v81
  v_fmac_f32 v71, v82, v82
  v_fmac_f32 v71, v83, v83
  v_fmac_f32 v71, v84, v84
  v_fmac_f32 v71, v85, v85
  v_fmac_f32 v71, v86, v86
  v_fmac_f32 v71, v87, v87
  v_fmac_f32 v71, v88, v88
  v_fmac_f32 v71, v89, v89
  s_nop 1
  v_add_f32_dpp v71, v71, v71 quad_perm:[1,0,3,2] row_mask:0xf bank_mask:0xf
  s_nop 1
  v_add_f32_dpp v71, v71, v71 quad_perm:[2,3,0,1] row_mask:0xf bank_mask:0xf
  s_nop 1
  v_add_f32_dpp v71, v71, v71 row_half_mirror row_mask:0xf bank_mask:0xf
  s_nop 1
  v_add_f32_dpp v71, v71, v71 row_mirror row_mask:0xf bank_mask:0xf
  v_mov_b32 v72, v71
  s_nop 1
  v_permlane16_swap_b32 v71, v72
  v_add_f32 v71, v71, v72
  v_mov_b32 v72, v71
  s_nop 1
  v_permlane32_swap_b32 v71, v72
  v_add_f32 v71, v71, v72
  v_mul_f32 v71, 0x3acccccd, v71
  v_cvt_pk_bf16_f32 v70, v70, v70
  v_and_b32 v70, 0xffff0000, v70
  v_cvt_pk_bf16_f32 v71, v71, v71
  v_and_b32 v71, 0xffff0000, v71
  v_add_f32 v71, 0x3727c5ac, v71
  v_cvt_pk_bf16_f32 v71, v71, v71
  v_and_b32 v71, 0xffff0000, v71
  v_pk_add_f32 v[60:61], v[60:61], v[70:71] op_sel_hi:[1,0] neg_lo:[0,1] neg_hi:[0,1]
  v_pk_add_f32 v[62:63], v[62:63], v[70:71] op_sel_hi:[1,0] neg_lo:[0,1] neg_hi:[0,1]
  v_pk_add_f32 v[64:65], v[64:65], v[70:71] op_sel_hi:[1,0] neg_lo:[0,1] neg_hi:[0,1]
  v_pk_add_f32 v[66:67], v[66:67], v[70:71] op_sel_hi:[1,0] neg_lo:[0,1] neg_hi:[0,1]
  v_pk_add_f32 v[68:69], v[68:69], v[70:71] op_sel_hi:[1,0] neg_lo:[0,1] neg_hi:[0,1]
  v_sqrt_f32 v71, v71
  v_cvt_pk_bf16_f32 v74, v60, v61
  v_cvt_pk_bf16_f32 v75, v62, v63
  v_cvt_pk_bf16_f32 v76, v64, v65
  v_cvt_pk_bf16_f32 v77, v66, v67
  v_cvt_pk_bf16_f32 v78, v68, v69
  v_cvt_pk_bf16_f32 v71, v71, v71
  v_and_b32 v71, 0xffff0000, v71
  v_rcp_f32 v71, v71
  v_lshlrev_b32 v60, 16, v74
  v_and_b32 v61, 0xffff0000, v74
  v_lshlrev_b32 v62, 16, v75
  v_and_b32 v63, 0xffff0000, v75
  v_lshlrev_b32 v64, 16, v76
  v_and_b32 v65, 0xffff0000, v76
  v_lshlrev_b32 v66, 16, v77
  v_and_b32 v67, 0xffff0000, v77
  v_lshlrev_b32 v68, 16, v78
  v_and_b32 v69, 0xffff0000, v78
  v_pk_mul_f32 v[60:61], v[60:61], v[70:71] op_sel:[0,1] op_sel_hi:[1,1]
  v_pk_mul_f32 v[62:63], v[62:63], v[70:71] op_sel:[0,1] op_sel_hi:[1,1]
  v_pk_mul_f32 v[64:65], v[64:65], v[70:71] op_sel:[0,1] op_sel_hi:[1,1]
  v_pk_mul_f32 v[66:67], v[66:67], v[70:71] op_sel:[0,1] op_sel_hi:[1,1]
  v_pk_mul_f32 v[68:69], v[68:69], v[70:71] op_sel:[0,1] op_sel_hi:[1,1]
  v_cvt_pk_bf16_f32 v92, v60, v61
  v_cvt_pk_bf16_f32 v93, v62, v63
  v_cvt_pk_bf16_f32 v94, v64, v65
  v_cvt_pk_bf16_f32 v95, v66, v67
  v_cvt_pk_bf16_f32 v96, v68, v69
  s_add_u32 s46, s54, 18878208
  buffer_store_dwordx4 v[92:95], v1, s[4:7], s46 offen sc1
  buffer_store_dword v96, v1, s[4:7], s46 offen offset:16 sc1
  s_waitcnt vmcnt(14)
  v_lshlrev_b32 v60, 16, v32
  v_and_b32 v61, 0xffff0000, v32
  v_lshlrev_b32 v62, 16, v33
  v_and_b32 v63, 0xffff0000, v33
  v_lshlrev_b32 v64, 16, v34
  v_and_b32 v65, 0xffff0000, v34
  v_lshlrev_b32 v66, 16, v35
  v_and_b32 v67, 0xffff0000, v35
  v_lshlrev_b32 v68, 16, v36
  v_and_b32 v69, 0xffff0000, v36
  v_add_f32 v70, v60, v61
  v_add_f32 v70, v70, v62
  v_add_f32 v70, v70, v63
  v_add_f32 v70, v70, v64
  v_add_f32 v70, v70, v65
  v_add_f32 v70, v70, v66
  v_add_f32 v70, v70, v67
  v_add_f32 v70, v70, v68
  v_add_f32 v70, v70, v69
  s_nop 1
  v_add_f32_dpp v70, v70, v70 quad_perm:[1,0,3,2] row_mask:0xf bank_mask:0xf
  s_nop 1
  v_add_f32_dpp v70, v70, v70 quad_perm:[2,3,0,1] row_mask:0xf bank_mask:0xf
  s_nop 1
  v_add_f32_dpp v70, v70, v70 row_half_mirror row_mask:0xf bank_mask:0xf
  s_nop 1
  v_add_f32_dpp v70, v70, v70 row_mirror row_mask:0xf bank_mask:0xf
  v_mov_b32 v72, v70
  s_nop 1
  v_permlane16_swap_b32 v70, v72
  v_add_f32 v70, v70, v72
  v_mov_b32 v72, v70
  s_nop 1
  v_permlane32_swap_b32 v70, v72
  v_add_f32 v70, v70, v72
  v_mul_f32 v70, 0x3acccccd, v70
  v_sub_f32 v80, v60, v70
  v_sub_f32 v81, v61, v70
  v_sub_f32 v82, v62, v70
  v_sub_f32 v83, v63, v70
  v_sub_f32 v84, v64, v70
  v_sub_f32 v85, v65, v70
  v_sub_f32 v86, v66, v70
  v_sub_f32 v87, v67, v70
  v_sub_f32 v88, v68, v70
  v_sub_f32 v89, v69, v70
  v_mul_f32 v71, v80, v80
  v_fmac_f32 v71, v81, v81
  v_fmac_f32 v71, v82, v82
  v_fmac_f32 v71, v83, v83
  v_fmac_f32 v71, v84, v84
  v_fmac_f32 v71, v85, v85
  v_fmac_f32 v71, v86, v86
  v_fmac_f32 v71, v87, v87
  v_fmac_f32 v71, v88, v88
  v_fmac_f32 v71, v89, v89
  s_nop 1
  v_add_f32_dpp v71, v71, v71 quad_perm:[1,0,3,2] row_mask:0xf bank_mask:0xf
  s_nop 1
  v_add_f32_dpp v71, v71, v71 quad_perm:[2,3,0,1] row_mask:0xf bank_mask:0xf
  s_nop 1
  v_add_f32_dpp v71, v71, v71 row_half_mirror row_mask:0xf bank_mask:0xf
  s_nop 1
  v_add_f32_dpp v71, v71, v71 row_mirror row_mask:0xf bank_mask:0xf
  v_mov_b32 v72, v71
  s_nop 1
  v_permlane16_swap_b32 v71, v72
  v_add_f32 v71, v71, v72
  v_mov_b32 v72, v71
  s_nop 1
  v_permlane32_swap_b32 v71, v72
  v_add_f32 v71, v71, v72
  v_mul_f32 v71, 0x3acccccd, v71
  v_cvt_pk_bf16_f32 v70, v70, v70
  v_and_b32 v70, 0xffff0000, v70
  v_cvt_pk_bf16_f32 v71, v71, v71
  v_and_b32 v71, 0xffff0000, v71
  v_add_f32 v71, 0x3727c5ac, v71
  v_cvt_pk_bf16_f32 v71, v71, v71
  v_and_b32 v71, 0xffff0000, v71
  v_pk_add_f32 v[60:61], v[60:61], v[70:71] op_sel_hi:[1,0] neg_lo:[0,1] neg_hi:[0,1]
  v_pk_add_f32 v[62:63], v[62:63], v[70:71] op_sel_hi:[1,0] neg_lo:[0,1] neg_hi:[0,1]
  v_pk_add_f32 v[64:65], v[64:65], v[70:71] op_sel_hi:[1,0] neg_lo:[0,1] neg_hi:[0,1]
  v_pk_add_f32 v[66:67], v[66:67], v[70:71] op_sel_hi:[1,0] neg_lo:[0,1] neg_hi:[0,1]
  v_pk_add_f32 v[68:69], v[68:69], v[70:71] op_sel_hi:[1,0] neg_lo:[0,1] neg_hi:[0,1]
  v_sqrt_f32 v71, v71
  v_cvt_pk_bf16_f32 v74, v60, v61
  v_cvt_pk_bf16_f32 v75, v62, v63
  v_cvt_pk_bf16_f32 v76, v64, v65
  v_cvt_pk_bf16_f32 v77, v66, v67
  v_cvt_pk_bf16_f32 v78, v68, v69
  v_cvt_pk_bf16_f32 v71, v71, v71
  v_and_b32 v71, 0xffff0000, v71
  v_rcp_f32 v71, v71
  v_lshlrev_b32 v60, 16, v74
  v_and_b32 v61, 0xffff0000, v74
  v_lshlrev_b32 v62, 16, v75
  v_and_b32 v63, 0xffff0000, v75
  v_lshlrev_b32 v64, 16, v76
  v_and_b32 v65, 0xffff0000, v76
  v_lshlrev_b32 v66, 16, v77
  v_and_b32 v67, 0xffff0000, v77
  v_lshlrev_b32 v68, 16, v78
  v_and_b32 v69, 0xffff0000, v78
  v_pk_mul_f32 v[60:61], v[60:61], v[70:71] op_sel:[0,1] op_sel_hi:[1,1]
  v_pk_mul_f32 v[62:63], v[62:63], v[70:71] op_sel:[0,1] op_sel_hi:[1,1]
  v_pk_mul_f32 v[64:65], v[64:65], v[70:71] op_sel:[0,1] op_sel_hi:[1,1]
  v_pk_mul_f32 v[66:67], v[66:67], v[70:71] op_sel:[0,1] op_sel_hi:[1,1]
  v_pk_mul_f32 v[68:69], v[68:69], v[70:71] op_sel:[0,1] op_sel_hi:[1,1]
  v_cvt_pk_bf16_f32 v92, v60, v61
  v_cvt_pk_bf16_f32 v93, v62, v63
  v_cvt_pk_bf16_f32 v94, v64, v65
  v_cvt_pk_bf16_f32 v95, v66, v67
  v_cvt_pk_bf16_f32 v96, v68, v69
  s_add_u32 s46, s54, 18879488
  buffer_store_dwordx4 v[92:95], v1, s[4:7], s46 offen sc1
  buffer_store_dword v96, v1, s[4:7], s46 offen offset:16 sc1
  s_waitcnt vmcnt(14)
  v_lshlrev_b32 v60, 16, v38
  v_and_b32 v61, 0xffff0000, v38
  v_lshlrev_b32 v62, 16, v39
  v_and_b32 v63, 0xffff0000, v39
  v_lshlrev_b32 v64, 16, v40
  v_and_b32 v65, 0xffff0000, v40
  v_lshlrev_b32 v66, 16, v41
  v_and_b32 v67, 0xffff0000, v41
  v_lshlrev_b32 v68, 16, v42
  v_and_b32 v69, 0xffff0000, v42
  v_add_f32 v70, v60, v61
  v_add_f32 v70, v70, v62
  v_add_f32 v70, v70, v63
  v_add_f32 v70, v70, v64
  v_add_f32 v70, v70, v65
  v_add_f32 v70, v70, v66
  v_add_f32 v70, v70, v67
  v_add_f32 v70, v70, v68
  v_add_f32 v70, v70, v69
  s_nop 1
  v_add_f32_dpp v70, v70, v70 quad_perm:[1,0,3,2] row_mask:0xf bank_mask:0xf
  s_nop 1
  v_add_f32_dpp v70, v70, v70 quad_perm:[2,3,0,1] row_mask:0xf bank_mask:0xf
  s_nop 1
  v_add_f32_dpp v70, v70, v70 row_half_mirror row_mask:0xf bank_mask:0xf
  s_nop 1
  v_add_f32_dpp v70, v70, v70 row_mirror row_mask:0xf bank_mask:0xf
  v_mov_b32 v72, v70
  s_nop 1
  v_permlane16_swap_b32 v70, v72
  v_add_f32 v70, v70, v72
  v_mov_b32 v72, v70
  s_nop 1
  v_permlane32_swap_b32 v70, v72
  v_add_f32 v70, v70, v72
  v_mul_f32 v70, 0x3acccccd, v70
  v_sub_f32 v80, v60, v70
  v_sub_f32 v81, v61, v70
  v_sub_f32 v82, v62, v70
  v_sub_f32 v83, v63, v70
  v_sub_f32 v84, v64, v70
  v_sub_f32 v85, v65, v70
  v_sub_f32 v86, v66, v70
  v_sub_f32 v87, v67, v70
  v_sub_f32 v88, v68, v70
  v_sub_f32 v89, v69, v70
  v_mul_f32 v71, v80, v80
  v_fmac_f32 v71, v81, v81
  v_fmac_f32 v71, v82, v82
  v_fmac_f32 v71, v83, v83
  v_fmac_f32 v71, v84, v84
  v_fmac_f32 v71, v85, v85
  v_fmac_f32 v71, v86, v86
  v_fmac_f32 v71, v87, v87
  v_fmac_f32 v71, v88, v88
  v_fmac_f32 v71, v89, v89
  s_nop 1
  v_add_f32_dpp v71, v71, v71 quad_perm:[1,0,3,2] row_mask:0xf bank_mask:0xf
  s_nop 1
  v_add_f32_dpp v71, v71, v71 quad_perm:[2,3,0,1] row_mask:0xf bank_mask:0xf
  s_nop 1
  v_add_f32_dpp v71, v71, v71 row_half_mirror row_mask:0xf bank_mask:0xf
  s_nop 1
  v_add_f32_dpp v71, v71, v71 row_mirror row_mask:0xf bank_mask:0xf
  v_mov_b32 v72, v71
  s_nop 1
  v_permlane16_swap_b32 v71, v72
  v_add_f32 v71, v71, v72
  v_mov_b32 v72, v71
  s_nop 1
  v_permlane32_swap_b32 v71, v72
  v_add_f32 v71, v71, v72
  v_mul_f32 v71, 0x3acccccd, v71
  v_cvt_pk_bf16_f32 v70, v70, v70
  v_and_b32 v70, 0xffff0000, v70
  v_cvt_pk_bf16_f32 v71, v71, v71
  v_and_b32 v71, 0xffff0000, v71
  v_add_f32 v71, 0x3727c5ac, v71
  v_cvt_pk_bf16_f32 v71, v71, v71
  v_and_b32 v71, 0xffff0000, v71
  v_pk_add_f32 v[60:61], v[60:61], v[70:71] op_sel_hi:[1,0] neg_lo:[0,1] neg_hi:[0,1]
  v_pk_add_f32 v[62:63], v[62:63], v[70:71] op_sel_hi:[1,0] neg_lo:[0,1] neg_hi:[0,1]
  v_pk_add_f32 v[64:65], v[64:65], v[70:71] op_sel_hi:[1,0] neg_lo:[0,1] neg_hi:[0,1]
  v_pk_add_f32 v[66:67], v[66:67], v[70:71] op_sel_hi:[1,0] neg_lo:[0,1] neg_hi:[0,1]
  v_pk_add_f32 v[68:69], v[68:69], v[70:71] op_sel_hi:[1,0] neg_lo:[0,1] neg_hi:[0,1]
  v_sqrt_f32 v71, v71
  v_cvt_pk_bf16_f32 v74, v60, v61
  v_cvt_pk_bf16_f32 v75, v62, v63
  v_cvt_pk_bf16_f32 v76, v64, v65
  v_cvt_pk_bf16_f32 v77, v66, v67
  v_cvt_pk_bf16_f32 v78, v68, v69
  v_cvt_pk_bf16_f32 v71, v71, v71
  v_and_b32 v71, 0xffff0000, v71
  v_rcp_f32 v71, v71
  v_lshlrev_b32 v60, 16, v74
  v_and_b32 v61, 0xffff0000, v74
  v_lshlrev_b32 v62, 16, v75
  v_and_b32 v63, 0xffff0000, v75
  v_lshlrev_b32 v64, 16, v76
  v_and_b32 v65, 0xffff0000, v76
  v_lshlrev_b32 v66, 16, v77
  v_and_b32 v67, 0xffff0000, v77
  v_lshlrev_b32 v68, 16, v78
  v_and_b32 v69, 0xffff0000, v78
  v_pk_mul_f32 v[60:61], v[60:61], v[70:71] op_sel:[0,1] op_sel_hi:[1,1]
  v_pk_mul_f32 v[62:63], v[62:63], v[70:71] op_sel:[0,1] op_sel_hi:[1,1]
  v_pk_mul_f32 v[64:65], v[64:65], v[70:71] op_sel:[0,1] op_sel_hi:[1,1]
  v_pk_mul_f32 v[66:67], v[66:67], v[70:71] op_sel:[0,1] op_sel_hi:[1,1]
  v_pk_mul_f32 v[68:69], v[68:69], v[70:71] op_sel:[0,1] op_sel_hi:[1,1]
  v_cvt_pk_bf16_f32 v92, v60, v61
  v_cvt_pk_bf16_f32 v93, v62, v63
  v_cvt_pk_bf16_f32 v94, v64, v65
  v_cvt_pk_bf16_f32 v95, v66, v67
  v_cvt_pk_bf16_f32 v96, v68, v69
  s_add_u32 s46, s54, 18880768
  buffer_store_dwordx4 v[92:95], v1, s[4:7], s46 offen sc1
  buffer_store_dword v96, v1, s[4:7], s46 offen offset:16 sc1
  s_waitcnt vmcnt(14)
  v_lshlrev_b32 v60, 16, v44
  v_and_b32 v61, 0xffff0000, v44
  v_lshlrev_b32 v62, 16, v45
  v_and_b32 v63, 0xffff0000, v45
  v_lshlrev_b32 v64, 16, v46
  v_and_b32 v65, 0xffff0000, v46
  v_lshlrev_b32 v66, 16, v47
  v_and_b32 v67, 0xffff0000, v47
  v_lshlrev_b32 v68, 16, v48
  v_and_b32 v69, 0xffff0000, v48
  v_add_f32 v70, v60, v61
  v_add_f32 v70, v70, v62
  v_add_f32 v70, v70, v63
  v_add_f32 v70, v70, v64
  v_add_f32 v70, v70, v65
  v_add_f32 v70, v70, v66
  v_add_f32 v70, v70, v67
  v_add_f32 v70, v70, v68
  v_add_f32 v70, v70, v69
  s_nop 1
  v_add_f32_dpp v70, v70, v70 quad_perm:[1,0,3,2] row_mask:0xf bank_mask:0xf
  s_nop 1
  v_add_f32_dpp v70, v70, v70 quad_perm:[2,3,0,1] row_mask:0xf bank_mask:0xf
  s_nop 1
  v_add_f32_dpp v70, v70, v70 row_half_mirror row_mask:0xf bank_mask:0xf
  s_nop 1
  v_add_f32_dpp v70, v70, v70 row_mirror row_mask:0xf bank_mask:0xf
  v_mov_b32 v72, v70
  s_nop 1
  v_permlane16_swap_b32 v70, v72
  v_add_f32 v70, v70, v72
  v_mov_b32 v72, v70
  s_nop 1
  v_permlane32_swap_b32 v70, v72
  v_add_f32 v70, v70, v72
  v_mul_f32 v70, 0x3acccccd, v70
  v_sub_f32 v80, v60, v70
  v_sub_f32 v81, v61, v70
  v_sub_f32 v82, v62, v70
  v_sub_f32 v83, v63, v70
  v_sub_f32 v84, v64, v70
  v_sub_f32 v85, v65, v70
  v_sub_f32 v86, v66, v70
  v_sub_f32 v87, v67, v70
  v_sub_f32 v88, v68, v70
  v_sub_f32 v89, v69, v70
  v_mul_f32 v71, v80, v80
  v_fmac_f32 v71, v81, v81
  v_fmac_f32 v71, v82, v82
  v_fmac_f32 v71, v83, v83
  v_fmac_f32 v71, v84, v84
  v_fmac_f32 v71, v85, v85
  v_fmac_f32 v71, v86, v86
  v_fmac_f32 v71, v87, v87
  v_fmac_f32 v71, v88, v88
  v_fmac_f32 v71, v89, v89
  s_nop 1
  v_add_f32_dpp v71, v71, v71 quad_perm:[1,0,3,2] row_mask:0xf bank_mask:0xf
  s_nop 1
  v_add_f32_dpp v71, v71, v71 quad_perm:[2,3,0,1] row_mask:0xf bank_mask:0xf
  s_nop 1
  v_add_f32_dpp v71, v71, v71 row_half_mirror row_mask:0xf bank_mask:0xf
  s_nop 1
  v_add_f32_dpp v71, v71, v71 row_mirror row_mask:0xf bank_mask:0xf
  v_mov_b32 v72, v71
  s_nop 1
  v_permlane16_swap_b32 v71, v72
  v_add_f32 v71, v71, v72
  v_mov_b32 v72, v71
  s_nop 1
  v_permlane32_swap_b32 v71, v72
  v_add_f32 v71, v71, v72
  v_mul_f32 v71, 0x3acccccd, v71
  v_cvt_pk_bf16_f32 v70, v70, v70
  v_and_b32 v70, 0xffff0000, v70
  v_cvt_pk_bf16_f32 v71, v71, v71
  v_and_b32 v71, 0xffff0000, v71
  v_add_f32 v71, 0x3727c5ac, v71
  v_cvt_pk_bf16_f32 v71, v71, v71
  v_and_b32 v71, 0xffff0000, v71
  v_pk_add_f32 v[60:61], v[60:61], v[70:71] op_sel_hi:[1,0] neg_lo:[0,1] neg_hi:[0,1]
  v_pk_add_f32 v[62:63], v[62:63], v[70:71] op_sel_hi:[1,0] neg_lo:[0,1] neg_hi:[0,1]
  v_pk_add_f32 v[64:65], v[64:65], v[70:71] op_sel_hi:[1,0] neg_lo:[0,1] neg_hi:[0,1]
  v_pk_add_f32 v[66:67], v[66:67], v[70:71] op_sel_hi:[1,0] neg_lo:[0,1] neg_hi:[0,1]
  v_pk_add_f32 v[68:69], v[68:69], v[70:71] op_sel_hi:[1,0] neg_lo:[0,1] neg_hi:[0,1]
  v_sqrt_f32 v71, v71
  v_cvt_pk_bf16_f32 v74, v60, v61
  v_cvt_pk_bf16_f32 v75, v62, v63
  v_cvt_pk_bf16_f32 v76, v64, v65
  v_cvt_pk_bf16_f32 v77, v66, v67
  v_cvt_pk_bf16_f32 v78, v68, v69
  v_cvt_pk_bf16_f32 v71, v71, v71
  v_and_b32 v71, 0xffff0000, v71
  v_rcp_f32 v71, v71
  v_lshlrev_b32 v60, 16, v74
  v_and_b32 v61, 0xffff0000, v74
  v_lshlrev_b32 v62, 16, v75
  v_and_b32 v63, 0xffff0000, v75
  v_lshlrev_b32 v64, 16, v76
  v_and_b32 v65, 0xffff0000, v76
  v_lshlrev_b32 v66, 16, v77
  v_and_b32 v67, 0xffff0000, v77
  v_lshlrev_b32 v68, 16, v78
  v_and_b32 v69, 0xffff0000, v78
  v_pk_mul_f32 v[60:61], v[60:61], v[70:71] op_sel:[0,1] op_sel_hi:[1,1]
  v_pk_mul_f32 v[62:63], v[62:63], v[70:71] op_sel:[0,1] op_sel_hi:[1,1]
  v_pk_mul_f32 v[64:65], v[64:65], v[70:71] op_sel:[0,1] op_sel_hi:[1,1]
  v_pk_mul_f32 v[66:67], v[66:67], v[70:71] op_sel:[0,1] op_sel_hi:[1,1]
  v_pk_mul_f32 v[68:69], v[68:69], v[70:71] op_sel:[0,1] op_sel_hi:[1,1]
  v_cvt_pk_bf16_f32 v92, v60, v61
  v_cvt_pk_bf16_f32 v93, v62, v63
  v_cvt_pk_bf16_f32 v94, v64, v65
  v_cvt_pk_bf16_f32 v95, v66, v67
  v_cvt_pk_bf16_f32 v96, v68, v69
  s_add_u32 s46, s54, 18882048
  buffer_store_dwordx4 v[92:95], v1, s[4:7], s46 offen sc1
  buffer_store_dword v96, v1, s[4:7], s46 offen offset:16 sc1
  s_waitcnt vmcnt(14)
  v_lshlrev_b32 v60, 16, v50
  v_and_b32 v61, 0xffff0000, v50
  v_lshlrev_b32 v62, 16, v51
  v_and_b32 v63, 0xffff0000, v51
  v_lshlrev_b32 v64, 16, v52
  v_and_b32 v65, 0xffff0000, v52
  v_lshlrev_b32 v66, 16, v53
  v_and_b32 v67, 0xffff0000, v53
  v_lshlrev_b32 v68, 16, v54
  v_and_b32 v69, 0xffff0000, v54
  v_add_f32 v70, v60, v61
  v_add_f32 v70, v70, v62
  v_add_f32 v70, v70, v63
  v_add_f32 v70, v70, v64
  v_add_f32 v70, v70, v65
  v_add_f32 v70, v70, v66
  v_add_f32 v70, v70, v67
  v_add_f32 v70, v70, v68
  v_add_f32 v70, v70, v69
  s_nop 1
  v_add_f32_dpp v70, v70, v70 quad_perm:[1,0,3,2] row_mask:0xf bank_mask:0xf
  s_nop 1
  v_add_f32_dpp v70, v70, v70 quad_perm:[2,3,0,1] row_mask:0xf bank_mask:0xf
  s_nop 1
  v_add_f32_dpp v70, v70, v70 row_half_mirror row_mask:0xf bank_mask:0xf
  s_nop 1
  v_add_f32_dpp v70, v70, v70 row_mirror row_mask:0xf bank_mask:0xf
  v_mov_b32 v72, v70
  s_nop 1
  v_permlane16_swap_b32 v70, v72
  v_add_f32 v70, v70, v72
  v_mov_b32 v72, v70
  s_nop 1
  v_permlane32_swap_b32 v70, v72
  v_add_f32 v70, v70, v72
  v_mul_f32 v70, 0x3acccccd, v70
  v_sub_f32 v80, v60, v70
  v_sub_f32 v81, v61, v70
  v_sub_f32 v82, v62, v70
  v_sub_f32 v83, v63, v70
  v_sub_f32 v84, v64, v70
  v_sub_f32 v85, v65, v70
  v_sub_f32 v86, v66, v70
  v_sub_f32 v87, v67, v70
  v_sub_f32 v88, v68, v70
  v_sub_f32 v89, v69, v70
  v_mul_f32 v71, v80, v80
  v_fmac_f32 v71, v81, v81
  v_fmac_f32 v71, v82, v82
  v_fmac_f32 v71, v83, v83
  v_fmac_f32 v71, v84, v84
  v_fmac_f32 v71, v85, v85
  v_fmac_f32 v71, v86, v86
  v_fmac_f32 v71, v87, v87
  v_fmac_f32 v71, v88, v88
  v_fmac_f32 v71, v89, v89
  s_nop 1
  v_add_f32_dpp v71, v71, v71 quad_perm:[1,0,3,2] row_mask:0xf bank_mask:0xf
  s_nop 1
  v_add_f32_dpp v71, v71, v71 quad_perm:[2,3,0,1] row_mask:0xf bank_mask:0xf
  s_nop 1
  v_add_f32_dpp v71, v71, v71 row_half_mirror row_mask:0xf bank_mask:0xf
  s_nop 1
  v_add_f32_dpp v71, v71, v71 row_mirror row_mask:0xf bank_mask:0xf
  v_mov_b32 v72, v71
  s_nop 1
  v_permlane16_swap_b32 v71, v72
  v_add_f32 v71, v71, v72
  v_mov_b32 v72, v71
  s_nop 1
  v_permlane32_swap_b32 v71, v72
  v_add_f32 v71, v71, v72
  v_mul_f32 v71, 0x3acccccd, v71
  v_cvt_pk_bf16_f32 v70, v70, v70
  v_and_b32 v70, 0xffff0000, v70
  v_cvt_pk_bf16_f32 v71, v71, v71
  v_and_b32 v71, 0xffff0000, v71
  v_add_f32 v71, 0x3727c5ac, v71
  v_cvt_pk_bf16_f32 v71, v71, v71
  v_and_b32 v71, 0xffff0000, v71
  v_pk_add_f32 v[60:61], v[60:61], v[70:71] op_sel_hi:[1,0] neg_lo:[0,1] neg_hi:[0,1]
  v_pk_add_f32 v[62:63], v[62:63], v[70:71] op_sel_hi:[1,0] neg_lo:[0,1] neg_hi:[0,1]
  v_pk_add_f32 v[64:65], v[64:65], v[70:71] op_sel_hi:[1,0] neg_lo:[0,1] neg_hi:[0,1]
  v_pk_add_f32 v[66:67], v[66:67], v[70:71] op_sel_hi:[1,0] neg_lo:[0,1] neg_hi:[0,1]
  v_pk_add_f32 v[68:69], v[68:69], v[70:71] op_sel_hi:[1,0] neg_lo:[0,1] neg_hi:[0,1]
  v_sqrt_f32 v71, v71
  v_cvt_pk_bf16_f32 v74, v60, v61
  v_cvt_pk_bf16_f32 v75, v62, v63
  v_cvt_pk_bf16_f32 v76, v64, v65
  v_cvt_pk_bf16_f32 v77, v66, v67
  v_cvt_pk_bf16_f32 v78, v68, v69
  v_cvt_pk_bf16_f32 v71, v71, v71
  v_and_b32 v71, 0xffff0000, v71
  v_rcp_f32 v71, v71
  v_lshlrev_b32 v60, 16, v74
  v_and_b32 v61, 0xffff0000, v74
  v_lshlrev_b32 v62, 16, v75
  v_and_b32 v63, 0xffff0000, v75
  v_lshlrev_b32 v64, 16, v76
  v_and_b32 v65, 0xffff0000, v76
  v_lshlrev_b32 v66, 16, v77
  v_and_b32 v67, 0xffff0000, v77
  v_lshlrev_b32 v68, 16, v78
  v_and_b32 v69, 0xffff0000, v78
  v_pk_mul_f32 v[60:61], v[60:61], v[70:71] op_sel:[0,1] op_sel_hi:[1,1]
  v_pk_mul_f32 v[62:63], v[62:63], v[70:71] op_sel:[0,1] op_sel_hi:[1,1]
  v_pk_mul_f32 v[64:65], v[64:65], v[70:71] op_sel:[0,1] op_sel_hi:[1,1]
  v_pk_mul_f32 v[66:67], v[66:67], v[70:71] op_sel:[0,1] op_sel_hi:[1,1]
  v_pk_mul_f32 v[68:69], v[68:69], v[70:71] op_sel:[0,1] op_sel_hi:[1,1]
  v_cvt_pk_bf16_f32 v92, v60, v61
  v_cvt_pk_bf16_f32 v93, v62, v63
  v_cvt_pk_bf16_f32 v94, v64, v65
  v_cvt_pk_bf16_f32 v95, v66, v67
  v_cvt_pk_bf16_f32 v96, v68, v69
  s_add_u32 s46, s54, 18883328
  buffer_store_dwordx4 v[92:95], v1, s[4:7], s46 offen sc1
  buffer_store_dword v96, v1, s[4:7], s46 offen offset:16 sc1
  s_waitcnt vmcnt(0)
  s_lshl_b32 s46, s53, 11
  s_lshl_b32 s47, s3, 9
  s_add_u32 s46, s46, s47
  s_add_u32 s46, s46, 0
  v_mov_b32 v2, 1
  buffer_store_dword v2, off, s[4:7], s46 sc1
  v_add_u32 v40, 0, v0
  v_mul_u32_u24 v41, 26215, v40
  v_lshrrev_b32 v41, 20, v41
  v_mul_u32_u24 v42, 40, v41
  v_sub_u32 v40, v40, v42
  v_lshlrev_b32 v40, 4, v40
  v_mul_u32_u24 v41, 1280, v41
  v_add_u32 v20, v40, v41
  v_add_u32 v40, 64, v0
  v_mul_u32_u24 v41, 26215, v40
  v_lshrrev_b32 v41, 20, v41
  v_mul_u32_u24 v42, 40, v41
  v_sub_u32 v40, v40, v42
  v_lshlrev_b32 v40, 4, v40
  v_mul_u32_u24 v41, 1280, v41
  v_add_u32 v21, v40, v41
  v_add_u32 v40, 128, v0
  v_mul_u32_u24 v41, 26215, v40
  v_lshrrev_b32 v41, 20, v41
  v_mul_u32_u24 v42, 40, v41
  v_sub_u32 v40, v40, v42
  v_lshlrev_b32 v40, 4, v40
  v_mul_u32_u24 v41, 1280, v41
  v_add_u32 v22, v40, v41
  v_add_u32 v40, 192, v0
  v_mul_u32_u24 v41, 26215, v40
  v_lshrrev_b32 v41, 20, v41
  v_mul_u32_u24 v42, 40, v41
  v_sub_u32 v40, v40, v42
  v_lshlrev_b32 v40, 4, v40
  v_mul_u32_u24 v41, 1280, v41
  v_add_u32 v23, v40, v41
  v_add_u32 v40, 256, v0
  v_mul_u32_u24 v41, 26215, v40
  v_lshrrev_b32 v41, 20, v41
  v_mul_u32_u24 v42, 40, v41
  v_sub_u32 v40, v40, v42
  v_lshlrev_b32 v40, 4, v40
  v_mul_u32_u24 v41, 1280, v41
  v_add_u32 v24, v40, v41
  s_mul_i32 s46, s3, 10240
  v_add_u32 v20, s46, v20
  v_add_u32 v21, s46, v21
  v_add_u32 v22, s46, v22
  v_add_u32 v23, s46, v23
  v_add_u32 v24, s46, v24
  s_mul_i32 s46, s43, 245760
  s_and_b32 s47, s43, 1
  s_mul_i32 s57, s47, 640
  s_add_u32 s46, s46, s57
  v_add_u32 v20, s46, v20
  v_add_u32 v21, s46, v21
  v_add_u32 v22, s46, v22
  v_add_u32 v23, s46, v23
  v_add_u32 v24, s46, v24
  s_mul_i32 s57, s47, 491520
  s_sub_u32 s57, 245760, s57
  v_add_u32 v52, s57, v20
  v_add_u32 v53, s57, v21
  v_add_u32 v54, s57, v22
  v_add_u32 v55, s57, v23
  v_add_u32 v56, s57, v24
  v_lshrrev_b32 v40, 4, v0
  v_mul_u32_u24 v40, 4, v40
  v_bfe_u32 v41, v0, 2, 2
  v_add_u32 v40, v40, v41
  v_mul_u32_u24 v40, 640, v40
  v_and_b32 v41, 3, v0
  v_mul_u32_u24 v41, 8, v41
  v_add_u32 v29, v40, v41
  s_mul_i32 s46, s3, 160
  v_add_u32 v29, s46, v29
  v_add_u32 v30, 0x10000, v29
  v_add_u32 v31, 0x20000, v29
  s_mul_i32 s56, s3, 5120
  s_mov_b32 s60, s26
  s_and_b32 s61, s27, 0xffff
  s_mov_b32 s62, 7864320
  s_mov_b32 s63, 0x20000
  s_sleep 127
  s_sleep 127
  s_mov_b32 s46, 0
  s_add_u32 m0, s56, 0
  s_nop 0
  buffer_load_dwordx4 v20, s[60:63], s46 offen lds
  s_mov_b32 s46, 0
  s_add_u32 m0, s56, 1024
  s_nop 0
  buffer_load_dwordx4 v21, s[60:63], s46 offen lds
  s_mov_b32 s46, 0
  s_add_u32 m0, s56, 2048
  s_nop 0
  buffer_load_dwordx4 v22, s[60:63], s46 offen lds
  s_mov_b32 s46, 0
  s_add_u32 m0, s56, 3072
  s_nop 0
  buffer_load_dwordx4 v23, s[60:63], s46 offen lds
  s_mov_b32 s46, 0
  s_add_u32 m0, s56, 4096
  s_nop 0
  buffer_load_dwordx4 v24, s[60:63], s46 offen lds
  s_mov_b32 s46, 40960
  s_add_u32 m0, s56, 20480
  s_nop 0
  buffer_load_dwordx4 v20, s[60:63], s46 offen lds
  s_mov_b32 s46, 40960
  s_add_u32 m0, s56, 21504
  s_nop 0
  buffer_load_dwordx4 v21, s[60:63], s46 offen lds
  s_mov_b32 s46, 40960
  s_add_u32 m0, s56, 22528
  s_nop 0
  buffer_load_dwordx4 v22, s[60:63], s46 offen lds
  s_mov_b32 s46, 40960
  s_add_u32 m0, s56, 23552
  s_nop 0
  buffer_load_dwordx4 v23, s[60:63], s46 offen lds
  s_mov_b32 s46, 40960
  s_add_u32 m0, s56, 24576
  s_nop 0
  buffer_load_dwordx4 v24, s[60:63], s46 offen lds
  s_mov_b32 s46, 81920
  s_add_u32 m0, s56, 40960
  s_nop 0
  buffer_load_dwordx4 v20, s[60:63], s46 offen lds
  s_mov_b32 s46, 81920
  s_add_u32 m0, s56, 41984
  s_nop 0
  buffer_load_dwordx4 v21, s[60:63], s46 offen lds
  s_mov_b32 s46, 81920
  s_add_u32 m0, s56, 43008
  s_nop 0
  buffer_load_dwordx4 v22, s[60:63], s46 offen lds
  s_mov_b32 s46, 81920
  s_add_u32 m0, s56, 44032
  s_nop 0
  buffer_load_dwordx4 v23, s[60:63], s46 offen lds
  s_mov_b32 s46, 81920
  s_add_u32 m0, s56, 45056
  s_nop 0
  buffer_load_dwordx4 v24, s[60:63], s46 offen lds
  s_mov_b32 s46, 122880
  s_add_u32 m0, s56, 61440
  s_nop 0
  buffer_load_dwordx4 v20, s[60:63], s46 offen lds
  s_mov_b32 s46, 122880
  s_add_u32 m0, s56, 62464
  s_nop 0
  buffer_load_dwordx4 v21, s[60:63], s46 offen lds
  s_mov_b32 s46, 122880
  s_add_u32 m0, s56, 63488
  s_nop 0
  buffer_load_dwordx4 v22, s[60:63], s46 offen lds
  s_mov_b32 s46, 122880
  s_add_u32 m0, s56, 64512
  s_nop 0
  buffer_load_dwordx4 v23, s[60:63], s46 offen lds
  s_mov_b32 s46, 122880
  s_add_u32 m0, s56, 65536
  s_nop 0
  buffer_load_dwordx4 v24, s[60:63], s46 offen lds
  s_mov_b32 s46, 163840
  s_add_u32 m0, s56, 81920
  s_nop 0
  buffer_load_dwordx4 v20, s[60:63], s46 offen lds
  s_mov_b32 s46, 163840
  s_add_u32 m0, s56, 82944
  s_nop 0
  buffer_load_dwordx4 v21, s[60:63], s46 offen lds
  s_mov_b32 s46, 163840
  s_add_u32 m0, s56, 83968
  s_nop 0
  buffer_load_dwordx4 v22, s[60:63], s46 offen lds
  s_mov_b32 s46, 163840
  s_add_u32 m0, s56, 84992
  s_nop 0
  buffer_load_dwordx4 v23, s[60:63], s46 offen lds
  s_mov_b32 s46, 163840
  s_add_u32 m0, s56, 86016
  s_nop 0
  buffer_load_dwordx4 v24, s[60:63], s46 offen lds
  s_mov_b32 s46, 204800
  s_add_u32 m0, s56, 102400
  s_nop 0
  buffer_load_dwordx4 v20, s[60:63], s46 offen lds
  s_mov_b32 s46, 204800
  s_add_u32 m0, s56, 103424
  s_nop 0
  buffer_load_dwordx4 v21, s[60:63], s46 offen lds
  s_mov_b32 s46, 204800
  s_add_u32 m0, s56, 104448
  s_nop 0
  buffer_load_dwordx4 v22, s[60:63], s46 offen lds
  s_mov_b32 s46, 204800
  s_add_u32 m0, s56, 105472
  s_nop 0
  buffer_load_dwordx4 v23, s[60:63], s46 offen lds
  s_mov_b32 s46, 204800
  s_add_u32 m0, s56, 106496
  s_nop 0
  buffer_load_dwordx4 v24, s[60:63], s46 offen lds
  s_mov_b32 s46, 0
  s_add_u32 m0, s56, 122880
  s_nop 0
  buffer_load_dwordx4 v52, s[60:63], s46 offen lds
  s_mov_b32 s46, 0
  s_add_u32 m0, s56, 123904
  s_nop 0
  buffer_load_dwordx4 v53, s[60:63], s46 offen lds
  s_mov_b32 s46, 0
  s_add_u32 m0, s56, 124928
  s_nop 0
  buffer_load_dwordx4 v54, s[60:63], s46 offen lds
  s_mov_b32 s46, 0
  s_add_u32 m0, s56, 125952
  s_nop 0
  buffer_load_dwordx4 v55, s[60:63], s46 offen lds
  s_mov_b32 s46, 0
  s_add_u32 m0, s56, 126976
  s_nop 0
  buffer_load_dwordx4 v56, s[60:63], s46 offen lds
  s_mov_b32 s46, 40960
  s_add_u32 m0, s56, 143360
  s_nop 0
  buffer_load_dwordx4 v52, s[60:63], s46 offen lds
  s_mov_b32 s46, 40960
  s_add_u32 m0, s56, 144384
  s_nop 0
  buffer_load_dwordx4 v53, s[60:63], s46 offen lds
  s_mov_b32 s46, 40960
  s_add_u32 m0, s56, 145408
  s_nop 0
  buffer_load_dwordx4 v54, s[60:63], s46 offen lds
  s_mov_b32 s46, 40960
  s_add_u32 m0, s56, 146432
  s_nop 0
  buffer_load_dwordx4 v55, s[60:63], s46 offen lds
  s_mov_b32 s46, 40960
  s_add_u32 m0, s56, 147456
  s_nop 0
  buffer_load_dwordx4 v56, s[60:63], s46 offen lds
  s_waitcnt vmcnt(35)
  s_barrier
  ds_read_b64_tr_b16 a[0:1], v29 offset:0
  ds_read_b64_tr_b16 a[2:3], v29 offset:10240
  ds_read_b64_tr_b16 a[48:49], v29 offset:32
  ds_read_b64_tr_b16 a[50:51], v29 offset:10272
  ds_read_b64_tr_b16 a[96:97], v29 offset:64
  ds_read_b64_tr_b16 a[98:99], v29 offset:10304
  ds_read_b64_tr_b16 a[144:145], v29 offset:96
  ds_read_b64_tr_b16 a[146:147], v29 offset:10336
  ds_read_b64_tr_b16 a[192:193], v29 offset:128
  ds_read_b64_tr_b16 a[194:195], v29 offset:10368
  s_waitcnt lgkmcnt(0)
  s_waitcnt vmcnt(30)
  s_barrier
  s_mov_b32 s46, 81920
  s_add_u32 m0, s56, 0
  s_nop 0
  buffer_load_dwordx4 v52, s[60:63], s46 offen lds
  s_mov_b32 s46, 81920
  s_add_u32 m0, s56, 1024
  s_nop 0
  buffer_load_dwordx4 v53, s[60:63], s46 offen lds
  s_mov_b32 s46, 81920
  s_add_u32 m0, s56, 2048
  s_nop 0
  buffer_load_dwordx4 v54, s[60:63], s46 offen lds
  s_mov_b32 s46, 81920
  s_add_u32 m0, s56, 3072
  s_nop 0
  buffer_load_dwordx4 v55, s[60:63], s46 offen lds
  s_mov_b32 s46, 81920
  s_add_u32 m0, s56, 4096
  s_nop 0
  buffer_load_dwordx4 v56, s[60:63], s46 offen lds
  ds_read_b64_tr_b16 a[4:5], v29 offset:20480
  ds_read_b64_tr_b16 a[6:7], v29 offset:30720
  ds_read_b64_tr_b16 a[52:53], v29 offset:20512
  ds_read_b64_tr_b16 a[54:55], v29 offset:30752
  ds_read_b64_tr_b16 a[100:101], v29 offset:20544
  ds_read_b64_tr_b16 a[102:103], v29 offset:30784
  ds_read_b64_tr_b16 a[148:149], v29 offset:20576
  ds_read_b64_tr_b16 a[150:151], v29 offset:30816
  ds_read_b64_tr_b16 a[196:197], v29 offset:20608
  ds_read_b64_tr_b16 a[198:199], v29 offset:30848
  s_waitcnt lgkmcnt(0)
  s_waitcnt vmcnt(30)
  s_barrier
  s_mov_b32 s46, 122880
  s_add_u32 m0, s56, 20480
  s_nop 0
  buffer_load_dwordx4 v52, s[60:63], s46 offen lds
  s_mov_b32 s46, 122880
  s_add_u32 m0, s56, 21504
  s_nop 0
  buffer_load_dwordx4 v53, s[60:63], s46 offen lds
  s_mov_b32 s46, 122880
  s_add_u32 m0, s56, 22528
  s_nop 0
  buffer_load_dwordx4 v54, s[60:63], s46 offen lds
  s_mov_b32 s46, 122880
  s_add_u32 m0, s56, 23552
  s_nop 0
  buffer_load_dwordx4 v55, s[60:63], s46 offen lds
  s_mov_b32 s46, 122880
  s_add_u32 m0, s56, 24576
  s_nop 0
  buffer_load_dwordx4 v56, s[60:63], s46 offen lds
  ds_read_b64_tr_b16 a[8:9], v29 offset:40960
  ds_read_b64_tr_b16 a[10:11], v29 offset:51200
  ds_read_b64_tr_b16 a[56:57], v29 offset:40992
  ds_read_b64_tr_b16 a[58:59], v29 offset:51232
  ds_read_b64_tr_b16 a[104:105], v29 offset:41024
  ds_read_b64_tr_b16 a[106:107], v29 offset:51264
  ds_read_b64_tr_b16 a[152:153], v29 offset:41056
  ds_read_b64_tr_b16 a[154:155], v29 offset:51296
  ds_read_b64_tr_b16 a[200:201], v29 offset:41088
  ds_read_b64_tr_b16 a[202:203], v29 offset:51328
  s_waitcnt lgkmcnt(0)
  s_waitcnt vmcnt(30)
  s_barrier
  s_mov_b32 s46, 163840
  s_add_u32 m0, s56, 40960
  s_nop 0
  buffer_load_dwordx4 v52, s[60:63], s46 offen lds
  s_mov_b32 s46, 163840
  s_add_u32 m0, s56, 41984
  s_nop 0
  buffer_load_dwordx4 v53, s[60:63], s46 offen lds
  s_mov_b32 s46, 163840
  s_add_u32 m0, s56, 43008
  s_nop 0
  buffer_load_dwordx4 v54, s[60:63], s46 offen lds
  s_mov_b32 s46, 163840
  s_add_u32 m0, s56, 44032
  s_nop 0
  buffer_load_dwordx4 v55, s[60:63], s46 offen lds
  s_mov_b32 s46, 163840
  s_add_u32 m0, s56, 45056
  s_nop 0
  buffer_load_dwordx4 v56, s[60:63], s46 offen lds
  ds_read_b64_tr_b16 a[12:13], v29 offset:61440
  ds_read_b64_tr_b16 a[14:15], v30 offset:6144
  ds_read_b64_tr_b16 a[60:61], v29 offset:61472
  ds_read_b64_tr_b16 a[62:63], v30 offset:6176
  ds_read_b64_tr_b16 a[108:109], v29 offset:61504
  ds_read_b64_tr_b16 a[110:111], v30 offset:6208
  ds_read_b64_tr_b16 a[156:157], v29 offset:61536
  ds_read_b64_tr_b16 a[158:159], v30 offset:6240
  ds_read_b64_tr_b16 a[204:205], v29 offset:61568
  ds_read_b64_tr_b16 a[206:207], v30 offset:6272
  s_waitcnt lgkmcnt(0)
  s_waitcnt vmcnt(30)
  s_barrier
  s_mov_b32 s46, 204800
  s_add_u32 m0, s56, 61440
  s_nop 0
  buffer_load_dwordx4 v52, s[60:63], s46 offen lds
  s_mov_b32 s46, 204800
  s_add_u32 m0, s56, 62464
  s_nop 0
  buffer_load_dwordx4 v53, s[60:63], s46 offen lds
  s_mov_b32 s46, 204800
  s_add_u32 m0, s56, 63488
  s_nop 0
  buffer_load_dwordx4 v54, s[60:63], s46 offen lds
  s_mov_b32 s46, 204800
  s_add_u32 m0, s56, 64512
  s_nop 0
  buffer_load_dwordx4 v55, s[60:63], s46 offen lds
  s_mov_b32 s46, 204800
  s_add_u32 m0, s56, 65536
  s_nop 0
  buffer_load_dwordx4 v56, s[60:63], s46 offen lds
  ds_read_b64_tr_b16 a[16:17], v30 offset:16384
  ds_read_b64_tr_b16 a[18:19], v30 offset:26624
  ds_read_b64_tr_b16 a[64:65], v30 offset:16416
  ds_read_b64_tr_b16 a[66:67], v30 offset:26656
  ds_read_b64_tr_b16 a[112:113], v30 offset:16448
  ds_read_b64_tr_b16 a[114:115], v30 offset:26688
  ds_read_b64_tr_b16 a[160:161], v30 offset:16480
  ds_read_b64_tr_b16 a[162:163], v30 offset:26720
  ds_read_b64_tr_b16 a[208:209], v30 offset:16512
  ds_read_b64_tr_b16 a[210:211], v30 offset:26752
  s_waitcnt lgkmcnt(0)
  s_waitcnt vmcnt(30)
  s_barrier
  ds_read_b64_tr_b16 a[20:21], v30 offset:36864
  ds_read_b64_tr_b16 a[22:23], v30 offset:47104
  ds_read_b64_tr_b16 a[68:69], v30 offset:36896
  ds_read_b64_tr_b16 a[70:71], v30 offset:47136
  ds_read_b64_tr_b16 a[116:117], v30 offset:36928
  ds_read_b64_tr_b16 a[118:119], v30 offset:47168
  ds_read_b64_tr_b16 a[164:165], v30 offset:36960
  ds_read_b64_tr_b16 a[166:167], v30 offset:47200
  ds_read_b64_tr_b16 a[212:213], v30 offset:36992
  ds_read_b64_tr_b16 a[214:215], v30 offset:47232
  s_waitcnt lgkmcnt(0)
  s_waitcnt vmcnt(25)
  s_barrier
  ds_read_b64_tr_b16 a[24:25], v30 offset:57344
  ds_read_b64_tr_b16 a[26:27], v31 offset:2048
  ds_read_b64_tr_b16 a[72:73], v30 offset:57376
  ds_read_b64_tr_b16 a[74:75], v31 offset:2080
  ds_read_b64_tr_b16 a[120:121], v30 offset:57408
  ds_read_b64_tr_b16 a[122:123], v31 offset:2112
  ds_read_b64_tr_b16 a[168:169], v30 offset:57440
  ds_read_b64_tr_b16 a[170:171], v31 offset:2144
  ds_read_b64_tr_b16 a[216:217], v30 offset:57472
  ds_read_b64_tr_b16 a[218:219], v31 offset:2176
  s_waitcnt lgkmcnt(0)
  s_waitcnt vmcnt(20)
  s_barrier
  ds_read_b64_tr_b16 a[28:29], v31 offset:12288
  ds_read_b64_tr_b16 a[30:31], v31 offset:22528
  ds_read_b64_tr_b16 a[76:77], v31 offset:12320
  ds_read_b64_tr_b16 a[78:79], v31 offset:22560
  ds_read_b64_tr_b16 a[124:125], v31 offset:12352
  ds_read_b64_tr_b16 a[126:127], v31 offset:22592
  ds_read_b64_tr_b16 a[172:173], v31 offset:12384
  ds_read_b64_tr_b16 a[174:175], v31 offset:22624
  ds_read_b64_tr_b16 a[220:221], v31 offset:12416
  ds_read_b64_tr_b16 a[222:223], v31 offset:22656
  s_waitcnt lgkmcnt(0)
  s_waitcnt vmcnt(15)
  s_barrier
  ds_read_b64_tr_b16 a[32:33], v29 offset:0
  ds_read_b64_tr_b16 a[34:35], v29 offset:10240
  ds_read_b64_tr_b16 a[80:81], v29 offset:32
  ds_read_b64_tr_b16 a[82:83], v29 offset:10272
  ds_read_b64_tr_b16 a[128:129], v29 offset:64
  ds_read_b64_tr_b16 a[130:131], v29 offset:10304
  ds_read_b64_tr_b16 a[176:177], v29 offset:96
  ds_read_b64_tr_b16 a[178:179], v29 offset:10336
  ds_read_b64_tr_b16 a[224:225], v29 offset:128
  ds_read_b64_tr_b16 a[226:227], v29 offset:10368
  s_waitcnt lgkmcnt(0)
  s_waitcnt vmcnt(10)
  s_barrier
  ds_read_b64_tr_b16 a[36:37], v29 offset:20480
  ds_read_b64_tr_b16 a[38:39], v29 offset:30720
  ds_read_b64_tr_b16 a[84:85], v29 offset:20512
  ds_read_b64_tr_b16 a[86:87], v29 offset:30752
  ds_read_b64_tr_b16 a[132:133], v29 offset:20544
  ds_read_b64_tr_b16 a[134:135], v29 offset:30784
  ds_read_b64_tr_b16 a[180:181], v29 offset:20576
  ds_read_b64_tr_b16 a[182:183], v29 offset:30816
  ds_read_b64_tr_b16 a[228:229], v29 offset:20608
  ds_read_b64_tr_b16 a[230:231], v29 offset:30848
  s_waitcnt lgkmcnt(0)
  s_waitcnt vmcnt(5)
  s_barrier
  ds_read_b64_tr_b16 a[40:41], v29 offset:40960
  ds_read_b64_tr_b16 a[42:43], v29 offset:51200
  ds_read_b64_tr_b16 a[88:89], v29 offset:40992
  ds_read_b64_tr_b16 a[90:91], v29 offset:51232
  ds_read_b64_tr_b16 a[136:137], v29 offset:41024
  ds_read_b64_tr_b16 a[138:139], v29 offset:51264
  ds_read_b64_tr_b16 a[184:185], v29 offset:41056
  ds_read_b64_tr_b16 a[186:187], v29 offset:51296
  ds_read_b64_tr_b16 a[232:233], v29 offset:41088
  ds_read_b64_tr_b16 a[234:235], v29 offset:51328
  s_waitcnt lgkmcnt(0)
  s_waitcnt vmcnt(0)
  s_barrier
  ds_read_b64_tr_b16 a[44:45], v29 offset:61440
  ds_read_b64_tr_b16 a[46:47], v30 offset:6144
  ds_read_b64_tr_b16 a[92:93], v29 offset:61472
  ds_read_b64_tr_b16 a[94:95], v30 offset:6176
  ds_read_b64_tr_b16 a[140:141], v29 offset:61504
  ds_read_b64_tr_b16 a[142:143], v30 offset:6208
  ds_read_b64_tr_b16 a[188:189], v29 offset:61536
  ds_read_b64_tr_b16 a[190:191], v30 offset:6240
  ds_read_b64_tr_b16 a[236:237], v29 offset:61568
  ds_read_b64_tr_b16 a[238:239], v30 offset:6272
  s_waitcnt lgkmcnt(0)
  s_barrier
  s_mov_b32 s48, 0x00ff00ff
  s_mov_b32 s49, 0x00ff00ff
  s_mov_b32 s50, 0x00ff00ff
  s_mov_b32 s51, 0xff00ff00
  v_and_b32 v30, 1, v0
  v_lshlrev_b32 v30, 4, v30
  v_mov_b32 v31, 0x3f80
  v_lshlrev_b32 v30, v30, v31
  v_bfe_u32 v31, v0, 1, 2
  v_cmp_eq_u32 vcc, 0, v31
  s_nop 1
  v_cndmask_b32 v24, 0, v30, vcc
  v_cmp_eq_u32 vcc, 1, v31
  s_nop 1
  v_cndmask_b32 v25, 0, v30, vcc
  v_cmp_eq_u32 vcc, 2, v31
  s_nop 1
  v_cndmask_b32 v26, 0, v30, vcc
  v_cmp_eq_u32 vcc, 3, v31
  s_nop 1
  v_cndmask_b32 v27, 0, v30, vcc
  v_cndmask_b32 v20, 0, v24, s[50:51]
  v_cndmask_b32 v21, 0, v25, s[50:51]
  v_cndmask_b32 v22, 0, v26, s[50:51]
  v_cndmask_b32 v23, 0, v27, s[50:51]
  s_mov_b32 s56, 0x03ff03ff
  s_mov_b32 s57, 0x03ff03ff
  s_and_b32 s53, s3, 1
  s_lshr_b32 s54, s3, 1
  v_lshlrev_b32 v1, 4, v0
  v_lshlrev_b32 v2, 5, v0
  v_lshlrev_b32 v30, 3, v0
  s_lshl_b32 s46, s53, 10
  v_add_u32 v3, s46, v1
  s_lshl_b32 s46, s53, 3
  v_add_u32 v4, s46, v1
  s_mul_i32 s46, s54, 6144
  v_add_u32 v5, s46, v1
  v_add_u32 v6, 36864, v1
  v_add_u32 v11, 36864, v30
  s_mul_i32 s46, s54, 3072
  v_add_u32 v7, s46, v6
  v_add_u32 v8, s46, v11
  s_mul_i32 s46, s53, 6144
  s_mul_i32 s47, s54, 3072
  s_add_u32 s46, s46, s47
  s_add_u32 s46, s46, 49152
  v_add_u32 v9, s46, v1
  v_add_u32 v10, 49152, v1
  s_mul_i32 s46, s3, 5632
  s_add_u32 s46, s46, 74752
  v_and_b32 v33, 15, v0
  v_mul_u32_u24 v33, 176, v33
  v_lshrrev_b32 v34, 4, v0
  v_lshlrev_b32 v34, 3, v34
  v_add3_u32 v12, v33, v34, s46
  v_add_u32 v33, 0, v0
  v_mul_u32_u24 v34, 6554, v33
  v_lshrrev_b32 v34, 16, v34
  v_add_u32 v33, v33, v34
  v_lshlrev_b32 v33, 4, v33
  v_add_u32 v26, s46, v33
  v_add_u32 v33, 64, v0
  v_mul_u32_u24 v34, 6554, v33
  v_lshrrev_b32 v34, 16, v34
  v_add_u32 v33, v33, v34
  v_lshlrev_b32 v33, 4, v33
  v_add_u32 v27, s46, v33
  v_add_u32 v33, 128, v0
  v_mul_u32_u24 v34, 6554, v33
  v_lshrrev_b32 v34, 16, v34
  v_add_u32 v33, v33, v34
  v_lshlrev_b32 v33, 4, v33
  v_add_u32 v28, s46, v33
  v_add_u32 v33, 192, v0
  v_mul_u32_u24 v34, 6554, v33
  v_lshrrev_b32 v34, 16, v34
  v_add_u32 v33, v33, v34
  v_lshlrev_b32 v33, 4, v33
  v_add_u32 v29, s46, v33
  v_add_u32 v33, 256, v0
  v_mul_u32_u24 v34, 6554, v33
  v_lshrrev_b32 v34, 16, v34
  v_add_u32 v33, v33, v34
  v_lshlrev_b32 v33, 4, v33
  v_add_u32 v30, s46, v33
  v_and_b32 v31, 15, v0
  v_lshrrev_b32 v32, 4, v0
  v_lshrrev_b32 v36, 5, v0
  v_lshlrev_b32 v34, 4, v31
  v_mov_b32 v35, 0x40000000
  v_cndmask_b32 v35, v35, 0, s[56:57]
  v_add_u32 v33, v34, v35
  v_and_b32 v34, 1, v32
  v_mul_u32_u24 v35, 40960, v34
  v_mul_u32_u24 v37, 5120, v36
  v_add3_u32 v14, v33, v35, v37
  v_lshlrev_b32 v34, 3, v34
  v_mul_u32_u24 v37, 160, v36
  v_add3_u32 v33, v33, v34, v37
  s_mul_i32 s46, s3, 320
  v_add_u32 v15, s46, v33
  s_lshl_b32 s46, s3, 3
  s_add_u32 s46, s46, 73728
  v_mov_b32 v16, s46
  v_mov_b32 v17, 73728
  v_lshlrev_b32 v32, 2, v32
  s_cmp_eq_u32 s53, 1
  s_cselect_b64 s[46:47], -1, 0
  v_add_u32 v33, 0, v32
  v_cmp_le_u32 vcc, v33, v31
  s_or_b64 s[64:65], vcc, s[46:47]
  s_and_b64 s[72:73], vcc, s[46:47]
  v_add_u32 v33, 1, v32
  v_cmp_le_u32 vcc, v33, v31
  s_or_b64 s[66:67], vcc, s[46:47]
  s_and_b64 s[74:75], vcc, s[46:47]
  v_add_u32 v33, 2, v32
  v_cmp_le_u32 vcc, v33, v31
  s_or_b64 s[68:69], vcc, s[46:47]
  s_and_b64 s[76:77], vcc, s[46:47]
  v_add_u32 v33, 3, v32
  v_cmp_le_u32 vcc, v33, v31
  s_or_b64 s[70:71], vcc, s[46:47]
  s_and_b64 s[78:79], vcc, s[46:47]
  s_cmp_eq_u32 s52, 0
  s_cselect_b32 s80, -1, 0
  s_cselect_b32 s81, 0, -1
  v_lshlrev_b32 v34, 27, v34
  v_add_u32 v31, v34, v15
  v_mov_b32 v33, 138752
  v_add_u32 v157, 136192, v15
  v_cndmask_b32 v157, v33, v157, s[56:57]
  v_add_u32 v158, 136192, v1
  v_add_u32 v159, 1024, v1
  v_add_u32 v33, 5242624, v1
  v_cmp_gt_u32 vcc, 16, v0
  s_nop 1
  v_cndmask_b32 v159, v33, v159, vcc
  v_add_u32 v247, 768, v1
  v_mov_b32 v33, 0x40000000
  v_cmp_gt_u32 vcc, 32, v0
  s_nop 1
  v_cndmask_b32 v247, v33, v247, vcc
  s_lshl_b32 s83, s52, 6
  s_mul_i32 s85, s83, 393216
  s_mul_i32 s46, s43, 12288
  s_add_u32 s85, s85, s46
  s_mul_i32 s47, s3, 3072
  s_add_u32 s85, s85, s47
  s_add_u32 s85, s85, 69206016
  s_lshl_b32 s86, s83, 14
  s_lshl_b32 s95, s43, 9
  s_add_u32 s86, s86, s95
  s_add_u32 s86, s86, 1441792
  s_mul_i32 s87, s52, 3145728
  s_add_u32 s87, s87, s46
  s_add_u32 s87, s87, s47
  s_add_u32 s87, s87, 37748736
  s_mul_i32 s88, s52, 65536
  s_lshl_b32 s95, s43, 8
  s_add_u32 s88, s88, s95
  s_add_u32 s88, s88, 794624
  s_mul_i32 s90, s52, 1310720
  s_add_u32 s90, s90, 7077888
  s_mul_i32 s95, s43, 20480
  s_add_u32 s89, s90, s95
  s_mul_i32 s95, s3, 5120
  s_add_u32 s89, s89, s95
  s_mul_i32 s95, s43, 160
  s_add_u32 s90, s90, s95
  s_mul_i32 s95, s54, 20480
  s_add_u32 s90, s90, s95
  s_mul_i32 s95, s53, 10240
  s_add_u32 s90, s90, s95
  s_lshl_b32 s62, s52, 6
  s_add_u32 s62, s62, s43
  s_xor_b32 s63, s62, 1
  s_mul_i32 s62, s62, 12288
  s_mul_i32 s63, s63, 12288
  s_add_u32 s95, s47, 9699328
  s_add_u32 s62, s62, s95
  s_add_u32 s63, s63, s95
  s_mul_i32 s95, s43, 1280
  s_mul_i32 s91, s52, 34603008
  s_add_u32 s91, s91, s95
  s_mul_i32 s92, s83, 40960
  s_add_u32 s92, s92, s95
  s_add_u32 s92, s92, 29360128
  s_lshl_b32 s93, s83, 12
  s_lshl_b32 s95, s43, 5
  s_add_u32 s93, s93, s95
  s_add_u32 s93, s93, 258048
  s_mov_b32 s58, s47
  s_mov_b32 s96, 0x3fb8aa3b
  s_mov_b32 s97, 0x3d93cd3a
  s_mov_b32 s82, 0
  s_cmp_eq_u32 s52, 0
  s_cselect_b32 s12, s16, s40
  s_cselect_b32 s13, s17, s41
  s_mov_b32 s14, 0x10000000
  s_cselect_b32 s14, 2621440, s14
  s_and_b32 s13, s13, 0xffff
  s_mov_b32 s15, 0x20000
  v_and_b32 v156, 7, v0
  v_lshlrev_b32 v156, 5, v156
  v_min_u32 v2, 352, v2
fwS_39:
  buffer_load_dword v13, v2, s[4:7], s86 offen sc1
  s_waitcnt vmcnt(0)
fcS_41:
  v_cmp_eq_u32 vcc, 0, v13
  s_cbranch_vccz foS_40
  s_add_u32 s45, s45, 1
  s_cmp_gt_u32 s45, 1048576
  s_cbranch_scc1 failaS_38
  s_sleep 4
  s_branch fwS_39
foS_40:
  s_mov_b32 s94, 0
  s_mov_b32 s59, s58
  s_mov_b32 s30, 0x10000000
  s_mov_b32 s31, 0
  s_add_u32 m0, s59, 0
  s_add_u32 s47, s85, 0
  buffer_load_dwordx4 v1, s[4:7], s47 offen offset:0 sc1 nt lds
  buffer_load_dwordx4 v1, s[4:7], s47 offen offset:1024 sc1 nt lds
  buffer_load_dwordx4 v1, s[4:7], s47 offen offset:2048 sc1 nt lds
  s_add_u32 m0, s59, 12288
  s_add_u32 s47, s85, 50331648
  buffer_load_dwordx4 v1, s[4:7], s47 offen offset:0 sc1 nt lds
  buffer_load_dwordx4 v1, s[4:7], s47 offen offset:1024 sc1 nt lds
  buffer_load_dwordx4 v1, s[4:7], s47 offen offset:2048 sc1 nt lds
  s_add_u32 m0, s59, 24576
  s_add_u32 s47, s85, 100663296
  buffer_load_dwordx4 v1, s[4:7], s47 offen offset:0 sc1 nt lds
  buffer_load_dwordx4 v1, s[4:7], s47 offen offset:1024 sc1 nt lds
  buffer_load_dwordx4 v1, s[4:7], s47 offen offset:2048 sc1 nt lds
  s_waitcnt vmcnt(0)
  s_barrier
  s_mov_b32 s2, 0
  s_mov_b32 s1, s90
  s_mov_b32 s0, 0x20000000
  buffer_load_dword v18, v156, s[4:7], s88 offen sc1
  v_add_u32 v92, s94, v3
  v_add_u32 v93, s94, v1
  v_add_u32 v94, s94, v4
  ds_read_b128 v[32:35], v92 offset:0
  ds_read_b128 v[160:163], v93 offset:12288
  ds_read_b128 v[176:179], v93 offset:13312
  ds_read_b128 v[36:39], v92 offset:3072
  ds_read_b128 v[164:167], v93 offset:15360
  ds_read_b128 v[180:183], v93 offset:16384
  ds_read_b128 v[40:43], v92 offset:6144
  ds_read_b128 v[168:171], v93 offset:18432
  ds_read_b128 v[184:187], v93 offset:19456
  ds_read_b128 v[44:47], v92 offset:9216
  ds_read_b128 v[172:175], v93 offset:21504
  ds_read_b128 v[188:191], v93 offset:22528
  s_waitcnt lgkmcnt(9)
  v_mfma_f32_16x16x32_bf16 v[80:83], v[160:163], v[32:35], 0
  v_mfma_f32_16x16x32_bf16 v[84:87], v[176:179], v[32:35], 0
  ds_read_b64 v[48:49], v94 offset:2048
  ds_read_b128 v[192:195], v93 offset:14336
  s_waitcnt lgkmcnt(8)
  v_mfma_f32_16x16x32_bf16 v[80:83], v[164:167], v[36:39], v[80:83]
  v_mfma_f32_16x16x32_bf16 v[84:87], v[180:183], v[36:39], v[84:87]
  ds_read_b64 v[50:51], v94 offset:5120
  ds_read_b128 v[196:199], v93 offset:17408
  s_waitcnt lgkmcnt(7)
  v_mfma_f32_16x16x32_bf16 v[80:83], v[168:171], v[40:43], v[80:83]
  v_mfma_f32_16x16x32_bf16 v[84:87], v[184:187], v[40:43], v[84:87]
  ds_read_b64 v[52:53], v94 offset:8192
  ds_read_b128 v[200:203], v93 offset:20480
  s_waitcnt lgkmcnt(6)
  v_mfma_f32_16x16x32_bf16 v[80:83], v[172:175], v[44:47], v[80:83]
  v_mfma_f32_16x16x32_bf16 v[84:87], v[188:191], v[44:47], v[84:87]
  ds_read_b64 v[54:55], v94 offset:11264
  ds_read_b128 v[204:207], v93 offset:23552
  s_nop 1
  s_waitcnt lgkmcnt(6)
  v_mfma_f32_16x16x16_bf16 v[96:99], v[192:193], v[48:49], 0
  v_mfma_f32_16x16x16_bf16 v[100:103], v[194:195], v[48:49], 0
  s_waitcnt lgkmcnt(4)
  v_mfma_f32_16x16x16_bf16 v[96:99], v[196:197], v[50:51], v[96:99]
  v_mfma_f32_16x16x16_bf16 v[100:103], v[198:199], v[50:51], v[100:103]
  s_waitcnt lgkmcnt(2)
  v_mfma_f32_16x16x16_bf16 v[96:99], v[200:201], v[52:53], v[96:99]
  v_mfma_f32_16x16x16_bf16 v[100:103], v[202:203], v[52:53], v[100:103]
  s_waitcnt lgkmcnt(0)
  v_mfma_f32_16x16x16_bf16 v[96:99], v[204:205], v[54:55], v[96:99]
  v_mfma_f32_16x16x16_bf16 v[100:103], v[206:207], v[54:55], v[100:103]
  s_mov_b64 s[98:99], 0
  s_mov_b64 s[100:101], 0
  .p2align 6
topS_42:
  s_cmp_lt_u32 s82, 63
  s_cselect_b32 s46, 16384, 0
  s_cselect_b32 s47, 393216, 0
  s_add_u32 s86, s86, s46
  s_add_u32 s85, s85, s47
  v_add_u32 v19, s94, v5
  s_sub_u32 s94, 98304, s94
  s_add_u32 s59, s58, s94
  s_cmp_eq_u32 s3, 0
  s_cselect_b32 s30, s30, 0x10000000
  s_waitcnt vmcnt(0)
  s_barrier
  s_cmp_eq_u32 s31, 1
  s_cbranch_scc1 e2S_44
  v_cmp_eq_u32 vcc, 0, v18
  s_cbranch_vccz hkS_43
  v_mov_b32 v92, 1
  s_waitcnt vmcnt(63)
  buffer_store_dword v92, off, s[4:7], s30 sc1
  s_mov_b32 s30, 0x10000000
fwS_45:
  buffer_load_dword v18, v156, s[4:7], s88 offen sc1
  s_waitcnt vmcnt(0)
fcS_47:
  v_cmp_eq_u32 vcc, 0, v18
  s_cbranch_vccz foS_46
  s_add_u32 s45, s45, 1
  s_cmp_gt_u32 s45, 1048576
  s_cbranch_scc1 failaS_38
  s_branch fwS_45
foS_46:
hkS_43:
  s_add_u32 m0, s58, 36864
  s_nop 0
  buffer_load_dwordx4 v1, s[4:7], s87 offen offset:0 sc1 lds
  buffer_load_dwordx4 v1, s[4:7], s87 offen offset:1024 sc1 lds
  buffer_load_dwordx4 v1, s[4:7], s87 offen offset:2048 sc1 lds
e2S_44:
  v_mov_b32 v92, 1
  s_waitcnt vmcnt(63)
  buffer_store_dword v92, off, s[4:7], s30 sc1
  s_mov_b32 s30, 0x10000000
  buffer_load_dword v13, v2, s[4:7], s86 offen sc1
  buffer_load_dwordx2 v[24:25], v15, s[12:15], s91 offen sc1
  s_mov_b32 s46, s1
  buffer_load_dwordx4 v[160:163], v14, s[4:7], s46 offen sc1
  s_add_u32 s46, s1, 81920
  buffer_load_dwordx4 v[164:167], v14, s[4:7], s46 offen sc1
  s_add_u32 s46, s1, 163840
  buffer_load_dwordx4 v[168:171], v14, s[4:7], s46 offen sc1
  s_add_u32 s46, s1, 245760
  buffer_load_dwordx4 v[172:175], v14, s[4:7], s46 offen sc1
  s_add_u32 s46, s1, 327680
  buffer_load_dwordx4 v[176:179], v14, s[4:7], s46 offen sc1
  s_add_u32 s46, s1, 409600
  buffer_load_dwordx4 v[180:183], v14, s[4:7], s46 offen sc1
  s_add_u32 s46, s1, 491520
  buffer_load_dwordx4 v[184:187], v14, s[4:7], s46 offen sc1
  s_add_u32 s46, s1, 573440
  buffer_load_dwordx4 v[188:191], v14, s[4:7], s46 offen sc1
  v_pk_add_f32 v[80:81], v[80:81], v[96:97]
  v_pk_add_f32 v[82:83], v[82:83], v[98:99]
  v_pk_add_f32 v[84:85], v[84:85], v[100:101]
  v_pk_add_f32 v[86:87], v[86:87], v[102:103]
  v_mov_b32 v98, s97
  v_cvt_pk_bf16_f32 v92, v80, v81
  v_cvt_pk_bf16_f32 v93, v82, v83
  v_cvt_pk_bf16_f32 v94, v84, v85
  v_cvt_pk_bf16_f32 v95, v86, v87
  v_lshlrev_b32 v80, 16, v92
  v_and_b32 v81, 0xffff0000, v92
  v_lshlrev_b32 v82, 16, v93
  v_and_b32 v83, 0xffff0000, v93
  v_lshlrev_b32 v84, 16, v94
  v_and_b32 v85, 0xffff0000, v94
  v_lshlrev_b32 v86, 16, v95
  v_and_b32 v87, 0xffff0000, v95
  v_pk_mul_f32 v[80:81], v[80:81], v[98:99] op_sel_hi:[1,0]
  v_pk_mul_f32 v[82:83], v[82:83], v[98:99] op_sel_hi:[1,0]
  v_pk_mul_f32 v[84:85], v[84:85], v[98:99] op_sel_hi:[1,0]
  v_pk_mul_f32 v[86:87], v[86:87], v[98:99] op_sel_hi:[1,0]
  v_cvt_pk_bf16_f32 v92, v80, v81
  v_cvt_pk_bf16_f32 v93, v82, v83
  v_cvt_pk_bf16_f32 v94, v84, v85
  v_cvt_pk_bf16_f32 v95, v86, v87
  v_lshlrev_b32 v80, 16, v92
  v_and_b32 v81, 0xffff0000, v92
  v_lshlrev_b32 v82, 16, v93
  v_and_b32 v83, 0xffff0000, v93
  v_lshlrev_b32 v84, 16, v94
  v_and_b32 v85, 0xffff0000, v94
  v_lshlrev_b32 v86, 16, v95
  v_and_b32 v87, 0xffff0000, v95
  v_mov_b32 v99, 0xff800000
  v_cndmask_b32 v80, v99, v80, s[64:65]
  v_cndmask_b32 v84, v99, v84, s[72:73]
  v_cndmask_b32 v81, v99, v81, s[66:67]
  v_cndmask_b32 v85, v99, v85, s[74:75]
  v_cndmask_b32 v82, v99, v82, s[68:69]
  v_cndmask_b32 v86, v99, v86, s[76:77]
  v_cndmask_b32 v83, v99, v83, s[70:71]
  v_cndmask_b32 v87, v99, v87, s[78:79]
  v_max3_f32 v96, v80, v81, v82
  v_max3_f32 v97, v83, v84, v85
  v_max3_f32 v96, v96, v86, v87
  s_lshr_b32 s84, s82, 1
  s_and_b32 s84, s84, 1
  s_xor_b32 s84, s84, 1
  s_and_b32 s95, s82, 1
  s_mul_i32 s28, s95, 393216
  s_add_u32 s29, s28, s63
  s_add_u32 s28, s28, s62
  s_mul_i32 s95, s95, 655360
  s_add_u32 s60, s89, s95
  s_add_u32 s61, s60, 4096
  s_add_u32 s95, s90, s95
  s_waitcnt vmcnt(11)
  s_barrier
  ds_read_b128 v[104:107], v6 offset:0
  ds_read_b128 v[108:111], v6 offset:1536
  ds_read_b128 v[112:115], v6 offset:3072
  ds_read_b128 v[116:119], v6 offset:4608
  ds_read_b64 v[120:121], v11 offset:1024
  ds_read_b64 v[122:123], v11 offset:2560
  ds_read_b64 v[124:125], v11 offset:4096
  ds_read_b64 v[126:127], v11 offset:5632
  ds_read_b128 v[128:131], v7 offset:6144
  ds_read_b64 v[132:133], v8 offset:7168
  ds_read_b128 v[134:137], v7 offset:7680
  ds_read_b64 v[138:139], v8 offset:8704
  s_waitcnt lgkmcnt(11)
  v_mfma_f32_16x16x32_bf16 v[88:91], v[104:107], v[32:35], 0
  s_waitcnt lgkmcnt(10)
  v_mfma_f32_16x16x32_bf16 v[88:91], v[108:111], v[36:39], v[88:91]
  s_waitcnt lgkmcnt(9)
  v_mfma_f32_16x16x32_bf16 v[88:91], v[112:115], v[40:43], v[88:91]
  s_waitcnt lgkmcnt(8)
  v_mfma_f32_16x16x32_bf16 v[88:91], v[116:119], v[44:47], v[88:91]
  s_waitcnt lgkmcnt(4)
  v_mfma_f32_16x16x16_bf16 v[100:103], v[120:121], v[48:49], 0
  v_mfma_f32_16x16x16_bf16 v[100:103], v[122:123], v[50:51], v[100:103]
  v_mfma_f32_16x16x16_bf16 v[100:103], v[124:125], v[52:53], v[100:103]
  v_mfma_f32_16x16x16_bf16 v[100:103], v[126:127], v[54:55], v[100:103]
  ds_read_b128 v[56:59], v19 offset:24576
  ds_read_b128 v[60:63], v19 offset:25600
  ds_read_b128 v[64:67], v19 offset:26624
  ds_read_b128 v[68:71], v19 offset:27648
  ds_read_b128 v[72:75], v19 offset:28672
  ds_read_b128 v[76:79], v19 offset:29696
  s_waitcnt vmcnt(9)
  s_branch fcS_50
fwS_48:
  buffer_load_dword v13, v2, s[4:7], s86 offen sc1
  s_waitcnt vmcnt(0)
fcS_50:
  v_cmp_eq_u32 vcc, 0, v13
  s_cbranch_vccz foS_49
  s_add_u32 s45, s45, 1
  s_cmp_gt_u32 s45, 1048576
  s_cbranch_scc1 failaS_38
  s_branch fwS_48
foS_49:
  s_nop 3
  s_add_u32 m0, s59, 0
  s_add_u32 s47, s85, 0
  buffer_load_dwordx4 v1, s[4:7], s47 offen offset:0 sc1 nt lds
  buffer_load_dwordx4 v1, s[4:7], s47 offen offset:1024 sc1 nt lds
  buffer_load_dwordx4 v1, s[4:7], s47 offen offset:2048 sc1 nt lds
  s_add_u32 m0, s59, 12288
  s_add_u32 s47, s85, 50331648
  buffer_load_dwordx4 v1, s[4:7], s47 offen offset:0 sc1 nt lds
  buffer_load_dwordx4 v1, s[4:7], s47 offen offset:1024 sc1 nt lds
  buffer_load_dwordx4 v1, s[4:7], s47 offen offset:2048 sc1 nt lds
  v_pk_add_f32 v[88:89], v[88:89], v[100:101]
  v_pk_add_f32 v[90:91], v[90:91], v[102:103]
  v_cvt_pk_bf16_f32 v92, v88, v89
  v_cvt_pk_bf16_f32 v93, v90, v91
  v_lshlrev_b32 v88, 16, v92
  v_and_b32 v89, 0xffff0000, v92
  v_lshlrev_b32 v90, 16, v93
  v_and_b32 v91, 0xffff0000, v93
  v_pk_mul_f32 v[88:89], v[88:89], v[98:99] op_sel_hi:[1,0]
  v_pk_mul_f32 v[90:91], v[90:91], v[98:99] op_sel_hi:[1,0]
  v_cvt_pk_bf16_f32 v92, v88, v89
  v_cvt_pk_bf16_f32 v93, v90, v91
  v_lshlrev_b32 v88, 16, v92
  v_and_b32 v89, 0xffff0000, v92
  v_lshlrev_b32 v90, 16, v93
  v_and_b32 v91, 0xffff0000, v93
  v_cndmask_b32 v88, v99, v88, s[80:81]
  v_cndmask_b32 v89, v99, v89, s[80:81]
  v_cndmask_b32 v90, v99, v90, s[80:81]
  v_cndmask_b32 v91, v99, v91, s[80:81]
  v_max3_f32 v97, v97, v88, v89
  v_max3_f32 v96, v96, v90, v91
  v_max_f32 v96, v96, v97
  v_mov_b32 v97, v96
  s_nop 1
  v_permlane16_swap_b32 v96, v97
  v_max_f32 v96, v96, v97
  v_mov_b32 v97, v96
  s_nop 1
  v_permlane32_swap_b32 v96, v97
  v_max_f32 v96, v96, v97
  v_mul_f32 v96, s96, v96
  v_mov_b32 v98, s96
  v_pk_fma_f32 v[80:81], v[80:81], v[98:99], v[96:97] op_sel_hi:[1,0,0] neg_lo:[0,0,1] neg_hi:[0,0,1]
  v_pk_fma_f32 v[82:83], v[82:83], v[98:99], v[96:97] op_sel_hi:[1,0,0] neg_lo:[0,0,1] neg_hi:[0,0,1]
  v_pk_fma_f32 v[84:85], v[84:85], v[98:99], v[96:97] op_sel_hi:[1,0,0] neg_lo:[0,0,1] neg_hi:[0,0,1]
  v_pk_fma_f32 v[86:87], v[86:87], v[98:99], v[96:97] op_sel_hi:[1,0,0] neg_lo:[0,0,1] neg_hi:[0,0,1]
  v_pk_fma_f32 v[88:89], v[88:89], v[98:99], v[96:97] op_sel_hi:[1,0,0] neg_lo:[0,0,1] neg_hi:[0,0,1]
  v_pk_fma_f32 v[90:91], v[90:91], v[98:99], v[96:97] op_sel_hi:[1,0,0] neg_lo:[0,0,1] neg_hi:[0,0,1]
  v_exp_f32 v80, v80
  v_exp_f32 v81, v81
  v_exp_f32 v82, v82
  v_exp_f32 v83, v83
  v_exp_f32 v84, v84
  v_exp_f32 v85, v85
  v_exp_f32 v86, v86
  v_exp_f32 v87, v87
  v_exp_f32 v88, v88
  v_exp_f32 v89, v89
  v_exp_f32 v90, v90
  v_exp_f32 v91, v91
  v_pk_add_f32 v[92:93], v[80:81], v[82:83]
  v_pk_add_f32 v[94:95], v[84:85], v[86:87]
  v_pk_add_f32 v[92:93], v[92:93], v[88:89]
  v_pk_add_f32 v[94:95], v[94:95], v[90:91]
  v_pk_add_f32 v[92:93], v[92:93], v[94:95]
  v_add_f32 v92, v92, v93
  v_mov_b32 v93, v92
  s_nop 1
  v_permlane16_swap_b32 v92, v93
  v_add_f32 v92, v92, v93
  v_mov_b32 v93, v92
  s_nop 1
  v_permlane32_swap_b32 v92, v93
  v_add_f32 v92, v92, v93
  v_rcp_f32 v92, v92
  s_nop 0
  v_pk_mul_f32 v[80:81], v[80:81], v[92:93] op_sel_hi:[1,0]
  v_pk_mul_f32 v[82:83], v[82:83], v[92:93] op_sel_hi:[1,0]
  v_pk_mul_f32 v[84:85], v[84:85], v[92:93] op_sel_hi:[1,0]
  v_pk_mul_f32 v[86:87], v[86:87], v[92:93] op_sel_hi:[1,0]
  v_pk_mul_f32 v[88:89], v[88:89], v[92:93] op_sel_hi:[1,0]
  v_pk_mul_f32 v[90:91], v[90:91], v[92:93] op_sel_hi:[1,0]
  v_cvt_pk_bf16_f32 v96, v80, v81
  v_cvt_pk_bf16_f32 v97, v82, v83
  v_cvt_pk_bf16_f32 v98, v84, v85
  v_cvt_pk_bf16_f32 v99, v86, v87
  v_cvt_pk_bf16_f32 v100, v88, v89
  v_cvt_pk_bf16_f32 v101, v90, v91
  s_waitcnt lgkmcnt(0)
  v_mfma_f32_16x16x32_bf16 v[32:35], v[56:59], v[96:99], 0
  v_mfma_f32_16x16x32_bf16 v[36:39], v[60:63], v[96:99], 0
  v_mfma_f32_16x16x32_bf16 v[40:43], v[64:67], v[96:99], 0
  v_mfma_f32_16x16x32_bf16 v[44:47], v[68:71], v[96:99], 0
  v_mfma_f32_16x16x32_bf16 v[48:51], v[72:75], v[96:99], 0
  v_mfma_f32_16x16x32_bf16 v[52:55], v[76:79], v[96:99], 0
  s_nop 0
  v_mfma_f32_16x16x16_bf16 v[32:35], v[128:129], v[100:101], v[32:35]
  v_mfma_f32_16x16x16_bf16 v[36:39], v[130:131], v[100:101], v[36:39]
  v_mfma_f32_16x16x16_bf16 v[40:43], v[132:133], v[100:101], v[40:43]
  v_mfma_f32_16x16x16_bf16 v[44:47], v[134:135], v[100:101], v[44:47]
  v_mfma_f32_16x16x16_bf16 v[48:51], v[136:137], v[100:101], v[48:51]
  v_mfma_f32_16x16x16_bf16 v[52:55], v[138:139], v[100:101], v[52:55]
  s_nop 3
  v_cvt_pk_bf16_f32 v104, v32, v33
  v_cvt_pk_bf16_f32 v105, v34, v35
  v_cvt_pk_bf16_f32 v106, v36, v37
  v_cvt_pk_bf16_f32 v107, v38, v39
  ds_write_b128 v9, v[104:107] offset:0
  v_bfi_b32 v104, 1, s84, v104
  buffer_store_dwordx4 v[104:107], v1, s[4:7], s28 offen offset:0 sc1
  v_cvt_pk_bf16_f32 v108, v40, v41
  v_cvt_pk_bf16_f32 v109, v42, v43
  v_cvt_pk_bf16_f32 v110, v44, v45
  v_cvt_pk_bf16_f32 v111, v46, v47
  ds_write_b128 v9, v[108:111] offset:1024
  v_bfi_b32 v108, 1, s84, v108
  buffer_store_dwordx4 v[108:111], v1, s[4:7], s28 offen offset:1024 sc1
  v_cvt_pk_bf16_f32 v112, v48, v49
  v_cvt_pk_bf16_f32 v113, v50, v51
  v_cvt_pk_bf16_f32 v114, v52, v53
  v_cvt_pk_bf16_f32 v115, v54, v55
  ds_write_b128 v9, v[112:115] offset:2048
  v_bfi_b32 v112, 1, s84, v112
  buffer_store_dwordx4 v[112:115], v1, s[4:7], s28 offen offset:2048 sc1
  s_waitcnt lgkmcnt(0)
  s_barrier
  ds_read_b128 v[32:35], v10 offset:0
  ds_read_b128 v[36:39], v10 offset:1024
  ds_read_b128 v[40:43], v10 offset:2048
  ds_read_b128 v[44:47], v10 offset:3072
  ds_read_b128 v[48:51], v10 offset:4096
  ds_read_b128 v[52:55], v10 offset:5120
  ds_read_b128 v[56:59], v10 offset:6144
  ds_read_b128 v[60:63], v10 offset:7168
  ds_read_b128 v[64:67], v10 offset:8192
  ds_read_b128 v[68:71], v10 offset:9216
  ds_read_b128 v[72:75], v10 offset:10240
  ds_read_b128 v[76:79], v10 offset:11264
  s_waitcnt vmcnt(9)
bS_51:
  v_bitop3_b32 v238, v160, v164, s2 bitop3:0x7e
  v_bitop3_b32 v238, v238, v168, s2 bitop3:0xf6
  v_bitop3_b32 v238, v238, v172, s2 bitop3:0xf6
  v_bitop3_b32 v238, v238, v176, s2 bitop3:0xf6
  v_bitop3_b32 v238, v238, v180, s2 bitop3:0xf6
  v_bitop3_b32 v238, v238, v184, s2 bitop3:0xf6
  v_bitop3_b32 v238, v238, v188, s2 bitop3:0xf6
  v_and_b32 v238, 1, v238
  v_cmp_ne_u32 vcc, 0, v238
  s_and_b64 vcc, vcc, s[98:99]
  s_cbranch_vccz okS_52
  s_mov_b32 s46, s1
  buffer_load_dwordx4 v[160:163], v14, s[4:7], s46 offen sc1
  s_add_u32 s46, s1, 81920
  buffer_load_dwordx4 v[164:167], v14, s[4:7], s46 offen sc1
  s_add_u32 s46, s1, 163840
  buffer_load_dwordx4 v[168:171], v14, s[4:7], s46 offen sc1
  s_add_u32 s46, s1, 245760
  buffer_load_dwordx4 v[172:175], v14, s[4:7], s46 offen sc1
  s_add_u32 s46, s1, 327680
  buffer_load_dwordx4 v[176:179], v14, s[4:7], s46 offen sc1
  s_add_u32 s46, s1, 409600
  buffer_load_dwordx4 v[180:183], v14, s[4:7], s46 offen sc1
  s_add_u32 s46, s1, 491520
  buffer_load_dwordx4 v[184:187], v14, s[4:7], s46 offen sc1
  s_add_u32 s46, s1, 573440
  buffer_load_dwordx4 v[188:191], v14, s[4:7], s46 offen sc1
  s_add_u32 s45, s45, 1
  s_cmp_gt_u32 s45, 1048576
  s_cbranch_scc1 failaS_38
  s_waitcnt vmcnt(0)
  s_branch bS_51
okS_52:
  s_add_u32 s87, s87, 393216
  s_add_u32 s88, s88, 8192
  s_waitcnt lgkmcnt(6)
  v_mfma_f32_16x16x32_bf16 v[104:107], a[0:3], v[32:35], 0
  v_mfma_f32_16x16x32_bf16 v[208:211], v[20:23], v[160:163], 0
  v_mfma_f32_16x16x32_bf16 v[208:211], v[20:23], v[164:167], v[208:211]
  v_mfma_f32_16x16x32_bf16 v[108:111], a[48:51], v[32:35], 0
  v_mfma_f32_16x16x32_bf16 v[208:211], v[20:23], v[168:171], v[208:211]
  v_mfma_f32_16x16x32_bf16 v[208:211], v[20:23], v[172:175], v[208:211]
  v_mfma_f32_16x16x32_bf16 v[112:115], a[96:99], v[32:35], 0
  v_mfma_f32_16x16x32_bf16 v[208:211], v[20:23], v[176:179], v[208:211]
  v_mfma_f32_16x16x32_bf16 v[208:211], v[20:23], v[180:183], v[208:211]
  v_mfma_f32_16x16x32_bf16 v[116:119], a[144:147], v[32:35], 0
  v_mfma_f32_16x16x32_bf16 v[208:211], v[20:23], v[184:187], v[208:211]
  v_mfma_f32_16x16x32_bf16 v[208:211], v[20:23], v[188:191], v[208:211]
  v_mfma_f32_16x16x32_bf16 v[120:123], a[192:195], v[32:35], 0
  s_nop 0
  s_nop 0
  v_mfma_f32_16x16x32_bf16 v[104:107], a[4:7], v[36:39], v[104:107]
  v_lshlrev_b32 v216, 16, v24
  v_and_b32 v217, 0xffff0000, v24
  v_mfma_f32_16x16x32_bf16 v[108:111], a[52:55], v[36:39], v[108:111]
  v_lshlrev_b32 v218, 16, v25
  v_and_b32 v219, 0xffff0000, v25
  v_mfma_f32_16x16x32_bf16 v[112:115], a[100:103], v[36:39], v[112:115]
  v_cvt_pk_bf16_f32 v232, v208, v209
  v_cvt_pk_bf16_f32 v233, v210, v211
  v_mfma_f32_16x16x32_bf16 v[116:119], a[148:151], v[36:39], v[116:119]
  v_lshlrev_b32 v208, 16, v232
  v_mfma_f32_16x16x32_bf16 v[120:123], a[196:199], v[36:39], v[120:123]
  v_and_b32 v209, 0xffff0000, v232
  v_mfma_f32_16x16x32_bf16 v[104:107], a[8:11], v[40:43], v[104:107]
  v_lshlrev_b32 v210, 16, v233
  v_mfma_f32_16x16x32_bf16 v[108:111], a[56:59], v[40:43], v[108:111]
  v_and_b32 v211, 0xffff0000, v233
  v_mfma_f32_16x16x32_bf16 v[112:115], a[104:107], v[40:43], v[112:115]
  v_add_f32 v216, v216, v208
  v_mfma_f32_16x16x32_bf16 v[116:119], a[152:155], v[40:43], v[116:119]
  v_add_f32 v217, v217, v209
  v_mfma_f32_16x16x32_bf16 v[120:123], a[200:203], v[40:43], v[120:123]
  v_add_f32 v218, v218, v210
  v_mfma_f32_16x16x32_bf16 v[104:107], a[12:15], v[44:47], v[104:107]
  v_add_f32 v219, v219, v211
  v_mfma_f32_16x16x32_bf16 v[108:111], a[60:63], v[44:47], v[108:111]
  v_cvt_pk_bf16_f32 v224, v216, v217
  v_mfma_f32_16x16x32_bf16 v[112:115], a[108:111], v[44:47], v[112:115]
  v_cvt_pk_bf16_f32 v225, v218, v219
  v_mfma_f32_16x16x32_bf16 v[116:119], a[156:159], v[44:47], v[116:119]
  v_lshlrev_b32 v216, 16, v224
  v_mfma_f32_16x16x32_bf16 v[120:123], a[204:207], v[44:47], v[120:123]
  v_and_b32 v217, 0xffff0000, v224
  v_mfma_f32_16x16x32_bf16 v[104:107], a[16:19], v[48:51], v[104:107]
  v_lshlrev_b32 v218, 16, v225
  v_mfma_f32_16x16x32_bf16 v[108:111], a[64:67], v[48:51], v[108:111]
  buffer_load_dword v13, v156, s[4:7], s88 offen sc1
  v_and_b32 v219, 0xffff0000, v225
  v_mfma_f32_16x16x32_bf16 v[112:115], a[112:115], v[48:51], v[112:115]
  buffer_load_dwordx4 v[144:147], v1, s[4:7], s29 offen offset:0 sc1
  v_add_f32 v236, v216, v217
  v_mfma_f32_16x16x32_bf16 v[116:119], a[160:163], v[48:51], v[116:119]
  buffer_load_dwordx4 v[148:151], v1, s[4:7], s29 offen offset:1024 sc1
  v_mul_f32 v237, v216, v216
  v_mfma_f32_16x16x32_bf16 v[120:123], a[208:211], v[48:51], v[120:123]
  buffer_load_dwordx4 v[152:155], v1, s[4:7], s29 offen offset:2048 sc1
  v_fmac_f32 v237, v217, v217
  v_mfma_f32_16x16x32_bf16 v[104:107], a[20:23], v[52:55], v[104:107]
  v_add_f32 v236, v236, v218
  v_mfma_f32_16x16x32_bf16 v[108:111], a[68:71], v[52:55], v[108:111]
  v_fmac_f32 v237, v218, v218
  v_mfma_f32_16x16x32_bf16 v[112:115], a[116:119], v[52:55], v[112:115]
  v_add_f32 v236, v236, v219
  v_mfma_f32_16x16x32_bf16 v[116:119], a[164:167], v[52:55], v[116:119]
  v_fmac_f32 v237, v219, v219
  v_mfma_f32_16x16x32_bf16 v[120:123], a[212:215], v[52:55], v[120:123]
  v_add_f32_dpp v236, v236, v236 quad_perm:[1,0,3,2] row_mask:0xf bank_mask:0xf
  s_waitcnt lgkmcnt(0)
  v_mfma_f32_16x16x32_bf16 v[124:127], a[0:3], v[56:59], 0
  v_add_f32_dpp v237, v237, v237 quad_perm:[1,0,3,2] row_mask:0xf bank_mask:0xf
  v_mfma_f32_16x16x32_bf16 v[128:131], a[48:51], v[56:59], 0
  v_add_f32_dpp v236, v236, v236 quad_perm:[2,3,0,1] row_mask:0xf bank_mask:0xf
  v_mfma_f32_16x16x32_bf16 v[132:135], a[96:99], v[56:59], 0
  v_add_f32_dpp v237, v237, v237 quad_perm:[2,3,0,1] row_mask:0xf bank_mask:0xf
  v_mfma_f32_16x16x32_bf16 v[136:139], a[144:147], v[56:59], 0
  v_add_f32_dpp v236, v236, v236 row_half_mirror row_mask:0xf bank_mask:0xf
  v_mfma_f32_16x16x32_bf16 v[140:143], a[192:195], v[56:59], 0
  v_add_f32_dpp v237, v237, v237 row_half_mirror row_mask:0xf bank_mask:0xf
  v_mfma_f32_16x16x32_bf16 v[124:127], a[4:7], v[60:63], v[124:127]
  v_add_f32_dpp v236, v236, v236 row_mirror row_mask:0xf bank_mask:0xf
  v_mfma_f32_16x16x32_bf16 v[128:131], a[52:55], v[60:63], v[128:131]
  v_add_f32_dpp v237, v237, v237 row_mirror row_mask:0xf bank_mask:0xf
  v_mfma_f32_16x16x32_bf16 v[132:135], a[100:103], v[60:63], v[132:135]
  v_mov_b32 v208, v236
  v_mfma_f32_16x16x32_bf16 v[136:139], a[148:151], v[60:63], v[136:139]
  v_mov_b32 v209, v237
  v_mfma_f32_16x16x32_bf16 v[140:143], a[196:199], v[60:63], v[140:143]
  v_permlane16_swap_b32 v236, v208
  v_mfma_f32_16x16x32_bf16 v[124:127], a[8:11], v[64:67], v[124:127]
  v_permlane16_swap_b32 v237, v209
  v_mfma_f32_16x16x32_bf16 v[128:131], a[56:59], v[64:67], v[128:131]
  v_add_f32 v236, v236, v208
  v_mfma_f32_16x16x32_bf16 v[132:135], a[104:107], v[64:67], v[132:135]
  v_add_f32 v237, v237, v209
  v_mfma_f32_16x16x32_bf16 v[136:139], a[152:155], v[64:67], v[136:139]
  v_mov_b32 v208, v236
  v_mfma_f32_16x16x32_bf16 v[140:143], a[200:203], v[64:67], v[140:143]
  s_waitcnt vmcnt(0)
bS_53:
  v_bitop3_b32 v18, v144, v148, s84 bitop3:0x7e
  v_bitop3_b32 v18, v18, v152, s84 bitop3:0xf6
  v_and_b32 v18, 1, v18
  v_cmp_ne_u32 vcc, 0, v18
  s_cbranch_vccz okS_54
  buffer_load_dwordx4 v[144:147], v1, s[4:7], s29 offen offset:0 sc1
  buffer_load_dwordx4 v[148:151], v1, s[4:7], s29 offen offset:1024 sc1
  buffer_load_dwordx4 v[152:155], v1, s[4:7], s29 offen offset:2048 sc1
  s_add_u32 s45, s45, 1
  s_cmp_gt_u32 s45, 1048576
  s_cbranch_scc1 failaS_38
  s_waitcnt vmcnt(0)
  s_branch bS_53
okS_54:
  v_cmp_eq_u32 vcc, 0, v13
  s_mov_b32 s31, 0
  s_cbranch_vccnz neS_55
  s_mov_b32 s31, 1
  s_add_u32 m0, s58, 36864
  s_nop 0
  buffer_load_dwordx4 v1, s[4:7], s87 offen offset:0 sc1 lds
  buffer_load_dwordx4 v1, s[4:7], s87 offen offset:1024 sc1 lds
  buffer_load_dwordx4 v1, s[4:7], s87 offen offset:2048 sc1 lds
neS_55:
  v_mov_b32 v209, v237
  v_mfma_f32_16x16x32_bf16 v[124:127], a[12:15], v[68:71], v[124:127]
  ds_write_b128 v9, v[144:147] offset:12288
  v_permlane32_swap_b32 v236, v208
  v_mfma_f32_16x16x32_bf16 v[128:131], a[60:63], v[68:71], v[128:131]
  ds_write_b128 v9, v[148:151] offset:13312
  v_permlane32_swap_b32 v237, v209
  v_mfma_f32_16x16x32_bf16 v[132:135], a[108:111], v[68:71], v[132:135]
  ds_write_b128 v9, v[152:155] offset:14336
  v_add_f32 v236, v236, v208
  v_mfma_f32_16x16x32_bf16 v[136:139], a[156:159], v[68:71], v[136:139]
  v_add_f32 v237, v237, v209
  v_mfma_f32_16x16x32_bf16 v[140:143], a[204:207], v[68:71], v[140:143]
  ds_write_b64 v16, v[236:237]
  v_mfma_f32_16x16x32_bf16 v[124:127], a[16:19], v[72:75], v[124:127]
  s_waitcnt lgkmcnt(0)
  s_barrier
  v_mfma_f32_16x16x32_bf16 v[128:131], a[64:67], v[72:75], v[128:131]
  ds_read_b128 v[208:211], v17
  v_mfma_f32_16x16x32_bf16 v[132:135], a[112:115], v[72:75], v[132:135]
  ds_read_b128 v[212:215], v17 offset:16
  v_mfma_f32_16x16x32_bf16 v[136:139], a[160:163], v[72:75], v[136:139]
  ds_read_b128 v[160:163], v10 offset:12288
  v_mfma_f32_16x16x32_bf16 v[140:143], a[208:211], v[72:75], v[140:143]
  ds_read_b128 v[164:167], v10 offset:13312
  v_mfma_f32_16x16x32_bf16 v[124:127], a[20:23], v[76:79], v[124:127]
  ds_read_b128 v[168:171], v10 offset:14336
  v_mfma_f32_16x16x32_bf16 v[128:131], a[68:71], v[76:79], v[128:131]
  ds_read_b128 v[172:175], v10 offset:15360
  v_mfma_f32_16x16x32_bf16 v[132:135], a[116:119], v[76:79], v[132:135]
  ds_read_b128 v[176:179], v10 offset:16384
  v_mfma_f32_16x16x32_bf16 v[136:139], a[164:167], v[76:79], v[136:139]
  ds_read_b128 v[180:183], v10 offset:17408
  v_mfma_f32_16x16x32_bf16 v[140:143], a[212:215], v[76:79], v[140:143]
  ds_read_b128 v[184:187], v10 offset:18432
  ds_read_b128 v[188:191], v10 offset:19456
  ds_read_b128 v[192:195], v10 offset:20480
  ds_read_b128 v[196:199], v10 offset:21504
  ds_read_b128 v[200:203], v10 offset:22528
  ds_read_b128 v[204:207], v10 offset:23552
  s_waitcnt lgkmcnt(6)
  v_mfma_f32_16x16x32_bf16 v[104:107], a[24:27], v[160:163], v[104:107]
  s_add_u32 m0, s59, 24576
  s_add_u32 s47, s85, 100663296
  v_mfma_f32_16x16x32_bf16 v[104:107], a[28:31], v[164:167], v[104:107]
  v_add_f32 v208, v208, v210
  v_mfma_f32_16x16x32_bf16 v[104:107], a[32:35], v[168:171], v[104:107]
  buffer_load_dwordx4 v1, s[4:7], s47 offen offset:0 sc1 nt lds
  v_mfma_f32_16x16x32_bf16 v[104:107], a[36:39], v[172:175], v[104:107]
  v_add_f32 v209, v209, v211
  v_mfma_f32_16x16x32_bf16 v[104:107], a[40:43], v[176:179], v[104:107]
  buffer_load_dwordx4 v1, s[4:7], s47 offen offset:1024 sc1 nt lds
  v_mfma_f32_16x16x32_bf16 v[104:107], a[44:47], v[180:183], v[104:107]
  v_add_f32 v212, v212, v214
  v_mfma_f32_16x16x32_bf16 v[108:111], a[72:75], v[160:163], v[108:111]
  buffer_load_dwordx4 v1, s[4:7], s47 offen offset:2048 sc1 nt lds
  v_mfma_f32_16x16x32_bf16 v[108:111], a[76:79], v[164:167], v[108:111]
  v_add_f32 v213, v213, v215
  v_mfma_f32_16x16x32_bf16 v[108:111], a[80:83], v[168:171], v[108:111]
  v_add_f32 v236, v208, v212
  v_mfma_f32_16x16x32_bf16 v[108:111], a[84:87], v[172:175], v[108:111]
  v_add_f32 v237, v209, v213
  v_mfma_f32_16x16x32_bf16 v[108:111], a[88:91], v[176:179], v[108:111]
  v_mul_f32 v236, 0x3acccccd, v236
  v_mfma_f32_16x16x32_bf16 v[108:111], a[92:95], v[180:183], v[108:111]
  v_mul_f32 v237, 0x3acccccd, v237
  v_mfma_f32_16x16x32_bf16 v[112:115], a[120:123], v[160:163], v[112:115]
  v_fma_f32 v237, -v236, v236, v237
  v_mfma_f32_16x16x32_bf16 v[112:115], a[124:127], v[164:167], v[112:115]
  v_cvt_pk_bf16_f32 v80, v104, v105
  v_max_f32 v237, 0, v237
  v_mfma_f32_16x16x32_bf16 v[112:115], a[128:131], v[168:171], v[112:115]
  v_cvt_pk_bf16_f32 v81, v106, v107
  v_cvt_pk_bf16_f32 v236, v236, v236
  v_mfma_f32_16x16x32_bf16 v[112:115], a[132:135], v[172:175], v[112:115]
  ds_write_b64 v12, v[80:81] offset:0
  v_and_b32 v236, 0xffff0000, v236
  v_mfma_f32_16x16x32_bf16 v[112:115], a[136:139], v[176:179], v[112:115]
  v_cvt_pk_bf16_f32 v237, v237, v237
  v_mfma_f32_16x16x32_bf16 v[112:115], a[140:143], v[180:183], v[112:115]
  v_and_b32 v237, 0xffff0000, v237
  v_mfma_f32_16x16x32_bf16 v[116:119], a[168:171], v[160:163], v[116:119]
  v_add_f32 v237, 0x3727c5ac, v237
  v_mfma_f32_16x16x32_bf16 v[116:119], a[172:175], v[164:167], v[116:119]
  v_cvt_pk_bf16_f32 v82, v108, v109
  v_cvt_pk_bf16_f32 v237, v237, v237
  v_mfma_f32_16x16x32_bf16 v[116:119], a[176:179], v[168:171], v[116:119]
  v_cvt_pk_bf16_f32 v83, v110, v111
  v_and_b32 v237, 0xffff0000, v237
  v_mfma_f32_16x16x32_bf16 v[116:119], a[180:183], v[172:175], v[116:119]
  ds_write_b64 v12, v[82:83] offset:32
  v_sub_f32 v216, v216, v236
  v_mfma_f32_16x16x32_bf16 v[116:119], a[184:187], v[176:179], v[116:119]
  v_sub_f32 v217, v217, v236
  v_mfma_f32_16x16x32_bf16 v[116:119], a[188:191], v[180:183], v[116:119]
  v_sub_f32 v218, v218, v236
  v_mfma_f32_16x16x32_bf16 v[120:123], a[216:219], v[160:163], v[120:123]
  v_sub_f32 v219, v219, v236
  v_mfma_f32_16x16x32_bf16 v[120:123], a[220:223], v[164:167], v[120:123]
  v_cvt_pk_bf16_f32 v80, v112, v113
  v_sqrt_f32 v237, v237
  v_mfma_f32_16x16x32_bf16 v[120:123], a[224:227], v[168:171], v[120:123]
  v_cvt_pk_bf16_f32 v81, v114, v115
  v_cvt_pk_bf16_f32 v232, v216, v217
  v_mfma_f32_16x16x32_bf16 v[120:123], a[228:231], v[172:175], v[120:123]
  ds_write_b64 v12, v[80:81] offset:64
  v_cvt_pk_bf16_f32 v233, v218, v219
  v_mfma_f32_16x16x32_bf16 v[120:123], a[232:235], v[176:179], v[120:123]
  v_cvt_pk_bf16_f32 v237, v237, v237
  s_waitcnt lgkmcnt(0)
  v_mfma_f32_16x16x32_bf16 v[120:123], a[236:239], v[180:183], v[120:123]
  v_and_b32 v237, 0xffff0000, v237
  v_mfma_f32_16x16x32_bf16 v[124:127], a[24:27], v[184:187], v[124:127]
  v_rcp_f32 v237, v237
  v_mfma_f32_16x16x32_bf16 v[124:127], a[28:31], v[188:191], v[124:127]
  v_cvt_pk_bf16_f32 v82, v116, v117
  v_lshlrev_b32 v216, 16, v232
  v_mfma_f32_16x16x32_bf16 v[124:127], a[32:35], v[192:195], v[124:127]
  v_cvt_pk_bf16_f32 v83, v118, v119
  v_and_b32 v217, 0xffff0000, v232
  v_mfma_f32_16x16x32_bf16 v[124:127], a[36:39], v[196:199], v[124:127]
  ds_write_b64 v12, v[82:83] offset:96
  v_lshlrev_b32 v218, 16, v233
  v_mfma_f32_16x16x32_bf16 v[124:127], a[40:43], v[200:203], v[124:127]
  v_and_b32 v219, 0xffff0000, v233
  v_mfma_f32_16x16x32_bf16 v[124:127], a[44:47], v[204:207], v[124:127]
  v_mul_f32 v216, v216, v237
  v_mfma_f32_16x16x32_bf16 v[128:131], a[72:75], v[184:187], v[128:131]
  v_mul_f32 v217, v217, v237
  v_mfma_f32_16x16x32_bf16 v[128:131], a[76:79], v[188:191], v[128:131]
  v_cvt_pk_bf16_f32 v80, v120, v121
  v_mul_f32 v218, v218, v237
  v_mfma_f32_16x16x32_bf16 v[128:131], a[80:83], v[192:195], v[128:131]
  v_cvt_pk_bf16_f32 v81, v122, v123
  v_mul_f32 v219, v219, v237
  v_mfma_f32_16x16x32_bf16 v[128:131], a[84:87], v[196:199], v[128:131]
  ds_write_b64 v12, v[80:81] offset:128
  v_cvt_pk_bf16_f32 v240, v216, v217
  v_mfma_f32_16x16x32_bf16 v[128:131], a[88:91], v[200:203], v[128:131]
  ds_read_b128 v[84:87], v26
  v_cvt_pk_bf16_f32 v241, v218, v219
  v_mfma_f32_16x16x32_bf16 v[128:131], a[92:95], v[204:207], v[128:131]
  ds_read_b128 v[88:91], v27
  v_mov_b32 v242, v240
  v_mfma_f32_16x16x32_bf16 v[132:135], a[120:123], v[184:187], v[132:135]
  v_mov_b32 v243, v241
  v_mfma_f32_16x16x32_bf16 v[132:135], a[124:127], v[188:191], v[132:135]
  v_cvt_pk_bf16_f32 v80, v124, v125
  v_permlane16_swap_b32 v240, v242
  v_mfma_f32_16x16x32_bf16 v[132:135], a[128:131], v[192:195], v[132:135]
  v_cvt_pk_bf16_f32 v81, v126, v127
  v_permlane16_swap_b32 v241, v243
  v_mfma_f32_16x16x32_bf16 v[132:135], a[132:135], v[196:199], v[132:135]
  ds_write_b64 v12, v[80:81] offset:2816
  v_mov_b32 v226, v224
  v_mfma_f32_16x16x32_bf16 v[132:135], a[136:139], v[200:203], v[132:135]
  v_mov_b32 v227, v225
  v_mfma_f32_16x16x32_bf16 v[132:135], a[140:143], v[204:207], v[132:135]
  v_permlane16_swap_b32 v224, v226
  v_mfma_f32_16x16x32_bf16 v[136:139], a[168:171], v[184:187], v[136:139]
  v_permlane16_swap_b32 v225, v227
  v_mfma_f32_16x16x32_bf16 v[136:139], a[172:175], v[188:191], v[136:139]
  s_waitcnt lgkmcnt(2)
  v_bfi_b32 v84, 1, s84, v84
  buffer_store_dwordx4 v[84:87], v1, s[4:7], s60 offen offset:0 sc1
  s_sub_u32 s55, s0, 5242880
  v_mfma_f32_16x16x32_bf16 v[136:139], a[176:179], v[192:195], v[136:139]
  v_cvt_pk_bf16_f32 v82, v128, v129
  buffer_store_dwordx4 v[240:243], v31, s[4:7], s55 offen sc1
  v_mfma_f32_16x16x32_bf16 v[136:139], a[180:183], v[196:199], v[136:139]
  v_cvt_pk_bf16_f32 v83, v130, v131
  buffer_store_dwordx4 v[224:227], v31, s[4:7], s0 offen sc1
  v_mfma_f32_16x16x32_bf16 v[136:139], a[184:187], v[200:203], v[136:139]
  ds_write_b64 v12, v[82:83] offset:2848
  v_mfma_f32_16x16x32_bf16 v[136:139], a[188:191], v[204:207], v[136:139]
  v_mfma_f32_16x16x32_bf16 v[140:143], a[216:219], v[184:187], v[140:143]
  v_mfma_f32_16x16x32_bf16 v[140:143], a[220:223], v[188:191], v[140:143]
  s_waitcnt lgkmcnt(2)
  v_bfi_b32 v88, 1, s84, v88
  buffer_store_dwordx4 v[88:91], v1, s[4:7], s60 offen offset:1024 sc1
  v_mfma_f32_16x16x32_bf16 v[140:143], a[224:227], v[192:195], v[140:143]
  v_cvt_pk_bf16_f32 v80, v132, v133
  v_mfma_f32_16x16x32_bf16 v[140:143], a[228:231], v[196:199], v[140:143]
  v_cvt_pk_bf16_f32 v81, v134, v135
  v_mfma_f32_16x16x32_bf16 v[140:143], a[232:235], v[200:203], v[140:143]
  ds_write_b64 v12, v[80:81] offset:2880
  v_mfma_f32_16x16x32_bf16 v[140:143], a[236:239], v[204:207], v[140:143]
  v_cvt_pk_bf16_f32 v82, v136, v137
  v_cvt_pk_bf16_f32 v83, v138, v139
  ds_write_b64 v12, v[82:83] offset:2912
  s_nop 4
  v_cvt_pk_bf16_f32 v80, v140, v141
  v_cvt_pk_bf16_f32 v81, v142, v143
  ds_write_b64 v12, v[80:81] offset:2944
  ds_read_b128 v[92:95], v28
  ds_read_b128 v[96:99], v29
  ds_read_b128 v[100:103], v30
  s_waitcnt lgkmcnt(2)
  v_bfi_b32 v92, 1, s84, v92
  buffer_store_dwordx4 v[92:95], v1, s[4:7], s60 offen offset:2048 sc1
  s_waitcnt lgkmcnt(1)
  v_bfi_b32 v96, 1, s84, v96
  buffer_store_dwordx4 v[96:99], v1, s[4:7], s60 offen offset:3072 sc1
  s_waitcnt lgkmcnt(0)
  v_bfi_b32 v100, 1, s84, v100
  buffer_store_dwordx4 v[100:103], v1, s[4:7], s61 offen offset:0 sc1
  buffer_load_dword v18, v156, s[4:7], s88 offen sc1
  s_cmp_eq_u32 s82, 0
  s_cselect_b32 s30, 0x10000000, s93
  s_cselect_b32 s46, 0, 40960
  s_add_u32 s91, s91, s46
  s_add_u32 s93, s93, 4096
  s_mov_b32 s2, s84
  s_mov_b32 s1, s95
  s_mov_b32 s0, s92
  s_add_u32 s92, s92, 40960
  s_mov_b32 s98, s56
  s_mov_b32 s99, s57
  s_add_u32 s82, s82, 1
  v_add_u32 v92, s94, v3
  v_add_u32 v93, s94, v1
  v_add_u32 v94, s94, v4
  ds_read_b128 v[32:35], v92 offset:0
  ds_read_b128 v[160:163], v93 offset:12288
  ds_read_b128 v[176:179], v93 offset:13312
  ds_read_b128 v[36:39], v92 offset:3072
  ds_read_b128 v[164:167], v93 offset:15360
  ds_read_b128 v[180:183], v93 offset:16384
  ds_read_b128 v[40:43], v92 offset:6144
  ds_read_b128 v[168:171], v93 offset:18432
  ds_read_b128 v[184:187], v93 offset:19456
  ds_read_b128 v[44:47], v92 offset:9216
  ds_read_b128 v[172:175], v93 offset:21504
  ds_read_b128 v[188:191], v93 offset:22528
  s_waitcnt lgkmcnt(9)
  v_mfma_f32_16x16x32_bf16 v[80:83], v[160:163], v[32:35], 0
  v_mfma_f32_16x16x32_bf16 v[84:87], v[176:179], v[32:35], 0
  ds_read_b64 v[48:49], v94 offset:2048
  ds_read_b128 v[192:195], v93 offset:14336
  s_waitcnt lgkmcnt(8)
  v_mfma_f32_16x16x32_bf16 v[80:83], v[164:167], v[36:39], v[80:83]
  v_mfma_f32_16x16x32_bf16 v[84:87], v[180:183], v[36:39], v[84:87]
  ds_read_b64 v[50:51], v94 offset:5120
  ds_read_b128 v[196:199], v93 offset:17408
  s_waitcnt lgkmcnt(7)
  v_mfma_f32_16x16x32_bf16 v[80:83], v[168:171], v[40:43], v[80:83]
  v_mfma_f32_16x16x32_bf16 v[84:87], v[184:187], v[40:43], v[84:87]
  ds_read_b64 v[52:53], v94 offset:8192
  ds_read_b128 v[200:203], v93 offset:20480
  s_waitcnt lgkmcnt(6)
  v_mfma_f32_16x16x32_bf16 v[80:83], v[172:175], v[44:47], v[80:83]
  v_mfma_f32_16x16x32_bf16 v[84:87], v[188:191], v[44:47], v[84:87]
  ds_read_b64 v[54:55], v94 offset:11264
  ds_read_b128 v[204:207], v93 offset:23552
  s_nop 1
  s_waitcnt lgkmcnt(6)
  v_mfma_f32_16x16x16_bf16 v[96:99], v[192:193], v[48:49], 0
  v_mfma_f32_16x16x16_bf16 v[100:103], v[194:195], v[48:49], 0
  s_waitcnt lgkmcnt(4)
  v_mfma_f32_16x16x16_bf16 v[96:99], v[196:197], v[50:51], v[96:99]
  v_mfma_f32_16x16x16_bf16 v[100:103], v[198:199], v[50:51], v[100:103]
  s_waitcnt lgkmcnt(2)
  v_mfma_f32_16x16x16_bf16 v[96:99], v[200:201], v[52:53], v[96:99]
  v_mfma_f32_16x16x16_bf16 v[100:103], v[202:203], v[52:53], v[100:103]
  s_waitcnt lgkmcnt(0)
  v_mfma_f32_16x16x16_bf16 v[96:99], v[204:205], v[54:55], v[96:99]
  v_mfma_f32_16x16x16_bf16 v[100:103], v[206:207], v[54:55], v[100:103]
  s_cmp_lt_u32 s82, 64
  s_cbranch_scc1 topS_42
  s_waitcnt vmcnt(0)
  s_barrier
  v_mov_b32 v92, 1
  s_waitcnt vmcnt(63)
  buffer_store_dword v92, off, s[4:7], s30 sc1
  s_mov_b32 s30, 0x10000000
  buffer_load_dwordx2 v[24:25], v15, s[12:15], s91 offen sc1
  s_mov_b32 s46, s1
  buffer_load_dwordx4 v[160:163], v14, s[4:7], s46 offen sc1
  s_add_u32 s46, s1, 81920
  buffer_load_dwordx4 v[164:167], v14, s[4:7], s46 offen sc1
  s_add_u32 s46, s1, 163840
  buffer_load_dwordx4 v[168:171], v14, s[4:7], s46 offen sc1
  s_add_u32 s46, s1, 245760
  buffer_load_dwordx4 v[172:175], v14, s[4:7], s46 offen sc1
  s_add_u32 s46, s1, 327680
  buffer_load_dwordx4 v[176:179], v14, s[4:7], s46 offen sc1
  s_add_u32 s46, s1, 409600
  buffer_load_dwordx4 v[180:183], v14, s[4:7], s46 offen sc1
  s_add_u32 s46, s1, 491520
  buffer_load_dwordx4 v[184:187], v14, s[4:7], s46 offen sc1
  s_add_u32 s46, s1, 573440
  buffer_load_dwordx4 v[188:191], v14, s[4:7], s46 offen sc1
  s_waitcnt vmcnt(0)
bS_56:
  v_mfma_f32_16x16x32_bf16 v[208:211], v[20:23], v[160:163], 0
  v_bitop3_b32 v238, v160, v164, s2 bitop3:0x7e
  v_mfma_f32_16x16x32_bf16 v[208:211], v[20:23], v[164:167], v[208:211]
  v_bitop3_b32 v238, v238, v168, s2 bitop3:0xf6
  v_mfma_f32_16x16x32_bf16 v[208:211], v[20:23], v[168:171], v[208:211]
  v_bitop3_b32 v238, v238, v172, s2 bitop3:0xf6
  v_mfma_f32_16x16x32_bf16 v[208:211], v[20:23], v[172:175], v[208:211]
  v_bitop3_b32 v238, v238, v176, s2 bitop3:0xf6
  v_mfma_f32_16x16x32_bf16 v[208:211], v[20:23], v[176:179], v[208:211]
  v_bitop3_b32 v238, v238, v180, s2 bitop3:0xf6
  v_mfma_f32_16x16x32_bf16 v[208:211], v[20:23], v[180:183], v[208:211]
  v_bitop3_b32 v238, v238, v184, s2 bitop3:0xf6
  v_mfma_f32_16x16x32_bf16 v[208:211], v[20:23], v[184:187], v[208:211]
  v_bitop3_b32 v238, v238, v188, s2 bitop3:0xf6
  v_mfma_f32_16x16x32_bf16 v[208:211], v[20:23], v[188:191], v[208:211]
  v_and_b32 v238, 1, v238
  v_cmp_ne_u32 vcc, 0, v238
  s_and_b64 vcc, vcc, s[56:57]
  s_cbranch_vccz okS_57
  s_nop 7
  s_mov_b32 s46, s1
  buffer_load_dwordx4 v[160:163], v14, s[4:7], s46 offen sc1
  s_add_u32 s46, s1, 81920
  buffer_load_dwordx4 v[164:167], v14, s[4:7], s46 offen sc1
  s_add_u32 s46, s1, 163840
  buffer_load_dwordx4 v[168:171], v14, s[4:7], s46 offen sc1
  s_add_u32 s46, s1, 245760
  buffer_load_dwordx4 v[172:175], v14, s[4:7], s46 offen sc1
  s_add_u32 s46, s1, 327680
  buffer_load_dwordx4 v[176:179], v14, s[4:7], s46 offen sc1
  s_add_u32 s46, s1, 409600
  buffer_load_dwordx4 v[180:183], v14, s[4:7], s46 offen sc1
  s_add_u32 s46, s1, 491520
  buffer_load_dwordx4 v[184:187], v14, s[4:7], s46 offen sc1
  s_add_u32 s46, s1, 573440
  buffer_load_dwordx4 v[188:191], v14, s[4:7], s46 offen sc1
  s_add_u32 s45, s45, 1
  s_cmp_gt_u32 s45, 1048576
  s_cbranch_scc1 failaS_38
  s_waitcnt vmcnt(0)
  s_branch bS_56
okS_57:
  s_nop 0
  v_lshlrev_b32 v216, 16, v24
  v_and_b32 v217, 0xffff0000, v24
  v_lshlrev_b32 v218, 16, v25
  v_and_b32 v219, 0xffff0000, v25
  v_cvt_pk_bf16_f32 v232, v208, v209
  v_cvt_pk_bf16_f32 v233, v210, v211
  v_lshlrev_b32 v208, 16, v232
  v_and_b32 v209, 0xffff0000, v232
  v_lshlrev_b32 v210, 16, v233
  v_and_b32 v211, 0xffff0000, v233
  v_pk_add_f32 v[216:217], v[216:217], v[208:209]
  v_pk_add_f32 v[218:219], v[218:219], v[210:211]
  v_cvt_pk_bf16_f32 v224, v216, v217
  v_cvt_pk_bf16_f32 v225, v218, v219
  v_lshlrev_b32 v216, 16, v224
  v_and_b32 v217, 0xffff0000, v224
  v_lshlrev_b32 v218, 16, v225
  v_and_b32 v219, 0xffff0000, v225
  v_add_f32 v236, v216, v217
  v_mul_f32 v237, v216, v216
  v_fmac_f32 v237, v217, v217
  v_add_f32 v236, v236, v218
  v_fmac_f32 v237, v218, v218
  v_add_f32 v236, v236, v219
  v_fmac_f32 v237, v219, v219
  s_nop 0
  v_add_f32_dpp v236, v236, v236 quad_perm:[1,0,3,2] row_mask:0xf bank_mask:0xf
  v_add_f32_dpp v237, v237, v237 quad_perm:[1,0,3,2] row_mask:0xf bank_mask:0xf
  s_nop 0
  v_add_f32_dpp v236, v236, v236 quad_perm:[2,3,0,1] row_mask:0xf bank_mask:0xf
  v_add_f32_dpp v237, v237, v237 quad_perm:[2,3,0,1] row_mask:0xf bank_mask:0xf
  s_nop 0
  v_add_f32_dpp v236, v236, v236 row_half_mirror row_mask:0xf bank_mask:0xf
  v_add_f32_dpp v237, v237, v237 row_half_mirror row_mask:0xf bank_mask:0xf
  s_nop 0
  v_add_f32_dpp v236, v236, v236 row_mirror row_mask:0xf bank_mask:0xf
  v_add_f32_dpp v237, v237, v237 row_mirror row_mask:0xf bank_mask:0xf
  v_mov_b32 v208, v236
  v_mov_b32 v209, v237
  s_nop 0
  v_permlane16_swap_b32 v236, v208
  v_permlane16_swap_b32 v237, v209
  v_pk_add_f32 v[236:237], v[236:237], v[208:209]
  v_mov_b32 v208, v236
  v_mov_b32 v209, v237
  s_nop 0
  v_permlane32_swap_b32 v236, v208
  v_permlane32_swap_b32 v237, v209
  v_pk_add_f32 v[236:237], v[236:237], v[208:209]
  ds_write_b64 v16, v[236:237]
  s_waitcnt lgkmcnt(0)
  s_barrier
  ds_read_b128 v[208:211], v17
  ds_read_b128 v[212:215], v17 offset:16
  s_waitcnt lgkmcnt(0)
  v_pk_add_f32 v[208:209], v[208:209], v[210:211]
  v_pk_add_f32 v[212:213], v[212:213], v[214:215]
  v_pk_add_f32 v[236:237], v[208:209], v[212:213]
  v_mul_f32 v236, 0x3acccccd, v236
  v_mul_f32 v237, 0x3acccccd, v237
  v_fma_f32 v237, -v236, v236, v237
  v_max_f32 v237, 0, v237
  v_cvt_pk_bf16_f32 v236, v236, v236
  v_and_b32 v236, 0xffff0000, v236
  v_cvt_pk_bf16_f32 v237, v237, v237
  v_and_b32 v237, 0xffff0000, v237
  v_add_f32 v237, 0x3727c5ac, v237
  v_cvt_pk_bf16_f32 v237, v237, v237
  v_and_b32 v237, 0xffff0000, v237
  v_pk_add_f32 v[216:217], v[216:217], v[236:237] op_sel_hi:[1,0] neg_lo:[0,1] neg_hi:[0,1]
  v_pk_add_f32 v[218:219], v[218:219], v[236:237] op_sel_hi:[1,0] neg_lo:[0,1] neg_hi:[0,1]
  v_sqrt_f32 v237, v237
  v_cvt_pk_bf16_f32 v232, v216, v217
  v_cvt_pk_bf16_f32 v233, v218, v219
  v_cvt_pk_bf16_f32 v237, v237, v237
  v_and_b32 v237, 0xffff0000, v237
  v_rcp_f32 v237, v237
  v_lshlrev_b32 v216, 16, v232
  v_and_b32 v217, 0xffff0000, v232
  v_lshlrev_b32 v218, 16, v233
  v_and_b32 v219, 0xffff0000, v233
  v_pk_mul_f32 v[216:217], v[216:217], v[236:237] op_sel:[0,1] op_sel_hi:[1,1]
  v_pk_mul_f32 v[218:219], v[218:219], v[236:237] op_sel:[0,1] op_sel_hi:[1,1]
  v_cvt_pk_bf16_f32 v240, v216, v217
  v_cvt_pk_bf16_f32 v241, v218, v219
  v_mov_b32 v242, v240
  v_mov_b32 v243, v241
  s_nop 0
  v_permlane16_swap_b32 v240, v242
  v_permlane16_swap_b32 v241, v243
  v_mov_b32 v226, v224
  v_mov_b32 v227, v225
  s_nop 0
  v_permlane16_swap_b32 v224, v226
  v_permlane16_swap_b32 v225, v227
  s_sub_u32 s55, s0, 5242880
  buffer_store_dwordx4 v[240:243], v31, s[4:7], s55 offen sc1
  buffer_store_dwordx4 v[224:227], v31, s[4:7], s0 offen sc1
  v_mov_b32 v18, 1
  s_waitcnt vmcnt(0)
  s_barrier
  buffer_store_dword v18, off, s[4:7], s93 sc1
  s_endpgm
failaS_38:
  s_mov_b64 exec, 1
  v_mov_b32 v150, 224
  v_mov_b32 v151, 2
  buffer_atomic_or v151, v150, s[8:11], 0 offen sc1
  s_endpgm
  .p2align 6
R_ffnS:
  s_lshr_b32 s52, s43, 4
  s_and_b32 s53, s43, 15
  v_add_u32 v40, 0, v0
  v_mul_u32_u24 v41, 87382, v40
  v_lshrrev_b32 v41, 20, v41
  v_mul_u32_u24 v42, 12, v41
  v_sub_u32 v40, v40, v42
  v_lshlrev_b32 v40, 4, v40
  v_mul_u32_u24 v41, 3072, v41
  v_add_u32 v16, v40, v41
  v_add_u32 v40, 64, v0
  v_mul_u32_u24 v41, 87382, v40
  v_lshrrev_b32 v41, 20, v41
  v_mul_u32_u24 v42, 12, v41
  v_sub_u32 v40, v40, v42
  v_lshlrev_b32 v40, 4, v40
  v_mul_u32_u24 v41, 3072, v41
  v_add_u32 v17, v40, v41
  v_add_u32 v40, 128, v0
  v_mul_u32_u24 v41, 87382, v40
  v_lshrrev_b32 v41, 20, v41
  v_mul_u32_u24 v42, 12, v41
  v_sub_u32 v40, v40, v42
  v_lshlrev_b32 v40, 4, v40
  v_mul_u32_u24 v41, 3072, v41
  v_add_u32 v18, v40, v41
  s_mul_i32 s46, s3, 49152
  v_add_u32 v16, s46, v16
  v_add_u32 v17, s46, v17
  v_add_u32 v18, s46, v18
  s_mul_i32 s46, s53, 192
  v_add_u32 v16, s46, v16
  v_add_u32 v17, s46, v17
  v_add_u32 v18, s46, v18
  v_add_u32 v40, 0, v0
  v_mul_u32_u24 v41, 26215, v40
  v_lshrrev_b32 v41, 20, v41
  v_mul_u32_u24 v42, 40, v41
  v_sub_u32 v40, v40, v42
  v_lshlrev_b32 v40, 4, v40
  v_mul_u32_u24 v41, 1280, v41
  v_add_u32 v20, v40, v41
  v_add_u32 v40, 64, v0
  v_mul_u32_u24 v41, 26215, v40
  v_lshrrev_b32 v41, 20, v41
  v_mul_u32_u24 v42, 40, v41
  v_sub_u32 v40, v40, v42
  v_lshlrev_b32 v40, 4, v40
  v_mul_u32_u24 v41, 1280, v41
  v_add_u32 v21, v40, v41
  v_add_u32 v40, 128, v0
  v_mul_u32_u24 v41, 26215, v40
  v_lshrrev_b32 v41, 20, v41
  v_mul_u32_u24 v42, 40, v41
  v_sub_u32 v40, v40, v42
  v_lshlrev_b32 v40, 4, v40
  v_mul_u32_u24 v41, 1280, v41
  v_add_u32 v22, v40, v41
  v_add_u32 v40, 192, v0
  v_mul_u32_u24 v41, 26215, v40
  v_lshrrev_b32 v41, 20, v41
  v_mul_u32_u24 v42, 40, v41
  v_sub_u32 v40, v40, v42
  v_lshlrev_b32 v40, 4, v40
  v_mul_u32_u24 v41, 1280, v41
  v_add_u32 v23, v40, v41
  v_add_u32 v40, 256, v0
  v_mul_u32_u24 v41, 26215, v40
  v_lshrrev_b32 v41, 20, v41
  v_mul_u32_u24 v42, 40, v41
  v_sub_u32 v40, v40, v42
  v_lshlrev_b32 v40, 4, v40
  v_mul_u32_u24 v41, 1280, v41
  v_add_u32 v24, v40, v41
  s_mul_i32 s46, s3, 10240
  v_add_u32 v20, s46, v20
  v_add_u32 v21, s46, v21
  v_add_u32 v22, s46, v22
  v_add_u32 v23, s46, v23
  v_add_u32 v24, s46, v24
  s_mul_i32 s46, s53, 122880
  s_and_b32 s47, s53, 1
  s_mul_i32 s57, s47, 640
  s_add_u32 s46, s46, s57
  v_add_u32 v20, s46, v20
  v_add_u32 v21, s46, v21
  v_add_u32 v22, s46, v22
  v_add_u32 v23, s46, v23
  v_add_u32 v24, s46, v24
  s_mul_i32 s57, s47, 245760
  s_sub_u32 s57, 122880, s57
  v_add_u32 v52, s57, v20
  v_add_u32 v53, s57, v21
  v_add_u32 v54, s57, v22
  v_add_u32 v55, s57, v23
  v_add_u32 v56, s57, v24
  v_lshrrev_b32 v40, 4, v0
  v_mul_u32_u24 v40, 8, v40
  v_bfe_u32 v41, v0, 2, 2
  v_add_u32 v40, v40, v41
  v_mul_u32_u24 v40, 192, v40
  v_and_b32 v41, 3, v0
  v_mul_u32_u24 v41, 8, v41
  v_add_u32 v26, v40, v41
  s_lshr_b32 s46, s3, 1
  s_mul_i32 s57, s46, 40960
  s_mul_i32 s46, s46, 96
  v_add_u32 v26, s46, v26
  v_add_u32 v27, 0x10000, v26
  v_add_u32 v28, 0x20000, v26
  v_lshrrev_b32 v40, 4, v0
  v_mul_u32_u24 v40, 4, v40
  v_bfe_u32 v41, v0, 2, 2
  v_add_u32 v40, v40, v41
  v_mul_u32_u24 v40, 640, v40
  v_and_b32 v41, 3, v0
  v_mul_u32_u24 v41, 8, v41
  v_add_u32 v29, v40, v41
  s_mul_i32 s46, s3, 160
  v_add_u32 v29, s46, v29
  v_add_u32 v30, 0x10000, v29
  v_add_u32 v31, 0x20000, v29
  s_mul_i32 s55, s3, 3072
  s_mul_i32 s56, s3, 5120
  s_mov_b32 s60, s32
  s_and_b32 s61, s33, 0xffff
  s_mov_b32 s62, 1966080
  s_mov_b32 s63, 0x20000
  s_mov_b32 s64, s34
  s_and_b32 s65, s35, 0xffff
  s_mov_b32 s66, 1966080
  s_mov_b32 s67, 0x20000
  s_mov_b32 s46, 0
  s_add_u32 m0, s55, 0
  s_nop 0
  buffer_load_dwordx4 v16, s[60:63], s46 offen lds
  s_mov_b32 s46, 0
  s_add_u32 m0, s55, 1024
  s_nop 0
  buffer_load_dwordx4 v17, s[60:63], s46 offen lds
  s_mov_b32 s46, 0
  s_add_u32 m0, s55, 2048
  s_nop 0
  buffer_load_dwordx4 v18, s[60:63], s46 offen lds
  s_mov_b32 s46, 196608
  s_add_u32 m0, s55, 12288
  s_nop 0
  buffer_load_dwordx4 v16, s[60:63], s46 offen lds
  s_mov_b32 s46, 196608
  s_add_u32 m0, s55, 13312
  s_nop 0
  buffer_load_dwordx4 v17, s[60:63], s46 offen lds
  s_mov_b32 s46, 196608
  s_add_u32 m0, s55, 14336
  s_nop 0
  buffer_load_dwordx4 v18, s[60:63], s46 offen lds
  s_mov_b32 s46, 393216
  s_add_u32 m0, s55, 24576
  s_nop 0
  buffer_load_dwordx4 v16, s[60:63], s46 offen lds
  s_mov_b32 s46, 393216
  s_add_u32 m0, s55, 25600
  s_nop 0
  buffer_load_dwordx4 v17, s[60:63], s46 offen lds
  s_mov_b32 s46, 393216
  s_add_u32 m0, s55, 26624
  s_nop 0
  buffer_load_dwordx4 v18, s[60:63], s46 offen lds
  s_mov_b32 s46, 589824
  s_add_u32 m0, s55, 36864
  s_nop 0
  buffer_load_dwordx4 v16, s[60:63], s46 offen lds
  s_mov_b32 s46, 589824
  s_add_u32 m0, s55, 37888
  s_nop 0
  buffer_load_dwordx4 v17, s[60:63], s46 offen lds
  s_mov_b32 s46, 589824
  s_add_u32 m0, s55, 38912
  s_nop 0
  buffer_load_dwordx4 v18, s[60:63], s46 offen lds
  s_mov_b32 s46, 786432
  s_add_u32 m0, s55, 49152
  s_nop 0
  buffer_load_dwordx4 v16, s[60:63], s46 offen lds
  s_mov_b32 s46, 786432
  s_add_u32 m0, s55, 50176
  s_nop 0
  buffer_load_dwordx4 v17, s[60:63], s46 offen lds
  s_mov_b32 s46, 786432
  s_add_u32 m0, s55, 51200
  s_nop 0
  buffer_load_dwordx4 v18, s[60:63], s46 offen lds
  s_mov_b32 s46, 983040
  s_add_u32 m0, s55, 61440
  s_nop 0
  buffer_load_dwordx4 v16, s[60:63], s46 offen lds
  s_mov_b32 s46, 983040
  s_add_u32 m0, s55, 62464
  s_nop 0
  buffer_load_dwordx4 v17, s[60:63], s46 offen lds
  s_mov_b32 s46, 983040
  s_add_u32 m0, s55, 63488
  s_nop 0
  buffer_load_dwordx4 v18, s[60:63], s46 offen lds
  s_mov_b32 s46, 1179648
  s_add_u32 m0, s55, 73728
  s_nop 0
  buffer_load_dwordx4 v16, s[60:63], s46 offen lds
  s_mov_b32 s46, 1179648
  s_add_u32 m0, s55, 74752
  s_nop 0
  buffer_load_dwordx4 v17, s[60:63], s46 offen lds
  s_mov_b32 s46, 1179648
  s_add_u32 m0, s55, 75776
  s_nop 0
  buffer_load_dwordx4 v18, s[60:63], s46 offen lds
  s_mov_b32 s46, 1376256
  s_add_u32 m0, s55, 86016
  s_nop 0
  buffer_load_dwordx4 v16, s[60:63], s46 offen lds
  s_mov_b32 s46, 1376256
  s_add_u32 m0, s55, 87040
  s_nop 0
  buffer_load_dwordx4 v17, s[60:63], s46 offen lds
  s_mov_b32 s46, 1376256
  s_add_u32 m0, s55, 88064
  s_nop 0
  buffer_load_dwordx4 v18, s[60:63], s46 offen lds
  s_mov_b32 s46, 1572864
  s_add_u32 m0, s55, 98304
  s_nop 0
  buffer_load_dwordx4 v16, s[60:63], s46 offen lds
  s_mov_b32 s46, 1572864
  s_add_u32 m0, s55, 99328
  s_nop 0
  buffer_load_dwordx4 v17, s[60:63], s46 offen lds
  s_mov_b32 s46, 1572864
  s_add_u32 m0, s55, 100352
  s_nop 0
  buffer_load_dwordx4 v18, s[60:63], s46 offen lds
  s_mov_b32 s46, 1769472
  s_add_u32 m0, s55, 110592
  s_nop 0
  buffer_load_dwordx4 v16, s[60:63], s46 offen lds
  s_mov_b32 s46, 1769472
  s_add_u32 m0, s55, 111616
  s_nop 0
  buffer_load_dwordx4 v17, s[60:63], s46 offen lds
  s_mov_b32 s46, 1769472
  s_add_u32 m0, s55, 112640
  s_nop 0
  buffer_load_dwordx4 v18, s[60:63], s46 offen lds
  s_mov_b32 s46, 0
  s_add_u32 m0, s56, 122880
  s_nop 0
  buffer_load_dwordx4 v20, s[64:67], s46 offen lds
  s_mov_b32 s46, 0
  s_add_u32 m0, s56, 123904
  s_nop 0
  buffer_load_dwordx4 v21, s[64:67], s46 offen lds
  s_mov_b32 s46, 0
  s_add_u32 m0, s56, 124928
  s_nop 0
  buffer_load_dwordx4 v22, s[64:67], s46 offen lds
  s_mov_b32 s46, 0
  s_add_u32 m0, s56, 125952
  s_nop 0
  buffer_load_dwordx4 v23, s[64:67], s46 offen lds
  s_mov_b32 s46, 0
  s_add_u32 m0, s56, 126976
  s_nop 0
  buffer_load_dwordx4 v24, s[64:67], s46 offen lds
  s_mov_b32 s46, 61440
  s_add_u32 m0, s56, 143360
  s_nop 0
  buffer_load_dwordx4 v20, s[64:67], s46 offen lds
  s_mov_b32 s46, 61440
  s_add_u32 m0, s56, 144384
  s_nop 0
  buffer_load_dwordx4 v21, s[64:67], s46 offen lds
  s_mov_b32 s46, 61440
  s_add_u32 m0, s56, 145408
  s_nop 0
  buffer_load_dwordx4 v22, s[64:67], s46 offen lds
  s_mov_b32 s46, 61440
  s_add_u32 m0, s56, 146432
  s_nop 0
  buffer_load_dwordx4 v23, s[64:67], s46 offen lds
  s_mov_b32 s46, 61440
  s_add_u32 m0, s56, 147456
  s_nop 0
  buffer_load_dwordx4 v24, s[64:67], s46 offen lds
  s_waitcnt vmcnt(37)
  s_barrier
  ds_read_b64_tr_b16 a[0:1], v26 offset:0
  ds_read_b64_tr_b16 a[2:3], v26 offset:768
  ds_read_b64_tr_b16 a[80:81], v26 offset:32
  ds_read_b64_tr_b16 a[82:83], v26 offset:800
  ds_read_b64_tr_b16 a[160:161], v26 offset:64
  ds_read_b64_tr_b16 a[162:163], v26 offset:832
  ds_read_b64_tr_b16 a[4:5], v26 offset:6144
  ds_read_b64_tr_b16 a[6:7], v26 offset:6912
  ds_read_b64_tr_b16 a[84:85], v26 offset:6176
  ds_read_b64_tr_b16 a[86:87], v26 offset:6944
  ds_read_b64_tr_b16 a[164:165], v26 offset:6208
  ds_read_b64_tr_b16 a[166:167], v26 offset:6976
  s_waitcnt lgkmcnt(0)
  s_waitcnt vmcnt(34)
  s_barrier
  ds_read_b64_tr_b16 a[8:9], v26 offset:12288
  ds_read_b64_tr_b16 a[10:11], v26 offset:13056
  ds_read_b64_tr_b16 a[88:89], v26 offset:12320
  ds_read_b64_tr_b16 a[90:91], v26 offset:13088
  ds_read_b64_tr_b16 a[168:169], v26 offset:12352
  ds_read_b64_tr_b16 a[170:171], v26 offset:13120
  ds_read_b64_tr_b16 a[12:13], v26 offset:18432
  ds_read_b64_tr_b16 a[14:15], v26 offset:19200
  ds_read_b64_tr_b16 a[92:93], v26 offset:18464
  ds_read_b64_tr_b16 a[94:95], v26 offset:19232
  ds_read_b64_tr_b16 a[172:173], v26 offset:18496
  ds_read_b64_tr_b16 a[174:175], v26 offset:19264
  s_waitcnt lgkmcnt(0)
  s_waitcnt vmcnt(31)
  s_barrier
  s_add_u32 s46, s57, 40960
  s_add_u32 m0, s56, 0
  s_nop 0
  buffer_load_dwordx4 v20, s[64:67], s46 offen lds
  s_add_u32 s46, s57, 40960
  s_add_u32 m0, s56, 1024
  s_nop 0
  buffer_load_dwordx4 v21, s[64:67], s46 offen lds
  s_add_u32 s46, s57, 40960
  s_add_u32 m0, s56, 2048
  s_nop 0
  buffer_load_dwordx4 v22, s[64:67], s46 offen lds
  s_add_u32 s46, s57, 40960
  s_add_u32 m0, s56, 3072
  s_nop 0
  buffer_load_dwordx4 v23, s[64:67], s46 offen lds
  s_add_u32 s46, s57, 40960
  s_add_u32 m0, s56, 4096
  s_nop 0
  buffer_load_dwordx4 v24, s[64:67], s46 offen lds
  ds_read_b64_tr_b16 a[16:17], v26 offset:24576
  ds_read_b64_tr_b16 a[18:19], v26 offset:25344
  ds_read_b64_tr_b16 a[96:97], v26 offset:24608
  ds_read_b64_tr_b16 a[98:99], v26 offset:25376
  ds_read_b64_tr_b16 a[176:177], v26 offset:24640
  ds_read_b64_tr_b16 a[178:179], v26 offset:25408
  ds_read_b64_tr_b16 a[20:21], v26 offset:30720
  ds_read_b64_tr_b16 a[22:23], v26 offset:31488
  ds_read_b64_tr_b16 a[100:101], v26 offset:30752
  ds_read_b64_tr_b16 a[102:103], v26 offset:31520
  ds_read_b64_tr_b16 a[180:181], v26 offset:30784
  ds_read_b64_tr_b16 a[182:183], v26 offset:31552
  s_waitcnt lgkmcnt(0)
  s_waitcnt vmcnt(33)
  s_barrier
  ds_read_b64_tr_b16 a[24:25], v26 offset:36864
  ds_read_b64_tr_b16 a[26:27], v26 offset:37632
  ds_read_b64_tr_b16 a[104:105], v26 offset:36896
  ds_read_b64_tr_b16 a[106:107], v26 offset:37664
  ds_read_b64_tr_b16 a[184:185], v26 offset:36928
  ds_read_b64_tr_b16 a[186:187], v26 offset:37696
  ds_read_b64_tr_b16 a[28:29], v26 offset:43008
  ds_read_b64_tr_b16 a[30:31], v26 offset:43776
  ds_read_b64_tr_b16 a[108:109], v26 offset:43040
  ds_read_b64_tr_b16 a[110:111], v26 offset:43808
  ds_read_b64_tr_b16 a[188:189], v26 offset:43072
  ds_read_b64_tr_b16 a[190:191], v26 offset:43840
  s_waitcnt lgkmcnt(0)
  s_waitcnt vmcnt(30)
  s_barrier
  s_mov_b32 s46, 0
  s_add_u32 m0, s56, 20480
  s_nop 0
  buffer_load_dwordx4 v52, s[64:67], s46 offen lds
  s_mov_b32 s46, 0
  s_add_u32 m0, s56, 21504
  s_nop 0
  buffer_load_dwordx4 v53, s[64:67], s46 offen lds
  s_mov_b32 s46, 0
  s_add_u32 m0, s56, 22528
  s_nop 0
  buffer_load_dwordx4 v54, s[64:67], s46 offen lds
  s_mov_b32 s46, 0
  s_add_u32 m0, s56, 23552
  s_nop 0
  buffer_load_dwordx4 v55, s[64:67], s46 offen lds
  s_mov_b32 s46, 0
  s_add_u32 m0, s56, 24576
  s_nop 0
  buffer_load_dwordx4 v56, s[64:67], s46 offen lds
  ds_read_b64_tr_b16 a[32:33], v26 offset:49152
  ds_read_b64_tr_b16 a[34:35], v26 offset:49920
  ds_read_b64_tr_b16 a[112:113], v26 offset:49184
  ds_read_b64_tr_b16 a[114:115], v26 offset:49952
  ds_read_b64_tr_b16 a[192:193], v26 offset:49216
  ds_read_b64_tr_b16 a[194:195], v26 offset:49984
  ds_read_b64_tr_b16 a[36:37], v26 offset:55296
  ds_read_b64_tr_b16 a[38:39], v26 offset:56064
  ds_read_b64_tr_b16 a[116:117], v26 offset:55328
  ds_read_b64_tr_b16 a[118:119], v26 offset:56096
  ds_read_b64_tr_b16 a[196:197], v26 offset:55360
  ds_read_b64_tr_b16 a[198:199], v26 offset:56128
  s_waitcnt lgkmcnt(0)
  s_waitcnt vmcnt(32)
  s_barrier
  s_mov_b32 s46, 61440
  s_add_u32 m0, s56, 40960
  s_nop 0
  buffer_load_dwordx4 v52, s[64:67], s46 offen lds
  s_mov_b32 s46, 61440
  s_add_u32 m0, s56, 41984
  s_nop 0
  buffer_load_dwordx4 v53, s[64:67], s46 offen lds
  s_mov_b32 s46, 61440
  s_add_u32 m0, s56, 43008
  s_nop 0
  buffer_load_dwordx4 v54, s[64:67], s46 offen lds
  s_mov_b32 s46, 61440
  s_add_u32 m0, s56, 44032
  s_nop 0
  buffer_load_dwordx4 v55, s[64:67], s46 offen lds
  s_mov_b32 s46, 61440
  s_add_u32 m0, s56, 45056
  s_nop 0
  buffer_load_dwordx4 v56, s[64:67], s46 offen lds
  ds_read_b64_tr_b16 a[40:41], v26 offset:61440
  ds_read_b64_tr_b16 a[42:43], v26 offset:62208
  ds_read_b64_tr_b16 a[120:121], v26 offset:61472
  ds_read_b64_tr_b16 a[122:123], v26 offset:62240
  ds_read_b64_tr_b16 a[200:201], v26 offset:61504
  ds_read_b64_tr_b16 a[202:203], v26 offset:62272
  ds_read_b64_tr_b16 a[44:45], v27 offset:2048
  ds_read_b64_tr_b16 a[46:47], v27 offset:2816
  ds_read_b64_tr_b16 a[124:125], v27 offset:2080
  ds_read_b64_tr_b16 a[126:127], v27 offset:2848
  ds_read_b64_tr_b16 a[204:205], v27 offset:2112
  ds_read_b64_tr_b16 a[206:207], v27 offset:2880
  s_waitcnt lgkmcnt(0)
  s_waitcnt vmcnt(34)
  s_barrier
  ds_read_b64_tr_b16 a[48:49], v27 offset:8192
  ds_read_b64_tr_b16 a[50:51], v27 offset:8960
  ds_read_b64_tr_b16 a[128:129], v27 offset:8224
  ds_read_b64_tr_b16 a[130:131], v27 offset:8992
  ds_read_b64_tr_b16 a[208:209], v27 offset:8256
  ds_read_b64_tr_b16 a[210:211], v27 offset:9024
  ds_read_b64_tr_b16 a[52:53], v27 offset:14336
  ds_read_b64_tr_b16 a[54:55], v27 offset:15104
  ds_read_b64_tr_b16 a[132:133], v27 offset:14368
  ds_read_b64_tr_b16 a[134:135], v27 offset:15136
  ds_read_b64_tr_b16 a[212:213], v27 offset:14400
  ds_read_b64_tr_b16 a[214:215], v27 offset:15168
  s_waitcnt lgkmcnt(0)
  s_waitcnt vmcnt(31)
  s_barrier
  s_add_u32 s46, s57, 40960
  s_add_u32 m0, s56, 61440
  s_nop 0
  buffer_load_dwordx4 v52, s[64:67], s46 offen lds
  s_add_u32 s46, s57, 40960
  s_add_u32 m0, s56, 62464
  s_nop 0
  buffer_load_dwordx4 v53, s[64:67], s46 offen lds
  s_add_u32 s46, s57, 40960
  s_add_u32 m0, s56, 63488
  s_nop 0
  buffer_load_dwordx4 v54, s[64:67], s46 offen lds
  s_add_u32 s46, s57, 40960
  s_add_u32 m0, s56, 64512
  s_nop 0
  buffer_load_dwordx4 v55, s[64:67], s46 offen lds
  s_add_u32 s46, s57, 40960
  s_add_u32 m0, s56, 65536
  s_nop 0
  buffer_load_dwordx4 v56, s[64:67], s46 offen lds
  ds_read_b64_tr_b16 a[56:57], v27 offset:20480
  ds_read_b64_tr_b16 a[58:59], v27 offset:21248
  ds_read_b64_tr_b16 a[136:137], v27 offset:20512
  ds_read_b64_tr_b16 a[138:139], v27 offset:21280
  ds_read_b64_tr_b16 a[216:217], v27 offset:20544
  ds_read_b64_tr_b16 a[218:219], v27 offset:21312
  ds_read_b64_tr_b16 a[60:61], v27 offset:26624
  ds_read_b64_tr_b16 a[62:63], v27 offset:27392
  ds_read_b64_tr_b16 a[140:141], v27 offset:26656
  ds_read_b64_tr_b16 a[142:143], v27 offset:27424
  ds_read_b64_tr_b16 a[220:221], v27 offset:26688
  ds_read_b64_tr_b16 a[222:223], v27 offset:27456
  s_waitcnt lgkmcnt(0)
  s_waitcnt vmcnt(33)
  s_barrier
  ds_read_b64_tr_b16 a[64:65], v27 offset:32768
  ds_read_b64_tr_b16 a[66:67], v27 offset:33536
  ds_read_b64_tr_b16 a[144:145], v27 offset:32800
  ds_read_b64_tr_b16 a[146:147], v27 offset:33568
  ds_read_b64_tr_b16 a[224:225], v27 offset:32832
  ds_read_b64_tr_b16 a[226:227], v27 offset:33600
  ds_read_b64_tr_b16 a[68:69], v27 offset:38912
  ds_read_b64_tr_b16 a[70:71], v27 offset:39680
  ds_read_b64_tr_b16 a[148:149], v27 offset:38944
  ds_read_b64_tr_b16 a[150:151], v27 offset:39712
  ds_read_b64_tr_b16 a[228:229], v27 offset:38976
  ds_read_b64_tr_b16 a[230:231], v27 offset:39744
  s_waitcnt lgkmcnt(0)
  s_waitcnt vmcnt(30)
  s_barrier
  ds_read_b64_tr_b16 a[72:73], v27 offset:45056
  ds_read_b64_tr_b16 a[74:75], v27 offset:45824
  ds_read_b64_tr_b16 a[152:153], v27 offset:45088
  ds_read_b64_tr_b16 a[154:155], v27 offset:45856
  ds_read_b64_tr_b16 a[232:233], v27 offset:45120
  ds_read_b64_tr_b16 a[234:235], v27 offset:45888
  ds_read_b64_tr_b16 a[76:77], v27 offset:51200
  ds_read_b64_tr_b16 a[78:79], v27 offset:51968
  ds_read_b64_tr_b16 a[156:157], v27 offset:51232
  ds_read_b64_tr_b16 a[158:159], v27 offset:52000
  ds_read_b64_tr_b16 a[236:237], v27 offset:51264
  ds_read_b64_tr_b16 a[238:239], v27 offset:52032
  s_waitcnt lgkmcnt(0)
  s_waitcnt vmcnt(25)
  s_barrier
  ds_read_b64_tr_b16 a[240:241], v30 offset:57344
  ds_read_b64_tr_b16 a[242:243], v31 offset:2048
  ds_read_b64_tr_b16 v[160:161], v30 offset:57376
  ds_read_b64_tr_b16 v[162:163], v31 offset:2080
  ds_read_b64_tr_b16 v[184:185], v30 offset:57408
  ds_read_b64_tr_b16 v[186:187], v31 offset:2112
  ds_read_b64_tr_b16 v[208:209], v30 offset:57440
  ds_read_b64_tr_b16 v[210:211], v31 offset:2144
  ds_read_b64_tr_b16 v[232:233], v30 offset:57472
  ds_read_b64_tr_b16 v[234:235], v31 offset:2176
  s_waitcnt lgkmcnt(0)
  s_waitcnt vmcnt(20)
  s_barrier
  ds_read_b64_tr_b16 a[244:245], v31 offset:12288
  ds_read_b64_tr_b16 a[246:247], v31 offset:22528
  ds_read_b64_tr_b16 v[164:165], v31 offset:12320
  ds_read_b64_tr_b16 v[166:167], v31 offset:22560
  ds_read_b64_tr_b16 v[188:189], v31 offset:12352
  ds_read_b64_tr_b16 v[190:191], v31 offset:22592
  ds_read_b64_tr_b16 v[212:213], v31 offset:12384
  ds_read_b64_tr_b16 v[214:215], v31 offset:22624
  ds_read_b64_tr_b16 v[236:237], v31 offset:12416
  ds_read_b64_tr_b16 v[238:239], v31 offset:22656
  s_waitcnt lgkmcnt(0)
  s_waitcnt vmcnt(15)
  s_barrier
  ds_read_b64_tr_b16 a[248:249], v29 offset:0
  ds_read_b64_tr_b16 a[250:251], v29 offset:10240
  ds_read_b64_tr_b16 v[168:169], v29 offset:32
  ds_read_b64_tr_b16 v[170:171], v29 offset:10272
  ds_read_b64_tr_b16 v[192:193], v29 offset:64
  ds_read_b64_tr_b16 v[194:195], v29 offset:10304
  ds_read_b64_tr_b16 v[216:217], v29 offset:96
  ds_read_b64_tr_b16 v[218:219], v29 offset:10336
  ds_read_b64_tr_b16 v[240:241], v29 offset:128
  ds_read_b64_tr_b16 v[242:243], v29 offset:10368
  s_waitcnt lgkmcnt(0)
  s_waitcnt vmcnt(10)
  s_barrier
  ds_read_b64_tr_b16 a[252:253], v29 offset:20480
  ds_read_b64_tr_b16 a[254:255], v29 offset:30720
  ds_read_b64_tr_b16 v[172:173], v29 offset:20512
  ds_read_b64_tr_b16 v[174:175], v29 offset:30752
  ds_read_b64_tr_b16 v[196:197], v29 offset:20544
  ds_read_b64_tr_b16 v[198:199], v29 offset:30784
  ds_read_b64_tr_b16 v[220:221], v29 offset:20576
  ds_read_b64_tr_b16 v[222:223], v29 offset:30816
  ds_read_b64_tr_b16 v[244:245], v29 offset:20608
  ds_read_b64_tr_b16 v[246:247], v29 offset:30848
  s_waitcnt lgkmcnt(0)
  s_waitcnt vmcnt(5)
  s_barrier
  ds_read_b64_tr_b16 v[152:153], v29 offset:40960
  ds_read_b64_tr_b16 v[154:155], v29 offset:51200
  ds_read_b64_tr_b16 v[176:177], v29 offset:40992
  ds_read_b64_tr_b16 v[178:179], v29 offset:51232
  ds_read_b64_tr_b16 v[200:201], v29 offset:41024
  ds_read_b64_tr_b16 v[202:203], v29 offset:51264
  ds_read_b64_tr_b16 v[224:225], v29 offset:41056
  ds_read_b64_tr_b16 v[226:227], v29 offset:51296
  ds_read_b64_tr_b16 v[248:249], v29 offset:41088
  ds_read_b64_tr_b16 v[250:251], v29 offset:51328
  s_waitcnt lgkmcnt(0)
  s_waitcnt vmcnt(0)
  s_barrier
  ds_read_b64_tr_b16 v[156:157], v29 offset:61440
  ds_read_b64_tr_b16 v[158:159], v30 offset:6144
  ds_read_b64_tr_b16 v[180:181], v29 offset:61472
  ds_read_b64_tr_b16 v[182:183], v30 offset:6176
  ds_read_b64_tr_b16 v[204:205], v29 offset:61504
  ds_read_b64_tr_b16 v[206:207], v30 offset:6208
  ds_read_b64_tr_b16 v[228:229], v29 offset:61536
  ds_read_b64_tr_b16 v[230:231], v30 offset:6240
  ds_read_b64_tr_b16 v[252:253], v29 offset:61568
  ds_read_b64_tr_b16 v[254:255], v30 offset:6272
  s_waitcnt lgkmcnt(0)
  s_barrier
  s_mov_b32 s48, 0x00ff00ff
  s_mov_b32 s49, 0x00ff00ff
  s_mov_b32 s50, 0x00ff00ff
  s_mov_b32 s51, 0xff00ff00
  v_and_b32 v30, 1, v0
  v_lshlrev_b32 v30, 4, v30
  v_mov_b32 v31, 0x3f80
  v_lshlrev_b32 v30, v30, v31
  v_bfe_u32 v31, v0, 1, 2
  v_cmp_eq_u32 vcc, 0, v31
  s_nop 1
  v_cndmask_b32 v24, 0, v30, vcc
  v_cmp_eq_u32 vcc, 1, v31
  s_nop 1
  v_cndmask_b32 v25, 0, v30, vcc
  v_cmp_eq_u32 vcc, 2, v31
  s_nop 1
  v_cndmask_b32 v26, 0, v30, vcc
  v_cmp_eq_u32 vcc, 3, v31
  s_nop 1
  v_cndmask_b32 v27, 0, v30, vcc
  v_cndmask_b32 v16, 0, v24, s[50:51]
  v_cndmask_b32 v17, 0, v25, s[50:51]
  v_cndmask_b32 v18, 0, v26, s[50:51]
  v_cndmask_b32 v19, 0, v27, s[50:51]
  s_mov_b32 s56, 0x03ff03ff
  s_mov_b32 s57, 0x03ff03ff
  v_lshrrev_b32 v40, 3, v0
  s_lshl_b32 s46, s3, 3
  v_add_u32 v40, s46, v40
  v_bfe_u32 v41, v40, 1, 3
  v_and_b32 v42, 7, v0
  v_xor_b32 v41, v41, v42
  v_lshlrev_b32 v41, 4, v41
  v_mul_u32_u24 v40, 1280, v40
  v_add_u32 v2, v40, v41
  v_bfe_u32 v40, v0, 3, 1
  v_mul_u32_u24 v40, 10240, v40
  v_and_b32 v41, 7, v0
  v_lshlrev_b32 v41, 7, v41
  v_add_u32 v40, v40, v41
  v_bfe_u32 v41, v0, 1, 3
  v_lshrrev_b32 v42, 4, v0
  v_xor_b32 v41, v41, v42
  v_lshlrev_b32 v41, 4, v41
  v_add_u32 v4, v40, v41
  v_xor_b32 v5, 64, v4
  s_and_b32 s54, s3, 1
  s_lshr_b32 s55, s3, 1
  v_lshlrev_b32 v1, 3, v0
  v_lshlrev_b32 v30, 4, v0
  s_mul_i32 s46, s54, 20480
  v_add_u32 v4, s46, v4
  v_add_u32 v5, s46, v5
  v_add_u32 v7, 40960, v30
  s_mul_i32 s46, s54, 3072
  s_lshl_b32 s47, s55, 10
  s_add_u32 s47, s47, s46
  v_add_u32 v3, s47, v7
  s_lshl_b32 s47, s55, 3
  s_add_u32 s47, s47, s46
  v_add_u32 v6, s47, v7
  s_mul_i32 s46, s3, 5632
  s_add_u32 s46, s46, 54272
  v_and_b32 v33, 15, v0
  v_mul_u32_u24 v33, 176, v33
  v_lshrrev_b32 v34, 4, v0
  v_lshlrev_b32 v34, 3, v34
  v_add3_u32 v8, v33, v34, s46
  v_add_u32 v33, 0, v0
  v_mul_u32_u24 v34, 6554, v33
  v_lshrrev_b32 v34, 16, v34
  v_add_u32 v33, v33, v34
  v_lshlrev_b32 v33, 4, v33
  v_add_u32 v144, s46, v33
  v_add_u32 v33, 64, v0
  v_mul_u32_u24 v34, 6554, v33
  v_lshrrev_b32 v34, 16, v34
  v_add_u32 v33, v33, v34
  v_lshlrev_b32 v33, 4, v33
  v_add_u32 v145, s46, v33
  v_add_u32 v33, 128, v0
  v_mul_u32_u24 v34, 6554, v33
  v_lshrrev_b32 v34, 16, v34
  v_add_u32 v33, v33, v34
  v_lshlrev_b32 v33, 4, v33
  v_add_u32 v146, s46, v33
  v_add_u32 v33, 192, v0
  v_mul_u32_u24 v34, 6554, v33
  v_lshrrev_b32 v34, 16, v34
  v_add_u32 v33, v33, v34
  v_lshlrev_b32 v33, 4, v33
  v_add_u32 v147, s46, v33
  v_add_u32 v33, 256, v0
  v_mul_u32_u24 v34, 6554, v33
  v_lshrrev_b32 v34, 16, v34
  v_add_u32 v33, v33, v34
  v_lshlrev_b32 v33, 4, v33
  v_add_u32 v148, s46, v33
  v_and_b32 v31, 15, v0
  v_lshrrev_b32 v32, 4, v0
  v_mov_b32 v9, v30
  v_lshrrev_b32 v36, 5, v0
  v_lshlrev_b32 v34, 4, v31
  v_mov_b32 v35, 0x40000000
  v_cndmask_b32 v35, v35, 0, s[56:57]
  v_add_u32 v33, v34, v35
  v_and_b32 v34, 1, v32
  v_mul_u32_u24 v35, 40960, v34
  v_mul_u32_u24 v37, 160, v36
  v_add3_u32 v10, v33, v35, v37
  v_lshlrev_b32 v34, 3, v34
  v_mul_u32_u24 v37, 1280, v36
  v_add3_u32 v33, v33, v34, v37
  s_mul_i32 s46, s3, 320
  v_add_u32 v11, s46, v33
  v_mov_b32 v33, 85504
  v_add_u32 v143, 79872, v11
  v_cndmask_b32 v143, v33, v143, s[56:57]
  v_and_b32 v142, 31, v0
  v_lshlrev_b32 v142, 5, v142
  v_lshlrev_b32 v34, 27, v34
  v_add_u32 v15, v34, v11
  v_lshlrev_b32 v36, 5, v36
  v_add_u32 v13, 53248, v36
  s_lshl_b32 s46, s3, 3
  v_add_u32 v12, s46, v13
  s_lshl_b32 s72, s52, 18
  s_add_u32 s72, s72, 262144
  s_mul_i32 s73, s52, 2621440
  s_add_u32 s73, s73, 24117248
  s_mul_i32 s75, s52, 655360
  s_add_u32 s75, s75, 5767168
  s_mul_i32 s79, s53, 20480
  s_add_u32 s74, s75, s79
  s_mul_i32 s79, s3, 5120
  s_add_u32 s74, s74, s79
  s_mul_i32 s79, s53, 320
  s_add_u32 s75, s75, s79
  s_mul_i32 s79, s55, 20480
  s_add_u32 s75, s75, s79
  s_mul_i32 s79, s54, 10240
  s_add_u32 s75, s75, s79
  s_mul_i32 s77, s53, 2560
  s_lshl_b32 s62, s52, 5
  s_add_u32 s62, s62, s53
  s_xor_b32 s63, s62, 1
  s_mul_i32 s62, s62, 6144
  s_mul_i32 s63, s63, 6144
  s_mul_i32 s79, s3, 1536
  s_add_u32 s79, s79, 11272192
  s_add_u32 s62, s62, s79
  s_add_u32 s63, s63, s79
  s_add_u32 s76, s73, 5242880
  s_add_u32 s76, s76, s77
  s_lshl_b32 s78, s53, 5
  s_add_u32 s78, s78, 131072
  s_mul_i32 s80, s3, 10240
  s_mov_b32 s70, 0
  s_mov_b32 s81, 0x10000000
  s_mov_b32 s31, 0
  s_cmp_eq_u32 s52, 0
  s_cselect_b32 s12, s40, s36
  s_cselect_b32 s13, s41, s37
  s_mov_b32 s14, 2621440
  s_cselect_b32 s14, 0x10000000, s14
  s_and_b32 s13, s13, 0xffff
  s_mov_b32 s15, 0x20000
  s_cmp_eq_u32 s52, 0
  s_cselect_b32 s86, 34603008, 0
  s_mov_b32 s87, 0x20000000
  s_cselect_b32 s87, 21495808, s87
  s_mov_b32 s88, 0x10000000
  s_cselect_b32 s78, s78, s88
  s_cselect_b32 s89, 2048, 0
  s_mov_b32 s30, 0
  s_mov_b32 s59, s75
  s_mov_b32 s82, 0x20000000
  s_mov_b32 s83, 0x20000000
  s_mov_b64 s[84:85], 0
  v_add_u32 v151, 79872, v9
  v_add_u32 v150, 2048, v9
  v_mov_b32 v33, 0x40000000
  v_cmp_gt_u32 vcc, 32, v0
  s_nop 1
  v_cndmask_b32 v150, v33, v150, vcc
  buffer_load_dword v149, v142, s[4:7], s72 offen sc1
  .p2align 6
topS_59:
  s_lshr_b32 s71, s70, 1
  s_and_b32 s71, s71, 1
  s_xor_b32 s71, s71, 1
  s_and_b32 s79, s70, 1
  s_mul_i32 s28, s79, 98304
  s_add_u32 s29, s28, s63
  s_add_u32 s28, s28, s62
  s_mul_i32 s79, s79, 327680
  s_add_u32 s60, s74, s79
  s_add_u32 s61, s60, 4096
  s_add_u32 s79, s75, s79
  s_waitcnt vmcnt(0)
  s_cmp_eq_u32 s31, 1
  s_cbranch_scc1 e2S_61
  v_cmp_eq_u32 vcc, 0, v149
  s_cbranch_vccnz e2S_61
  s_mov_b32 s31, 1
  s_mov_b32 m0, s80
  s_nop 0
  buffer_load_dwordx4 v2, s[4:7], s73 offen offset:0 sc1 lds
  s_add_u32 m0, m0, 896
  s_nop 0
  buffer_load_dwordx4 v2, s[4:7], s73 offen offset:128 sc1 lds
  s_add_u32 m0, m0, 896
  s_nop 0
  buffer_load_dwordx4 v2, s[4:7], s73 offen offset:256 sc1 lds
  s_add_u32 m0, m0, 896
  s_nop 0
  buffer_load_dwordx4 v2, s[4:7], s73 offen offset:384 sc1 lds
  s_add_u32 m0, m0, 896
  s_nop 0
  buffer_load_dwordx4 v2, s[4:7], s73 offen offset:512 sc1 lds
  s_add_u32 m0, m0, 896
  s_nop 0
  buffer_load_dwordx4 v2, s[4:7], s73 offen offset:640 sc1 lds
  s_add_u32 m0, m0, 896
  s_nop 0
  buffer_load_dwordx4 v2, s[4:7], s73 offen offset:768 sc1 lds
  s_add_u32 m0, m0, 896
  s_nop 0
  buffer_load_dwordx4 v2, s[4:7], s73 offen offset:896 sc1 lds
  s_add_u32 m0, m0, 896
  s_nop 0
  buffer_load_dwordx4 v2, s[4:7], s73 offen offset:1024 sc1 lds
  s_add_u32 m0, m0, 896
  s_nop 0
  buffer_load_dwordx4 v2, s[4:7], s73 offen offset:1152 sc1 lds
e2S_61:
bS_62:
  v_mfma_f32_16x16x32_bf16 v[68:71], v[16:19], v[24:27], 0
  v_bitop3_b32 v98, v24, v28, s30 bitop3:0x7e
  v_mfma_f32_16x16x32_bf16 v[68:71], v[16:19], v[28:31], v[68:71]
  v_bitop3_b32 v98, v98, v32, s30 bitop3:0xf6
  v_mfma_f32_16x16x32_bf16 v[68:71], v[16:19], v[32:35], v[68:71]
  v_bitop3_b32 v98, v98, v36, s30 bitop3:0xf6
  v_mfma_f32_16x16x32_bf16 v[68:71], v[16:19], v[36:39], v[68:71]
  v_bitop3_b32 v98, v98, v40, s30 bitop3:0xf6
  v_mfma_f32_16x16x32_bf16 v[72:75], v[16:19], v[40:43], 0
  v_bitop3_b32 v98, v98, v44, s30 bitop3:0xf6
  v_mfma_f32_16x16x32_bf16 v[72:75], v[16:19], v[44:47], v[72:75]
  v_bitop3_b32 v98, v98, v48, s30 bitop3:0xf6
  v_mfma_f32_16x16x32_bf16 v[72:75], v[16:19], v[48:51], v[72:75]
  v_bitop3_b32 v98, v98, v52, s30 bitop3:0xf6
  v_mfma_f32_16x16x32_bf16 v[72:75], v[16:19], v[52:55], v[72:75]
  v_and_b32 v98, 1, v98
  v_cmp_ne_u32 vcc, 0, v98
  s_and_b64 vcc, vcc, s[84:85]
  s_cbranch_vccz okS_63
  s_add_u32 s46, s59, 0
  buffer_load_dwordx4 v[24:27], v10, s[4:7], s46 offen sc1
  s_add_u32 s46, s59, 81920
  buffer_load_dwordx4 v[28:31], v10, s[4:7], s46 offen sc1
  s_add_u32 s46, s59, 163840
  buffer_load_dwordx4 v[32:35], v10, s[4:7], s46 offen sc1
  s_add_u32 s46, s59, 245760
  buffer_load_dwordx4 v[36:39], v10, s[4:7], s46 offen sc1
  s_add_u32 s46, s59, 5120
  buffer_load_dwordx4 v[40:43], v10, s[4:7], s46 offen sc1
  s_add_u32 s46, s59, 87040
  buffer_load_dwordx4 v[44:47], v10, s[4:7], s46 offen sc1
  s_add_u32 s46, s59, 168960
  buffer_load_dwordx4 v[48:51], v10, s[4:7], s46 offen sc1
  s_add_u32 s46, s59, 250880
  buffer_load_dwordx4 v[52:55], v10, s[4:7], s46 offen sc1
  s_add_u32 s45, s45, 1
  s_cmp_gt_u32 s45, 1048576
  s_cbranch_scc1 failfS_58
  s_waitcnt vmcnt(0)
  s_branch bS_62
okS_63:
  v_lshlrev_b32 v76, 16, v20
  v_and_b32 v77, 0xffff0000, v20
  v_lshlrev_b32 v78, 16, v21
  v_and_b32 v79, 0xffff0000, v21
  v_lshlrev_b32 v80, 16, v22
  v_and_b32 v81, 0xffff0000, v22
  v_lshlrev_b32 v82, 16, v23
  v_and_b32 v83, 0xffff0000, v23
  v_cvt_pk_bf16_f32 v92, v68, v69
  v_cvt_pk_bf16_f32 v93, v70, v71
  v_cvt_pk_bf16_f32 v94, v72, v73
  v_cvt_pk_bf16_f32 v95, v74, v75
  v_lshlrev_b32 v68, 16, v92
  v_and_b32 v69, 0xffff0000, v92
  v_lshlrev_b32 v70, 16, v93
  v_and_b32 v71, 0xffff0000, v93
  v_lshlrev_b32 v72, 16, v94
  v_and_b32 v73, 0xffff0000, v94
  v_lshlrev_b32 v74, 16, v95
  v_and_b32 v75, 0xffff0000, v95
  v_pk_add_f32 v[76:77], v[76:77], v[68:69]
  v_pk_add_f32 v[78:79], v[78:79], v[70:71]
  v_pk_add_f32 v[80:81], v[80:81], v[72:73]
  v_pk_add_f32 v[82:83], v[82:83], v[74:75]
  v_cvt_pk_bf16_f32 v120, v76, v77
  v_cvt_pk_bf16_f32 v121, v78, v79
  v_cvt_pk_bf16_f32 v124, v80, v81
  v_cvt_pk_bf16_f32 v125, v82, v83
  v_lshlrev_b32 v76, 16, v120
  v_and_b32 v77, 0xffff0000, v120
  v_lshlrev_b32 v78, 16, v121
  v_and_b32 v79, 0xffff0000, v121
  v_lshlrev_b32 v80, 16, v124
  v_and_b32 v81, 0xffff0000, v124
  v_lshlrev_b32 v82, 16, v125
  v_and_b32 v83, 0xffff0000, v125
  v_add_f32 v96, v76, v77
  v_mul_f32 v97, v76, v76
  v_fmac_f32 v97, v77, v77
  v_add_f32 v96, v96, v78
  v_fmac_f32 v97, v78, v78
  v_add_f32 v96, v96, v79
  v_fmac_f32 v97, v79, v79
  v_add_f32 v96, v96, v80
  v_fmac_f32 v97, v80, v80
  v_add_f32 v96, v96, v81
  v_fmac_f32 v97, v81, v81
  v_add_f32 v96, v96, v82
  v_fmac_f32 v97, v82, v82
  v_add_f32 v96, v96, v83
  v_fmac_f32 v97, v83, v83
  s_nop 0
  v_add_f32_dpp v96, v96, v96 quad_perm:[1,0,3,2] row_mask:0xf bank_mask:0xf
  v_add_f32_dpp v97, v97, v97 quad_perm:[1,0,3,2] row_mask:0xf bank_mask:0xf
  s_nop 0
  v_add_f32_dpp v96, v96, v96 quad_perm:[2,3,0,1] row_mask:0xf bank_mask:0xf
  v_add_f32_dpp v97, v97, v97 quad_perm:[2,3,0,1] row_mask:0xf bank_mask:0xf
  s_nop 0
  v_add_f32_dpp v96, v96, v96 row_half_mirror row_mask:0xf bank_mask:0xf
  v_add_f32_dpp v97, v97, v97 row_half_mirror row_mask:0xf bank_mask:0xf
  s_nop 0
  v_add_f32_dpp v96, v96, v96 row_mirror row_mask:0xf bank_mask:0xf
  v_add_f32_dpp v97, v97, v97 row_mirror row_mask:0xf bank_mask:0xf
  v_mov_b32 v68, v96
  v_mov_b32 v69, v97
  s_nop 0
  v_permlane16_swap_b32 v96, v68
  v_permlane16_swap_b32 v97, v69
  v_pk_add_f32 v[96:97], v[96:97], v[68:69]
  ds_write_b64 v12, v[96:97]
  s_cmp_eq_u32 s31, 1
  s_cbranch_scc1 haveS_60
fwS_64:
  buffer_load_dword v149, v142, s[4:7], s72 offen sc1
  s_waitcnt vmcnt(0)
fcS_66:
  v_cmp_eq_u32 vcc, 0, v149
  s_cbranch_vccz foS_65
  s_add_u32 s45, s45, 1
  s_cmp_gt_u32 s45, 1048576
  s_cbranch_scc1 failfS_58
  s_sleep 1
  s_branch fwS_64
foS_65:
  s_mov_b32 m0, s80
  s_nop 0
  buffer_load_dwordx4 v2, s[4:7], s73 offen offset:0 sc1 lds
  s_add_u32 m0, m0, 896
  s_nop 0
  buffer_load_dwordx4 v2, s[4:7], s73 offen offset:128 sc1 lds
  s_add_u32 m0, m0, 896
  s_nop 0
  buffer_load_dwordx4 v2, s[4:7], s73 offen offset:256 sc1 lds
  s_add_u32 m0, m0, 896
  s_nop 0
  buffer_load_dwordx4 v2, s[4:7], s73 offen offset:384 sc1 lds
  s_add_u32 m0, m0, 896
  s_nop 0
  buffer_load_dwordx4 v2, s[4:7], s73 offen offset:512 sc1 lds
  s_add_u32 m0, m0, 896
  s_nop 0
  buffer_load_dwordx4 v2, s[4:7], s73 offen offset:640 sc1 lds
  s_add_u32 m0, m0, 896
  s_nop 0
  buffer_load_dwordx4 v2, s[4:7], s73 offen offset:768 sc1 lds
  s_add_u32 m0, m0, 896
  s_nop 0
  buffer_load_dwordx4 v2, s[4:7], s73 offen offset:896 sc1 lds
  s_add_u32 m0, m0, 896
  s_nop 0
  buffer_load_dwordx4 v2, s[4:7], s73 offen offset:1024 sc1 lds
  s_add_u32 m0, m0, 896
  s_nop 0
  buffer_load_dwordx4 v2, s[4:7], s73 offen offset:1152 sc1 lds
haveS_60:
  s_waitcnt vmcnt(0) lgkmcnt(0)
  s_barrier
  ds_read_b128 v[68:71], v13
  ds_read_b128 v[72:75], v13 offset:16
  ds_read_b128 v[24:27], v4 offset:0
  ds_read_b128 v[28:31], v5 offset:0
  ds_read_b128 v[32:35], v4 offset:1024
  ds_read_b128 v[36:39], v5 offset:1024
  ds_read_b128 v[40:43], v4 offset:2048
  ds_read_b128 v[44:47], v5 offset:2048
  ds_read_b128 v[48:51], v4 offset:3072
  s_waitcnt lgkmcnt(6)
  v_mfma_f32_16x16x32_bf16 v[56:59], a[0:3], v[24:27], 0
  ds_read_b128 v[52:55], v5 offset:3072
  v_add_f32 v68, v68, v70
  v_mfma_f32_16x16x32_bf16 v[60:63], a[80:83], v[24:27], 0
  v_add_f32 v69, v69, v71
  v_add_f32 v72, v72, v74
  v_mfma_f32_16x16x32_bf16 v[64:67], a[160:163], v[24:27], 0
  v_add_f32 v73, v73, v75
  v_add_f32 v96, v68, v72
  s_waitcnt lgkmcnt(6)
  v_mfma_f32_16x16x32_bf16 v[56:59], a[4:7], v[28:31], v[56:59]
  ds_read_b128 v[24:27], v4 offset:4096
  v_add_f32 v97, v69, v73
  v_mfma_f32_16x16x32_bf16 v[60:63], a[84:87], v[28:31], v[60:63]
  v_mul_f32 v96, 0x3acccccd, v96
  v_mul_f32 v97, 0x3acccccd, v97
  v_mfma_f32_16x16x32_bf16 v[64:67], a[164:167], v[28:31], v[64:67]
  v_fma_f32 v97, -v96, v96, v97
  v_max_f32 v97, 0, v97
  s_waitcnt lgkmcnt(6)
  v_mfma_f32_16x16x32_bf16 v[56:59], a[8:11], v[32:35], v[56:59]
  ds_read_b128 v[28:31], v5 offset:4096
  v_cvt_pk_bf16_f32 v96, v96, v96
  v_mfma_f32_16x16x32_bf16 v[60:63], a[88:91], v[32:35], v[60:63]
  v_and_b32 v96, 0xffff0000, v96
  v_cvt_pk_bf16_f32 v97, v97, v97
  v_mfma_f32_16x16x32_bf16 v[64:67], a[168:171], v[32:35], v[64:67]
  v_and_b32 v97, 0xffff0000, v97
  v_add_f32 v97, 0x3727c5ac, v97
  s_waitcnt lgkmcnt(6)
  v_mfma_f32_16x16x32_bf16 v[56:59], a[12:15], v[36:39], v[56:59]
  ds_read_b128 v[32:35], v4 offset:5120
  v_cvt_pk_bf16_f32 v97, v97, v97
  v_mfma_f32_16x16x32_bf16 v[60:63], a[92:95], v[36:39], v[60:63]
  v_and_b32 v97, 0xffff0000, v97
  v_sub_f32 v76, v76, v96
  v_mfma_f32_16x16x32_bf16 v[64:67], a[172:175], v[36:39], v[64:67]
  v_sub_f32 v77, v77, v96
  v_sub_f32 v78, v78, v96
  s_waitcnt lgkmcnt(6)
  v_mfma_f32_16x16x32_bf16 v[56:59], a[16:19], v[40:43], v[56:59]
  ds_read_b128 v[36:39], v5 offset:5120
  v_sub_f32 v79, v79, v96
  v_mfma_f32_16x16x32_bf16 v[60:63], a[96:99], v[40:43], v[60:63]
  v_sub_f32 v80, v80, v96
  v_sub_f32 v81, v81, v96
  v_mfma_f32_16x16x32_bf16 v[64:67], a[176:179], v[40:43], v[64:67]
  v_sub_f32 v82, v82, v96
  v_sub_f32 v83, v83, v96
  s_waitcnt lgkmcnt(6)
  v_mfma_f32_16x16x32_bf16 v[56:59], a[20:23], v[44:47], v[56:59]
  ds_read_b128 v[40:43], v4 offset:6144
  v_sqrt_f32 v97, v97
  v_mfma_f32_16x16x32_bf16 v[60:63], a[100:103], v[44:47], v[60:63]
  v_cvt_pk_bf16_f32 v92, v76, v77
  v_cvt_pk_bf16_f32 v93, v78, v79
  v_mfma_f32_16x16x32_bf16 v[64:67], a[180:183], v[44:47], v[64:67]
  v_cvt_pk_bf16_f32 v94, v80, v81
  v_cvt_pk_bf16_f32 v95, v82, v83
  s_waitcnt lgkmcnt(6)
  v_mfma_f32_16x16x32_bf16 v[56:59], a[24:27], v[48:51], v[56:59]
  ds_read_b128 v[44:47], v5 offset:6144
  v_cvt_pk_bf16_f32 v97, v97, v97
  v_mfma_f32_16x16x32_bf16 v[60:63], a[104:107], v[48:51], v[60:63]
  v_and_b32 v97, 0xffff0000, v97
  v_rcp_f32 v97, v97
  v_mfma_f32_16x16x32_bf16 v[64:67], a[184:187], v[48:51], v[64:67]
  v_lshlrev_b32 v76, 16, v92
  v_and_b32 v77, 0xffff0000, v92
  s_waitcnt lgkmcnt(6)
  v_mfma_f32_16x16x32_bf16 v[56:59], a[28:31], v[52:55], v[56:59]
  ds_read_b128 v[48:51], v4 offset:7168
  v_lshlrev_b32 v78, 16, v93
  v_mfma_f32_16x16x32_bf16 v[60:63], a[108:111], v[52:55], v[60:63]
  v_and_b32 v79, 0xffff0000, v93
  v_lshlrev_b32 v80, 16, v94
  v_mfma_f32_16x16x32_bf16 v[64:67], a[188:191], v[52:55], v[64:67]
  v_and_b32 v81, 0xffff0000, v94
  v_lshlrev_b32 v82, 16, v95
  s_waitcnt lgkmcnt(6)
  v_mfma_f32_16x16x32_bf16 v[56:59], a[32:35], v[24:27], v[56:59]
  ds_read_b128 v[52:55], v5 offset:7168
  v_and_b32 v83, 0xffff0000, v95
  v_mfma_f32_16x16x32_bf16 v[60:63], a[112:115], v[24:27], v[60:63]
  v_mul_f32 v76, v76, v97
  v_mul_f32 v77, v77, v97
  v_mfma_f32_16x16x32_bf16 v[64:67], a[192:195], v[24:27], v[64:67]
  v_mul_f32 v78, v78, v97
  v_mul_f32 v79, v79, v97
  s_waitcnt lgkmcnt(6)
  v_mfma_f32_16x16x32_bf16 v[56:59], a[36:39], v[28:31], v[56:59]
  ds_read_b128 v[24:27], v4 offset:8192
  v_mul_f32 v80, v80, v97
  v_mfma_f32_16x16x32_bf16 v[60:63], a[116:119], v[28:31], v[60:63]
  v_mul_f32 v81, v81, v97
  v_mul_f32 v82, v82, v97
  v_mfma_f32_16x16x32_bf16 v[64:67], a[196:199], v[28:31], v[64:67]
  v_mul_f32 v83, v83, v97
  v_cvt_pk_bf16_f32 v128, v76, v77
  s_waitcnt lgkmcnt(6)
  v_mfma_f32_16x16x32_bf16 v[56:59], a[40:43], v[32:35], v[56:59]
  ds_read_b128 v[28:31], v5 offset:8192
  v_cvt_pk_bf16_f32 v129, v78, v79
  v_mfma_f32_16x16x32_bf16 v[60:63], a[120:123], v[32:35], v[60:63]
  v_cvt_pk_bf16_f32 v132, v80, v81
  v_cvt_pk_bf16_f32 v133, v82, v83
  v_mfma_f32_16x16x32_bf16 v[64:67], a[200:203], v[32:35], v[64:67]
  ds_write_b64 v143, v[128:129] offset:0
  s_waitcnt lgkmcnt(6)
  v_mfma_f32_16x16x32_bf16 v[56:59], a[44:47], v[36:39], v[56:59]
  ds_read_b128 v[32:35], v4 offset:9216
  v_mfma_f32_16x16x32_bf16 v[60:63], a[124:127], v[36:39], v[60:63]
  v_mfma_f32_16x16x32_bf16 v[64:67], a[204:207], v[36:39], v[64:67]
  ds_write_b64 v143, v[132:133] offset:160
  s_waitcnt lgkmcnt(6)
  v_mfma_f32_16x16x32_bf16 v[56:59], a[48:51], v[40:43], v[56:59]
  ds_read_b128 v[36:39], v5 offset:9216
  v_mfma_f32_16x16x32_bf16 v[60:63], a[128:131], v[40:43], v[60:63]
  v_mfma_f32_16x16x32_bf16 v[64:67], a[208:211], v[40:43], v[64:67]
  ds_write_b64 v143, v[120:121] offset:2560
  s_waitcnt lgkmcnt(6)
  v_mfma_f32_16x16x32_bf16 v[56:59], a[52:55], v[44:47], v[56:59]
  v_mfma_f32_16x16x32_bf16 v[60:63], a[132:135], v[44:47], v[60:63]
  v_mfma_f32_16x16x32_bf16 v[64:67], a[212:215], v[44:47], v[64:67]
  ds_write_b64 v143, v[124:125] offset:2720
  s_waitcnt lgkmcnt(5)
  v_mfma_f32_16x16x32_bf16 v[56:59], a[56:59], v[48:51], v[56:59]
  v_mfma_f32_16x16x32_bf16 v[60:63], a[136:139], v[48:51], v[60:63]
  v_mfma_f32_16x16x32_bf16 v[64:67], a[216:219], v[48:51], v[64:67]
  s_waitcnt lgkmcnt(4)
  v_mfma_f32_16x16x32_bf16 v[56:59], a[60:63], v[52:55], v[56:59]
  v_mfma_f32_16x16x32_bf16 v[60:63], a[140:143], v[52:55], v[60:63]
  v_mfma_f32_16x16x32_bf16 v[64:67], a[220:223], v[52:55], v[64:67]
  s_waitcnt lgkmcnt(3)
  v_mfma_f32_16x16x32_bf16 v[56:59], a[64:67], v[24:27], v[56:59]
  v_mfma_f32_16x16x32_bf16 v[60:63], a[144:147], v[24:27], v[60:63]
  v_mfma_f32_16x16x32_bf16 v[64:67], a[224:227], v[24:27], v[64:67]
  s_waitcnt lgkmcnt(2)
  v_mfma_f32_16x16x32_bf16 v[56:59], a[68:71], v[28:31], v[56:59]
  v_mfma_f32_16x16x32_bf16 v[60:63], a[148:151], v[28:31], v[60:63]
  v_mfma_f32_16x16x32_bf16 v[64:67], a[228:231], v[28:31], v[64:67]
  s_waitcnt lgkmcnt(1)
  v_mfma_f32_16x16x32_bf16 v[56:59], a[72:75], v[32:35], v[56:59]
  v_mfma_f32_16x16x32_bf16 v[60:63], a[152:155], v[32:35], v[60:63]
  v_mfma_f32_16x16x32_bf16 v[64:67], a[232:235], v[32:35], v[64:67]
  s_waitcnt lgkmcnt(0)
  v_mfma_f32_16x16x32_bf16 v[56:59], a[76:79], v[36:39], v[56:59]
  v_mfma_f32_16x16x32_bf16 v[60:63], a[156:159], v[36:39], v[60:63]
  v_mfma_f32_16x16x32_bf16 v[64:67], a[236:239], v[36:39], v[64:67]
  s_nop 5
  v_max_f32 v56, 0, v56
  v_max_f32 v57, 0, v57
  v_max_f32 v58, 0, v58
  v_max_f32 v59, 0, v59
  v_max_f32 v60, 0, v60
  v_max_f32 v61, 0, v61
  v_max_f32 v62, 0, v62
  v_max_f32 v63, 0, v63
  v_max_f32 v64, 0, v64
  v_max_f32 v65, 0, v65
  v_max_f32 v66, 0, v66
  v_max_f32 v67, 0, v67
  v_cvt_pk_bf16_f32 v112, v56, v57
  v_cvt_pk_bf16_f32 v113, v58, v59
  v_cvt_pk_bf16_f32 v114, v60, v61
  v_cvt_pk_bf16_f32 v115, v62, v63
  v_cvt_pk_bf16_f32 v116, v64, v65
  v_cvt_pk_bf16_f32 v117, v66, v67
  ds_write_b128 v3, v[112:115]
  ds_write_b64 v6, v[116:117] offset:2048
  v_bfi_b32 v112, 1, s71, v112
  v_bfi_b32 v116, 1, s71, v116
  buffer_store_dwordx4 v[112:115], v9, s[4:7], s28 offen sc1
  buffer_store_dwordx2 v[116:117], v1, s[4:7], s28 offen offset:1024 sc1
  s_waitcnt lgkmcnt(0)
  s_barrier
  s_cmp_eq_u32 s3, 3
  s_cbranch_scc0 w3S_67
  ds_read_b128 v[116:119], v151 offset:0
  ds_read_b128 v[120:123], v151 offset:1024
  ds_read_b128 v[124:127], v151 offset:2048
  ds_read_b128 v[128:131], v151 offset:2560
  ds_read_b128 v[132:135], v151 offset:3584
  ds_read_b128 v[48:51], v151 offset:4608
w3S_67:
  ds_read_b128 v[24:27], v7 offset:0
  ds_read_b128 v[28:31], v7 offset:1024
  ds_read_b128 v[32:35], v7 offset:2048
  ds_read_b128 v[36:39], v7 offset:3072
  ds_read_b128 v[40:43], v7 offset:4096
  ds_read_b128 v[44:47], v7 offset:5120
  s_add_u32 s72, s72, 4096
  s_add_u32 s73, s73, 40960
  s_waitcnt lgkmcnt(3)
  v_mfma_f32_16x16x32_bf16 v[72:75], a[240:243], v[24:27], 0
  v_mfma_f32_16x16x32_bf16 v[76:79], v[160:163], v[24:27], 0
  v_mfma_f32_16x16x32_bf16 v[80:83], v[184:187], v[24:27], 0
  v_mfma_f32_16x16x32_bf16 v[84:87], v[208:211], v[24:27], 0
  v_mfma_f32_16x16x32_bf16 v[88:91], v[232:235], v[24:27], 0
  v_mfma_f32_16x16x32_bf16 v[72:75], a[244:247], v[28:31], v[72:75]
  v_mfma_f32_16x16x32_bf16 v[76:79], v[164:167], v[28:31], v[76:79]
  v_mfma_f32_16x16x32_bf16 v[80:83], v[188:191], v[28:31], v[80:83]
  v_mfma_f32_16x16x32_bf16 v[84:87], v[212:215], v[28:31], v[84:87]
  buffer_load_dwordx4 v[136:139], v9, s[4:7], s29 offen sc1
  v_mfma_f32_16x16x32_bf16 v[88:91], v[236:239], v[28:31], v[88:91]
  buffer_load_dwordx2 v[140:141], v1, s[4:7], s29 offen offset:1024 sc1
  v_mfma_f32_16x16x32_bf16 v[72:75], a[248:251], v[32:35], v[72:75]
  s_cmp_eq_u32 s3, 3
  s_cbranch_scc0 w3S_68
  buffer_store_dwordx4 v[116:119], v9, s[4:7], s83 offen offset:0 sc1
  buffer_store_dwordx4 v[120:123], v9, s[4:7], s83 offen offset:1024 sc1
  buffer_store_dwordx4 v[124:127], v150, s[4:7], s83 offen offset:0 sc1
  buffer_store_dwordx4 v[128:131], v9, s[12:15], s82 offen offset:0 sc1
  buffer_store_dwordx4 v[132:135], v9, s[12:15], s82 offen offset:1024 sc1
  buffer_store_dwordx4 v[48:51], v150, s[12:15], s82 offen offset:0 sc1
w3S_68:
  v_mfma_f32_16x16x32_bf16 v[76:79], v[168:171], v[32:35], v[76:79]
  v_mfma_f32_16x16x32_bf16 v[80:83], v[192:195], v[32:35], v[80:83]
  v_mfma_f32_16x16x32_bf16 v[84:87], v[216:219], v[32:35], v[84:87]
  v_mfma_f32_16x16x32_bf16 v[88:91], v[240:243], v[32:35], v[88:91]
  s_waitcnt lgkmcnt(0)
  v_mfma_f32_16x16x32_bf16 v[92:95], a[240:243], v[36:39], 0
  v_mfma_f32_16x16x32_bf16 v[96:99], v[160:163], v[36:39], 0
  v_mfma_f32_16x16x32_bf16 v[100:103], v[184:187], v[36:39], 0
  v_mfma_f32_16x16x32_bf16 v[104:107], v[208:211], v[36:39], 0
  v_mfma_f32_16x16x32_bf16 v[108:111], v[232:235], v[36:39], 0
  v_mfma_f32_16x16x32_bf16 v[92:95], a[244:247], v[40:43], v[92:95]
  v_mfma_f32_16x16x32_bf16 v[96:99], v[164:167], v[40:43], v[96:99]
  v_mfma_f32_16x16x32_bf16 v[100:103], v[188:191], v[40:43], v[100:103]
  v_mfma_f32_16x16x32_bf16 v[104:107], v[212:215], v[40:43], v[104:107]
  v_mfma_f32_16x16x32_bf16 v[108:111], v[236:239], v[40:43], v[108:111]
  s_waitcnt vmcnt(6)
  s_cmp_eq_u32 s3, 3
  s_cbranch_scc1 w3S_71
  s_waitcnt vmcnt(0)
w3S_71:
bS_69:
  v_bitop3_b32 v14, v136, v140, s71 bitop3:0x7e
  v_and_b32 v14, 1, v14
  v_cmp_ne_u32 vcc, 0, v14
  s_cbranch_vccz okS_70
  buffer_load_dwordx4 v[136:139], v9, s[4:7], s29 offen sc1
  buffer_load_dwordx2 v[140:141], v1, s[4:7], s29 offen offset:1024 sc1
  s_add_u32 s45, s45, 1
  s_cmp_gt_u32 s45, 1048576
  s_cbranch_scc1 failfS_58
  s_waitcnt vmcnt(0)
  s_branch bS_69
okS_70:
  v_mfma_f32_16x16x32_bf16 v[92:95], a[248:251], v[44:47], v[92:95]
  ds_write_b128 v3, v[136:139] offset:6144
  v_mfma_f32_16x16x32_bf16 v[96:99], v[168:171], v[44:47], v[96:99]
  ds_write_b64 v6, v[140:141] offset:8192
  v_mfma_f32_16x16x32_bf16 v[100:103], v[192:195], v[44:47], v[100:103]
  v_mfma_f32_16x16x32_bf16 v[104:107], v[216:219], v[44:47], v[104:107]
  s_waitcnt lgkmcnt(0)
  s_barrier
  v_mfma_f32_16x16x32_bf16 v[108:111], v[240:243], v[44:47], v[108:111]
  ds_read_b128 v[48:51], v7 offset:6144
  ds_read_b128 v[52:55], v7 offset:7168
  ds_read_b128 v[56:59], v7 offset:8192
  ds_read_b128 v[60:63], v7 offset:9216
  ds_read_b128 v[64:67], v7 offset:10240
  ds_read_b128 v[68:71], v7 offset:11264
  s_waitcnt lgkmcnt(3)
  v_mfma_f32_16x16x32_bf16 v[72:75], a[252:255], v[48:51], v[72:75]
  buffer_load_dword v149, v142, s[4:7], s72 offen sc1
  v_mfma_f32_16x16x32_bf16 v[72:75], v[152:155], v[52:55], v[72:75]
  v_mfma_f32_16x16x32_bf16 v[72:75], v[156:159], v[56:59], v[72:75]
  v_mfma_f32_16x16x32_bf16 v[76:79], v[172:175], v[48:51], v[76:79]
  v_mfma_f32_16x16x32_bf16 v[76:79], v[176:179], v[52:55], v[76:79]
  v_mfma_f32_16x16x32_bf16 v[76:79], v[180:183], v[56:59], v[76:79]
  v_mfma_f32_16x16x32_bf16 v[80:83], v[196:199], v[48:51], v[80:83]
  v_mfma_f32_16x16x32_bf16 v[80:83], v[200:203], v[52:55], v[80:83]
  v_mfma_f32_16x16x32_bf16 v[80:83], v[204:207], v[56:59], v[80:83]
  v_mfma_f32_16x16x32_bf16 v[84:87], v[220:223], v[48:51], v[84:87]
  v_mfma_f32_16x16x32_bf16 v[84:87], v[224:227], v[52:55], v[84:87]
  v_cvt_pk_bf16_f32 v112, v72, v73
  v_mfma_f32_16x16x32_bf16 v[84:87], v[228:231], v[56:59], v[84:87]
  v_cvt_pk_bf16_f32 v113, v74, v75
  v_mfma_f32_16x16x32_bf16 v[88:91], v[244:247], v[48:51], v[88:91]
  ds_write_b64 v8, v[112:113] offset:0
  v_mfma_f32_16x16x32_bf16 v[88:91], v[248:251], v[52:55], v[88:91]
  v_cvt_pk_bf16_f32 v114, v76, v77
  s_waitcnt lgkmcnt(0)
  v_mfma_f32_16x16x32_bf16 v[88:91], v[252:255], v[56:59], v[88:91]
  v_cvt_pk_bf16_f32 v115, v78, v79
  v_mfma_f32_16x16x32_bf16 v[92:95], a[252:255], v[60:63], v[92:95]
  ds_write_b64 v8, v[114:115] offset:32
  v_mfma_f32_16x16x32_bf16 v[92:95], v[152:155], v[64:67], v[92:95]
  v_cvt_pk_bf16_f32 v112, v80, v81
  v_mfma_f32_16x16x32_bf16 v[92:95], v[156:159], v[68:71], v[92:95]
  v_cvt_pk_bf16_f32 v113, v82, v83
  v_mfma_f32_16x16x32_bf16 v[96:99], v[172:175], v[60:63], v[96:99]
  ds_write_b64 v8, v[112:113] offset:64
  v_mfma_f32_16x16x32_bf16 v[96:99], v[176:179], v[64:67], v[96:99]
  v_cvt_pk_bf16_f32 v114, v84, v85
  v_mfma_f32_16x16x32_bf16 v[96:99], v[180:183], v[68:71], v[96:99]
  v_cvt_pk_bf16_f32 v115, v86, v87
  v_mfma_f32_16x16x32_bf16 v[100:103], v[196:199], v[60:63], v[100:103]
  ds_write_b64 v8, v[114:115] offset:96
  v_mfma_f32_16x16x32_bf16 v[100:103], v[200:203], v[64:67], v[100:103]
  s_cmp_eq_u32 s3, 3
  s_cbranch_scc0 w3S_72
  v_mov_b32 v14, 1
  s_waitcnt vmcnt(1)
  buffer_store_dword v14, off, s[4:7], s81 sc1
w3S_72:
  v_cvt_pk_bf16_f32 v112, v88, v89
  v_mfma_f32_16x16x32_bf16 v[100:103], v[204:207], v[68:71], v[100:103]
  v_cvt_pk_bf16_f32 v113, v90, v91
  v_mfma_f32_16x16x32_bf16 v[104:107], v[220:223], v[60:63], v[104:107]
  ds_write_b64 v8, v[112:113] offset:128
  v_mfma_f32_16x16x32_bf16 v[104:107], v[224:227], v[64:67], v[104:107]
  ds_read_b128 v[116:119], v144
  v_mfma_f32_16x16x32_bf16 v[104:107], v[228:231], v[68:71], v[104:107]
  ds_read_b128 v[120:123], v145
  v_mfma_f32_16x16x32_bf16 v[108:111], v[244:247], v[60:63], v[108:111]
  v_cvt_pk_bf16_f32 v112, v92, v93
  v_mfma_f32_16x16x32_bf16 v[108:111], v[248:251], v[64:67], v[108:111]
  s_waitcnt lgkmcnt(1)
  v_bfi_b32 v116, 1, s71, v116
  buffer_store_dwordx4 v[116:119], v9, s[4:7], s60 offen offset:0 sc1
  v_mfma_f32_16x16x32_bf16 v[108:111], v[252:255], v[68:71], v[108:111]
  v_cvt_pk_bf16_f32 v113, v94, v95
  s_waitcnt lgkmcnt(0)
  v_bfi_b32 v120, 1, s71, v120
  buffer_store_dwordx4 v[120:123], v9, s[4:7], s60 offen offset:1024 sc1
  ds_write_b64 v8, v[112:113] offset:2816
  v_cvt_pk_bf16_f32 v114, v96, v97
  v_cvt_pk_bf16_f32 v115, v98, v99
  ds_write_b64 v8, v[114:115] offset:2848
  v_cvt_pk_bf16_f32 v112, v100, v101
  v_cvt_pk_bf16_f32 v113, v102, v103
  ds_write_b64 v8, v[112:113] offset:2880
  v_cvt_pk_bf16_f32 v114, v104, v105
  v_cvt_pk_bf16_f32 v115, v106, v107
  ds_write_b64 v8, v[114:115] offset:2912
  v_cvt_pk_bf16_f32 v112, v108, v109
  v_cvt_pk_bf16_f32 v113, v110, v111
  ds_write_b64 v8, v[112:113] offset:2944
  ds_read_b128 v[124:127], v146
  ds_read_b128 v[128:131], v147
  ds_read_b128 v[132:135], v148
  s_waitcnt lgkmcnt(2)
  v_bfi_b32 v124, 1, s71, v124
  buffer_store_dwordx4 v[124:127], v9, s[4:7], s60 offen offset:2048 sc1
  s_waitcnt lgkmcnt(1)
  v_bfi_b32 v128, 1, s71, v128
  buffer_store_dwordx4 v[128:131], v9, s[4:7], s60 offen offset:3072 sc1
  s_waitcnt lgkmcnt(0)
  v_bfi_b32 v132, 1, s71, v132
  buffer_store_dwordx4 v[132:135], v9, s[4:7], s61 offen offset:0 sc1
  s_waitcnt vmcnt(5)
  s_mov_b32 s31, 0
  v_cmp_eq_u32 vcc, 0, v149
  s_cbranch_vccnz neS_73
  s_cmp_eq_u32 s70, 63
  s_cbranch_scc1 neS_73
  s_mov_b32 s31, 1
  s_mov_b32 m0, s80
  s_nop 0
  buffer_load_dwordx4 v2, s[4:7], s73 offen offset:0 sc1 lds
  s_add_u32 m0, m0, 896
  s_nop 0
  buffer_load_dwordx4 v2, s[4:7], s73 offen offset:128 sc1 lds
  s_add_u32 m0, m0, 896
  s_nop 0
  buffer_load_dwordx4 v2, s[4:7], s73 offen offset:256 sc1 lds
  s_add_u32 m0, m0, 896
  s_nop 0
  buffer_load_dwordx4 v2, s[4:7], s73 offen offset:384 sc1 lds
  s_add_u32 m0, m0, 896
  s_nop 0
  buffer_load_dwordx4 v2, s[4:7], s73 offen offset:512 sc1 lds
  s_add_u32 m0, m0, 896
  s_nop 0
  buffer_load_dwordx4 v2, s[4:7], s73 offen offset:640 sc1 lds
  s_add_u32 m0, m0, 896
  s_nop 0
  buffer_load_dwordx4 v2, s[4:7], s73 offen offset:768 sc1 lds
  s_add_u32 m0, m0, 896
  s_nop 0
  buffer_load_dwordx4 v2, s[4:7], s73 offen offset:896 sc1 lds
  s_add_u32 m0, m0, 896
  s_nop 0
  buffer_load_dwordx4 v2, s[4:7], s73 offen offset:1024 sc1 lds
  s_add_u32 m0, m0, 896
  s_nop 0
  buffer_load_dwordx4 v2, s[4:7], s73 offen offset:1152 sc1 lds
neS_73:
  s_mov_b32 s81, s78
  s_add_u32 s78, s78, s89
  s_mov_b32 s30, s71
  s_mov_b32 s59, s79
  s_add_u32 s82, s77, s86
  s_add_u32 s83, s77, s87
  s_add_u32 s77, s77, 40960
  s_mov_b64 s[84:85], s[56:57]
  s_add_u32 s70, s70, 1
  buffer_load_dwordx2 v[20:21], v11, s[4:7], s76 offen offset:0 sc1
  buffer_load_dwordx2 v[22:23], v11, s[4:7], s76 offen offset:160 sc1
  s_add_u32 s76, s76, 40960
  s_sleep 4
  s_add_u32 s46, s59, 0
  buffer_load_dwordx4 v[24:27], v10, s[4:7], s46 offen sc1
  s_add_u32 s46, s59, 81920
  buffer_load_dwordx4 v[28:31], v10, s[4:7], s46 offen sc1
  s_add_u32 s46, s59, 163840
  buffer_load_dwordx4 v[32:35], v10, s[4:7], s46 offen sc1
  s_add_u32 s46, s59, 245760
  buffer_load_dwordx4 v[36:39], v10, s[4:7], s46 offen sc1
  s_add_u32 s46, s59, 5120
  buffer_load_dwordx4 v[40:43], v10, s[4:7], s46 offen sc1
  s_add_u32 s46, s59, 87040
  buffer_load_dwordx4 v[44:47], v10, s[4:7], s46 offen sc1
  s_add_u32 s46, s59, 168960
  buffer_load_dwordx4 v[48:51], v10, s[4:7], s46 offen sc1
  s_add_u32 s46, s59, 250880
  buffer_load_dwordx4 v[52:55], v10, s[4:7], s46 offen sc1
  buffer_load_dword v149, v142, s[4:7], s72 offen sc1
  s_cmp_lt_u32 s70, 64
  s_cbranch_scc1 topS_59
  s_waitcnt vmcnt(0)
  s_add_u32 s46, s59, 0
  buffer_load_dwordx4 v[24:27], v10, s[4:7], s46 offen sc1
  s_add_u32 s46, s59, 81920
  buffer_load_dwordx4 v[28:31], v10, s[4:7], s46 offen sc1
  s_add_u32 s46, s59, 163840
  buffer_load_dwordx4 v[32:35], v10, s[4:7], s46 offen sc1
  s_add_u32 s46, s59, 245760
  buffer_load_dwordx4 v[36:39], v10, s[4:7], s46 offen sc1
  s_add_u32 s46, s59, 5120
  buffer_load_dwordx4 v[40:43], v10, s[4:7], s46 offen sc1
  s_add_u32 s46, s59, 87040
  buffer_load_dwordx4 v[44:47], v10, s[4:7], s46 offen sc1
  s_add_u32 s46, s59, 168960
  buffer_load_dwordx4 v[48:51], v10, s[4:7], s46 offen sc1
  s_add_u32 s46, s59, 250880
  buffer_load_dwordx4 v[52:55], v10, s[4:7], s46 offen sc1
  s_waitcnt vmcnt(0)
bS_74:
  v_mfma_f32_16x16x32_bf16 v[68:71], v[16:19], v[24:27], 0
  v_bitop3_b32 v98, v24, v28, s30 bitop3:0x7e
  v_mfma_f32_16x16x32_bf16 v[68:71], v[16:19], v[28:31], v[68:71]
  v_bitop3_b32 v98, v98, v32, s30 bitop3:0xf6
  v_mfma_f32_16x16x32_bf16 v[68:71], v[16:19], v[32:35], v[68:71]
  v_bitop3_b32 v98, v98, v36, s30 bitop3:0xf6
  v_mfma_f32_16x16x32_bf16 v[68:71], v[16:19], v[36:39], v[68:71]
  v_bitop3_b32 v98, v98, v40, s30 bitop3:0xf6
  v_mfma_f32_16x16x32_bf16 v[72:75], v[16:19], v[40:43], 0
  v_bitop3_b32 v98, v98, v44, s30 bitop3:0xf6
  v_mfma_f32_16x16x32_bf16 v[72:75], v[16:19], v[44:47], v[72:75]
  v_bitop3_b32 v98, v98, v48, s30 bitop3:0xf6
  v_mfma_f32_16x16x32_bf16 v[72:75], v[16:19], v[48:51], v[72:75]
  v_bitop3_b32 v98, v98, v52, s30 bitop3:0xf6
  v_mfma_f32_16x16x32_bf16 v[72:75], v[16:19], v[52:55], v[72:75]
  v_and_b32 v98, 1, v98
  v_cmp_ne_u32 vcc, 0, v98
  s_and_b64 vcc, vcc, s[56:57]
  s_cbranch_vccz okS_75
  s_nop 7
  s_add_u32 s46, s59, 0
  buffer_load_dwordx4 v[24:27], v10, s[4:7], s46 offen sc1
  s_add_u32 s46, s59, 81920
  buffer_load_dwordx4 v[28:31], v10, s[4:7], s46 offen sc1
  s_add_u32 s46, s59, 163840
  buffer_load_dwordx4 v[32:35], v10, s[4:7], s46 offen sc1
  s_add_u32 s46, s59, 245760
  buffer_load_dwordx4 v[36:39], v10, s[4:7], s46 offen sc1
  s_add_u32 s46, s59, 5120
  buffer_load_dwordx4 v[40:43], v10, s[4:7], s46 offen sc1
  s_add_u32 s46, s59, 87040
  buffer_load_dwordx4 v[44:47], v10, s[4:7], s46 offen sc1
  s_add_u32 s46, s59, 168960
  buffer_load_dwordx4 v[48:51], v10, s[4:7], s46 offen sc1
  s_add_u32 s46, s59, 250880
  buffer_load_dwordx4 v[52:55], v10, s[4:7], s46 offen sc1
  s_add_u32 s45, s45, 1
  s_cmp_gt_u32 s45, 1048576
  s_cbranch_scc1 failfS_58
  s_waitcnt vmcnt(0)
  s_branch bS_74
okS_75:
  s_nop 0
  v_lshlrev_b32 v76, 16, v20
  v_and_b32 v77, 0xffff0000, v20
  v_lshlrev_b32 v78, 16, v21
  v_and_b32 v79, 0xffff0000, v21
  v_lshlrev_b32 v80, 16, v22
  v_and_b32 v81, 0xffff0000, v22
  v_lshlrev_b32 v82, 16, v23
  v_and_b32 v83, 0xffff0000, v23
  v_cvt_pk_bf16_f32 v92, v68, v69
  v_cvt_pk_bf16_f32 v93, v70, v71
  v_cvt_pk_bf16_f32 v94, v72, v73
  v_cvt_pk_bf16_f32 v95, v74, v75
  v_lshlrev_b32 v68, 16, v92
  v_and_b32 v69, 0xffff0000, v92
  v_lshlrev_b32 v70, 16, v93
  v_and_b32 v71, 0xffff0000, v93
  v_lshlrev_b32 v72, 16, v94
  v_and_b32 v73, 0xffff0000, v94
  v_lshlrev_b32 v74, 16, v95
  v_and_b32 v75, 0xffff0000, v95
  v_pk_add_f32 v[76:77], v[76:77], v[68:69]
  v_pk_add_f32 v[78:79], v[78:79], v[70:71]
  v_pk_add_f32 v[80:81], v[80:81], v[72:73]
  v_pk_add_f32 v[82:83], v[82:83], v[74:75]
  v_cvt_pk_bf16_f32 v84, v76, v77
  v_cvt_pk_bf16_f32 v85, v78, v79
  v_cvt_pk_bf16_f32 v88, v80, v81
  v_cvt_pk_bf16_f32 v89, v82, v83
  v_lshlrev_b32 v76, 16, v84
  v_and_b32 v77, 0xffff0000, v84
  v_lshlrev_b32 v78, 16, v85
  v_and_b32 v79, 0xffff0000, v85
  v_lshlrev_b32 v80, 16, v88
  v_and_b32 v81, 0xffff0000, v88
  v_lshlrev_b32 v82, 16, v89
  v_and_b32 v83, 0xffff0000, v89
  v_add_f32 v96, v76, v77
  v_mul_f32 v97, v76, v76
  v_fmac_f32 v97, v77, v77
  v_add_f32 v96, v96, v78
  v_fmac_f32 v97, v78, v78
  v_add_f32 v96, v96, v79
  v_fmac_f32 v97, v79, v79
  v_add_f32 v96, v96, v80
  v_fmac_f32 v97, v80, v80
  v_add_f32 v96, v96, v81
  v_fmac_f32 v97, v81, v81
  v_add_f32 v96, v96, v82
  v_fmac_f32 v97, v82, v82
  v_add_f32 v96, v96, v83
  v_fmac_f32 v97, v83, v83
  s_nop 0
  v_add_f32_dpp v96, v96, v96 quad_perm:[1,0,3,2] row_mask:0xf bank_mask:0xf
  v_add_f32_dpp v97, v97, v97 quad_perm:[1,0,3,2] row_mask:0xf bank_mask:0xf
  s_nop 0
  v_add_f32_dpp v96, v96, v96 quad_perm:[2,3,0,1] row_mask:0xf bank_mask:0xf
  v_add_f32_dpp v97, v97, v97 quad_perm:[2,3,0,1] row_mask:0xf bank_mask:0xf
  s_nop 0
  v_add_f32_dpp v96, v96, v96 row_half_mirror row_mask:0xf bank_mask:0xf
  v_add_f32_dpp v97, v97, v97 row_half_mirror row_mask:0xf bank_mask:0xf
  s_nop 0
  v_add_f32_dpp v96, v96, v96 row_mirror row_mask:0xf bank_mask:0xf
  v_add_f32_dpp v97, v97, v97 row_mirror row_mask:0xf bank_mask:0xf
  v_mov_b32 v68, v96
  v_mov_b32 v69, v97
  s_nop 0
  v_permlane16_swap_b32 v96, v68
  v_permlane16_swap_b32 v97, v69
  v_pk_add_f32 v[96:97], v[96:97], v[68:69]
  ds_write_b64 v12, v[96:97]
  s_waitcnt lgkmcnt(0)
  s_barrier
  ds_read_b128 v[68:71], v13
  ds_read_b128 v[72:75], v13 offset:16
  s_waitcnt lgkmcnt(0)
  v_pk_add_f32 v[68:69], v[68:69], v[70:71]
  v_pk_add_f32 v[72:73], v[72:73], v[74:75]
  v_pk_add_f32 v[96:97], v[68:69], v[72:73]
  v_mul_f32 v96, 0x3acccccd, v96
  v_mul_f32 v97, 0x3acccccd, v97
  v_fma_f32 v97, -v96, v96, v97
  v_max_f32 v97, 0, v97
  v_cvt_pk_bf16_f32 v96, v96, v96
  v_and_b32 v96, 0xffff0000, v96
  v_cvt_pk_bf16_f32 v97, v97, v97
  v_and_b32 v97, 0xffff0000, v97
  v_add_f32 v97, 0x3727c5ac, v97
  v_cvt_pk_bf16_f32 v97, v97, v97
  v_and_b32 v97, 0xffff0000, v97
  v_pk_add_f32 v[76:77], v[76:77], v[96:97] op_sel_hi:[1,0] neg_lo:[0,1] neg_hi:[0,1]
  v_pk_add_f32 v[78:79], v[78:79], v[96:97] op_sel_hi:[1,0] neg_lo:[0,1] neg_hi:[0,1]
  v_pk_add_f32 v[80:81], v[80:81], v[96:97] op_sel_hi:[1,0] neg_lo:[0,1] neg_hi:[0,1]
  v_pk_add_f32 v[82:83], v[82:83], v[96:97] op_sel_hi:[1,0] neg_lo:[0,1] neg_hi:[0,1]
  v_sqrt_f32 v97, v97
  v_cvt_pk_bf16_f32 v92, v76, v77
  v_cvt_pk_bf16_f32 v93, v78, v79
  v_cvt_pk_bf16_f32 v94, v80, v81
  v_cvt_pk_bf16_f32 v95, v82, v83
  v_cvt_pk_bf16_f32 v97, v97, v97
  v_and_b32 v97, 0xffff0000, v97
  v_rcp_f32 v97, v97
  v_lshlrev_b32 v76, 16, v92
  v_and_b32 v77, 0xffff0000, v92
  v_lshlrev_b32 v78, 16, v93
  v_and_b32 v79, 0xffff0000, v93
  v_lshlrev_b32 v80, 16, v94
  v_and_b32 v81, 0xffff0000, v94
  v_lshlrev_b32 v82, 16, v95
  v_and_b32 v83, 0xffff0000, v95
  v_pk_mul_f32 v[76:77], v[76:77], v[96:97] op_sel:[0,1] op_sel_hi:[1,1]
  v_pk_mul_f32 v[78:79], v[78:79], v[96:97] op_sel:[0,1] op_sel_hi:[1,1]
  v_pk_mul_f32 v[80:81], v[80:81], v[96:97] op_sel:[0,1] op_sel_hi:[1,1]
  v_pk_mul_f32 v[82:83], v[82:83], v[96:97] op_sel:[0,1] op_sel_hi:[1,1]
  v_cvt_pk_bf16_f32 v100, v76, v77
  v_cvt_pk_bf16_f32 v101, v78, v79
  v_cvt_pk_bf16_f32 v104, v80, v81
  v_cvt_pk_bf16_f32 v105, v82, v83
  v_mov_b32 v102, v100
  v_mov_b32 v103, v101
  v_mov_b32 v106, v104
  v_mov_b32 v107, v105
  v_permlane16_swap_b32 v100, v102
  v_permlane16_swap_b32 v101, v103
  v_permlane16_swap_b32 v104, v106
  v_permlane16_swap_b32 v105, v107
  v_mov_b32 v86, v84
  v_mov_b32 v87, v85
  v_mov_b32 v90, v88
  v_mov_b32 v91, v89
  v_permlane16_swap_b32 v84, v86
  v_permlane16_swap_b32 v85, v87
  v_permlane16_swap_b32 v88, v90
  v_permlane16_swap_b32 v89, v91
  buffer_store_dwordx4 v[100:103], v15, s[4:7], s83 offen offset:0 sc1
  buffer_store_dwordx4 v[104:107], v15, s[4:7], s83 offen offset:160 sc1
  buffer_store_dwordx4 v[84:87], v15, s[12:15], s82 offen offset:0 sc1
  buffer_store_dwordx4 v[88:91], v15, s[12:15], s82 offen offset:160 sc1
  v_mov_b32 v14, 1
  s_waitcnt vmcnt(0)
  s_barrier
  buffer_store_dword v14, off, s[4:7], s81 sc1
  s_endpgm
failfS_58:
  s_mov_b64 exec, 1
  v_mov_b32 v150, 224
  v_mov_b32 v151, 4
  buffer_atomic_or v151, v150, s[8:11], 0 offen sc1
  s_endpgm
  .p2align 6
R_qkvS:
  s_sub_u32 s52, s42, 5
  s_cmp_eq_u32 s52, 1
  s_cselect_b32 s60, s22, s20
  s_cselect_b32 s61, s23, s21
  s_cmp_eq_u32 s52, 2
  s_cselect_b32 s60, s24, s60
  s_cselect_b32 s61, s25, s61
  s_and_b32 s61, s61, 0xffff
  s_mov_b32 s62, 7864320
  s_mov_b32 s63, 0x20000
  v_add_u32 v40, 0, v0
  v_mul_u32_u24 v41, 43691, v40
  v_lshrrev_b32 v41, 20, v41
  v_mul_u32_u24 v42, 24, v41
  v_sub_u32 v40, v40, v42
  v_lshlrev_b32 v40, 4, v40
  v_mul_u32_u24 v41, 12288, v41
  v_add_u32 v16, v40, v41
  v_add_u32 v40, 64, v0
  v_mul_u32_u24 v41, 43691, v40
  v_lshrrev_b32 v41, 20, v41
  v_mul_u32_u24 v42, 24, v41
  v_sub_u32 v40, v40, v42
  v_lshlrev_b32 v40, 4, v40
  v_mul_u32_u24 v41, 12288, v41
  v_add_u32 v17, v40, v41
  v_add_u32 v40, 128, v0
  v_mul_u32_u24 v41, 43691, v40
  v_lshrrev_b32 v41, 20, v41
  v_mul_u32_u24 v42, 24, v41
  v_sub_u32 v40, v40, v42
  v_lshlrev_b32 v40, 4, v40
  v_mul_u32_u24 v41, 12288, v41
  v_add_u32 v18, v40, v41
  s_mul_i32 s46, s3, 98304
  v_add_u32 v16, s46, v16
  v_add_u32 v17, s46, v17
  v_add_u32 v18, s46, v18
  s_mul_i32 s46, s43, 384
  v_add_u32 v16, s46, v16
  v_add_u32 v17, s46, v17
  v_add_u32 v18, s46, v18
  v_lshrrev_b32 v40, 4, v0
  v_mul_u32_u24 v40, 8, v40
  v_bfe_u32 v41, v0, 2, 2
  v_add_u32 v40, v40, v41
  v_mul_u32_u24 v40, 384, v40
  v_and_b32 v41, 3, v0
  v_mul_u32_u24 v41, 8, v41
  v_add_u32 v26, v40, v41
  s_mul_i32 s46, s3, 96
  v_add_u32 v26, s46, v26
  v_add_u32 v27, 0x10000, v26
  v_add_u32 v28, 0x20000, v26
  s_mul_i32 s55, s3, 3072
  s_mov_b32 s46, 0
  s_add_u32 m0, s55, 0
  s_nop 0
  buffer_load_dwordx4 v16, s[60:63], s46 offen lds
  s_mov_b32 s46, 0
  s_add_u32 m0, s55, 1024
  s_nop 0
  buffer_load_dwordx4 v17, s[60:63], s46 offen lds
  s_mov_b32 s46, 0
  s_add_u32 m0, s55, 2048
  s_nop 0
  buffer_load_dwordx4 v18, s[60:63], s46 offen lds
  s_mov_b32 s46, 393216
  s_add_u32 m0, s55, 12288
  s_nop 0
  buffer_load_dwordx4 v16, s[60:63], s46 offen lds
  s_mov_b32 s46, 393216
  s_add_u32 m0, s55, 13312
  s_nop 0
  buffer_load_dwordx4 v17, s[60:63], s46 offen lds
  s_mov_b32 s46, 393216
  s_add_u32 m0, s55, 14336
  s_nop 0
  buffer_load_dwordx4 v18, s[60:63], s46 offen lds
  s_mov_b32 s46, 786432
  s_add_u32 m0, s55, 24576
  s_nop 0
  buffer_load_dwordx4 v16, s[60:63], s46 offen lds
  s_mov_b32 s46, 786432
  s_add_u32 m0, s55, 25600
  s_nop 0
  buffer_load_dwordx4 v17, s[60:63], s46 offen lds
  s_mov_b32 s46, 786432
  s_add_u32 m0, s55, 26624
  s_nop 0
  buffer_load_dwordx4 v18, s[60:63], s46 offen lds
  s_mov_b32 s46, 1179648
  s_add_u32 m0, s55, 36864
  s_nop 0
  buffer_load_dwordx4 v16, s[60:63], s46 offen lds
  s_mov_b32 s46, 1179648
  s_add_u32 m0, s55, 37888
  s_nop 0
  buffer_load_dwordx4 v17, s[60:63], s46 offen lds
  s_mov_b32 s46, 1179648
  s_add_u32 m0, s55, 38912
  s_nop 0
  buffer_load_dwordx4 v18, s[60:63], s46 offen lds
  s_mov_b32 s46, 1572864
  s_add_u32 m0, s55, 49152
  s_nop 0
  buffer_load_dwordx4 v16, s[60:63], s46 offen lds
  s_mov_b32 s46, 1572864
  s_add_u32 m0, s55, 50176
  s_nop 0
  buffer_load_dwordx4 v17, s[60:63], s46 offen lds
  s_mov_b32 s46, 1572864
  s_add_u32 m0, s55, 51200
  s_nop 0
  buffer_load_dwordx4 v18, s[60:63], s46 offen lds
  s_mov_b32 s46, 1966080
  s_add_u32 m0, s55, 61440
  s_nop 0
  buffer_load_dwordx4 v16, s[60:63], s46 offen lds
  s_mov_b32 s46, 1966080
  s_add_u32 m0, s55, 62464
  s_nop 0
  buffer_load_dwordx4 v17, s[60:63], s46 offen lds
  s_mov_b32 s46, 1966080
  s_add_u32 m0, s55, 63488
  s_nop 0
  buffer_load_dwordx4 v18, s[60:63], s46 offen lds
  s_mov_b32 s46, 2359296
  s_add_u32 m0, s55, 73728
  s_nop 0
  buffer_load_dwordx4 v16, s[60:63], s46 offen lds
  s_mov_b32 s46, 2359296
  s_add_u32 m0, s55, 74752
  s_nop 0
  buffer_load_dwordx4 v17, s[60:63], s46 offen lds
  s_mov_b32 s46, 2359296
  s_add_u32 m0, s55, 75776
  s_nop 0
  buffer_load_dwordx4 v18, s[60:63], s46 offen lds
  s_mov_b32 s46, 2752512
  s_add_u32 m0, s55, 86016
  s_nop 0
  buffer_load_dwordx4 v16, s[60:63], s46 offen lds
  s_mov_b32 s46, 2752512
  s_add_u32 m0, s55, 87040
  s_nop 0
  buffer_load_dwordx4 v17, s[60:63], s46 offen lds
  s_mov_b32 s46, 2752512
  s_add_u32 m0, s55, 88064
  s_nop 0
  buffer_load_dwordx4 v18, s[60:63], s46 offen lds
  s_mov_b32 s46, 3145728
  s_add_u32 m0, s55, 98304
  s_nop 0
  buffer_load_dwordx4 v16, s[60:63], s46 offen lds
  s_mov_b32 s46, 3145728
  s_add_u32 m0, s55, 99328
  s_nop 0
  buffer_load_dwordx4 v17, s[60:63], s46 offen lds
  s_mov_b32 s46, 3145728
  s_add_u32 m0, s55, 100352
  s_nop 0
  buffer_load_dwordx4 v18, s[60:63], s46 offen lds
  s_mov_b32 s46, 3538944
  s_add_u32 m0, s55, 110592
  s_nop 0
  buffer_load_dwordx4 v16, s[60:63], s46 offen lds
  s_mov_b32 s46, 3538944
  s_add_u32 m0, s55, 111616
  s_nop 0
  buffer_load_dwordx4 v17, s[60:63], s46 offen lds
  s_mov_b32 s46, 3538944
  s_add_u32 m0, s55, 112640
  s_nop 0
  buffer_load_dwordx4 v18, s[60:63], s46 offen lds
  s_mov_b32 s46, 3932160
  s_add_u32 m0, s55, 122880
  s_nop 0
  buffer_load_dwordx4 v16, s[60:63], s46 offen lds
  s_mov_b32 s46, 3932160
  s_add_u32 m0, s55, 123904
  s_nop 0
  buffer_load_dwordx4 v17, s[60:63], s46 offen lds
  s_mov_b32 s46, 3932160
  s_add_u32 m0, s55, 124928
  s_nop 0
  buffer_load_dwordx4 v18, s[60:63], s46 offen lds
  s_mov_b32 s46, 4325376
  s_add_u32 m0, s55, 135168
  s_nop 0
  buffer_load_dwordx4 v16, s[60:63], s46 offen lds
  s_mov_b32 s46, 4325376
  s_add_u32 m0, s55, 136192
  s_nop 0
  buffer_load_dwordx4 v17, s[60:63], s46 offen lds
  s_mov_b32 s46, 4325376
  s_add_u32 m0, s55, 137216
  s_nop 0
  buffer_load_dwordx4 v18, s[60:63], s46 offen lds
  s_mov_b32 s46, 4718592
  s_add_u32 m0, s55, 147456
  s_nop 0
  buffer_load_dwordx4 v16, s[60:63], s46 offen lds
  s_mov_b32 s46, 4718592
  s_add_u32 m0, s55, 148480
  s_nop 0
  buffer_load_dwordx4 v17, s[60:63], s46 offen lds
  s_mov_b32 s46, 4718592
  s_add_u32 m0, s55, 149504
  s_nop 0
  buffer_load_dwordx4 v18, s[60:63], s46 offen lds
  s_waitcnt vmcnt(36)
  s_barrier
  ds_read_b64_tr_b16 a[0:1], v26 offset:0
  ds_read_b64_tr_b16 a[2:3], v26 offset:1536
  ds_read_b64_tr_b16 a[80:81], v26 offset:32
  ds_read_b64_tr_b16 a[82:83], v26 offset:1568
  ds_read_b64_tr_b16 a[160:161], v26 offset:64
  ds_read_b64_tr_b16 a[162:163], v26 offset:1600
  s_waitcnt lgkmcnt(0)
  s_waitcnt vmcnt(33)
  s_barrier
  s_mov_b32 s46, 5111808
  s_add_u32 m0, s55, 0
  s_nop 0
  buffer_load_dwordx4 v16, s[60:63], s46 offen lds
  s_mov_b32 s46, 5111808
  s_add_u32 m0, s55, 1024
  s_nop 0
  buffer_load_dwordx4 v17, s[60:63], s46 offen lds
  s_mov_b32 s46, 5111808
  s_add_u32 m0, s55, 2048
  s_nop 0
  buffer_load_dwordx4 v18, s[60:63], s46 offen lds
  ds_read_b64_tr_b16 a[4:5], v26 offset:12288
  ds_read_b64_tr_b16 a[6:7], v26 offset:13824
  ds_read_b64_tr_b16 a[84:85], v26 offset:12320
  ds_read_b64_tr_b16 a[86:87], v26 offset:13856
  ds_read_b64_tr_b16 a[164:165], v26 offset:12352
  ds_read_b64_tr_b16 a[166:167], v26 offset:13888
  s_waitcnt lgkmcnt(0)
  s_waitcnt vmcnt(33)
  s_barrier
  s_mov_b32 s46, 5505024
  s_add_u32 m0, s55, 12288
  s_nop 0
  buffer_load_dwordx4 v16, s[60:63], s46 offen lds
  s_mov_b32 s46, 5505024
  s_add_u32 m0, s55, 13312
  s_nop 0
  buffer_load_dwordx4 v17, s[60:63], s46 offen lds
  s_mov_b32 s46, 5505024
  s_add_u32 m0, s55, 14336
  s_nop 0
  buffer_load_dwordx4 v18, s[60:63], s46 offen lds
  ds_read_b64_tr_b16 a[8:9], v26 offset:24576
  ds_read_b64_tr_b16 a[10:11], v26 offset:26112
  ds_read_b64_tr_b16 a[88:89], v26 offset:24608
  ds_read_b64_tr_b16 a[90:91], v26 offset:26144
  ds_read_b64_tr_b16 a[168:169], v26 offset:24640
  ds_read_b64_tr_b16 a[170:171], v26 offset:26176
  s_waitcnt lgkmcnt(0)
  s_waitcnt vmcnt(33)
  s_barrier
  s_mov_b32 s46, 5898240
  s_add_u32 m0, s55, 24576
  s_nop 0
  buffer_load_dwordx4 v16, s[60:63], s46 offen lds
  s_mov_b32 s46, 5898240
  s_add_u32 m0, s55, 25600
  s_nop 0
  buffer_load_dwordx4 v17, s[60:63], s46 offen lds
  s_mov_b32 s46, 5898240
  s_add_u32 m0, s55, 26624
  s_nop 0
  buffer_load_dwordx4 v18, s[60:63], s46 offen lds
  ds_read_b64_tr_b16 a[12:13], v26 offset:36864
  ds_read_b64_tr_b16 a[14:15], v26 offset:38400
  ds_read_b64_tr_b16 a[92:93], v26 offset:36896
  ds_read_b64_tr_b16 a[94:95], v26 offset:38432
  ds_read_b64_tr_b16 a[172:173], v26 offset:36928
  ds_read_b64_tr_b16 a[174:175], v26 offset:38464
  s_waitcnt lgkmcnt(0)
  s_waitcnt vmcnt(33)
  s_barrier
  s_mov_b32 s46, 6291456
  s_add_u32 m0, s55, 36864
  s_nop 0
  buffer_load_dwordx4 v16, s[60:63], s46 offen lds
  s_mov_b32 s46, 6291456
  s_add_u32 m0, s55, 37888
  s_nop 0
  buffer_load_dwordx4 v17, s[60:63], s46 offen lds
  s_mov_b32 s46, 6291456
  s_add_u32 m0, s55, 38912
  s_nop 0
  buffer_load_dwordx4 v18, s[60:63], s46 offen lds
  ds_read_b64_tr_b16 a[16:17], v26 offset:49152
  ds_read_b64_tr_b16 a[18:19], v26 offset:50688
  ds_read_b64_tr_b16 a[96:97], v26 offset:49184
  ds_read_b64_tr_b16 a[98:99], v26 offset:50720
  ds_read_b64_tr_b16 a[176:177], v26 offset:49216
  ds_read_b64_tr_b16 a[178:179], v26 offset:50752
  s_waitcnt lgkmcnt(0)
  s_waitcnt vmcnt(33)
  s_barrier
  s_mov_b32 s46, 6684672
  s_add_u32 m0, s55, 49152
  s_nop 0
  buffer_load_dwordx4 v16, s[60:63], s46 offen lds
  s_mov_b32 s46, 6684672
  s_add_u32 m0, s55, 50176
  s_nop 0
  buffer_load_dwordx4 v17, s[60:63], s46 offen lds
  s_mov_b32 s46, 6684672
  s_add_u32 m0, s55, 51200
  s_nop 0
  buffer_load_dwordx4 v18, s[60:63], s46 offen lds
  ds_read_b64_tr_b16 a[20:21], v26 offset:61440
  ds_read_b64_tr_b16 a[22:23], v26 offset:62976
  ds_read_b64_tr_b16 a[100:101], v26 offset:61472
  ds_read_b64_tr_b16 a[102:103], v26 offset:63008
  ds_read_b64_tr_b16 a[180:181], v26 offset:61504
  ds_read_b64_tr_b16 a[182:183], v26 offset:63040
  s_waitcnt lgkmcnt(0)
  s_waitcnt vmcnt(33)
  s_barrier
  s_mov_b32 s46, 7077888
  s_add_u32 m0, s55, 61440
  s_nop 0
  buffer_load_dwordx4 v16, s[60:63], s46 offen lds
  s_mov_b32 s46, 7077888
  s_add_u32 m0, s55, 62464
  s_nop 0
  buffer_load_dwordx4 v17, s[60:63], s46 offen lds
  s_mov_b32 s46, 7077888
  s_add_u32 m0, s55, 63488
  s_nop 0
  buffer_load_dwordx4 v18, s[60:63], s46 offen lds
  ds_read_b64_tr_b16 a[24:25], v27 offset:8192
  ds_read_b64_tr_b16 a[26:27], v27 offset:9728
  ds_read_b64_tr_b16 a[104:105], v27 offset:8224
  ds_read_b64_tr_b16 a[106:107], v27 offset:9760
  ds_read_b64_tr_b16 a[184:185], v27 offset:8256
  ds_read_b64_tr_b16 a[186:187], v27 offset:9792
  s_waitcnt lgkmcnt(0)
  s_waitcnt vmcnt(33)
  s_barrier
  s_mov_b32 s46, 7471104
  s_add_u32 m0, s55, 73728
  s_nop 0
  buffer_load_dwordx4 v16, s[60:63], s46 offen lds
  s_mov_b32 s46, 7471104
  s_add_u32 m0, s55, 74752
  s_nop 0
  buffer_load_dwordx4 v17, s[60:63], s46 offen lds
  s_mov_b32 s46, 7471104
  s_add_u32 m0, s55, 75776
  s_nop 0
  buffer_load_dwordx4 v18, s[60:63], s46 offen lds
  ds_read_b64_tr_b16 a[28:29], v27 offset:20480
  ds_read_b64_tr_b16 a[30:31], v27 offset:22016
  ds_read_b64_tr_b16 a[108:109], v27 offset:20512
  ds_read_b64_tr_b16 a[110:111], v27 offset:22048
  ds_read_b64_tr_b16 a[188:189], v27 offset:20544
  ds_read_b64_tr_b16 a[190:191], v27 offset:22080
  s_waitcnt lgkmcnt(0)
  s_waitcnt vmcnt(33)
  s_barrier
  ds_read_b64_tr_b16 a[32:33], v27 offset:32768
  ds_read_b64_tr_b16 a[34:35], v27 offset:34304
  ds_read_b64_tr_b16 a[112:113], v27 offset:32800
  ds_read_b64_tr_b16 a[114:115], v27 offset:34336
  ds_read_b64_tr_b16 a[192:193], v27 offset:32832
  ds_read_b64_tr_b16 a[194:195], v27 offset:34368
  s_waitcnt lgkmcnt(0)
  s_waitcnt vmcnt(30)
  s_barrier
  ds_read_b64_tr_b16 a[36:37], v27 offset:45056
  ds_read_b64_tr_b16 a[38:39], v27 offset:46592
  ds_read_b64_tr_b16 a[116:117], v27 offset:45088
  ds_read_b64_tr_b16 a[118:119], v27 offset:46624
  ds_read_b64_tr_b16 a[196:197], v27 offset:45120
  ds_read_b64_tr_b16 a[198:199], v27 offset:46656
  s_waitcnt lgkmcnt(0)
  s_waitcnt vmcnt(27)
  s_barrier
  ds_read_b64_tr_b16 a[40:41], v27 offset:57344
  ds_read_b64_tr_b16 a[42:43], v27 offset:58880
  ds_read_b64_tr_b16 a[120:121], v27 offset:57376
  ds_read_b64_tr_b16 a[122:123], v27 offset:58912
  ds_read_b64_tr_b16 a[200:201], v27 offset:57408
  ds_read_b64_tr_b16 a[202:203], v27 offset:58944
  s_waitcnt lgkmcnt(0)
  s_waitcnt vmcnt(24)
  s_barrier
  ds_read_b64_tr_b16 a[44:45], v28 offset:4096
  ds_read_b64_tr_b16 a[46:47], v28 offset:5632
  ds_read_b64_tr_b16 a[124:125], v28 offset:4128
  ds_read_b64_tr_b16 a[126:127], v28 offset:5664
  ds_read_b64_tr_b16 a[204:205], v28 offset:4160
  ds_read_b64_tr_b16 a[206:207], v28 offset:5696
  s_waitcnt lgkmcnt(0)
  s_waitcnt vmcnt(21)
  s_barrier
  ds_read_b64_tr_b16 a[48:49], v28 offset:16384
  ds_read_b64_tr_b16 a[50:51], v28 offset:17920
  ds_read_b64_tr_b16 a[128:129], v28 offset:16416
  ds_read_b64_tr_b16 a[130:131], v28 offset:17952
  ds_read_b64_tr_b16 a[208:209], v28 offset:16448
  ds_read_b64_tr_b16 a[210:211], v28 offset:17984
  s_waitcnt lgkmcnt(0)
  s_waitcnt vmcnt(18)
  s_barrier
  ds_read_b64_tr_b16 a[52:53], v26 offset:0
  ds_read_b64_tr_b16 a[54:55], v26 offset:1536
  ds_read_b64_tr_b16 a[132:133], v26 offset:32
  ds_read_b64_tr_b16 a[134:135], v26 offset:1568
  ds_read_b64_tr_b16 a[212:213], v26 offset:64
  ds_read_b64_tr_b16 a[214:215], v26 offset:1600
  s_waitcnt lgkmcnt(0)
  s_waitcnt vmcnt(15)
  s_barrier
  ds_read_b64_tr_b16 a[56:57], v26 offset:12288
  ds_read_b64_tr_b16 a[58:59], v26 offset:13824
  ds_read_b64_tr_b16 a[136:137], v26 offset:12320
  ds_read_b64_tr_b16 a[138:139], v26 offset:13856
  ds_read_b64_tr_b16 a[216:217], v26 offset:12352
  ds_read_b64_tr_b16 a[218:219], v26 offset:13888
  s_waitcnt lgkmcnt(0)
  s_waitcnt vmcnt(12)
  s_barrier
  ds_read_b64_tr_b16 a[60:61], v26 offset:24576
  ds_read_b64_tr_b16 a[62:63], v26 offset:26112
  ds_read_b64_tr_b16 a[140:141], v26 offset:24608
  ds_read_b64_tr_b16 a[142:143], v26 offset:26144
  ds_read_b64_tr_b16 a[220:221], v26 offset:24640
  ds_read_b64_tr_b16 a[222:223], v26 offset:26176
  s_waitcnt lgkmcnt(0)
  s_waitcnt vmcnt(9)
  s_barrier
  ds_read_b64_tr_b16 a[64:65], v26 offset:36864
  ds_read_b64_tr_b16 a[66:67], v26 offset:38400
  ds_read_b64_tr_b16 a[144:145], v26 offset:36896
  ds_read_b64_tr_b16 a[146:147], v26 offset:38432
  ds_read_b64_tr_b16 a[224:225], v26 offset:36928
  ds_read_b64_tr_b16 a[226:227], v26 offset:38464
  s_waitcnt lgkmcnt(0)
  s_waitcnt vmcnt(6)
  s_barrier
  ds_read_b64_tr_b16 a[68:69], v26 offset:49152
  ds_read_b64_tr_b16 a[70:71], v26 offset:50688
  ds_read_b64_tr_b16 a[148:149], v26 offset:49184
  ds_read_b64_tr_b16 a[150:151], v26 offset:50720
  ds_read_b64_tr_b16 a[228:229], v26 offset:49216
  ds_read_b64_tr_b16 a[230:231], v26 offset:50752
  s_waitcnt lgkmcnt(0)
  s_waitcnt vmcnt(3)
  s_barrier
  ds_read_b64_tr_b16 a[72:73], v26 offset:61440
  ds_read_b64_tr_b16 a[74:75], v26 offset:62976
  ds_read_b64_tr_b16 a[152:153], v26 offset:61472
  ds_read_b64_tr_b16 a[154:155], v26 offset:63008
  ds_read_b64_tr_b16 a[232:233], v26 offset:61504
  ds_read_b64_tr_b16 a[234:235], v26 offset:63040
  s_waitcnt lgkmcnt(0)
  s_waitcnt vmcnt(0)
  s_barrier
  ds_read_b64_tr_b16 a[76:77], v27 offset:8192
  ds_read_b64_tr_b16 a[78:79], v27 offset:9728
  ds_read_b64_tr_b16 a[156:157], v27 offset:8224
  ds_read_b64_tr_b16 a[158:159], v27 offset:9760
  ds_read_b64_tr_b16 a[236:237], v27 offset:8256
  ds_read_b64_tr_b16 a[238:239], v27 offset:9792
  s_waitcnt lgkmcnt(0)
  s_barrier
  v_lshlrev_b32 v1, 4, v0
  v_and_b32 v2, 15, v0
  v_lshlrev_b32 v2, 5, v2
  v_lshrrev_b32 v40, 3, v0
  s_lshl_b32 s46, s3, 3
  v_add_u32 v40, s46, v40
  v_bfe_u32 v41, v40, 1, 3
  v_and_b32 v42, 7, v0
  v_xor_b32 v41, v41, v42
  v_lshlrev_b32 v41, 4, v41
  v_mul_u32_u24 v40, 1280, v40
  v_add_u32 v3, v40, v41
  v_bfe_u32 v40, v0, 3, 1
  v_mul_u32_u24 v40, 10240, v40
  v_and_b32 v41, 7, v0
  v_lshlrev_b32 v41, 7, v41
  v_add_u32 v40, v40, v41
  v_bfe_u32 v41, v0, 1, 3
  v_lshrrev_b32 v42, 4, v0
  v_xor_b32 v41, v41, v42
  v_lshlrev_b32 v41, 4, v41
  v_add_u32 v4, v40, v41
  v_xor_b32 v5, 64, v4
  s_mul_i32 s70, s52, 50331648
  s_mul_i32 s46, s43, 12288
  s_add_u32 s70, s70, s46
  s_mul_i32 s46, s3, 3072
  s_add_u32 s70, s70, s46
  s_add_u32 s70, s70, 69206016
  s_lshl_b32 s71, s43, 9
  s_lshl_b32 s46, s52, 7
  s_add_u32 s71, s71, s46
  s_lshl_b32 s46, s3, 5
  s_add_u32 s71, s71, s46
  s_add_u32 s71, s71, 1441792
  s_mul_i32 s72, s3, 10240
  v_lshlrev_b32 v16, 9, v0
  s_mov_b32 s73, 0
fwS_77:
  buffer_load_dword v8, v16, s[4:7], s73 offen sc1
  s_waitcnt vmcnt(0)
fcS_79:
  v_cmp_eq_u32 vcc, 0, v8
  s_cbranch_vccz foS_78
  s_add_u32 s45, s45, 1
  s_cmp_gt_u32 s45, 1048576
  s_cbranch_scc1 failqS_76
  s_sleep 2
  s_branch fwS_77
foS_78:
  s_mov_b32 s73, 32768
fwS_80:
  buffer_load_dword v8, v16, s[4:7], s73 offen sc1
  s_waitcnt vmcnt(0)
fcS_82:
  v_cmp_eq_u32 vcc, 0, v8
  s_cbranch_vccz foS_81
  s_add_u32 s45, s45, 1
  s_cmp_gt_u32 s45, 1048576
  s_cbranch_scc1 failqS_76
  s_sleep 2
  s_branch fwS_80
foS_81:
  s_mov_b32 s73, 65536
fwS_83:
  buffer_load_dword v8, v16, s[4:7], s73 offen sc1
  s_waitcnt vmcnt(0)
fcS_85:
  v_cmp_eq_u32 vcc, 0, v8
  s_cbranch_vccz foS_84
  s_add_u32 s45, s45, 1
  s_cmp_gt_u32 s45, 1048576
  s_cbranch_scc1 failqS_76
  s_sleep 2
  s_branch fwS_83
foS_84:
  s_mov_b32 s73, 98304
fwS_86:
  buffer_load_dword v8, v16, s[4:7], s73 offen sc1
  s_waitcnt vmcnt(0)
fcS_88:
  v_cmp_eq_u32 vcc, 0, v8
  s_cbranch_vccz foS_87
  s_add_u32 s45, s45, 1
  s_cmp_gt_u32 s45, 1048576
  s_cbranch_scc1 failqS_76
  s_sleep 2
  s_branch fwS_86
foS_87:
  s_mov_b32 s64, 1
  s_mov_b32 s65, 0
  s_mov_b32 s66, 0
  s_mov_b32 s68, 0
  s_mov_b32 s75, 0x10000000
  s_mov_b32 s69, 0
  s_mul_i32 s73, s66, 40960
  s_add_u32 s73, s73, 18874368
  s_add_u32 s74, s68, s72
  s_mov_b32 m0, s74
  s_nop 0
  buffer_load_dwordx4 v3, s[4:7], s73 offen offset:0 sc1 lds
  s_add_u32 m0, m0, 896
  s_nop 0
  buffer_load_dwordx4 v3, s[4:7], s73 offen offset:128 sc1 lds
  s_add_u32 m0, m0, 896
  s_nop 0
  buffer_load_dwordx4 v3, s[4:7], s73 offen offset:256 sc1 lds
  s_add_u32 m0, m0, 896
  s_nop 0
  buffer_load_dwordx4 v3, s[4:7], s73 offen offset:384 sc1 lds
  s_add_u32 m0, m0, 896
  s_nop 0
  buffer_load_dwordx4 v3, s[4:7], s73 offen offset:512 sc1 lds
  s_add_u32 m0, m0, 896
  s_nop 0
  buffer_load_dwordx4 v3, s[4:7], s73 offen offset:640 sc1 lds
  s_add_u32 m0, m0, 896
  s_nop 0
  buffer_load_dwordx4 v3, s[4:7], s73 offen offset:768 sc1 lds
  s_add_u32 m0, m0, 896
  s_nop 0
  buffer_load_dwordx4 v3, s[4:7], s73 offen offset:896 sc1 lds
  s_add_u32 m0, m0, 896
  s_nop 0
  buffer_load_dwordx4 v3, s[4:7], s73 offen offset:1024 sc1 lds
  s_add_u32 m0, m0, 896
  s_nop 0
  buffer_load_dwordx4 v3, s[4:7], s73 offen offset:1152 sc1 lds
  s_cmp_eq_u32 s52, 2
  s_cbranch_scc1 isvS_89
topS_90:
  s_waitcnt vmcnt(0)
top3S_91:
  s_waitcnt vmcnt(3)
  s_barrier
  v_add_u32 v6, s68, v4
  v_add_u32 v7, s68, v5
  ds_read_b128 v[16:19], v6 offset:0
  ds_read_b128 v[20:23], v6 offset:20480
  ds_read_b128 v[24:27], v7 offset:0
  ds_read_b128 v[28:31], v7 offset:20480
  ds_read_b128 v[32:35], v6 offset:1024
  ds_read_b128 v[36:39], v6 offset:21504
  s_add_u32 s46, s65, 10
  s_min_u32 s46, s46, 64
  s_cmp_lt_u32 s64, s46
  s_cbranch_scc0 n2S_92
  s_mov_b32 s67, s64
  s_add_u32 s64, s64, 1
  s_mov_b32 s69, 1
  s_sub_u32 s47, 40960, s68
  s_mul_i32 s73, s67, 40960
  s_add_u32 s73, s73, 18874368
  s_add_u32 s74, s47, s72
  s_branch cmpS_93
n2S_92:
  s_add_u32 s67, s65, 64
  s_add_u32 s65, s65, 1
  s_mov_b32 s69, 0
cmpS_93:
  s_waitcnt lgkmcnt(4)
  v_mfma_f32_16x16x32_bf16 v[48:51], a[0:3], v[16:19], 0
  ds_read_b128 v[40:43], v7 offset:1024
  v_mfma_f32_16x16x32_bf16 v[52:55], a[80:83], v[16:19], 0
  v_mov_b32 v8, 1
  v_mfma_f32_16x16x32_bf16 v[56:59], a[160:163], v[16:19], 0
  v_mfma_f32_16x16x32_bf16 v[60:63], a[0:3], v[20:23], 0
  ds_read_b128 v[44:47], v7 offset:21504
  v_mfma_f32_16x16x32_bf16 v[64:67], a[80:83], v[20:23], 0
  v_mfma_f32_16x16x32_bf16 v[68:71], a[160:163], v[20:23], 0
  s_waitcnt lgkmcnt(4)
  v_mfma_f32_16x16x32_bf16 v[48:51], a[4:7], v[24:27], v[48:51]
  ds_read_b128 v[16:19], v6 offset:2048
  v_mfma_f32_16x16x32_bf16 v[52:55], a[84:87], v[24:27], v[52:55]
  v_mfma_f32_16x16x32_bf16 v[56:59], a[164:167], v[24:27], v[56:59]
  v_mfma_f32_16x16x32_bf16 v[60:63], a[4:7], v[28:31], v[60:63]
  ds_read_b128 v[20:23], v6 offset:22528
  v_mfma_f32_16x16x32_bf16 v[64:67], a[84:87], v[28:31], v[64:67]
  v_mfma_f32_16x16x32_bf16 v[68:71], a[164:167], v[28:31], v[68:71]
  s_waitcnt lgkmcnt(4)
  v_mfma_f32_16x16x32_bf16 v[48:51], a[8:11], v[32:35], v[48:51]
  ds_read_b128 v[24:27], v7 offset:2048
  v_mfma_f32_16x16x32_bf16 v[52:55], a[88:91], v[32:35], v[52:55]
  v_mfma_f32_16x16x32_bf16 v[56:59], a[168:171], v[32:35], v[56:59]
  v_mfma_f32_16x16x32_bf16 v[60:63], a[8:11], v[36:39], v[60:63]
  ds_read_b128 v[28:31], v7 offset:22528
  v_mfma_f32_16x16x32_bf16 v[64:67], a[88:91], v[36:39], v[64:67]
  v_mfma_f32_16x16x32_bf16 v[68:71], a[168:171], v[36:39], v[68:71]
  s_waitcnt lgkmcnt(4)
  v_mfma_f32_16x16x32_bf16 v[48:51], a[12:15], v[40:43], v[48:51]
  ds_read_b128 v[32:35], v6 offset:3072
  v_mfma_f32_16x16x32_bf16 v[52:55], a[92:95], v[40:43], v[52:55]
  v_mfma_f32_16x16x32_bf16 v[56:59], a[172:175], v[40:43], v[56:59]
  v_mfma_f32_16x16x32_bf16 v[60:63], a[12:15], v[44:47], v[60:63]
  ds_read_b128 v[36:39], v6 offset:23552
  v_mfma_f32_16x16x32_bf16 v[64:67], a[92:95], v[44:47], v[64:67]
  v_mfma_f32_16x16x32_bf16 v[68:71], a[172:175], v[44:47], v[68:71]
  s_waitcnt lgkmcnt(4)
  v_mfma_f32_16x16x32_bf16 v[48:51], a[16:19], v[16:19], v[48:51]
  ds_read_b128 v[40:43], v7 offset:3072
  v_mfma_f32_16x16x32_bf16 v[52:55], a[96:99], v[16:19], v[52:55]
  v_mfma_f32_16x16x32_bf16 v[56:59], a[176:179], v[16:19], v[56:59]
  v_mfma_f32_16x16x32_bf16 v[60:63], a[16:19], v[20:23], v[60:63]
  ds_read_b128 v[44:47], v7 offset:23552
  v_mfma_f32_16x16x32_bf16 v[64:67], a[96:99], v[20:23], v[64:67]
  v_mfma_f32_16x16x32_bf16 v[68:71], a[176:179], v[20:23], v[68:71]
  s_waitcnt lgkmcnt(4)
  v_mfma_f32_16x16x32_bf16 v[48:51], a[20:23], v[24:27], v[48:51]
  ds_read_b128 v[16:19], v6 offset:4096
  v_mfma_f32_16x16x32_bf16 v[52:55], a[100:103], v[24:27], v[52:55]
  v_mfma_f32_16x16x32_bf16 v[56:59], a[180:183], v[24:27], v[56:59]
  v_mfma_f32_16x16x32_bf16 v[60:63], a[20:23], v[28:31], v[60:63]
  ds_read_b128 v[20:23], v6 offset:24576
  v_mfma_f32_16x16x32_bf16 v[64:67], a[100:103], v[28:31], v[64:67]
  v_mfma_f32_16x16x32_bf16 v[68:71], a[180:183], v[28:31], v[68:71]
  s_waitcnt lgkmcnt(4)
  v_mfma_f32_16x16x32_bf16 v[48:51], a[24:27], v[32:35], v[48:51]
  ds_read_b128 v[24:27], v7 offset:4096
  v_mfma_f32_16x16x32_bf16 v[52:55], a[104:107], v[32:35], v[52:55]
  v_mfma_f32_16x16x32_bf16 v[56:59], a[184:187], v[32:35], v[56:59]
  v_mfma_f32_16x16x32_bf16 v[60:63], a[24:27], v[36:39], v[60:63]
  ds_read_b128 v[28:31], v7 offset:24576
  v_mfma_f32_16x16x32_bf16 v[64:67], a[104:107], v[36:39], v[64:67]
  v_mfma_f32_16x16x32_bf16 v[68:71], a[184:187], v[36:39], v[68:71]
  s_waitcnt lgkmcnt(4)
  v_mfma_f32_16x16x32_bf16 v[48:51], a[28:31], v[40:43], v[48:51]
  ds_read_b128 v[32:35], v6 offset:5120
  v_mfma_f32_16x16x32_bf16 v[52:55], a[108:111], v[40:43], v[52:55]
  v_mfma_f32_16x16x32_bf16 v[56:59], a[188:191], v[40:43], v[56:59]
  v_mfma_f32_16x16x32_bf16 v[60:63], a[28:31], v[44:47], v[60:63]
  ds_read_b128 v[36:39], v6 offset:25600
  v_mfma_f32_16x16x32_bf16 v[64:67], a[108:111], v[44:47], v[64:67]
  v_mfma_f32_16x16x32_bf16 v[68:71], a[188:191], v[44:47], v[68:71]
  s_waitcnt vmcnt(0)
  buffer_store_dword v8, off, s[4:7], s75 sc1
  s_cmp_eq_u32 s69, 1
  s_cbranch_scc0 nopfS_95
  s_waitcnt lgkmcnt(4)
  v_mfma_f32_16x16x32_bf16 v[48:51], a[32:35], v[16:19], v[48:51]
  ds_read_b128 v[40:43], v7 offset:5120
  v_mfma_f32_16x16x32_bf16 v[52:55], a[112:115], v[16:19], v[52:55]
  s_mov_b32 m0, s74
  v_mfma_f32_16x16x32_bf16 v[56:59], a[192:195], v[16:19], v[56:59]
  buffer_load_dwordx4 v3, s[4:7], s73 offen offset:0 sc1 lds
  v_mfma_f32_16x16x32_bf16 v[60:63], a[32:35], v[20:23], v[60:63]
  ds_read_b128 v[44:47], v7 offset:25600
  v_mfma_f32_16x16x32_bf16 v[64:67], a[112:115], v[20:23], v[64:67]
  v_mfma_f32_16x16x32_bf16 v[68:71], a[192:195], v[20:23], v[68:71]
  s_waitcnt lgkmcnt(4)
  v_mfma_f32_16x16x32_bf16 v[48:51], a[36:39], v[24:27], v[48:51]
  ds_read_b128 v[16:19], v6 offset:6144
  v_mfma_f32_16x16x32_bf16 v[52:55], a[116:119], v[24:27], v[52:55]
  s_add_u32 m0, m0, 896
  v_mfma_f32_16x16x32_bf16 v[56:59], a[196:199], v[24:27], v[56:59]
  buffer_load_dwordx4 v3, s[4:7], s73 offen offset:128 sc1 lds
  v_mfma_f32_16x16x32_bf16 v[60:63], a[36:39], v[28:31], v[60:63]
  ds_read_b128 v[20:23], v6 offset:26624
  v_mfma_f32_16x16x32_bf16 v[64:67], a[116:119], v[28:31], v[64:67]
  v_mfma_f32_16x16x32_bf16 v[68:71], a[196:199], v[28:31], v[68:71]
  s_waitcnt lgkmcnt(4)
  v_mfma_f32_16x16x32_bf16 v[48:51], a[40:43], v[32:35], v[48:51]
  ds_read_b128 v[24:27], v7 offset:6144
  v_mfma_f32_16x16x32_bf16 v[52:55], a[120:123], v[32:35], v[52:55]
  s_add_u32 m0, m0, 896
  v_mfma_f32_16x16x32_bf16 v[56:59], a[200:203], v[32:35], v[56:59]
  buffer_load_dwordx4 v3, s[4:7], s73 offen offset:256 sc1 lds
  v_mfma_f32_16x16x32_bf16 v[60:63], a[40:43], v[36:39], v[60:63]
  ds_read_b128 v[28:31], v7 offset:26624
  v_mfma_f32_16x16x32_bf16 v[64:67], a[120:123], v[36:39], v[64:67]
  v_mfma_f32_16x16x32_bf16 v[68:71], a[200:203], v[36:39], v[68:71]
  s_waitcnt lgkmcnt(4)
  v_mfma_f32_16x16x32_bf16 v[48:51], a[44:47], v[40:43], v[48:51]
  ds_read_b128 v[32:35], v6 offset:7168
  v_mfma_f32_16x16x32_bf16 v[52:55], a[124:127], v[40:43], v[52:55]
  s_add_u32 m0, m0, 896
  v_mfma_f32_16x16x32_bf16 v[56:59], a[204:207], v[40:43], v[56:59]
  buffer_load_dwordx4 v3, s[4:7], s73 offen offset:384 sc1 lds
  v_mfma_f32_16x16x32_bf16 v[60:63], a[44:47], v[44:47], v[60:63]
  ds_read_b128 v[36:39], v6 offset:27648
  v_mfma_f32_16x16x32_bf16 v[64:67], a[124:127], v[44:47], v[64:67]
  v_mfma_f32_16x16x32_bf16 v[68:71], a[204:207], v[44:47], v[68:71]
  s_waitcnt lgkmcnt(4)
  v_mfma_f32_16x16x32_bf16 v[48:51], a[48:51], v[16:19], v[48:51]
  ds_read_b128 v[40:43], v7 offset:7168
  v_mfma_f32_16x16x32_bf16 v[52:55], a[128:131], v[16:19], v[52:55]
  s_add_u32 m0, m0, 896
  v_mfma_f32_16x16x32_bf16 v[56:59], a[208:211], v[16:19], v[56:59]
  buffer_load_dwordx4 v3, s[4:7], s73 offen offset:512 sc1 lds
  v_mfma_f32_16x16x32_bf16 v[60:63], a[48:51], v[20:23], v[60:63]
  ds_read_b128 v[44:47], v7 offset:27648
  v_mfma_f32_16x16x32_bf16 v[64:67], a[128:131], v[20:23], v[64:67]
  v_mfma_f32_16x16x32_bf16 v[68:71], a[208:211], v[20:23], v[68:71]
  s_waitcnt lgkmcnt(4)
  v_mfma_f32_16x16x32_bf16 v[48:51], a[52:55], v[24:27], v[48:51]
  ds_read_b128 v[16:19], v6 offset:8192
  v_mfma_f32_16x16x32_bf16 v[52:55], a[132:135], v[24:27], v[52:55]
  s_add_u32 m0, m0, 896
  v_mfma_f32_16x16x32_bf16 v[56:59], a[212:215], v[24:27], v[56:59]
  buffer_load_dwordx4 v3, s[4:7], s73 offen offset:640 sc1 lds
  v_mfma_f32_16x16x32_bf16 v[60:63], a[52:55], v[28:31], v[60:63]
  ds_read_b128 v[20:23], v6 offset:28672
  v_mfma_f32_16x16x32_bf16 v[64:67], a[132:135], v[28:31], v[64:67]
  v_mfma_f32_16x16x32_bf16 v[68:71], a[212:215], v[28:31], v[68:71]
  s_waitcnt lgkmcnt(4)
  v_mfma_f32_16x16x32_bf16 v[48:51], a[56:59], v[32:35], v[48:51]
  ds_read_b128 v[24:27], v7 offset:8192
  v_mfma_f32_16x16x32_bf16 v[52:55], a[136:139], v[32:35], v[52:55]
  s_add_u32 m0, m0, 896
  v_mfma_f32_16x16x32_bf16 v[56:59], a[216:219], v[32:35], v[56:59]
  buffer_load_dwordx4 v3, s[4:7], s73 offen offset:768 sc1 lds
  v_mfma_f32_16x16x32_bf16 v[60:63], a[56:59], v[36:39], v[60:63]
  ds_read_b128 v[28:31], v7 offset:28672
  v_mfma_f32_16x16x32_bf16 v[64:67], a[136:139], v[36:39], v[64:67]
  v_mfma_f32_16x16x32_bf16 v[68:71], a[216:219], v[36:39], v[68:71]
  s_waitcnt lgkmcnt(4)
  v_mfma_f32_16x16x32_bf16 v[48:51], a[60:63], v[40:43], v[48:51]
  ds_read_b128 v[32:35], v6 offset:9216
  v_mfma_f32_16x16x32_bf16 v[52:55], a[140:143], v[40:43], v[52:55]
  s_add_u32 m0, m0, 896
  v_mfma_f32_16x16x32_bf16 v[56:59], a[220:223], v[40:43], v[56:59]
  buffer_load_dwordx4 v3, s[4:7], s73 offen offset:896 sc1 lds
  v_mfma_f32_16x16x32_bf16 v[60:63], a[60:63], v[44:47], v[60:63]
  ds_read_b128 v[36:39], v6 offset:29696
  v_mfma_f32_16x16x32_bf16 v[64:67], a[140:143], v[44:47], v[64:67]
  v_mfma_f32_16x16x32_bf16 v[68:71], a[220:223], v[44:47], v[68:71]
  s_waitcnt lgkmcnt(4)
  v_mfma_f32_16x16x32_bf16 v[48:51], a[64:67], v[16:19], v[48:51]
  ds_read_b128 v[40:43], v7 offset:9216
  v_mfma_f32_16x16x32_bf16 v[52:55], a[144:147], v[16:19], v[52:55]
  s_add_u32 m0, m0, 896
  v_mfma_f32_16x16x32_bf16 v[56:59], a[224:227], v[16:19], v[56:59]
  buffer_load_dwordx4 v3, s[4:7], s73 offen offset:1024 sc1 lds
  v_mfma_f32_16x16x32_bf16 v[60:63], a[64:67], v[20:23], v[60:63]
  ds_read_b128 v[44:47], v7 offset:29696
  v_mfma_f32_16x16x32_bf16 v[64:67], a[144:147], v[20:23], v[64:67]
  v_mfma_f32_16x16x32_bf16 v[68:71], a[224:227], v[20:23], v[68:71]
  s_waitcnt lgkmcnt(4)
  v_mfma_f32_16x16x32_bf16 v[48:51], a[68:71], v[24:27], v[48:51]
  v_mfma_f32_16x16x32_bf16 v[52:55], a[148:151], v[24:27], v[52:55]
  s_add_u32 m0, m0, 896
  v_mfma_f32_16x16x32_bf16 v[56:59], a[228:231], v[24:27], v[56:59]
  buffer_load_dwordx4 v3, s[4:7], s73 offen offset:1152 sc1 lds
  v_mfma_f32_16x16x32_bf16 v[60:63], a[68:71], v[28:31], v[60:63]
  v_mfma_f32_16x16x32_bf16 v[64:67], a[148:151], v[28:31], v[64:67]
  v_mfma_f32_16x16x32_bf16 v[68:71], a[228:231], v[28:31], v[68:71]
  s_waitcnt lgkmcnt(2)
  v_mfma_f32_16x16x32_bf16 v[48:51], a[72:75], v[32:35], v[48:51]
  v_mfma_f32_16x16x32_bf16 v[52:55], a[152:155], v[32:35], v[52:55]
  v_mfma_f32_16x16x32_bf16 v[56:59], a[232:235], v[32:35], v[56:59]
  v_mfma_f32_16x16x32_bf16 v[60:63], a[72:75], v[36:39], v[60:63]
  v_mfma_f32_16x16x32_bf16 v[64:67], a[152:155], v[36:39], v[64:67]
  v_mfma_f32_16x16x32_bf16 v[68:71], a[232:235], v[36:39], v[68:71]
  s_waitcnt lgkmcnt(0)
  v_mfma_f32_16x16x32_bf16 v[48:51], a[76:79], v[40:43], v[48:51]
  v_mfma_f32_16x16x32_bf16 v[52:55], a[156:159], v[40:43], v[52:55]
  v_mfma_f32_16x16x32_bf16 v[56:59], a[236:239], v[40:43], v[56:59]
  v_mfma_f32_16x16x32_bf16 v[60:63], a[76:79], v[44:47], v[60:63]
  v_mfma_f32_16x16x32_bf16 v[64:67], a[156:159], v[44:47], v[64:67]
  v_mfma_f32_16x16x32_bf16 v[68:71], a[236:239], v[44:47], v[68:71]
  s_branch joinS_96
nopfS_95:
  s_min_u32 s47, s67, 127
  s_lshl_b32 s47, s47, 11
  s_add_u32 s47, s47, 0
  buffer_load_dword v8, v2, s[4:7], s47 offen sc1
  s_waitcnt lgkmcnt(4)
  v_mfma_f32_16x16x32_bf16 v[48:51], a[32:35], v[16:19], v[48:51]
  ds_read_b128 v[40:43], v7 offset:5120
  v_mfma_f32_16x16x32_bf16 v[52:55], a[112:115], v[16:19], v[52:55]
  v_mfma_f32_16x16x32_bf16 v[56:59], a[192:195], v[16:19], v[56:59]
  v_mfma_f32_16x16x32_bf16 v[60:63], a[32:35], v[20:23], v[60:63]
  ds_read_b128 v[44:47], v7 offset:25600
  v_mfma_f32_16x16x32_bf16 v[64:67], a[112:115], v[20:23], v[64:67]
  v_mfma_f32_16x16x32_bf16 v[68:71], a[192:195], v[20:23], v[68:71]
  s_waitcnt lgkmcnt(4)
  v_mfma_f32_16x16x32_bf16 v[48:51], a[36:39], v[24:27], v[48:51]
  ds_read_b128 v[16:19], v6 offset:6144
  v_mfma_f32_16x16x32_bf16 v[52:55], a[116:119], v[24:27], v[52:55]
  v_mfma_f32_16x16x32_bf16 v[56:59], a[196:199], v[24:27], v[56:59]
  v_mfma_f32_16x16x32_bf16 v[60:63], a[36:39], v[28:31], v[60:63]
  ds_read_b128 v[20:23], v6 offset:26624
  v_mfma_f32_16x16x32_bf16 v[64:67], a[116:119], v[28:31], v[64:67]
  v_mfma_f32_16x16x32_bf16 v[68:71], a[196:199], v[28:31], v[68:71]
  s_waitcnt lgkmcnt(4)
  v_mfma_f32_16x16x32_bf16 v[48:51], a[40:43], v[32:35], v[48:51]
  ds_read_b128 v[24:27], v7 offset:6144
  v_mfma_f32_16x16x32_bf16 v[52:55], a[120:123], v[32:35], v[52:55]
  v_mfma_f32_16x16x32_bf16 v[56:59], a[200:203], v[32:35], v[56:59]
  v_mfma_f32_16x16x32_bf16 v[60:63], a[40:43], v[36:39], v[60:63]
  ds_read_b128 v[28:31], v7 offset:26624
  v_mfma_f32_16x16x32_bf16 v[64:67], a[120:123], v[36:39], v[64:67]
  v_mfma_f32_16x16x32_bf16 v[68:71], a[200:203], v[36:39], v[68:71]
  s_waitcnt lgkmcnt(4)
  v_mfma_f32_16x16x32_bf16 v[48:51], a[44:47], v[40:43], v[48:51]
  ds_read_b128 v[32:35], v6 offset:7168
  v_mfma_f32_16x16x32_bf16 v[52:55], a[124:127], v[40:43], v[52:55]
  v_mfma_f32_16x16x32_bf16 v[56:59], a[204:207], v[40:43], v[56:59]
  v_mfma_f32_16x16x32_bf16 v[60:63], a[44:47], v[44:47], v[60:63]
  ds_read_b128 v[36:39], v6 offset:27648
  v_mfma_f32_16x16x32_bf16 v[64:67], a[124:127], v[44:47], v[64:67]
  v_mfma_f32_16x16x32_bf16 v[68:71], a[204:207], v[44:47], v[68:71]
  s_waitcnt vmcnt(0)
  v_cmp_eq_u32 vcc, 0, v8
  s_cbranch_vccnz neS_97
  s_cmp_ge_u32 s67, 128
  s_cbranch_scc1 neS_97
  s_mov_b32 s69, 1
  s_sub_u32 s47, 40960, s68
  s_mul_i32 s73, s67, 40960
  s_add_u32 s73, s73, 18874368
  s_add_u32 s74, s47, s72
  s_waitcnt lgkmcnt(4)
  v_mfma_f32_16x16x32_bf16 v[48:51], a[48:51], v[16:19], v[48:51]
  ds_read_b128 v[40:43], v7 offset:7168
  v_mfma_f32_16x16x32_bf16 v[52:55], a[128:131], v[16:19], v[52:55]
  s_mov_b32 m0, s74
  v_mfma_f32_16x16x32_bf16 v[56:59], a[208:211], v[16:19], v[56:59]
  buffer_load_dwordx4 v3, s[4:7], s73 offen offset:0 sc1 lds
  v_mfma_f32_16x16x32_bf16 v[60:63], a[48:51], v[20:23], v[60:63]
  ds_read_b128 v[44:47], v7 offset:27648
  v_mfma_f32_16x16x32_bf16 v[64:67], a[128:131], v[20:23], v[64:67]
  s_add_u32 m0, m0, 896
  v_mfma_f32_16x16x32_bf16 v[68:71], a[208:211], v[20:23], v[68:71]
  buffer_load_dwordx4 v3, s[4:7], s73 offen offset:128 sc1 lds
  s_waitcnt lgkmcnt(4)
  v_mfma_f32_16x16x32_bf16 v[48:51], a[52:55], v[24:27], v[48:51]
  ds_read_b128 v[16:19], v6 offset:8192
  v_mfma_f32_16x16x32_bf16 v[52:55], a[132:135], v[24:27], v[52:55]
  s_add_u32 m0, m0, 896
  v_mfma_f32_16x16x32_bf16 v[56:59], a[212:215], v[24:27], v[56:59]
  buffer_load_dwordx4 v3, s[4:7], s73 offen offset:256 sc1 lds
  v_mfma_f32_16x16x32_bf16 v[60:63], a[52:55], v[28:31], v[60:63]
  ds_read_b128 v[20:23], v6 offset:28672
  v_mfma_f32_16x16x32_bf16 v[64:67], a[132:135], v[28:31], v[64:67]
  s_add_u32 m0, m0, 896
  v_mfma_f32_16x16x32_bf16 v[68:71], a[212:215], v[28:31], v[68:71]
  buffer_load_dwordx4 v3, s[4:7], s73 offen offset:384 sc1 lds
  s_waitcnt lgkmcnt(4)
  v_mfma_f32_16x16x32_bf16 v[48:51], a[56:59], v[32:35], v[48:51]
  ds_read_b128 v[24:27], v7 offset:8192
  v_mfma_f32_16x16x32_bf16 v[52:55], a[136:139], v[32:35], v[52:55]
  s_add_u32 m0, m0, 896
  v_mfma_f32_16x16x32_bf16 v[56:59], a[216:219], v[32:35], v[56:59]
  buffer_load_dwordx4 v3, s[4:7], s73 offen offset:512 sc1 lds
  v_mfma_f32_16x16x32_bf16 v[60:63], a[56:59], v[36:39], v[60:63]
  ds_read_b128 v[28:31], v7 offset:28672
  v_mfma_f32_16x16x32_bf16 v[64:67], a[136:139], v[36:39], v[64:67]
  v_mfma_f32_16x16x32_bf16 v[68:71], a[216:219], v[36:39], v[68:71]
  s_waitcnt lgkmcnt(4)
  v_mfma_f32_16x16x32_bf16 v[48:51], a[60:63], v[40:43], v[48:51]
  ds_read_b128 v[32:35], v6 offset:9216
  v_mfma_f32_16x16x32_bf16 v[52:55], a[140:143], v[40:43], v[52:55]
  s_add_u32 m0, m0, 896
  v_mfma_f32_16x16x32_bf16 v[56:59], a[220:223], v[40:43], v[56:59]
  buffer_load_dwordx4 v3, s[4:7], s73 offen offset:640 sc1 lds
  v_mfma_f32_16x16x32_bf16 v[60:63], a[60:63], v[44:47], v[60:63]
  ds_read_b128 v[36:39], v6 offset:29696
  v_mfma_f32_16x16x32_bf16 v[64:67], a[140:143], v[44:47], v[64:67]
  v_mfma_f32_16x16x32_bf16 v[68:71], a[220:223], v[44:47], v[68:71]
  s_waitcnt lgkmcnt(4)
  v_mfma_f32_16x16x32_bf16 v[48:51], a[64:67], v[16:19], v[48:51]
  ds_read_b128 v[40:43], v7 offset:9216
  v_mfma_f32_16x16x32_bf16 v[52:55], a[144:147], v[16:19], v[52:55]
  s_add_u32 m0, m0, 896
  v_mfma_f32_16x16x32_bf16 v[56:59], a[224:227], v[16:19], v[56:59]
  buffer_load_dwordx4 v3, s[4:7], s73 offen offset:768 sc1 lds
  v_mfma_f32_16x16x32_bf16 v[60:63], a[64:67], v[20:23], v[60:63]
  ds_read_b128 v[44:47], v7 offset:29696
  v_mfma_f32_16x16x32_bf16 v[64:67], a[144:147], v[20:23], v[64:67]
  v_mfma_f32_16x16x32_bf16 v[68:71], a[224:227], v[20:23], v[68:71]
  s_waitcnt lgkmcnt(4)
  v_mfma_f32_16x16x32_bf16 v[48:51], a[68:71], v[24:27], v[48:51]
  v_mfma_f32_16x16x32_bf16 v[52:55], a[148:151], v[24:27], v[52:55]
  s_add_u32 m0, m0, 896
  v_mfma_f32_16x16x32_bf16 v[56:59], a[228:231], v[24:27], v[56:59]
  buffer_load_dwordx4 v3, s[4:7], s73 offen offset:896 sc1 lds
  v_mfma_f32_16x16x32_bf16 v[60:63], a[68:71], v[28:31], v[60:63]
  v_mfma_f32_16x16x32_bf16 v[64:67], a[148:151], v[28:31], v[64:67]
  v_mfma_f32_16x16x32_bf16 v[68:71], a[228:231], v[28:31], v[68:71]
  s_waitcnt lgkmcnt(2)
  v_mfma_f32_16x16x32_bf16 v[48:51], a[72:75], v[32:35], v[48:51]
  v_mfma_f32_16x16x32_bf16 v[52:55], a[152:155], v[32:35], v[52:55]
  s_add_u32 m0, m0, 896
  v_mfma_f32_16x16x32_bf16 v[56:59], a[232:235], v[32:35], v[56:59]
  buffer_load_dwordx4 v3, s[4:7], s73 offen offset:1024 sc1 lds
  v_mfma_f32_16x16x32_bf16 v[60:63], a[72:75], v[36:39], v[60:63]
  v_mfma_f32_16x16x32_bf16 v[64:67], a[152:155], v[36:39], v[64:67]
  v_mfma_f32_16x16x32_bf16 v[68:71], a[232:235], v[36:39], v[68:71]
  s_waitcnt lgkmcnt(0)
  v_mfma_f32_16x16x32_bf16 v[48:51], a[76:79], v[40:43], v[48:51]
  v_mfma_f32_16x16x32_bf16 v[52:55], a[156:159], v[40:43], v[52:55]
  s_add_u32 m0, m0, 896
  v_mfma_f32_16x16x32_bf16 v[56:59], a[236:239], v[40:43], v[56:59]
  buffer_load_dwordx4 v3, s[4:7], s73 offen offset:1152 sc1 lds
  v_mfma_f32_16x16x32_bf16 v[60:63], a[76:79], v[44:47], v[60:63]
  v_mfma_f32_16x16x32_bf16 v[64:67], a[156:159], v[44:47], v[64:67]
  v_mfma_f32_16x16x32_bf16 v[68:71], a[236:239], v[44:47], v[68:71]
  s_branch joinS_96
neS_97:
  s_waitcnt lgkmcnt(4)
  v_mfma_f32_16x16x32_bf16 v[48:51], a[48:51], v[16:19], v[48:51]
  ds_read_b128 v[40:43], v7 offset:7168
  v_mfma_f32_16x16x32_bf16 v[52:55], a[128:131], v[16:19], v[52:55]
  v_mfma_f32_16x16x32_bf16 v[56:59], a[208:211], v[16:19], v[56:59]
  v_mfma_f32_16x16x32_bf16 v[60:63], a[48:51], v[20:23], v[60:63]
  ds_read_b128 v[44:47], v7 offset:27648
  v_mfma_f32_16x16x32_bf16 v[64:67], a[128:131], v[20:23], v[64:67]
  v_mfma_f32_16x16x32_bf16 v[68:71], a[208:211], v[20:23], v[68:71]
  s_waitcnt lgkmcnt(4)
  v_mfma_f32_16x16x32_bf16 v[48:51], a[52:55], v[24:27], v[48:51]
  ds_read_b128 v[16:19], v6 offset:8192
  v_mfma_f32_16x16x32_bf16 v[52:55], a[132:135], v[24:27], v[52:55]
  v_mfma_f32_16x16x32_bf16 v[56:59], a[212:215], v[24:27], v[56:59]
  v_mfma_f32_16x16x32_bf16 v[60:63], a[52:55], v[28:31], v[60:63]
  ds_read_b128 v[20:23], v6 offset:28672
  v_mfma_f32_16x16x32_bf16 v[64:67], a[132:135], v[28:31], v[64:67]
  v_mfma_f32_16x16x32_bf16 v[68:71], a[212:215], v[28:31], v[68:71]
  s_waitcnt lgkmcnt(4)
  v_mfma_f32_16x16x32_bf16 v[48:51], a[56:59], v[32:35], v[48:51]
  ds_read_b128 v[24:27], v7 offset:8192
  v_mfma_f32_16x16x32_bf16 v[52:55], a[136:139], v[32:35], v[52:55]
  v_mfma_f32_16x16x32_bf16 v[56:59], a[216:219], v[32:35], v[56:59]
  v_mfma_f32_16x16x32_bf16 v[60:63], a[56:59], v[36:39], v[60:63]
  ds_read_b128 v[28:31], v7 offset:28672
  v_mfma_f32_16x16x32_bf16 v[64:67], a[136:139], v[36:39], v[64:67]
  v_mfma_f32_16x16x32_bf16 v[68:71], a[216:219], v[36:39], v[68:71]
  s_waitcnt lgkmcnt(4)
  v_mfma_f32_16x16x32_bf16 v[48:51], a[60:63], v[40:43], v[48:51]
  ds_read_b128 v[32:35], v6 offset:9216
  v_mfma_f32_16x16x32_bf16 v[52:55], a[140:143], v[40:43], v[52:55]
  v_mfma_f32_16x16x32_bf16 v[56:59], a[220:223], v[40:43], v[56:59]
  v_mfma_f32_16x16x32_bf16 v[60:63], a[60:63], v[44:47], v[60:63]
  ds_read_b128 v[36:39], v6 offset:29696
  v_mfma_f32_16x16x32_bf16 v[64:67], a[140:143], v[44:47], v[64:67]
  v_mfma_f32_16x16x32_bf16 v[68:71], a[220:223], v[44:47], v[68:71]
  s_waitcnt lgkmcnt(4)
  v_mfma_f32_16x16x32_bf16 v[48:51], a[64:67], v[16:19], v[48:51]
  ds_read_b128 v[40:43], v7 offset:9216
  v_mfma_f32_16x16x32_bf16 v[52:55], a[144:147], v[16:19], v[52:55]
  v_mfma_f32_16x16x32_bf16 v[56:59], a[224:227], v[16:19], v[56:59]
  v_mfma_f32_16x16x32_bf16 v[60:63], a[64:67], v[20:23], v[60:63]
  ds_read_b128 v[44:47], v7 offset:29696
  v_mfma_f32_16x16x32_bf16 v[64:67], a[144:147], v[20:23], v[64:67]
  v_mfma_f32_16x16x32_bf16 v[68:71], a[224:227], v[20:23], v[68:71]
  s_waitcnt lgkmcnt(4)
  v_mfma_f32_16x16x32_bf16 v[48:51], a[68:71], v[24:27], v[48:51]
  v_mfma_f32_16x16x32_bf16 v[52:55], a[148:151], v[24:27], v[52:55]
  v_mfma_f32_16x16x32_bf16 v[56:59], a[228:231], v[24:27], v[56:59]
  v_mfma_f32_16x16x32_bf16 v[60:63], a[68:71], v[28:31], v[60:63]
  v_mfma_f32_16x16x32_bf16 v[64:67], a[148:151], v[28:31], v[64:67]
  v_mfma_f32_16x16x32_bf16 v[68:71], a[228:231], v[28:31], v[68:71]
  s_waitcnt lgkmcnt(2)
  v_mfma_f32_16x16x32_bf16 v[48:51], a[72:75], v[32:35], v[48:51]
  v_mfma_f32_16x16x32_bf16 v[52:55], a[152:155], v[32:35], v[52:55]
  v_mfma_f32_16x16x32_bf16 v[56:59], a[232:235], v[32:35], v[56:59]
  v_mfma_f32_16x16x32_bf16 v[60:63], a[72:75], v[36:39], v[60:63]
  v_mfma_f32_16x16x32_bf16 v[64:67], a[152:155], v[36:39], v[64:67]
  v_mfma_f32_16x16x32_bf16 v[68:71], a[232:235], v[36:39], v[68:71]
  s_waitcnt lgkmcnt(0)
  v_mfma_f32_16x16x32_bf16 v[48:51], a[76:79], v[40:43], v[48:51]
  v_mfma_f32_16x16x32_bf16 v[52:55], a[156:159], v[40:43], v[52:55]
  v_mfma_f32_16x16x32_bf16 v[56:59], a[236:239], v[40:43], v[56:59]
  v_mfma_f32_16x16x32_bf16 v[60:63], a[76:79], v[44:47], v[60:63]
  v_mfma_f32_16x16x32_bf16 v[64:67], a[156:159], v[44:47], v[64:67]
  v_mfma_f32_16x16x32_bf16 v[68:71], a[236:239], v[44:47], v[68:71]
joinS_96:
  s_mul_i32 s73, s66, 393216
  s_add_u32 s73, s73, s70
  s_lshl_b32 s75, s66, 14
  s_add_u32 s75, s75, s71
  s_sub_u32 s68, 40960, s68
  s_nop 1
  v_cvt_pk_bf16_f32 v72, v48, v49
  v_cvt_pk_bf16_f32 v73, v50, v51
  v_cvt_pk_bf16_f32 v74, v52, v53
  v_cvt_pk_bf16_f32 v75, v54, v55
  buffer_store_dwordx4 v[72:75], v1, s[4:7], s73 offen offset:0 sc1
  v_cvt_pk_bf16_f32 v76, v60, v61
  v_cvt_pk_bf16_f32 v77, v62, v63
  v_cvt_pk_bf16_f32 v78, v64, v65
  v_cvt_pk_bf16_f32 v79, v66, v67
  buffer_store_dwordx4 v[76:79], v1, s[4:7], s73 offen offset:1024 sc1
  v_cvt_pk_bf16_f32 v80, v56, v57
  v_cvt_pk_bf16_f32 v81, v58, v59
  v_cvt_pk_bf16_f32 v82, v68, v69
  v_cvt_pk_bf16_f32 v83, v70, v71
  buffer_store_dwordx4 v[80:83], v1, s[4:7], s73 offen offset:2048 sc1
  s_mov_b32 s66, s67
  s_cmp_eq_u32 s69, 1
  s_cbranch_scc1 top3S_91
  s_cmp_ge_u32 s66, 128
  s_cbranch_scc1 endS_94
  s_lshl_b32 s47, s66, 11
  s_add_u32 s47, s47, 0
  buffer_load_dword v8, v2, s[4:7], s47 offen sc1
  v_mov_b32 v9, 1
  s_waitcnt vmcnt(0)
  buffer_store_dword v9, off, s[4:7], s75 sc1
  s_mov_b32 s75, 0x10000000
  s_waitcnt vmcnt(1)
  s_branch fcS_100
fwS_98:
  buffer_load_dword v8, v2, s[4:7], s47 offen sc1
  s_waitcnt vmcnt(0)
fcS_100:
  v_cmp_eq_u32 vcc, 0, v8
  s_cbranch_vccz foS_99
  s_add_u32 s45, s45, 1
  s_cmp_gt_u32 s45, 1048576
  s_cbranch_scc1 failqS_76
  s_sleep 1
  s_branch fwS_98
foS_99:
  s_mul_i32 s73, s66, 40960
  s_add_u32 s73, s73, 18874368
  s_add_u32 s74, s68, s72
  s_mov_b32 m0, s74
  s_nop 0
  buffer_load_dwordx4 v3, s[4:7], s73 offen offset:0 sc1 lds
  s_add_u32 m0, m0, 896
  s_nop 0
  buffer_load_dwordx4 v3, s[4:7], s73 offen offset:128 sc1 lds
  s_add_u32 m0, m0, 896
  s_nop 0
  buffer_load_dwordx4 v3, s[4:7], s73 offen offset:256 sc1 lds
  s_add_u32 m0, m0, 896
  s_nop 0
  buffer_load_dwordx4 v3, s[4:7], s73 offen offset:384 sc1 lds
  s_add_u32 m0, m0, 896
  s_nop 0
  buffer_load_dwordx4 v3, s[4:7], s73 offen offset:512 sc1 lds
  s_add_u32 m0, m0, 896
  s_nop 0
  buffer_load_dwordx4 v3, s[4:7], s73 offen offset:640 sc1 lds
  s_add_u32 m0, m0, 896
  s_nop 0
  buffer_load_dwordx4 v3, s[4:7], s73 offen offset:768 sc1 lds
  s_add_u32 m0, m0, 896
  s_nop 0
  buffer_load_dwordx4 v3, s[4:7], s73 offen offset:896 sc1 lds
  s_add_u32 m0, m0, 896
  s_nop 0
  buffer_load_dwordx4 v3, s[4:7], s73 offen offset:1024 sc1 lds
  s_add_u32 m0, m0, 896
  s_nop 0
  buffer_load_dwordx4 v3, s[4:7], s73 offen offset:1152 sc1 lds
  s_branch topS_90
endS_94:
  v_mov_b32 v8, 1
  s_waitcnt vmcnt(0)
  buffer_store_dword v8, off, s[4:7], s75 sc1
  s_endpgm
isvS_89:
topS_101:
  s_waitcnt vmcnt(0)
top3S_102:
  s_waitcnt vmcnt(3)
  s_barrier
  v_add_u32 v6, s68, v4
  v_add_u32 v7, s68, v5
  ds_read_b128 v[16:19], v6 offset:0
  ds_read_b128 v[20:23], v6 offset:20480
  ds_read_b128 v[24:27], v7 offset:0
  ds_read_b128 v[28:31], v7 offset:20480
  ds_read_b128 v[32:35], v6 offset:1024
  ds_read_b128 v[36:39], v6 offset:21504
  s_add_u32 s46, s65, 10
  s_min_u32 s46, s46, 64
  s_cmp_lt_u32 s64, s46
  s_cbranch_scc0 n2S_103
  s_mov_b32 s67, s64
  s_add_u32 s64, s64, 1
  s_mov_b32 s69, 1
  s_sub_u32 s47, 40960, s68
  s_mul_i32 s73, s67, 40960
  s_add_u32 s73, s73, 18874368
  s_add_u32 s74, s47, s72
  s_branch cmpS_104
n2S_103:
  s_add_u32 s67, s65, 64
  s_add_u32 s65, s65, 1
  s_mov_b32 s69, 0
cmpS_104:
  s_waitcnt lgkmcnt(4)
  v_mfma_f32_16x16x32_bf16 v[48:51], v[16:19], a[0:3], 0
  ds_read_b128 v[40:43], v7 offset:1024
  v_mfma_f32_16x16x32_bf16 v[52:55], v[16:19], a[80:83], 0
  v_mov_b32 v8, 1
  v_mfma_f32_16x16x32_bf16 v[56:59], v[16:19], a[160:163], 0
  v_mfma_f32_16x16x32_bf16 v[60:63], v[20:23], a[0:3], 0
  ds_read_b128 v[44:47], v7 offset:21504
  v_mfma_f32_16x16x32_bf16 v[64:67], v[20:23], a[80:83], 0
  v_mfma_f32_16x16x32_bf16 v[68:71], v[20:23], a[160:163], 0
  s_waitcnt lgkmcnt(4)
  v_mfma_f32_16x16x32_bf16 v[48:51], v[24:27], a[4:7], v[48:51]
  ds_read_b128 v[16:19], v6 offset:2048
  v_mfma_f32_16x16x32_bf16 v[52:55], v[24:27], a[84:87], v[52:55]
  v_mfma_f32_16x16x32_bf16 v[56:59], v[24:27], a[164:167], v[56:59]
  v_mfma_f32_16x16x32_bf16 v[60:63], v[28:31], a[4:7], v[60:63]
  ds_read_b128 v[20:23], v6 offset:22528
  v_mfma_f32_16x16x32_bf16 v[64:67], v[28:31], a[84:87], v[64:67]
  v_mfma_f32_16x16x32_bf16 v[68:71], v[28:31], a[164:167], v[68:71]
  s_waitcnt lgkmcnt(4)
  v_mfma_f32_16x16x32_bf16 v[48:51], v[32:35], a[8:11], v[48:51]
  ds_read_b128 v[24:27], v7 offset:2048
  v_mfma_f32_16x16x32_bf16 v[52:55], v[32:35], a[88:91], v[52:55]
  v_mfma_f32_16x16x32_bf16 v[56:59], v[32:35], a[168:171], v[56:59]
  v_mfma_f32_16x16x32_bf16 v[60:63], v[36:39], a[8:11], v[60:63]
  ds_read_b128 v[28:31], v7 offset:22528
  v_mfma_f32_16x16x32_bf16 v[64:67], v[36:39], a[88:91], v[64:67]
  v_mfma_f32_16x16x32_bf16 v[68:71], v[36:39], a[168:171], v[68:71]
  s_waitcnt lgkmcnt(4)
  v_mfma_f32_16x16x32_bf16 v[48:51], v[40:43], a[12:15], v[48:51]
  ds_read_b128 v[32:35], v6 offset:3072
  v_mfma_f32_16x16x32_bf16 v[52:55], v[40:43], a[92:95], v[52:55]
  v_mfma_f32_16x16x32_bf16 v[56:59], v[40:43], a[172:175], v[56:59]
  v_mfma_f32_16x16x32_bf16 v[60:63], v[44:47], a[12:15], v[60:63]
  ds_read_b128 v[36:39], v6 offset:23552
  v_mfma_f32_16x16x32_bf16 v[64:67], v[44:47], a[92:95], v[64:67]
  v_mfma_f32_16x16x32_bf16 v[68:71], v[44:47], a[172:175], v[68:71]
  s_waitcnt lgkmcnt(4)
  v_mfma_f32_16x16x32_bf16 v[48:51], v[16:19], a[16:19], v[48:51]
  ds_read_b128 v[40:43], v7 offset:3072
  v_mfma_f32_16x16x32_bf16 v[52:55], v[16:19], a[96:99], v[52:55]
  v_mfma_f32_16x16x32_bf16 v[56:59], v[16:19], a[176:179], v[56:59]
  v_mfma_f32_16x16x32_bf16 v[60:63], v[20:23], a[16:19], v[60:63]
  ds_read_b128 v[44:47], v7 offset:23552
  v_mfma_f32_16x16x32_bf16 v[64:67], v[20:23], a[96:99], v[64:67]
  v_mfma_f32_16x16x32_bf16 v[68:71], v[20:23], a[176:179], v[68:71]
  s_waitcnt lgkmcnt(4)
  v_mfma_f32_16x16x32_bf16 v[48:51], v[24:27], a[20:23], v[48:51]
  ds_read_b128 v[16:19], v6 offset:4096
  v_mfma_f32_16x16x32_bf16 v[52:55], v[24:27], a[100:103], v[52:55]
  v_mfma_f32_16x16x32_bf16 v[56:59], v[24:27], a[180:183], v[56:59]
  v_mfma_f32_16x16x32_bf16 v[60:63], v[28:31], a[20:23], v[60:63]
  ds_read_b128 v[20:23], v6 offset:24576
  v_mfma_f32_16x16x32_bf16 v[64:67], v[28:31], a[100:103], v[64:67]
  v_mfma_f32_16x16x32_bf16 v[68:71], v[28:31], a[180:183], v[68:71]
  s_waitcnt lgkmcnt(4)
  v_mfma_f32_16x16x32_bf16 v[48:51], v[32:35], a[24:27], v[48:51]
  ds_read_b128 v[24:27], v7 offset:4096
  v_mfma_f32_16x16x32_bf16 v[52:55], v[32:35], a[104:107], v[52:55]
  v_mfma_f32_16x16x32_bf16 v[56:59], v[32:35], a[184:187], v[56:59]
  v_mfma_f32_16x16x32_bf16 v[60:63], v[36:39], a[24:27], v[60:63]
  ds_read_b128 v[28:31], v7 offset:24576
  v_mfma_f32_16x16x32_bf16 v[64:67], v[36:39], a[104:107], v[64:67]
  v_mfma_f32_16x16x32_bf16 v[68:71], v[36:39], a[184:187], v[68:71]
  s_waitcnt lgkmcnt(4)
  v_mfma_f32_16x16x32_bf16 v[48:51], v[40:43], a[28:31], v[48:51]
  ds_read_b128 v[32:35], v6 offset:5120
  v_mfma_f32_16x16x32_bf16 v[52:55], v[40:43], a[108:111], v[52:55]
  v_mfma_f32_16x16x32_bf16 v[56:59], v[40:43], a[188:191], v[56:59]
  v_mfma_f32_16x16x32_bf16 v[60:63], v[44:47], a[28:31], v[60:63]
  ds_read_b128 v[36:39], v6 offset:25600
  v_mfma_f32_16x16x32_bf16 v[64:67], v[44:47], a[108:111], v[64:67]
  v_mfma_f32_16x16x32_bf16 v[68:71], v[44:47], a[188:191], v[68:71]
  s_waitcnt vmcnt(0)
  buffer_store_dword v8, off, s[4:7], s75 sc1
  s_cmp_eq_u32 s69, 1
  s_cbranch_scc0 nopfS_106
  s_waitcnt lgkmcnt(4)
  v_mfma_f32_16x16x32_bf16 v[48:51], v[16:19], a[32:35], v[48:51]
  ds_read_b128 v[40:43], v7 offset:5120
  v_mfma_f32_16x16x32_bf16 v[52:55], v[16:19], a[112:115], v[52:55]
  s_mov_b32 m0, s74
  v_mfma_f32_16x16x32_bf16 v[56:59], v[16:19], a[192:195], v[56:59]
  buffer_load_dwordx4 v3, s[4:7], s73 offen offset:0 sc1 lds
  v_mfma_f32_16x16x32_bf16 v[60:63], v[20:23], a[32:35], v[60:63]
  ds_read_b128 v[44:47], v7 offset:25600
  v_mfma_f32_16x16x32_bf16 v[64:67], v[20:23], a[112:115], v[64:67]
  v_mfma_f32_16x16x32_bf16 v[68:71], v[20:23], a[192:195], v[68:71]
  s_waitcnt lgkmcnt(4)
  v_mfma_f32_16x16x32_bf16 v[48:51], v[24:27], a[36:39], v[48:51]
  ds_read_b128 v[16:19], v6 offset:6144
  v_mfma_f32_16x16x32_bf16 v[52:55], v[24:27], a[116:119], v[52:55]
  s_add_u32 m0, m0, 896
  v_mfma_f32_16x16x32_bf16 v[56:59], v[24:27], a[196:199], v[56:59]
  buffer_load_dwordx4 v3, s[4:7], s73 offen offset:128 sc1 lds
  v_mfma_f32_16x16x32_bf16 v[60:63], v[28:31], a[36:39], v[60:63]
  ds_read_b128 v[20:23], v6 offset:26624
  v_mfma_f32_16x16x32_bf16 v[64:67], v[28:31], a[116:119], v[64:67]
  v_mfma_f32_16x16x32_bf16 v[68:71], v[28:31], a[196:199], v[68:71]
  s_waitcnt lgkmcnt(4)
  v_mfma_f32_16x16x32_bf16 v[48:51], v[32:35], a[40:43], v[48:51]
  ds_read_b128 v[24:27], v7 offset:6144
  v_mfma_f32_16x16x32_bf16 v[52:55], v[32:35], a[120:123], v[52:55]
  s_add_u32 m0, m0, 896
  v_mfma_f32_16x16x32_bf16 v[56:59], v[32:35], a[200:203], v[56:59]
  buffer_load_dwordx4 v3, s[4:7], s73 offen offset:256 sc1 lds
  v_mfma_f32_16x16x32_bf16 v[60:63], v[36:39], a[40:43], v[60:63]
  ds_read_b128 v[28:31], v7 offset:26624
  v_mfma_f32_16x16x32_bf16 v[64:67], v[36:39], a[120:123], v[64:67]
  v_mfma_f32_16x16x32_bf16 v[68:71], v[36:39], a[200:203], v[68:71]
  s_waitcnt lgkmcnt(4)
  v_mfma_f32_16x16x32_bf16 v[48:51], v[40:43], a[44:47], v[48:51]
  ds_read_b128 v[32:35], v6 offset:7168
  v_mfma_f32_16x16x32_bf16 v[52:55], v[40:43], a[124:127], v[52:55]
  s_add_u32 m0, m0, 896
  v_mfma_f32_16x16x32_bf16 v[56:59], v[40:43], a[204:207], v[56:59]
  buffer_load_dwordx4 v3, s[4:7], s73 offen offset:384 sc1 lds
  v_mfma_f32_16x16x32_bf16 v[60:63], v[44:47], a[44:47], v[60:63]
  ds_read_b128 v[36:39], v6 offset:27648
  v_mfma_f32_16x16x32_bf16 v[64:67], v[44:47], a[124:127], v[64:67]
  v_mfma_f32_16x16x32_bf16 v[68:71], v[44:47], a[204:207], v[68:71]
  s_waitcnt lgkmcnt(4)
  v_mfma_f32_16x16x32_bf16 v[48:51], v[16:19], a[48:51], v[48:51]
  ds_read_b128 v[40:43], v7 offset:7168
  v_mfma_f32_16x16x32_bf16 v[52:55], v[16:19], a[128:131], v[52:55]
  s_add_u32 m0, m0, 896
  v_mfma_f32_16x16x32_bf16 v[56:59], v[16:19], a[208:211], v[56:59]
  buffer_load_dwordx4 v3, s[4:7], s73 offen offset:512 sc1 lds
  v_mfma_f32_16x16x32_bf16 v[60:63], v[20:23], a[48:51], v[60:63]
  ds_read_b128 v[44:47], v7 offset:27648
  v_mfma_f32_16x16x32_bf16 v[64:67], v[20:23], a[128:131], v[64:67]
  v_mfma_f32_16x16x32_bf16 v[68:71], v[20:23], a[208:211], v[68:71]
  s_waitcnt lgkmcnt(4)
  v_mfma_f32_16x16x32_bf16 v[48:51], v[24:27], a[52:55], v[48:51]
  ds_read_b128 v[16:19], v6 offset:8192
  v_mfma_f32_16x16x32_bf16 v[52:55], v[24:27], a[132:135], v[52:55]
  s_add_u32 m0, m0, 896
  v_mfma_f32_16x16x32_bf16 v[56:59], v[24:27], a[212:215], v[56:59]
  buffer_load_dwordx4 v3, s[4:7], s73 offen offset:640 sc1 lds
  v_mfma_f32_16x16x32_bf16 v[60:63], v[28:31], a[52:55], v[60:63]
  ds_read_b128 v[20:23], v6 offset:28672
  v_mfma_f32_16x16x32_bf16 v[64:67], v[28:31], a[132:135], v[64:67]
  v_mfma_f32_16x16x32_bf16 v[68:71], v[28:31], a[212:215], v[68:71]
  s_waitcnt lgkmcnt(4)
  v_mfma_f32_16x16x32_bf16 v[48:51], v[32:35], a[56:59], v[48:51]
  ds_read_b128 v[24:27], v7 offset:8192
  v_mfma_f32_16x16x32_bf16 v[52:55], v[32:35], a[136:139], v[52:55]
  s_add_u32 m0, m0, 896
  v_mfma_f32_16x16x32_bf16 v[56:59], v[32:35], a[216:219], v[56:59]
  buffer_load_dwordx4 v3, s[4:7], s73 offen offset:768 sc1 lds
  v_mfma_f32_16x16x32_bf16 v[60:63], v[36:39], a[56:59], v[60:63]
  ds_read_b128 v[28:31], v7 offset:28672
  v_mfma_f32_16x16x32_bf16 v[64:67], v[36:39], a[136:139], v[64:67]
  v_mfma_f32_16x16x32_bf16 v[68:71], v[36:39], a[216:219], v[68:71]
  s_waitcnt lgkmcnt(4)
  v_mfma_f32_16x16x32_bf16 v[48:51], v[40:43], a[60:63], v[48:51]
  ds_read_b128 v[32:35], v6 offset:9216
  v_mfma_f32_16x16x32_bf16 v[52:55], v[40:43], a[140:143], v[52:55]
  s_add_u32 m0, m0, 896
  v_mfma_f32_16x16x32_bf16 v[56:59], v[40:43], a[220:223], v[56:59]
  buffer_load_dwordx4 v3, s[4:7], s73 offen offset:896 sc1 lds
  v_mfma_f32_16x16x32_bf16 v[60:63], v[44:47], a[60:63], v[60:63]
  ds_read_b128 v[36:39], v6 offset:29696
  v_mfma_f32_16x16x32_bf16 v[64:67], v[44:47], a[140:143], v[64:67]
  v_mfma_f32_16x16x32_bf16 v[68:71], v[44:47], a[220:223], v[68:71]
  s_waitcnt lgkmcnt(4)
  v_mfma_f32_16x16x32_bf16 v[48:51], v[16:19], a[64:67], v[48:51]
  ds_read_b128 v[40:43], v7 offset:9216
  v_mfma_f32_16x16x32_bf16 v[52:55], v[16:19], a[144:147], v[52:55]
  s_add_u32 m0, m0, 896
  v_mfma_f32_16x16x32_bf16 v[56:59], v[16:19], a[224:227], v[56:59]
  buffer_load_dwordx4 v3, s[4:7], s73 offen offset:1024 sc1 lds
  v_mfma_f32_16x16x32_bf16 v[60:63], v[20:23], a[64:67], v[60:63]
  ds_read_b128 v[44:47], v7 offset:29696
  v_mfma_f32_16x16x32_bf16 v[64:67], v[20:23], a[144:147], v[64:67]
  v_mfma_f32_16x16x32_bf16 v[68:71], v[20:23], a[224:227], v[68:71]
  s_waitcnt lgkmcnt(4)
  v_mfma_f32_16x16x32_bf16 v[48:51], v[24:27], a[68:71], v[48:51]
  v_mfma_f32_16x16x32_bf16 v[52:55], v[24:27], a[148:151], v[52:55]
  s_add_u32 m0, m0, 896
  v_mfma_f32_16x16x32_bf16 v[56:59], v[24:27], a[228:231], v[56:59]
  buffer_load_dwordx4 v3, s[4:7], s73 offen offset:1152 sc1 lds
  v_mfma_f32_16x16x32_bf16 v[60:63], v[28:31], a[68:71], v[60:63]
  v_mfma_f32_16x16x32_bf16 v[64:67], v[28:31], a[148:151], v[64:67]
  v_mfma_f32_16x16x32_bf16 v[68:71], v[28:31], a[228:231], v[68:71]
  s_waitcnt lgkmcnt(2)
  v_mfma_f32_16x16x32_bf16 v[48:51], v[32:35], a[72:75], v[48:51]
  v_mfma_f32_16x16x32_bf16 v[52:55], v[32:35], a[152:155], v[52:55]
  v_mfma_f32_16x16x32_bf16 v[56:59], v[32:35], a[232:235], v[56:59]
  v_mfma_f32_16x16x32_bf16 v[60:63], v[36:39], a[72:75], v[60:63]
  v_mfma_f32_16x16x32_bf16 v[64:67], v[36:39], a[152:155], v[64:67]
  v_mfma_f32_16x16x32_bf16 v[68:71], v[36:39], a[232:235], v[68:71]
  s_waitcnt lgkmcnt(0)
  v_mfma_f32_16x16x32_bf16 v[48:51], v[40:43], a[76:79], v[48:51]
  v_mfma_f32_16x16x32_bf16 v[52:55], v[40:43], a[156:159], v[52:55]
  v_mfma_f32_16x16x32_bf16 v[56:59], v[40:43], a[236:239], v[56:59]
  v_mfma_f32_16x16x32_bf16 v[60:63], v[44:47], a[76:79], v[60:63]
  v_mfma_f32_16x16x32_bf16 v[64:67], v[44:47], a[156:159], v[64:67]
  v_mfma_f32_16x16x32_bf16 v[68:71], v[44:47], a[236:239], v[68:71]
  s_branch joinS_107
nopfS_106:
  s_min_u32 s47, s67, 127
  s_lshl_b32 s47, s47, 11
  s_add_u32 s47, s47, 0
  buffer_load_dword v8, v2, s[4:7], s47 offen sc1
  s_waitcnt lgkmcnt(4)
  v_mfma_f32_16x16x32_bf16 v[48:51], v[16:19], a[32:35], v[48:51]
  ds_read_b128 v[40:43], v7 offset:5120
  v_mfma_f32_16x16x32_bf16 v[52:55], v[16:19], a[112:115], v[52:55]
  v_mfma_f32_16x16x32_bf16 v[56:59], v[16:19], a[192:195], v[56:59]
  v_mfma_f32_16x16x32_bf16 v[60:63], v[20:23], a[32:35], v[60:63]
  ds_read_b128 v[44:47], v7 offset:25600
  v_mfma_f32_16x16x32_bf16 v[64:67], v[20:23], a[112:115], v[64:67]
  v_mfma_f32_16x16x32_bf16 v[68:71], v[20:23], a[192:195], v[68:71]
  s_waitcnt lgkmcnt(4)
  v_mfma_f32_16x16x32_bf16 v[48:51], v[24:27], a[36:39], v[48:51]
  ds_read_b128 v[16:19], v6 offset:6144
  v_mfma_f32_16x16x32_bf16 v[52:55], v[24:27], a[116:119], v[52:55]
  v_mfma_f32_16x16x32_bf16 v[56:59], v[24:27], a[196:199], v[56:59]
  v_mfma_f32_16x16x32_bf16 v[60:63], v[28:31], a[36:39], v[60:63]
  ds_read_b128 v[20:23], v6 offset:26624
  v_mfma_f32_16x16x32_bf16 v[64:67], v[28:31], a[116:119], v[64:67]
  v_mfma_f32_16x16x32_bf16 v[68:71], v[28:31], a[196:199], v[68:71]
  s_waitcnt lgkmcnt(4)
  v_mfma_f32_16x16x32_bf16 v[48:51], v[32:35], a[40:43], v[48:51]
  ds_read_b128 v[24:27], v7 offset:6144
  v_mfma_f32_16x16x32_bf16 v[52:55], v[32:35], a[120:123], v[52:55]
  v_mfma_f32_16x16x32_bf16 v[56:59], v[32:35], a[200:203], v[56:59]
  v_mfma_f32_16x16x32_bf16 v[60:63], v[36:39], a[40:43], v[60:63]
  ds_read_b128 v[28:31], v7 offset:26624
  v_mfma_f32_16x16x32_bf16 v[64:67], v[36:39], a[120:123], v[64:67]
  v_mfma_f32_16x16x32_bf16 v[68:71], v[36:39], a[200:203], v[68:71]
  s_waitcnt lgkmcnt(4)
  v_mfma_f32_16x16x32_bf16 v[48:51], v[40:43], a[44:47], v[48:51]
  ds_read_b128 v[32:35], v6 offset:7168
  v_mfma_f32_16x16x32_bf16 v[52:55], v[40:43], a[124:127], v[52:55]
  v_mfma_f32_16x16x32_bf16 v[56:59], v[40:43], a[204:207], v[56:59]
  v_mfma_f32_16x16x32_bf16 v[60:63], v[44:47], a[44:47], v[60:63]
  ds_read_b128 v[36:39], v6 offset:27648
  v_mfma_f32_16x16x32_bf16 v[64:67], v[44:47], a[124:127], v[64:67]
  v_mfma_f32_16x16x32_bf16 v[68:71], v[44:47], a[204:207], v[68:71]
  s_waitcnt vmcnt(0)
  v_cmp_eq_u32 vcc, 0, v8
  s_cbranch_vccnz neS_108
  s_cmp_ge_u32 s67, 128
  s_cbranch_scc1 neS_108
  s_mov_b32 s69, 1
  s_sub_u32 s47, 40960, s68
  s_mul_i32 s73, s67, 40960
  s_add_u32 s73, s73, 18874368
  s_add_u32 s74, s47, s72
  s_waitcnt lgkmcnt(4)
  v_mfma_f32_16x16x32_bf16 v[48:51], v[16:19], a[48:51], v[48:51]
  ds_read_b128 v[40:43], v7 offset:7168
  v_mfma_f32_16x16x32_bf16 v[52:55], v[16:19], a[128:131], v[52:55]
  s_mov_b32 m0, s74
  v_mfma_f32_16x16x32_bf16 v[56:59], v[16:19], a[208:211], v[56:59]
  buffer_load_dwordx4 v3, s[4:7], s73 offen offset:0 sc1 lds
  v_mfma_f32_16x16x32_bf16 v[60:63], v[20:23], a[48:51], v[60:63]
  ds_read_b128 v[44:47], v7 offset:27648
  v_mfma_f32_16x16x32_bf16 v[64:67], v[20:23], a[128:131], v[64:67]
  s_add_u32 m0, m0, 896
  v_mfma_f32_16x16x32_bf16 v[68:71], v[20:23], a[208:211], v[68:71]
  buffer_load_dwordx4 v3, s[4:7], s73 offen offset:128 sc1 lds
  s_waitcnt lgkmcnt(4)
  v_mfma_f32_16x16x32_bf16 v[48:51], v[24:27], a[52:55], v[48:51]
  ds_read_b128 v[16:19], v6 offset:8192
  v_mfma_f32_16x16x32_bf16 v[52:55], v[24:27], a[132:135], v[52:55]
  s_add_u32 m0, m0, 896
  v_mfma_f32_16x16x32_bf16 v[56:59], v[24:27], a[212:215], v[56:59]
  buffer_load_dwordx4 v3, s[4:7], s73 offen offset:256 sc1 lds
  v_mfma_f32_16x16x32_bf16 v[60:63], v[28:31], a[52:55], v[60:63]
  ds_read_b128 v[20:23], v6 offset:28672
  v_mfma_f32_16x16x32_bf16 v[64:67], v[28:31], a[132:135], v[64:67]
  s_add_u32 m0, m0, 896
  v_mfma_f32_16x16x32_bf16 v[68:71], v[28:31], a[212:215], v[68:71]
  buffer_load_dwordx4 v3, s[4:7], s73 offen offset:384 sc1 lds
  s_waitcnt lgkmcnt(4)
  v_mfma_f32_16x16x32_bf16 v[48:51], v[32:35], a[56:59], v[48:51]
  ds_read_b128 v[24:27], v7 offset:8192
  v_mfma_f32_16x16x32_bf16 v[52:55], v[32:35], a[136:139], v[52:55]
  s_add_u32 m0, m0, 896
  v_mfma_f32_16x16x32_bf16 v[56:59], v[32:35], a[216:219], v[56:59]
  buffer_load_dwordx4 v3, s[4:7], s73 offen offset:512 sc1 lds
  v_mfma_f32_16x16x32_bf16 v[60:63], v[36:39], a[56:59], v[60:63]
  ds_read_b128 v[28:31], v7 offset:28672
  v_mfma_f32_16x16x32_bf16 v[64:67], v[36:39], a[136:139], v[64:67]
  v_mfma_f32_16x16x32_bf16 v[68:71], v[36:39], a[216:219], v[68:71]
  s_waitcnt lgkmcnt(4)
  v_mfma_f32_16x16x32_bf16 v[48:51], v[40:43], a[60:63], v[48:51]
  ds_read_b128 v[32:35], v6 offset:9216
  v_mfma_f32_16x16x32_bf16 v[52:55], v[40:43], a[140:143], v[52:55]
  s_add_u32 m0, m0, 896
  v_mfma_f32_16x16x32_bf16 v[56:59], v[40:43], a[220:223], v[56:59]
  buffer_load_dwordx4 v3, s[4:7], s73 offen offset:640 sc1 lds
  v_mfma_f32_16x16x32_bf16 v[60:63], v[44:47], a[60:63], v[60:63]
  ds_read_b128 v[36:39], v6 offset:29696
  v_mfma_f32_16x16x32_bf16 v[64:67], v[44:47], a[140:143], v[64:67]
  v_mfma_f32_16x16x32_bf16 v[68:71], v[44:47], a[220:223], v[68:71]
  s_waitcnt lgkmcnt(4)
  v_mfma_f32_16x16x32_bf16 v[48:51], v[16:19], a[64:67], v[48:51]
  ds_read_b128 v[40:43], v7 offset:9216
  v_mfma_f32_16x16x32_bf16 v[52:55], v[16:19], a[144:147], v[52:55]
  s_add_u32 m0, m0, 896
  v_mfma_f32_16x16x32_bf16 v[56:59], v[16:19], a[224:227], v[56:59]
  buffer_load_dwordx4 v3, s[4:7], s73 offen offset:768 sc1 lds
  v_mfma_f32_16x16x32_bf16 v[60:63], v[20:23], a[64:67], v[60:63]
  ds_read_b128 v[44:47], v7 offset:29696
  v_mfma_f32_16x16x32_bf16 v[64:67], v[20:23], a[144:147], v[64:67]
  v_mfma_f32_16x16x32_bf16 v[68:71], v[20:23], a[224:227], v[68:71]
  s_waitcnt lgkmcnt(4)
  v_mfma_f32_16x16x32_bf16 v[48:51], v[24:27], a[68:71], v[48:51]
  v_mfma_f32_16x16x32_bf16 v[52:55], v[24:27], a[148:151], v[52:55]
  s_add_u32 m0, m0, 896
  v_mfma_f32_16x16x32_bf16 v[56:59], v[24:27], a[228:231], v[56:59]
  buffer_load_dwordx4 v3, s[4:7], s73 offen offset:896 sc1 lds
  v_mfma_f32_16x16x32_bf16 v[60:63], v[28:31], a[68:71], v[60:63]
  v_mfma_f32_16x16x32_bf16 v[64:67], v[28:31], a[148:151], v[64:67]
  v_mfma_f32_16x16x32_bf16 v[68:71], v[28:31], a[228:231], v[68:71]
  s_waitcnt lgkmcnt(2)
  v_mfma_f32_16x16x32_bf16 v[48:51], v[32:35], a[72:75], v[48:51]
  v_mfma_f32_16x16x32_bf16 v[52:55], v[32:35], a[152:155], v[52:55]
  s_add_u32 m0, m0, 896
  v_mfma_f32_16x16x32_bf16 v[56:59], v[32:35], a[232:235], v[56:59]
  buffer_load_dwordx4 v3, s[4:7], s73 offen offset:1024 sc1 lds
  v_mfma_f32_16x16x32_bf16 v[60:63], v[36:39], a[72:75], v[60:63]
  v_mfma_f32_16x16x32_bf16 v[64:67], v[36:39], a[152:155], v[64:67]
  v_mfma_f32_16x16x32_bf16 v[68:71], v[36:39], a[232:235], v[68:71]
  s_waitcnt lgkmcnt(0)
  v_mfma_f32_16x16x32_bf16 v[48:51], v[40:43], a[76:79], v[48:51]
  v_mfma_f32_16x16x32_bf16 v[52:55], v[40:43], a[156:159], v[52:55]
  s_add_u32 m0, m0, 896
  v_mfma_f32_16x16x32_bf16 v[56:59], v[40:43], a[236:239], v[56:59]
  buffer_load_dwordx4 v3, s[4:7], s73 offen offset:1152 sc1 lds
  v_mfma_f32_16x16x32_bf16 v[60:63], v[44:47], a[76:79], v[60:63]
  v_mfma_f32_16x16x32_bf16 v[64:67], v[44:47], a[156:159], v[64:67]
  v_mfma_f32_16x16x32_bf16 v[68:71], v[44:47], a[236:239], v[68:71]
  s_branch joinS_107
neS_108:
  s_waitcnt lgkmcnt(4)
  v_mfma_f32_16x16x32_bf16 v[48:51], v[16:19], a[48:51], v[48:51]
  ds_read_b128 v[40:43], v7 offset:7168
  v_mfma_f32_16x16x32_bf16 v[52:55], v[16:19], a[128:131], v[52:55]
  v_mfma_f32_16x16x32_bf16 v[56:59], v[16:19], a[208:211], v[56:59]
  v_mfma_f32_16x16x32_bf16 v[60:63], v[20:23], a[48:51], v[60:63]
  ds_read_b128 v[44:47], v7 offset:27648
  v_mfma_f32_16x16x32_bf16 v[64:67], v[20:23], a[128:131], v[64:67]
  v_mfma_f32_16x16x32_bf16 v[68:71], v[20:23], a[208:211], v[68:71]
  s_waitcnt lgkmcnt(4)
  v_mfma_f32_16x16x32_bf16 v[48:51], v[24:27], a[52:55], v[48:51]
  ds_read_b128 v[16:19], v6 offset:8192
  v_mfma_f32_16x16x32_bf16 v[52:55], v[24:27], a[132:135], v[52:55]
  v_mfma_f32_16x16x32_bf16 v[56:59], v[24:27], a[212:215], v[56:59]
  v_mfma_f32_16x16x32_bf16 v[60:63], v[28:31], a[52:55], v[60:63]
  ds_read_b128 v[20:23], v6 offset:28672
  v_mfma_f32_16x16x32_bf16 v[64:67], v[28:31], a[132:135], v[64:67]
  v_mfma_f32_16x16x32_bf16 v[68:71], v[28:31], a[212:215], v[68:71]
  s_waitcnt lgkmcnt(4)
  v_mfma_f32_16x16x32_bf16 v[48:51], v[32:35], a[56:59], v[48:51]
  ds_read_b128 v[24:27], v7 offset:8192
  v_mfma_f32_16x16x32_bf16 v[52:55], v[32:35], a[136:139], v[52:55]
  v_mfma_f32_16x16x32_bf16 v[56:59], v[32:35], a[216:219], v[56:59]
  v_mfma_f32_16x16x32_bf16 v[60:63], v[36:39], a[56:59], v[60:63]
  ds_read_b128 v[28:31], v7 offset:28672
  v_mfma_f32_16x16x32_bf16 v[64:67], v[36:39], a[136:139], v[64:67]
  v_mfma_f32_16x16x32_bf16 v[68:71], v[36:39], a[216:219], v[68:71]
  s_waitcnt lgkmcnt(4)
  v_mfma_f32_16x16x32_bf16 v[48:51], v[40:43], a[60:63], v[48:51]
  ds_read_b128 v[32:35], v6 offset:9216
  v_mfma_f32_16x16x32_bf16 v[52:55], v[40:43], a[140:143], v[52:55]
  v_mfma_f32_16x16x32_bf16 v[56:59], v[40:43], a[220:223], v[56:59]
  v_mfma_f32_16x16x32_bf16 v[60:63], v[44:47], a[60:63], v[60:63]
  ds_read_b128 v[36:39], v6 offset:29696
  v_mfma_f32_16x16x32_bf16 v[64:67], v[44:47], a[140:143], v[64:67]
  v_mfma_f32_16x16x32_bf16 v[68:71], v[44:47], a[220:223], v[68:71]
  s_waitcnt lgkmcnt(4)
  v_mfma_f32_16x16x32_bf16 v[48:51], v[16:19], a[64:67], v[48:51]
  ds_read_b128 v[40:43], v7 offset:9216
  v_mfma_f32_16x16x32_bf16 v[52:55], v[16:19], a[144:147], v[52:55]
  v_mfma_f32_16x16x32_bf16 v[56:59], v[16:19], a[224:227], v[56:59]
  v_mfma_f32_16x16x32_bf16 v[60:63], v[20:23], a[64:67], v[60:63]
  ds_read_b128 v[44:47], v7 offset:29696
  v_mfma_f32_16x16x32_bf16 v[64:67], v[20:23], a[144:147], v[64:67]
  v_mfma_f32_16x16x32_bf16 v[68:71], v[20:23], a[224:227], v[68:71]
  s_waitcnt lgkmcnt(4)
  v_mfma_f32_16x16x32_bf16 v[48:51], v[24:27], a[68:71], v[48:51]
  v_mfma_f32_16x16x32_bf16 v[52:55], v[24:27], a[148:151], v[52:55]
  v_mfma_f32_16x16x32_bf16 v[56:59], v[24:27], a[228:231], v[56:59]
  v_mfma_f32_16x16x32_bf16 v[60:63], v[28:31], a[68:71], v[60:63]
  v_mfma_f32_16x16x32_bf16 v[64:67], v[28:31], a[148:151], v[64:67]
  v_mfma_f32_16x16x32_bf16 v[68:71], v[28:31], a[228:231], v[68:71]
  s_waitcnt lgkmcnt(2)
  v_mfma_f32_16x16x32_bf16 v[48:51], v[32:35], a[72:75], v[48:51]
  v_mfma_f32_16x16x32_bf16 v[52:55], v[32:35], a[152:155], v[52:55]
  v_mfma_f32_16x16x32_bf16 v[56:59], v[32:35], a[232:235], v[56:59]
  v_mfma_f32_16x16x32_bf16 v[60:63], v[36:39], a[72:75], v[60:63]
  v_mfma_f32_16x16x32_bf16 v[64:67], v[36:39], a[152:155], v[64:67]
  v_mfma_f32_16x16x32_bf16 v[68:71], v[36:39], a[232:235], v[68:71]
  s_waitcnt lgkmcnt(0)
  v_mfma_f32_16x16x32_bf16 v[48:51], v[40:43], a[76:79], v[48:51]
  v_mfma_f32_16x16x32_bf16 v[52:55], v[40:43], a[156:159], v[52:55]
  v_mfma_f32_16x16x32_bf16 v[56:59], v[40:43], a[236:239], v[56:59]
  v_mfma_f32_16x16x32_bf16 v[60:63], v[44:47], a[76:79], v[60:63]
  v_mfma_f32_16x16x32_bf16 v[64:67], v[44:47], a[156:159], v[64:67]
  v_mfma_f32_16x16x32_bf16 v[68:71], v[44:47], a[236:239], v[68:71]
joinS_107:
  s_mul_i32 s73, s66, 393216
  s_add_u32 s73, s73, s70
  s_lshl_b32 s75, s66, 14
  s_add_u32 s75, s75, s71
  s_sub_u32 s68, 40960, s68
  s_nop 1
  v_cvt_pk_bf16_f32 v72, v48, v49
  v_cvt_pk_bf16_f32 v73, v50, v51
  v_cvt_pk_bf16_f32 v74, v60, v61
  v_cvt_pk_bf16_f32 v75, v62, v63
  buffer_store_dwordx4 v[72:75], v1, s[4:7], s73 offen offset:0 sc1
  v_cvt_pk_bf16_f32 v76, v52, v53
  v_cvt_pk_bf16_f32 v77, v54, v55
  v_cvt_pk_bf16_f32 v78, v64, v65
  v_cvt_pk_bf16_f32 v79, v66, v67
  buffer_store_dwordx4 v[76:79], v1, s[4:7], s73 offen offset:1024 sc1
  v_cvt_pk_bf16_f32 v80, v56, v57
  v_cvt_pk_bf16_f32 v81, v58, v59
  v_cvt_pk_bf16_f32 v82, v68, v69
  v_cvt_pk_bf16_f32 v83, v70, v71
  buffer_store_dwordx4 v[80:83], v1, s[4:7], s73 offen offset:2048 sc1
  s_mov_b32 s66, s67
  s_cmp_eq_u32 s69, 1
  s_cbranch_scc1 top3S_102
  s_cmp_ge_u32 s66, 128
  s_cbranch_scc1 endS_105
  s_lshl_b32 s47, s66, 11
  s_add_u32 s47, s47, 0
  buffer_load_dword v8, v2, s[4:7], s47 offen sc1
  v_mov_b32 v9, 1
  s_waitcnt vmcnt(0)
  buffer_store_dword v9, off, s[4:7], s75 sc1
  s_mov_b32 s75, 0x10000000
  s_waitcnt vmcnt(1)
  s_branch fcS_111
fwS_109:
  buffer_load_dword v8, v2, s[4:7], s47 offen sc1
  s_waitcnt vmcnt(0)
fcS_111:
  v_cmp_eq_u32 vcc, 0, v8
  s_cbranch_vccz foS_110
  s_add_u32 s45, s45, 1
  s_cmp_gt_u32 s45, 1048576
  s_cbranch_scc1 failqS_76
  s_sleep 1
  s_branch fwS_109
foS_110:
  s_mul_i32 s73, s66, 40960
  s_add_u32 s73, s73, 18874368
  s_add_u32 s74, s68, s72
  s_mov_b32 m0, s74
  s_nop 0
  buffer_load_dwordx4 v3, s[4:7], s73 offen offset:0 sc1 lds
  s_add_u32 m0, m0, 896
  s_nop 0
  buffer_load_dwordx4 v3, s[4:7], s73 offen offset:128 sc1 lds
  s_add_u32 m0, m0, 896
  s_nop 0
  buffer_load_dwordx4 v3, s[4:7], s73 offen offset:256 sc1 lds
  s_add_u32 m0, m0, 896
  s_nop 0
  buffer_load_dwordx4 v3, s[4:7], s73 offen offset:384 sc1 lds
  s_add_u32 m0, m0, 896
  s_nop 0
  buffer_load_dwordx4 v3, s[4:7], s73 offen offset:512 sc1 lds
  s_add_u32 m0, m0, 896
  s_nop 0
  buffer_load_dwordx4 v3, s[4:7], s73 offen offset:640 sc1 lds
  s_add_u32 m0, m0, 896
  s_nop 0
  buffer_load_dwordx4 v3, s[4:7], s73 offen offset:768 sc1 lds
  s_add_u32 m0, m0, 896
  s_nop 0
  buffer_load_dwordx4 v3, s[4:7], s73 offen offset:896 sc1 lds
  s_add_u32 m0, m0, 896
  s_nop 0
  buffer_load_dwordx4 v3, s[4:7], s73 offen offset:1024 sc1 lds
  s_add_u32 m0, m0, 896
  s_nop 0
  buffer_load_dwordx4 v3, s[4:7], s73 offen offset:1152 sc1 lds
  s_branch topS_101
endS_105:
  v_mov_b32 v8, 1
  s_waitcnt vmcnt(0)
  buffer_store_dword v8, off, s[4:7], s75 sc1
  s_endpgm
failqS_76:
  s_mov_b64 exec, 1
  v_mov_b32 v150, 224
  v_mov_b32 v151, 8
  buffer_atomic_or v151, v150, s[8:11], 0 offen sc1
  s_endpgm

.section .rodata,"a"
.p2align 6
.amdhsa_kernel interleave_layers__memory_aug_recurrent_mem_tr__dense_activation_relu__prompt_kernel
  .amdhsa_next_free_vgpr 512
  .amdhsa_next_free_sgpr 102
  .amdhsa_accum_offset 256
  .amdhsa_group_segment_fixed_size 0
  .amdhsa_kernarg_size 104
  .amdhsa_user_sgpr_count 2
  .amdhsa_user_sgpr_kernarg_segment_ptr 1
  .amdhsa_system_sgpr_workgroup_id_x 1
.end_amdhsa_kernel
```
